```python
import torch

def _softmax(x, axis=-1):
    return torch.softmax(x, dim=axis)

def _gelu(x):
    return torch.nn.functional.gelu(x, approximate='tanh')

def _silu(x):
    return torch.nn.functional.silu(x)

def _sigmoid(x):
    return torch.sigmoid(x)

def _layernorm(x, axis=-1, eps=1e-05):
    m = x.mean(dim=axis, keepdim=True)
    v = x.var(dim=axis, keepdim=True, unbiased=False)
    return (x - m) / torch.sqrt(v + eps)

def _scatter_add(tgt, idx, src, axis=0):
    return tgt.clone().index_add_(axis, idx, src)

def _segment_sum(src, seg, n):
    out = torch.zeros((n,) + src.shape[1:], dtype=src.dtype)
    return out.index_add_(0, seg, src)

def _pad(x, pw):
    flat = tuple((v for pair in reversed(pw) for v in pair))
    return torch.nn.functional.pad(x, flat)
kernel_name = 'interleave_layers__memory_aug_recurrent_mem_tr__dense_activation_relu__prompt'

def setup_inputs():

    _w = lambda a: (lambda t: t.to(torch.bfloat16) if t.is_floating_point() else t)(torch.as_tensor(a))

    def _A_setup():
        B, S, Dm = (1, 2048, 640)
        H, Dh = (32, 128)
        M, seg = (8, 32)
        seg = min(seg, S)
        S = S // seg * seg
        return {'x': _w((lambda *s: torch.randn(*s, dtype=torch.bfloat16) * 0.05)(B, S, Dm)), 'mem0': _w((lambda *s: torch.randn(*s, dtype=torch.bfloat16) * 0.8)(B, M, Dm)), 'Wq': _w((lambda *s: torch.randn(*s, dtype=torch.bfloat16) * 0.8)(Dm, H, Dh) * Dm ** (-0.5)), 'Wk': _w((lambda *s: torch.randn(*s, dtype=torch.bfloat16) * 0.8)(Dm, H, Dh) * Dm ** (-0.5)), 'Wv': _w((lambda *s: torch.randn(*s, dtype=torch.bfloat16) * 0.8)(Dm, H, Dh) * Dm ** (-0.5)), 'Wo': _w((lambda *s: torch.randn(*s, dtype=torch.bfloat16) * 0.8)(H, Dh, Dm) * (H * Dh) ** (-0.5)), 'seg_len': seg}
    _A_in = _A_setup()

    def _B_setup():
        B, S, D, Dff = (1, 2048, 640, 1728)
        return {'x': _w((lambda *s: torch.randn(*s, dtype=torch.bfloat16) * 0.05)(B, S, D)), 'w1': _w((lambda *s: torch.randn(*s, dtype=torch.bfloat16) * 0.05)(D, Dff)), 'w2': _w((lambda *s: torch.randn(*s, dtype=torch.bfloat16) * 0.05)(Dff, D))}
    _B_in = _B_setup()
    return {'A_x': _A_in['x'], 'A_mem0': _A_in['mem0'], 'A_Wq': _A_in['Wq'], 'A_Wk': _A_in['Wk'], 'A_Wv': _A_in['Wv'], 'A_Wo': _A_in['Wo'], 'A_seg_len': _A_in['seg_len'], 'B_x': _B_in['x'], 'B_w1': _B_in['w1'], 'B_w2': _B_in['w2']}

def reference(A_x, A_mem0, A_Wq, A_Wk, A_Wv, A_Wo, A_seg_len, B_x, B_w1, B_w2):

    def _A_ref(x, mem0, Wq, Wk, Wv, Wo, seg_len):
        B, S, Dm = x.shape
        H, Dh = (Wq.shape[1], Wq.shape[2])
        M = mem0.shape[1]
        scale = Dh ** (-0.5)
        n_seg = S // seg_len
        L = M + seg_len
        idx = torch.arange(L)
        mask = (idx[:, None] < M) | (idx[:, None] >= idx[None, :])
        mem = mem0
        outs = []
        for s in range(n_seg):
            xs = x[:, s * seg_len:(s + 1) * seg_len, :].clone()
            h = torch.concatenate([mem, xs], axis=1)
            q = torch.einsum('btd,dhe->bhte', h, Wq)
            k = torch.einsum('btd,dhe->bhte', h, Wk)
            v = torch.einsum('btd,dhe->bhte', h, Wv)
            scores = torch.einsum('bhqe,bhke->bhqk', q, k) * scale
            scores = torch.where(mask[None, None], scores, -1000000000.0)
            p = _softmax(scores, axis=-1)
            o = torch.einsum('bhqk,bhke->bhqe', p, v)
            o = torch.einsum('bhte,hed->btd', o, Wo)
            mem = o[:, :M, :].clone()
            outs.append(o[:, M:, :])
        return torch.concatenate(outs, axis=1)

    def _B_ref(x, w1, w2):
        h = torch.einsum('bsd,df->bsf', x, w1)
        zero = torch.zeros_like(h)
        h = torch.maximum(h, zero)
        return torch.einsum('bsf,fd->bsd', h, w2)
    x = A_x
    x = x + _A_ref(_layernorm(x, axis=-1), A_mem0, A_Wq, A_Wk, A_Wv, A_Wo, A_seg_len)
    x = x + _B_ref(_layernorm(x, axis=-1), B_w1, B_w2)
    x = x + _A_ref(_layernorm(x, axis=-1), A_mem0, A_Wq, A_Wk, A_Wv, A_Wo, A_seg_len)
    x = x + _B_ref(_layernorm(x, axis=-1), B_w1, B_w2)
    return x
```

```asm
; @launch grid=(256,1,1) block=(256,1,1) lds=163840
.amdgcn_target "amdgcn-amd-amdhsa--gfx950"
.text
.globl interleave_layers__memory_aug_recurrent_mem_tr__dense_activation_relu__prompt_kernel
.p2align 8
.type interleave_layers__memory_aug_recurrent_mem_tr__dense_activation_relu__prompt_kernel,@function
interleave_layers__memory_aug_recurrent_mem_tr__dense_activation_relu__prompt_kernel:

    s_load_dwordx2 s[4:5], s[0:1], 96
    s_load_dwordx2 s[96:97], s[0:1], 88
    s_load_dwordx2 s[88:89], s[0:1], 16
    s_cmp_ge_u32 s2, 256
    s_cbranch_scc1 M_EXIT
    s_getreg_b32 s9, hwreg(HW_REG_XCC_ID)
    s_and_b32 s9, s9, 7
    s_mov_b32 s6, 0x10000000
    s_mov_b32 s7, 0x00020000
    s_mov_b32 s98, 256
    s_mov_b32 s99, 0x00020000
    s_lshl_b32 s10, s9, 2
    v_mov_b32 v1, 1
    v_mov_b32 v2, 0
    v_cmp_eq_u32 vcc, 0, v0
    s_waitcnt lgkmcnt(0)
    s_and_saveexec_b64 s[16:17], vcc
    s_cbranch_execz M_NOAT
    buffer_atomic_add v1, off, s[96:99], s10 sc0
M_NOAT:
    s_mov_b64 exec, s[16:17]
    v_lshlrev_b32 v5, 4, v0
    v_mov_b32 v8, 0
    v_mov_b32 v9, 0
    v_mov_b32 v10, 0
    v_mov_b32 v11, 0
    s_mul_i32 s10, s2, 4096
    s_add_u32 s10, s10, 155189248
    v_min_u32 v6, 4080, v5
    buffer_store_dwordx4 v[8:11], v6, s[4:7], s10 offen sc1
    s_and_b32 s10, s2, 127
    s_mul_i32 s10, s10, 2560
    s_lshr_b32 s12, s2, 7
    s_mul_i32 s12, s12, 4194304
    s_add_u32 s10, s10, s12
    s_add_u32 s10, s10, 133169152
    v_min_u32 v6, 2544, v5
    buffer_store_dwordx4 v[8:11], v6, s[4:7], s10 offen sc1
    s_mov_b32 s18, 0
    s_and_saveexec_b64 s[16:17], vcc
    s_cbranch_execz M_NOAT2
    s_cmp_lg_u32 s18, 0
    s_cbranch_scc1 M_W1
    s_waitcnt vmcnt(2)
M_W1:
    s_waitcnt vmcnt(2)
    ds_write_b32 v2, v1
    s_waitcnt lgkmcnt(0)
M_NOAT2:
    s_mov_b64 exec, s[16:17]
    s_barrier
    ds_read_b32 v1, v2
    s_waitcnt lgkmcnt(0)
    v_readfirstlane_b32 s8, v1
    s_cmp_lt_u32 s8, 32
    s_cbranch_scc1 M_SLOT
    s_mov_b32 s18, 0
    s_barrier
    v_mov_b32 v1, 1
    s_and_saveexec_b64 s[16:17], vcc
    s_cbranch_execz M_OV1
    buffer_atomic_add v1, off, s[96:99], 0 offset:160 sc0
    s_waitcnt vmcnt(0)
    ds_write_b32 v2, v1
    s_waitcnt lgkmcnt(0)
M_OV1:
    s_mov_b64 exec, s[16:17]
    s_barrier
    ds_read_b32 v1, v2
    v_and_b32 v3, 7, v0
    v_lshlrev_b32 v3, 2, v3
    s_waitcnt lgkmcnt(0)
    v_readfirstlane_b32 s12, v1
    s_mov_b32 s13, 0
M_OV2:
    buffer_load_dword v4, v3, s[96:99], 0 offen sc1
    s_waitcnt vmcnt(0)
    s_mov_b32 s14, 0
    v_readlane_b32 s20, v4, 0
    v_readlane_b32 s21, v4, 1
    v_readlane_b32 s22, v4, 2
    v_readlane_b32 s23, v4, 3
    v_readlane_b32 s24, v4, 4
    v_readlane_b32 s25, v4, 5
    v_readlane_b32 s26, v4, 6
    v_readlane_b32 s27, v4, 7
    s_nop 3
    s_add_u32 s14, s14, s20
    s_add_u32 s14, s14, s21
    s_add_u32 s14, s14, s22
    s_add_u32 s14, s14, s23
    s_add_u32 s14, s14, s24
    s_add_u32 s14, s14, s25
    s_add_u32 s14, s14, s26
    s_add_u32 s14, s14, s27
    s_cmp_ge_u32 s14, 256
    s_cbranch_scc1 M_OV3
    s_sleep 4
    s_add_u32 s13, s13, 1
    s_cmp_lt_u32 s13, 200000
    s_cbranch_scc1 M_OV2
    s_endpgm
M_OV3:
    s_min_u32 s14, s20, 32
    s_sub_u32 s15, 32, s14
    s_mov_b32 s9, 0
    s_add_u32 s8, s14, s12
    s_cmp_lt_u32 s12, s15
    s_cbranch_scc1 M_SLOT
    s_sub_u32 s12, s12, s15
    s_min_u32 s14, s21, 32
    s_sub_u32 s15, 32, s14
    s_mov_b32 s9, 1
    s_add_u32 s8, s14, s12
    s_cmp_lt_u32 s12, s15
    s_cbranch_scc1 M_SLOT
    s_sub_u32 s12, s12, s15
    s_min_u32 s14, s22, 32
    s_sub_u32 s15, 32, s14
    s_mov_b32 s9, 2
    s_add_u32 s8, s14, s12
    s_cmp_lt_u32 s12, s15
    s_cbranch_scc1 M_SLOT
    s_sub_u32 s12, s12, s15
    s_min_u32 s14, s23, 32
    s_sub_u32 s15, 32, s14
    s_mov_b32 s9, 3
    s_add_u32 s8, s14, s12
    s_cmp_lt_u32 s12, s15
    s_cbranch_scc1 M_SLOT
    s_sub_u32 s12, s12, s15
    s_min_u32 s14, s24, 32
    s_sub_u32 s15, 32, s14
    s_mov_b32 s9, 4
    s_add_u32 s8, s14, s12
    s_cmp_lt_u32 s12, s15
    s_cbranch_scc1 M_SLOT
    s_sub_u32 s12, s12, s15
    s_min_u32 s14, s25, 32
    s_sub_u32 s15, 32, s14
    s_mov_b32 s9, 5
    s_add_u32 s8, s14, s12
    s_cmp_lt_u32 s12, s15
    s_cbranch_scc1 M_SLOT
    s_sub_u32 s12, s12, s15
    s_min_u32 s14, s26, 32
    s_sub_u32 s15, 32, s14
    s_mov_b32 s9, 6
    s_add_u32 s8, s14, s12
    s_cmp_lt_u32 s12, s15
    s_cbranch_scc1 M_SLOT
    s_sub_u32 s12, s12, s15
    s_min_u32 s14, s27, 32
    s_sub_u32 s15, 32, s14
    s_mov_b32 s9, 7
    s_add_u32 s8, s14, s12
    s_cmp_lt_u32 s12, s15
    s_cbranch_scc1 M_SLOT
    s_sub_u32 s12, s12, s15
    s_endpgm
M_SLOT:
    s_lshl_b32 s100, s9, 5
    s_add_u32 s100, s100, s8
    s_lshr_b32 s11, s9, 2
    s_and_b32 s9, s9, 3
    s_sub_u32 s19, s2, 1
    s_cmp_ge_u32 s19, 2
    s_cbranch_scc1 M_ARR
    s_mov_b32 s18, 0
    s_load_dwordx2 s[88:89], s[0:1], 8
    s_mov_b32 s90, 10240
    s_mov_b32 s91, 0x00020000
    s_mov_b32 s92, 0x05040100
    s_mov_b32 s93, 0x07060302
    s_waitcnt lgkmcnt(0)
    v_mov_b32 v28, -1
    v_mov_b32 v29, -1
    v_mov_b32 v30, -1
    v_mov_b32 v31, -1
    s_mul_i32 s12, s19, 4194304
    v_bfe_u32 v12, v0, 4, 2
    v_lshlrev_b32 v12, 1, v12
    v_bfe_u32 v13, v0, 2, 1
    v_add_u32 v12, v12, v13
    v_mul_u32_u24 v12, 1280, v12
    v_lshrrev_b32 v13, 6, v0
    v_lshl_add_u32 v12, v13, 5, v12
    v_and_b32 v13, 3, v0
    v_lshl_add_u32 v12, v13, 3, v12
    v_bfe_u32 v13, v0, 3, 1
    v_lshl_add_u32 v12, v13, 2, v12
    v_lshlrev_b32 v14, 2, v0
    buffer_load_dword v16, v12, s[88:91], 0 offen offset:0
    buffer_load_dword v17, v12, s[88:91], 0 offen offset:128
    buffer_load_dword v18, v12, s[88:91], 0 offen offset:256
    buffer_load_dword v19, v12, s[88:91], 0 offen offset:384
    buffer_load_dword v20, v12, s[88:91], 0 offen offset:512
    buffer_load_dword v21, v12, s[88:91], 0 offen offset:640
    buffer_load_dword v22, v12, s[88:91], 0 offen offset:768
    buffer_load_dword v23, v12, s[88:91], 0 offen offset:896
    buffer_load_dword v24, v12, s[88:91], 0 offen offset:1024
    buffer_load_dword v25, v12, s[88:91], 0 offen offset:1152
    s_add_u32 s10, s12, 133507072
    buffer_store_dwordx4 v[28:31], v5, s[4:7], s10 offen sc1
    s_add_u32 s10, s12, 133511168
    buffer_store_dwordx4 v[28:31], v5, s[4:7], s10 offen sc1
    s_add_u32 s10, s12, 133515264
    buffer_store_dwordx4 v[28:31], v5, s[4:7], s10 offen sc1
    s_add_u32 s10, s12, 133519360
    buffer_store_dwordx4 v[28:31], v5, s[4:7], s10 offen sc1
    s_add_u32 s10, s12, 133523456
    buffer_store_dwordx4 v[28:31], v5, s[4:7], s10 offen sc1
    s_waitcnt vmcnt(0)
    v_min_u32 v16, -2, v16
    s_add_u32 s10, s12, 133496832
    buffer_store_dword v16, v14, s[4:7], s10 offen sc1
    v_min_u32 v17, -2, v17
    s_add_u32 s10, s12, 133497856
    buffer_store_dword v17, v14, s[4:7], s10 offen sc1
    v_min_u32 v18, -2, v18
    s_add_u32 s10, s12, 133498880
    buffer_store_dword v18, v14, s[4:7], s10 offen sc1
    v_min_u32 v19, -2, v19
    s_add_u32 s10, s12, 133499904
    buffer_store_dword v19, v14, s[4:7], s10 offen sc1
    v_min_u32 v20, -2, v20
    s_add_u32 s10, s12, 133500928
    buffer_store_dword v20, v14, s[4:7], s10 offen sc1
    v_min_u32 v21, -2, v21
    s_add_u32 s10, s12, 133501952
    buffer_store_dword v21, v14, s[4:7], s10 offen sc1
    v_min_u32 v22, -2, v22
    s_add_u32 s10, s12, 133502976
    buffer_store_dword v22, v14, s[4:7], s10 offen sc1
    v_min_u32 v23, -2, v23
    s_add_u32 s10, s12, 133504000
    buffer_store_dword v23, v14, s[4:7], s10 offen sc1
    v_min_u32 v24, -2, v24
    s_add_u32 s10, s12, 133505024
    buffer_store_dword v24, v14, s[4:7], s10 offen sc1
    v_min_u32 v25, -2, v25
    s_add_u32 s10, s12, 133506048
    buffer_store_dword v25, v14, s[4:7], s10 offen sc1
M_ARR:
    s_cmp_lg_u32 s18, 0
    s_cbranch_scc1 ARR_2
    s_waitcnt vmcnt(0)
ARR_2:
    s_waitcnt vmcnt(0)
    s_barrier
    v_cmp_eq_u32 vcc, 0, v0
    v_mov_b32 v1, 1
    s_and_saveexec_b64 s[16:17], vcc
    s_cbranch_execz ARR_1
    buffer_atomic_add v1, off, s[96:99], 0 offset:128
ARR_1:
    s_mov_b64 exec, s[16:17]
    s_cmp_eq_u32 s9, 0
    s_cbranch_scc1 R_CH
    s_sub_u32 s9, s9, 1
    s_lshl_b32 s9, s9, 5
    s_add_u32 s9, s9, s8
    s_lshl_b32 s8, s9, 1
    s_sub_u32 s8, s8, 0
    s_cmp_lt_u32 s9, 10
    s_cbranch_scc1 R_O
    s_sub_u32 s8, s9, 10
    s_cmp_lt_u32 s9, 42
    s_cbranch_scc1 R_KV
    s_lshl_b32 s8, s9, 1
    s_sub_u32 s8, s8, 83
    s_cmp_lt_u32 s9, 52
    s_cbranch_scc1 R_O
    s_sub_u32 s8, s9, 52
    s_cmp_lt_u32 s9, 59
    s_cbranch_scc1 R_F1
    s_sub_u32 s8, s9, 59
    s_cmp_lt_u32 s9, 75
    s_cbranch_scc1 R_Q
    s_sub_u32 s8, s9, 75
    s_cmp_lt_u32 s9, 85
    s_cbranch_scc1 R_F2
    s_sub_u32 s8, s9, 85
    s_cmp_lt_u32 s9, 96
    s_cbranch_scc1 R_AT
M_EXIT:
    s_endpgm
.p2align 6
R_CH:
    v_lshrrev_b32 v11, 6, v0
    v_and_b32 v0, 63, v0
    v_readfirstlane_b32 s9, v11
    v_lshlrev_b32 v1, 4, v0
    v_and_b32 v12, 15, v0
    v_lshrrev_b32 v13, 4, v0
    s_mov_b32 s32, 0x33333333
    s_mov_b32 s33, 0x33333333
    v_mov_b32 v14, 0xeeee
    v_mov_b32 v15, 0x4444
    v_cndmask_b32 v2, v14, v15, s[32:33]
    v_lshrrev_b32 v15, 2, v12
    v_lshlrev_b32 v14, 7, v15
    v_lshl_add_u32 v14, v13, 5, v14
    v_and_b32 v15, 3, v12
    v_lshl_add_u32 v14, v15, 2, v14
    s_lshl_b32 s27, s9, 10
    s_add_u32 s27, s27, 10240
    v_add_u32 v3, s27, v14
    v_lshrrev_b32 v14, 2, v12
    v_lshlrev_b32 v14, 5, v14
    v_and_b32 v15, 1, v12
    v_lshl_add_u32 v14, v15, 4, v14
    v_lshl_add_u32 v4, v13, 7, v14
    s_lshl_b32 s27, s9, 1
    v_lshrrev_b32 v14, 1, v13
    v_add_u32 v14, s27, v14
    v_and_b32 v14, 3, v14
    v_lshl_add_u32 v14, v14, 4, v12
    v_lshlrev_b32 v14, 4, v14
    v_and_b32 v15, 1, v13
    v_lshl_add_u32 v14, v15, 3, v14
    s_lshr_b32 s27, s9, 1
    s_lshl_b32 s27, s27, 10
    s_add_u32 s27, s27, 22528
    v_add_u32 v5, s27, v14
    s_lshl_b32 s27, s9, 5
    s_add_u32 s27, s27, s8
    s_lshr_b32 s44, s8, 1
    s_add_u32 s44, s44, 64
    s_cmp_lt_u32 s9, 2
    s_cselect_b32 s27, s27, s44
    s_cselect_b32 s22, 1, 0
    s_and_b32 s44, s8, 1
    s_lshl_b32 s44, s44, 2
    s_add_u32 s44, s44, s9
    s_cmp_eq_u32 s44, 2
    s_cselect_b32 s22, 1, s22
    v_lshrrev_b32 v14, 3, v0
    v_mul_u32_u24 v14, 40960, v14
    v_and_b32 v16, 7, v0
    v_lshl_add_u32 v14, v16, 4, v14
    s_lshl_b32 s44, s27, 7
    v_add_u32 v6, s44, v14
    s_mul_i32 s44, s27, 205
    s_lshr_b32 s44, s44, 12
    s_mul_i32 s45, s44, 20
    s_sub_u32 s45, s27, s45
    s_mul_i32 s44, s44, 5
    v_lshrrev_b32 v17, 1, v13
    s_cmp_lt_u32 s45, 16
    s_cbranch_scc0 CH_P_3
    s_lshr_b32 s27, s45, 3
    s_lshl_b32 s27, s27, 1
    s_add_u32 s44, s44, s27
    v_add_u32 v19, s44, v17
    s_and_b32 s27, s45, 7
    s_lshl_b32 s27, s27, 3
    v_add_u32 v18, s27, v16
    s_branch CH_P_4
CH_P_3:
    s_add_u32 s44, s44, 4
    v_mov_b32 v19, s44
    s_sub_u32 s27, s45, 16
    s_lshl_b32 s27, s27, 3
    v_add_u32 v18, s27, v16
    v_lshl_add_u32 v18, v18, 1, v17
CH_P_4:
    v_lshlrev_b32 v20, 9, v19
    v_bfe_u32 v14, v18, 3, 1
    v_lshl_add_u32 v20, v14, 8, v20
    v_lshrrev_b32 v14, 4, v18
    v_lshl_add_u32 v20, v14, 6, v20
    v_and_b32 v14, 1, v18
    v_lshl_add_u32 v20, v14, 5, v20
    v_and_b32 v14, 1, v13
    v_lshl_add_u32 v20, v14, 4, v20
    v_bfe_u32 v14, v18, 1, 2
    v_lshl_add_u32 v7, v14, 2, v20
    v_lshrrev_b32 v14, 1, v13
    v_lshlrev_b32 v14, 10, v14
    v_and_b32 v15, 1, v13
    v_lshl_add_u32 v14, v15, 9, v14
    v_lshl_add_u32 v8, v12, 4, v14
    s_lshr_b32 s27, s9, 1
    s_lshl_b32 s27, s27, 13
    s_and_b32 s44, s9, 1
    s_lshl_b32 s44, s44, 8
    s_add_u32 s27, s27, s44
    s_add_u32 s94, s27, 4096
    v_lshlrev_b32 v14, 9, v13
    v_lshrrev_b32 v15, 3, v12
    v_lshl_add_u32 v14, v15, 8, v14
    v_and_b32 v15, 7, v12
    v_lshl_add_u32 v14, v15, 4, v14
    s_lshr_b32 s27, s9, 1
    s_lshl_b32 s27, s27, 7
    s_and_b32 s44, s9, 1
    s_lshl_b32 s44, s44, 13
    s_add_u32 s27, s27, s44
    v_add_u32 v9, s27, v14
    s_lshl_b32 s37, s9, 11
    s_add_u32 s37, s37, 14336
    s_mov_b32 s30, 0x00ff00ff
    s_mov_b32 s31, 0x00ff00ff
    s_mov_b32 s40, 0x3e0293ee
    s_mov_b32 s41, 0x3e0293ee
    s_mov_b32 s10, 0
    s_mov_b32 s26, 1
    s_mul_i32 s12, s11, 4194304
    s_add_u32 s12, s12, 133496832
    s_add_u32 s13, s12, 10240
    s_add_u32 s14, s13, 10240
    s_mul_i32 s46, s9, 2560
    s_mul_i32 s27, s11, 33554432
    s_lshl_b32 s44, s8, 14
    s_add_u32 s27, s27, s44
    s_add_u32 s20, s27, 0
    s_lshr_b32 s27, s27, 2
    s_add_u32 s15, s27, 138412032
    s_lshl_b32 s27, s9, 10
    s_add_u32 s15, s15, s27
    s_mul_i32 s27, s11, 4194304
    s_add_u32 s16, s27, 133169152
    s_add_u32 s17, s16, 10240
    s_add_u32 s18, s17, 10240
    s_add_u32 s19, s18, 10240
    s_mul_i32 s27, s8, 10240
    s_add_u32 s24, s16, s27
    s_add_u32 s24, s24, s46
    s_lshl_b32 s27, s8, 2
    s_add_u32 s27, s27, s9
    s_lshr_b32 s44, s27, 1
    s_mul_i32 s43, s44, 81920
    s_and_b32 s44, s9, 1
    s_lshl_b32 s44, s44, 8
    s_add_u32 s43, s43, s44
    s_mul_i32 s44, s11, 131072
    s_lshl_b32 s45, s8, 12
    s_add_u32 s44, s44, s45
    s_add_u32 s38, s44, 155451392
    s_lshl_b32 s45, s9, 2
    s_add_u32 s39, s44, s45
    s_add_u32 s34, s39, 155713536
    s_lshl_b32 s39, s100, 9
    s_add_u32 s39, s39, 156246016
    s_lshl_b32 s42, s27, 13
    s_lshl_b32 s45, s11, 20
    s_add_u32 s42, s42, s45
    s_add_u32 s42, s42, 156377088
    s_lshl_b32 s47, s9, 12
    s_lshl_b32 s27, s8, 2
    s_add_u32 s27, s27, s9
    s_mul_i32 s48, s27, 18432
    s_mul_i32 s27, s11, 4194304
    s_add_u32 s48, s48, s27
    s_add_u32 s48, s48, 130023424
    s_add_u32 s49, s48, 2048
    s_add_u32 s50, s48, 4096
    s_add_u32 s51, s48, 6144
    s_add_u32 s52, s48, 8192
    s_add_u32 s53, s48, 10240
    s_add_u32 s54, s48, 12288
    s_add_u32 s55, s48, 14336
    s_add_u32 s56, s48, 16384
    v_lshlrev_b32 v11, 16, v13
    v_lshl_add_u32 v11, v12, 2, v11
    v_mul_u32_u24 v10, 10240, v13
    v_lshl_add_u32 v10, v12, 2, v10
    s_mul_i32 s44, s9, 34816
    s_add_u32 s44, s44, 24576
    v_add_u32 v0, s44, v1
    s_load_dwordx2 s[72:73], s[0:1], 16
    s_mov_b32 s74, 5242880
    s_mov_b32 s75, 0x00020000
    s_load_dwordx2 s[76:77], s[0:1], 24
    s_mov_b32 s78, 5242880
    s_mov_b32 s79, 0x00020000
    s_load_dwordx2 s[80:81], s[0:1], 32
    s_mov_b32 s82, 5242880
    s_mov_b32 s83, 0x00020000
    s_load_dwordx2 s[84:85], s[0:1], 40
    s_mov_b32 s86, 5242880
    s_mov_b32 s87, 0x00020000
    s_mov_b32 s92, 0x05040100
    s_mov_b32 s93, 0x07060302
    v_add_u32 v76, 5120, v10
    s_lshl_b32 s45, s8, 8
    s_lshl_b32 s44, s9, 6
    s_add_u32 s45, s45, s44
    s_mul_i32 s95, s8, 163840
    s_mul_i32 s44, s9, 320
    s_add_u32 s95, s95, s44
    s_waitcnt lgkmcnt(0)
    s_mov_b32 s27, s45
    v_add_u32 v20, 0, v11
    v_add_u32 v21, 8192, v11
    v_add_u32 v22, 16384, v11
    v_add_u32 v23, 24576, v11
    v_add_u32 v24, 32768, v11
    v_add_u32 v25, 40960, v11
    v_add_u32 v26, 49152, v11
    v_add_u32 v27, 57344, v11
    buffer_load_dword v28, v20, s[72:75], s27 offen offset:0
    buffer_load_dword v29, v21, s[72:75], s27 offen offset:0
    buffer_load_dword v30, v22, s[72:75], s27 offen offset:0
    buffer_load_dword v31, v23, s[72:75], s27 offen offset:0
    buffer_load_dword v32, v24, s[72:75], s27 offen offset:0
    buffer_load_dword v33, v25, s[72:75], s27 offen offset:0
    buffer_load_dword v34, v26, s[72:75], s27 offen offset:0
    buffer_load_dword v35, v27, s[72:75], s27 offen offset:0
    s_add_u32 s27, s27, 262144
    buffer_load_dword v36, v20, s[72:75], s27 offen offset:0
    buffer_load_dword v37, v21, s[72:75], s27 offen offset:0
    buffer_load_dword v38, v22, s[72:75], s27 offen offset:0
    buffer_load_dword v39, v23, s[72:75], s27 offen offset:0
    buffer_load_dword v40, v24, s[72:75], s27 offen offset:0
    buffer_load_dword v41, v25, s[72:75], s27 offen offset:0
    buffer_load_dword v42, v26, s[72:75], s27 offen offset:0
    buffer_load_dword v43, v27, s[72:75], s27 offen offset:0
    s_add_u32 s27, s27, 262144
    buffer_load_dword v44, v20, s[72:75], s27 offen offset:0
    buffer_load_dword v45, v21, s[72:75], s27 offen offset:0
    buffer_load_dword v46, v22, s[72:75], s27 offen offset:0
    buffer_load_dword v47, v23, s[72:75], s27 offen offset:0
    buffer_load_dword v48, v24, s[72:75], s27 offen offset:0
    buffer_load_dword v49, v25, s[72:75], s27 offen offset:0
    buffer_load_dword v50, v26, s[72:75], s27 offen offset:0
    buffer_load_dword v51, v27, s[72:75], s27 offen offset:0
    s_add_u32 s27, s27, 262144
    buffer_load_dword v52, v20, s[72:75], s27 offen offset:0
    buffer_load_dword v53, v21, s[72:75], s27 offen offset:0
    buffer_load_dword v54, v22, s[72:75], s27 offen offset:0
    buffer_load_dword v55, v23, s[72:75], s27 offen offset:0
    buffer_load_dword v56, v24, s[72:75], s27 offen offset:0
    buffer_load_dword v57, v25, s[72:75], s27 offen offset:0
    buffer_load_dword v58, v26, s[72:75], s27 offen offset:0
    buffer_load_dword v59, v27, s[72:75], s27 offen offset:0
    s_add_u32 s27, s27, 262144
    buffer_load_dword v60, v20, s[72:75], s27 offen offset:0
    buffer_load_dword v61, v21, s[72:75], s27 offen offset:0
    buffer_load_dword v62, v22, s[72:75], s27 offen offset:0
    buffer_load_dword v63, v23, s[72:75], s27 offen offset:0
    buffer_load_dword v64, v24, s[72:75], s27 offen offset:0
    buffer_load_dword v65, v25, s[72:75], s27 offen offset:0
    buffer_load_dword v66, v26, s[72:75], s27 offen offset:0
    buffer_load_dword v67, v27, s[72:75], s27 offen offset:0
    s_add_u32 s27, s27, 262144
    buffer_load_dword v68, v20, s[72:75], s27 offen offset:0
    buffer_load_dword v69, v21, s[72:75], s27 offen offset:0
    buffer_load_dword v70, v22, s[72:75], s27 offen offset:0
    buffer_load_dword v71, v23, s[72:75], s27 offen offset:0
    buffer_load_dword v72, v24, s[72:75], s27 offen offset:0
    buffer_load_dword v73, v25, s[72:75], s27 offen offset:0
    buffer_load_dword v74, v26, s[72:75], s27 offen offset:0
    buffer_load_dword v75, v27, s[72:75], s27 offen offset:0
    s_add_u32 s27, s27, 262144
    s_waitcnt vmcnt(40)
    v_perm_b32 v12, v29, v28, s92
    v_perm_b32 v13, v31, v30, s92
    v_perm_b32 v14, v33, v32, s92
    v_perm_b32 v15, v35, v34, s92
    buffer_store_dwordx4 v[12:15], v1, s[4:7], s52 offen offset:0
    v_perm_b32 v16, v29, v28, s93
    v_perm_b32 v17, v31, v30, s93
    v_perm_b32 v18, v33, v32, s93
    v_perm_b32 v19, v35, v34, s93
    buffer_store_dwordx4 v[16:19], v1, s[4:7], s48 offen offset:0
    buffer_load_dword v28, v20, s[72:75], s27 offen offset:0
    buffer_load_dword v29, v21, s[72:75], s27 offen offset:0
    buffer_load_dword v30, v22, s[72:75], s27 offen offset:0
    buffer_load_dword v31, v23, s[72:75], s27 offen offset:0
    buffer_load_dword v32, v24, s[72:75], s27 offen offset:0
    buffer_load_dword v33, v25, s[72:75], s27 offen offset:0
    buffer_load_dword v34, v26, s[72:75], s27 offen offset:0
    buffer_load_dword v35, v27, s[72:75], s27 offen offset:0
    s_add_u32 s27, s27, 262144
    s_waitcnt vmcnt(42)
    v_perm_b32 v12, v37, v36, s92
    v_perm_b32 v13, v39, v38, s92
    v_perm_b32 v14, v41, v40, s92
    v_perm_b32 v15, v43, v42, s92
    buffer_store_dwordx4 v[12:15], v1, s[4:7], s52 offen offset:1024
    v_perm_b32 v16, v37, v36, s93
    v_perm_b32 v17, v39, v38, s93
    v_perm_b32 v18, v41, v40, s93
    v_perm_b32 v19, v43, v42, s93
    buffer_store_dwordx4 v[16:19], v1, s[4:7], s48 offen offset:1024
    buffer_load_dword v36, v20, s[72:75], s27 offen offset:0
    buffer_load_dword v37, v21, s[72:75], s27 offen offset:0
    buffer_load_dword v38, v22, s[72:75], s27 offen offset:0
    buffer_load_dword v39, v23, s[72:75], s27 offen offset:0
    buffer_load_dword v40, v24, s[72:75], s27 offen offset:0
    buffer_load_dword v41, v25, s[72:75], s27 offen offset:0
    buffer_load_dword v42, v26, s[72:75], s27 offen offset:0
    buffer_load_dword v43, v27, s[72:75], s27 offen offset:0
    s_add_u32 s27, s27, 262144
    s_waitcnt vmcnt(44)
    v_perm_b32 v12, v45, v44, s92
    v_perm_b32 v13, v47, v46, s92
    v_perm_b32 v14, v49, v48, s92
    v_perm_b32 v15, v51, v50, s92
    buffer_store_dwordx4 v[12:15], v1, s[4:7], s51 offen offset:0
    v_perm_b32 v80, v45, v44, s93
    v_perm_b32 v81, v47, v46, s93
    v_perm_b32 v82, v49, v48, s93
    v_perm_b32 v83, v51, v50, s93
    buffer_load_dword v44, v20, s[72:75], s27 offen offset:0
    buffer_load_dword v45, v21, s[72:75], s27 offen offset:0
    buffer_load_dword v46, v22, s[72:75], s27 offen offset:0
    buffer_load_dword v47, v23, s[72:75], s27 offen offset:0
    buffer_load_dword v48, v24, s[72:75], s27 offen offset:0
    buffer_load_dword v49, v25, s[72:75], s27 offen offset:0
    buffer_load_dword v50, v26, s[72:75], s27 offen offset:0
    buffer_load_dword v51, v27, s[72:75], s27 offen offset:0
    s_add_u32 s27, s27, 262144
    s_waitcnt vmcnt(45)
    v_perm_b32 v16, v53, v52, s92
    v_perm_b32 v17, v55, v54, s92
    v_perm_b32 v18, v57, v56, s92
    v_perm_b32 v19, v59, v58, s92
    buffer_store_dwordx4 v[16:19], v1, s[4:7], s51 offen offset:1024
    v_perm_b32 v84, v53, v52, s93
    v_perm_b32 v85, v55, v54, s93
    v_perm_b32 v86, v57, v56, s93
    v_perm_b32 v87, v59, v58, s93
    buffer_load_dword v52, v20, s[72:75], s27 offen offset:0
    buffer_load_dword v53, v21, s[72:75], s27 offen offset:0
    buffer_load_dword v54, v22, s[72:75], s27 offen offset:0
    buffer_load_dword v55, v23, s[72:75], s27 offen offset:0
    buffer_load_dword v56, v24, s[72:75], s27 offen offset:0
    buffer_load_dword v57, v25, s[72:75], s27 offen offset:0
    buffer_load_dword v58, v26, s[72:75], s27 offen offset:0
    buffer_load_dword v59, v27, s[72:75], s27 offen offset:0
    s_add_u32 s27, s27, 262144
    s_waitcnt vmcnt(46)
    v_perm_b32 v104, v61, v60, s92
    v_perm_b32 v105, v63, v62, s92
    v_perm_b32 v106, v65, v64, s92
    v_perm_b32 v107, v67, v66, s92
    v_perm_b32 v12, v61, v60, s93
    v_perm_b32 v13, v63, v62, s93
    v_perm_b32 v14, v65, v64, s93
    v_perm_b32 v15, v67, v66, s93
    ds_write_b128 v0, v[12:15] offset:0
    buffer_load_dword v60, v20, s[72:75], s27 offen offset:0
    buffer_load_dword v61, v21, s[72:75], s27 offen offset:0
    buffer_load_dword v62, v22, s[72:75], s27 offen offset:0
    buffer_load_dword v63, v23, s[72:75], s27 offen offset:0
    buffer_load_dword v64, v24, s[72:75], s27 offen offset:0
    buffer_load_dword v65, v25, s[72:75], s27 offen offset:0
    buffer_load_dword v66, v26, s[72:75], s27 offen offset:0
    buffer_load_dword v67, v27, s[72:75], s27 offen offset:0
    s_add_u32 s27, s27, 262144
    s_waitcnt vmcnt(46)
    v_perm_b32 v108, v69, v68, s92
    v_perm_b32 v109, v71, v70, s92
    v_perm_b32 v110, v73, v72, s92
    v_perm_b32 v111, v75, v74, s92
    v_perm_b32 v16, v69, v68, s93
    v_perm_b32 v17, v71, v70, s93
    v_perm_b32 v18, v73, v72, s93
    v_perm_b32 v19, v75, v74, s93
    ds_write_b128 v0, v[16:19] offset:1024
    buffer_load_dword v68, v20, s[72:75], s27 offen offset:0
    buffer_load_dword v69, v21, s[72:75], s27 offen offset:0
    buffer_load_dword v70, v22, s[72:75], s27 offen offset:0
    buffer_load_dword v71, v23, s[72:75], s27 offen offset:0
    buffer_load_dword v72, v24, s[72:75], s27 offen offset:0
    buffer_load_dword v73, v25, s[72:75], s27 offen offset:0
    buffer_load_dword v74, v26, s[72:75], s27 offen offset:0
    buffer_load_dword v75, v27, s[72:75], s27 offen offset:0
    s_add_u32 s27, s27, 262144
    s_waitcnt vmcnt(44)
    v_perm_b32 v120, v29, v28, s92
    v_perm_b32 v121, v31, v30, s92
    v_perm_b32 v122, v33, v32, s92
    v_perm_b32 v123, v35, v34, s92
    v_perm_b32 v128, v29, v28, s93
    v_perm_b32 v129, v31, v30, s93
    v_perm_b32 v130, v33, v32, s93
    v_perm_b32 v131, v35, v34, s93
    buffer_load_dword v28, v20, s[72:75], s27 offen offset:0
    buffer_load_dword v29, v21, s[72:75], s27 offen offset:0
    buffer_load_dword v30, v22, s[72:75], s27 offen offset:0
    buffer_load_dword v31, v23, s[72:75], s27 offen offset:0
    buffer_load_dword v32, v24, s[72:75], s27 offen offset:0
    buffer_load_dword v33, v25, s[72:75], s27 offen offset:0
    buffer_load_dword v34, v26, s[72:75], s27 offen offset:0
    buffer_load_dword v35, v27, s[72:75], s27 offen offset:0
    s_add_u32 s27, s27, 262144
    s_waitcnt vmcnt(42)
    v_perm_b32 v124, v37, v36, s92
    v_perm_b32 v125, v39, v38, s92
    v_perm_b32 v126, v41, v40, s92
    v_perm_b32 v127, v43, v42, s92
    v_perm_b32 v132, v37, v36, s93
    v_perm_b32 v133, v39, v38, s93
    v_perm_b32 v134, v41, v40, s93
    v_perm_b32 v135, v43, v42, s93
    buffer_load_dword v36, v20, s[72:75], s27 offen offset:0
    buffer_load_dword v37, v21, s[72:75], s27 offen offset:0
    buffer_load_dword v38, v22, s[72:75], s27 offen offset:0
    buffer_load_dword v39, v23, s[72:75], s27 offen offset:0
    buffer_load_dword v40, v24, s[72:75], s27 offen offset:0
    buffer_load_dword v41, v25, s[72:75], s27 offen offset:0
    buffer_load_dword v42, v26, s[72:75], s27 offen offset:0
    buffer_load_dword v43, v27, s[72:75], s27 offen offset:0
    s_add_u32 s27, s27, 262144
    s_waitcnt vmcnt(41)
    v_perm_b32 v144, v45, v44, s92
    v_perm_b32 v145, v47, v46, s92
    v_perm_b32 v146, v49, v48, s92
    v_perm_b32 v147, v51, v50, s92
    v_perm_b32 v12, v45, v44, s93
    v_perm_b32 v13, v47, v46, s93
    v_perm_b32 v14, v49, v48, s93
    v_perm_b32 v15, v51, v50, s93
    ds_write_b128 v0, v[12:15] offset:6144
    buffer_load_dword v44, v20, s[72:75], s27 offen offset:0
    buffer_load_dword v45, v21, s[72:75], s27 offen offset:0
    buffer_load_dword v46, v22, s[72:75], s27 offen offset:0
    buffer_load_dword v47, v23, s[72:75], s27 offen offset:0
    buffer_load_dword v48, v24, s[72:75], s27 offen offset:0
    buffer_load_dword v49, v25, s[72:75], s27 offen offset:0
    buffer_load_dword v50, v26, s[72:75], s27 offen offset:0
    buffer_load_dword v51, v27, s[72:75], s27 offen offset:0
    s_add_u32 s27, s27, 262144
    s_waitcnt vmcnt(40)
    v_perm_b32 v148, v53, v52, s92
    v_perm_b32 v149, v55, v54, s92
    v_perm_b32 v150, v57, v56, s92
    v_perm_b32 v151, v59, v58, s92
    v_perm_b32 v16, v53, v52, s93
    v_perm_b32 v17, v55, v54, s93
    v_perm_b32 v18, v57, v56, s93
    v_perm_b32 v19, v59, v58, s93
    ds_write_b128 v0, v[16:19] offset:7168
    buffer_load_dword v52, v20, s[72:75], s27 offen offset:0
    buffer_load_dword v53, v21, s[72:75], s27 offen offset:0
    buffer_load_dword v54, v22, s[72:75], s27 offen offset:0
    buffer_load_dword v55, v23, s[72:75], s27 offen offset:0
    buffer_load_dword v56, v24, s[72:75], s27 offen offset:0
    buffer_load_dword v57, v25, s[72:75], s27 offen offset:0
    buffer_load_dword v58, v26, s[72:75], s27 offen offset:0
    buffer_load_dword v59, v27, s[72:75], s27 offen offset:0
    s_add_u32 s27, s27, 262144
    s_waitcnt vmcnt(40)
    v_perm_b32 v12, v61, v60, s92
    v_perm_b32 v13, v63, v62, s92
    v_perm_b32 v14, v65, v64, s92
    v_perm_b32 v15, v67, v66, s92
    ds_write_b128 v0, v[12:15] offset:8192
    v_perm_b32 v168, v61, v60, s93
    v_perm_b32 v169, v63, v62, s93
    v_perm_b32 v170, v65, v64, s93
    v_perm_b32 v171, v67, v66, s93
    buffer_load_dword v60, v20, s[72:75], s27 offen offset:0
    buffer_load_dword v61, v21, s[72:75], s27 offen offset:0
    buffer_load_dword v62, v22, s[72:75], s27 offen offset:0
    buffer_load_dword v63, v23, s[72:75], s27 offen offset:0
    buffer_load_dword v64, v24, s[72:75], s27 offen offset:0
    buffer_load_dword v65, v25, s[72:75], s27 offen offset:0
    buffer_load_dword v66, v26, s[72:75], s27 offen offset:0
    buffer_load_dword v67, v27, s[72:75], s27 offen offset:0
    s_add_u32 s27, s27, 262144
    s_waitcnt vmcnt(40)
    v_perm_b32 v16, v69, v68, s92
    v_perm_b32 v17, v71, v70, s92
    v_perm_b32 v18, v73, v72, s92
    v_perm_b32 v19, v75, v74, s92
    ds_write_b128 v0, v[16:19] offset:9216
    v_perm_b32 v172, v69, v68, s93
    v_perm_b32 v173, v71, v70, s93
    v_perm_b32 v174, v73, v72, s93
    v_perm_b32 v175, v75, v74, s93
    buffer_load_dword v68, v20, s[72:75], s27 offen offset:0
    buffer_load_dword v69, v21, s[72:75], s27 offen offset:0
    buffer_load_dword v70, v22, s[72:75], s27 offen offset:0
    buffer_load_dword v71, v23, s[72:75], s27 offen offset:0
    buffer_load_dword v72, v24, s[72:75], s27 offen offset:0
    buffer_load_dword v73, v25, s[72:75], s27 offen offset:0
    buffer_load_dword v74, v26, s[72:75], s27 offen offset:0
    buffer_load_dword v75, v27, s[72:75], s27 offen offset:0
    s_add_u32 s27, s27, 262144
    s_waitcnt vmcnt(40)
    v_perm_b32 v184, v29, v28, s92
    v_perm_b32 v185, v31, v30, s92
    v_perm_b32 v186, v33, v32, s92
    v_perm_b32 v187, v35, v34, s92
    v_perm_b32 v192, v29, v28, s93
    v_perm_b32 v193, v31, v30, s93
    v_perm_b32 v194, v33, v32, s93
    v_perm_b32 v195, v35, v34, s93
    buffer_load_dword v28, v20, s[72:75], s27 offen offset:0
    buffer_load_dword v29, v21, s[72:75], s27 offen offset:0
    buffer_load_dword v30, v22, s[72:75], s27 offen offset:0
    buffer_load_dword v31, v23, s[72:75], s27 offen offset:0
    buffer_load_dword v32, v24, s[72:75], s27 offen offset:0
    buffer_load_dword v33, v25, s[72:75], s27 offen offset:0
    buffer_load_dword v34, v26, s[72:75], s27 offen offset:0
    buffer_load_dword v35, v27, s[72:75], s27 offen offset:0
    s_add_u32 s27, s27, 262144
    s_waitcnt vmcnt(40)
    v_perm_b32 v188, v37, v36, s92
    v_perm_b32 v189, v39, v38, s92
    v_perm_b32 v190, v41, v40, s92
    v_perm_b32 v191, v43, v42, s92
    v_perm_b32 v196, v37, v36, s93
    v_perm_b32 v197, v39, v38, s93
    v_perm_b32 v198, v41, v40, s93
    v_perm_b32 v199, v43, v42, s93
    buffer_load_dword v36, v20, s[72:75], s27 offen offset:0
    buffer_load_dword v37, v21, s[72:75], s27 offen offset:0
    buffer_load_dword v38, v22, s[72:75], s27 offen offset:0
    buffer_load_dword v39, v23, s[72:75], s27 offen offset:0
    buffer_load_dword v40, v24, s[72:75], s27 offen offset:0
    buffer_load_dword v41, v25, s[72:75], s27 offen offset:0
    buffer_load_dword v42, v26, s[72:75], s27 offen offset:0
    buffer_load_dword v43, v27, s[72:75], s27 offen offset:0
    s_add_u32 s27, s27, 262144
    s_mov_b32 s27, s45
    s_waitcnt vmcnt(40)
    v_perm_b32 v208, v45, v44, s92
    v_perm_b32 v209, v47, v46, s92
    v_perm_b32 v210, v49, v48, s92
    v_perm_b32 v211, v51, v50, s92
    v_perm_b32 v12, v45, v44, s93
    v_perm_b32 v13, v47, v46, s93
    v_perm_b32 v14, v49, v48, s93
    v_perm_b32 v15, v51, v50, s93
    ds_write_b128 v0, v[12:15] offset:14336
    buffer_load_dword v44, v20, s[76:79], s27 offen offset:0
    buffer_load_dword v45, v21, s[76:79], s27 offen offset:0
    buffer_load_dword v46, v22, s[76:79], s27 offen offset:0
    buffer_load_dword v47, v23, s[76:79], s27 offen offset:0
    buffer_load_dword v48, v24, s[76:79], s27 offen offset:0
    buffer_load_dword v49, v25, s[76:79], s27 offen offset:0
    buffer_load_dword v50, v26, s[76:79], s27 offen offset:0
    buffer_load_dword v51, v27, s[76:79], s27 offen offset:0
    s_add_u32 s27, s27, 262144
    s_waitcnt vmcnt(40)
    v_perm_b32 v212, v53, v52, s92
    v_perm_b32 v213, v55, v54, s92
    v_perm_b32 v214, v57, v56, s92
    v_perm_b32 v215, v59, v58, s92
    v_perm_b32 v16, v53, v52, s93
    v_perm_b32 v17, v55, v54, s93
    v_perm_b32 v18, v57, v56, s93
    v_perm_b32 v19, v59, v58, s93
    ds_write_b128 v0, v[16:19] offset:15360
    buffer_load_dword v52, v20, s[76:79], s27 offen offset:0
    buffer_load_dword v53, v21, s[76:79], s27 offen offset:0
    buffer_load_dword v54, v22, s[76:79], s27 offen offset:0
    buffer_load_dword v55, v23, s[76:79], s27 offen offset:0
    buffer_load_dword v56, v24, s[76:79], s27 offen offset:0
    buffer_load_dword v57, v25, s[76:79], s27 offen offset:0
    buffer_load_dword v58, v26, s[76:79], s27 offen offset:0
    buffer_load_dword v59, v27, s[76:79], s27 offen offset:0
    s_add_u32 s27, s27, 262144
    s_waitcnt vmcnt(40)
    v_perm_b32 v12, v61, v60, s92
    v_perm_b32 v13, v63, v62, s92
    v_perm_b32 v14, v65, v64, s92
    v_perm_b32 v15, v67, v66, s92
    ds_write_b128 v0, v[12:15] offset:16384
    v_perm_b32 v232, v61, v60, s93
    v_perm_b32 v233, v63, v62, s93
    v_perm_b32 v234, v65, v64, s93
    v_perm_b32 v235, v67, v66, s93
    buffer_load_dword v60, v20, s[76:79], s27 offen offset:0
    buffer_load_dword v61, v21, s[76:79], s27 offen offset:0
    buffer_load_dword v62, v22, s[76:79], s27 offen offset:0
    buffer_load_dword v63, v23, s[76:79], s27 offen offset:0
    buffer_load_dword v64, v24, s[76:79], s27 offen offset:0
    buffer_load_dword v65, v25, s[76:79], s27 offen offset:0
    buffer_load_dword v66, v26, s[76:79], s27 offen offset:0
    buffer_load_dword v67, v27, s[76:79], s27 offen offset:0
    s_add_u32 s27, s27, 262144
    s_waitcnt vmcnt(40)
    v_perm_b32 v16, v69, v68, s92
    v_perm_b32 v17, v71, v70, s92
    v_perm_b32 v18, v73, v72, s92
    v_perm_b32 v19, v75, v74, s92
    ds_write_b128 v0, v[16:19] offset:17408
    v_perm_b32 v236, v69, v68, s93
    v_perm_b32 v237, v71, v70, s93
    v_perm_b32 v238, v73, v72, s93
    v_perm_b32 v239, v75, v74, s93
    buffer_load_dword v68, v20, s[76:79], s27 offen offset:0
    buffer_load_dword v69, v21, s[76:79], s27 offen offset:0
    buffer_load_dword v70, v22, s[76:79], s27 offen offset:0
    buffer_load_dword v71, v23, s[76:79], s27 offen offset:0
    buffer_load_dword v72, v24, s[76:79], s27 offen offset:0
    buffer_load_dword v73, v25, s[76:79], s27 offen offset:0
    buffer_load_dword v74, v26, s[76:79], s27 offen offset:0
    buffer_load_dword v75, v27, s[76:79], s27 offen offset:0
    s_add_u32 s27, s27, 262144
    s_waitcnt vmcnt(40)
    v_perm_b32 v248, v29, v28, s92
    v_perm_b32 v249, v31, v30, s92
    v_perm_b32 v250, v33, v32, s92
    v_perm_b32 v251, v35, v34, s92
    v_perm_b32 v12, v29, v28, s93
    v_perm_b32 v13, v31, v30, s93
    v_perm_b32 v14, v33, v32, s93
    v_perm_b32 v15, v35, v34, s93
    v_accvgpr_write_b32 a0, v12
    v_accvgpr_write_b32 a1, v13
    v_accvgpr_write_b32 a2, v14
    v_accvgpr_write_b32 a3, v15
    buffer_load_dword v28, v20, s[76:79], s27 offen offset:0
    buffer_load_dword v29, v21, s[76:79], s27 offen offset:0
    buffer_load_dword v30, v22, s[76:79], s27 offen offset:0
    buffer_load_dword v31, v23, s[76:79], s27 offen offset:0
    buffer_load_dword v32, v24, s[76:79], s27 offen offset:0
    buffer_load_dword v33, v25, s[76:79], s27 offen offset:0
    buffer_load_dword v34, v26, s[76:79], s27 offen offset:0
    buffer_load_dword v35, v27, s[76:79], s27 offen offset:0
    s_add_u32 s27, s27, 262144
    s_waitcnt vmcnt(40)
    v_perm_b32 v252, v37, v36, s92
    v_perm_b32 v253, v39, v38, s92
    v_perm_b32 v254, v41, v40, s92
    v_perm_b32 v255, v43, v42, s92
    v_perm_b32 v16, v37, v36, s93
    v_perm_b32 v17, v39, v38, s93
    v_perm_b32 v18, v41, v40, s93
    v_perm_b32 v19, v43, v42, s93
    v_accvgpr_write_b32 a4, v16
    v_accvgpr_write_b32 a5, v17
    v_accvgpr_write_b32 a6, v18
    v_accvgpr_write_b32 a7, v19
    buffer_load_dword v36, v20, s[76:79], s27 offen offset:0
    buffer_load_dword v37, v21, s[76:79], s27 offen offset:0
    buffer_load_dword v38, v22, s[76:79], s27 offen offset:0
    buffer_load_dword v39, v23, s[76:79], s27 offen offset:0
    buffer_load_dword v40, v24, s[76:79], s27 offen offset:0
    buffer_load_dword v41, v25, s[76:79], s27 offen offset:0
    buffer_load_dword v42, v26, s[76:79], s27 offen offset:0
    buffer_load_dword v43, v27, s[76:79], s27 offen offset:0
    s_add_u32 s27, s27, 262144
    s_waitcnt vmcnt(40)
    v_perm_b32 v12, v45, v44, s92
    v_perm_b32 v13, v47, v46, s92
    v_perm_b32 v14, v49, v48, s92
    v_perm_b32 v15, v51, v50, s92
    buffer_store_dwordx4 v[12:15], v1, s[4:7], s49 offen offset:0
    v_perm_b32 v16, v45, v44, s93
    v_perm_b32 v17, v47, v46, s93
    v_perm_b32 v18, v49, v48, s93
    v_perm_b32 v19, v51, v50, s93
    buffer_store_dwordx4 v[16:19], v1, s[4:7], s50 offen offset:0
    buffer_load_dword v44, v20, s[76:79], s27 offen offset:0
    buffer_load_dword v45, v21, s[76:79], s27 offen offset:0
    buffer_load_dword v46, v22, s[76:79], s27 offen offset:0
    buffer_load_dword v47, v23, s[76:79], s27 offen offset:0
    buffer_load_dword v48, v24, s[76:79], s27 offen offset:0
    buffer_load_dword v49, v25, s[76:79], s27 offen offset:0
    buffer_load_dword v50, v26, s[76:79], s27 offen offset:0
    buffer_load_dword v51, v27, s[76:79], s27 offen offset:0
    s_add_u32 s27, s27, 262144
    s_waitcnt vmcnt(42)
    v_perm_b32 v12, v53, v52, s92
    v_perm_b32 v13, v55, v54, s92
    v_perm_b32 v14, v57, v56, s92
    v_perm_b32 v15, v59, v58, s92
    buffer_store_dwordx4 v[12:15], v1, s[4:7], s49 offen offset:1024
    v_perm_b32 v16, v53, v52, s93
    v_perm_b32 v17, v55, v54, s93
    v_perm_b32 v18, v57, v56, s93
    v_perm_b32 v19, v59, v58, s93
    buffer_store_dwordx4 v[16:19], v1, s[4:7], s50 offen offset:1024
    buffer_load_dword v52, v20, s[76:79], s27 offen offset:0
    buffer_load_dword v53, v21, s[76:79], s27 offen offset:0
    buffer_load_dword v54, v22, s[76:79], s27 offen offset:0
    buffer_load_dword v55, v23, s[76:79], s27 offen offset:0
    buffer_load_dword v56, v24, s[76:79], s27 offen offset:0
    buffer_load_dword v57, v25, s[76:79], s27 offen offset:0
    buffer_load_dword v58, v26, s[76:79], s27 offen offset:0
    buffer_load_dword v59, v27, s[76:79], s27 offen offset:0
    s_add_u32 s27, s27, 262144
    s_waitcnt vmcnt(44)
    v_perm_b32 v88, v61, v60, s92
    v_perm_b32 v89, v63, v62, s92
    v_perm_b32 v90, v65, v64, s92
    v_perm_b32 v91, v67, v66, s92
    v_perm_b32 v96, v61, v60, s93
    v_perm_b32 v97, v63, v62, s93
    v_perm_b32 v98, v65, v64, s93
    v_perm_b32 v99, v67, v66, s93
    buffer_load_dword v60, v20, s[76:79], s27 offen offset:0
    buffer_load_dword v61, v21, s[76:79], s27 offen offset:0
    buffer_load_dword v62, v22, s[76:79], s27 offen offset:0
    buffer_load_dword v63, v23, s[76:79], s27 offen offset:0
    buffer_load_dword v64, v24, s[76:79], s27 offen offset:0
    buffer_load_dword v65, v25, s[76:79], s27 offen offset:0
    buffer_load_dword v66, v26, s[76:79], s27 offen offset:0
    buffer_load_dword v67, v27, s[76:79], s27 offen offset:0
    s_add_u32 s27, s27, 262144
    s_waitcnt vmcnt(44)
    v_perm_b32 v92, v69, v68, s92
    v_perm_b32 v93, v71, v70, s92
    v_perm_b32 v94, v73, v72, s92
    v_perm_b32 v95, v75, v74, s92
    v_perm_b32 v100, v69, v68, s93
    v_perm_b32 v101, v71, v70, s93
    v_perm_b32 v102, v73, v72, s93
    v_perm_b32 v103, v75, v74, s93
    buffer_load_dword v68, v20, s[76:79], s27 offen offset:0
    buffer_load_dword v69, v21, s[76:79], s27 offen offset:0
    buffer_load_dword v70, v22, s[76:79], s27 offen offset:0
    buffer_load_dword v71, v23, s[76:79], s27 offen offset:0
    buffer_load_dword v72, v24, s[76:79], s27 offen offset:0
    buffer_load_dword v73, v25, s[76:79], s27 offen offset:0
    buffer_load_dword v74, v26, s[76:79], s27 offen offset:0
    buffer_load_dword v75, v27, s[76:79], s27 offen offset:0
    s_add_u32 s27, s27, 262144
    s_waitcnt vmcnt(44)
    v_perm_b32 v112, v29, v28, s92
    v_perm_b32 v113, v31, v30, s92
    v_perm_b32 v114, v33, v32, s92
    v_perm_b32 v115, v35, v34, s92
    v_perm_b32 v12, v29, v28, s93
    v_perm_b32 v13, v31, v30, s93
    v_perm_b32 v14, v33, v32, s93
    v_perm_b32 v15, v35, v34, s93
    ds_write_b128 v0, v[12:15] offset:2048
    buffer_load_dword v28, v20, s[76:79], s27 offen offset:0
    buffer_load_dword v29, v21, s[76:79], s27 offen offset:0
    buffer_load_dword v30, v22, s[76:79], s27 offen offset:0
    buffer_load_dword v31, v23, s[76:79], s27 offen offset:0
    buffer_load_dword v32, v24, s[76:79], s27 offen offset:0
    buffer_load_dword v33, v25, s[76:79], s27 offen offset:0
    buffer_load_dword v34, v26, s[76:79], s27 offen offset:0
    buffer_load_dword v35, v27, s[76:79], s27 offen offset:0
    s_add_u32 s27, s27, 262144
    s_waitcnt vmcnt(44)
    v_perm_b32 v116, v37, v36, s92
    v_perm_b32 v117, v39, v38, s92
    v_perm_b32 v118, v41, v40, s92
    v_perm_b32 v119, v43, v42, s92
    v_perm_b32 v16, v37, v36, s93
    v_perm_b32 v17, v39, v38, s93
    v_perm_b32 v18, v41, v40, s93
    v_perm_b32 v19, v43, v42, s93
    ds_write_b128 v0, v[16:19] offset:3072
    buffer_load_dword v36, v20, s[76:79], s27 offen offset:0
    buffer_load_dword v37, v21, s[76:79], s27 offen offset:0
    buffer_load_dword v38, v22, s[76:79], s27 offen offset:0
    buffer_load_dword v39, v23, s[76:79], s27 offen offset:0
    buffer_load_dword v40, v24, s[76:79], s27 offen offset:0
    buffer_load_dword v41, v25, s[76:79], s27 offen offset:0
    buffer_load_dword v42, v26, s[76:79], s27 offen offset:0
    buffer_load_dword v43, v27, s[76:79], s27 offen offset:0
    s_add_u32 s27, s27, 262144
    s_waitcnt vmcnt(42)
    v_perm_b32 v12, v45, v44, s92
    v_perm_b32 v13, v47, v46, s92
    v_perm_b32 v14, v49, v48, s92
    v_perm_b32 v15, v51, v50, s92
    ds_write_b128 v0, v[12:15] offset:4096
    v_perm_b32 v136, v45, v44, s93
    v_perm_b32 v137, v47, v46, s93
    v_perm_b32 v138, v49, v48, s93
    v_perm_b32 v139, v51, v50, s93
    buffer_load_dword v44, v20, s[76:79], s27 offen offset:0
    buffer_load_dword v45, v21, s[76:79], s27 offen offset:0
    buffer_load_dword v46, v22, s[76:79], s27 offen offset:0
    buffer_load_dword v47, v23, s[76:79], s27 offen offset:0
    buffer_load_dword v48, v24, s[76:79], s27 offen offset:0
    buffer_load_dword v49, v25, s[76:79], s27 offen offset:0
    buffer_load_dword v50, v26, s[76:79], s27 offen offset:0
    buffer_load_dword v51, v27, s[76:79], s27 offen offset:0
    s_add_u32 s27, s27, 262144
    s_waitcnt vmcnt(40)
    v_perm_b32 v16, v53, v52, s92
    v_perm_b32 v17, v55, v54, s92
    v_perm_b32 v18, v57, v56, s92
    v_perm_b32 v19, v59, v58, s92
    ds_write_b128 v0, v[16:19] offset:5120
    v_perm_b32 v140, v53, v52, s93
    v_perm_b32 v141, v55, v54, s93
    v_perm_b32 v142, v57, v56, s93
    v_perm_b32 v143, v59, v58, s93
    buffer_load_dword v52, v20, s[76:79], s27 offen offset:0
    buffer_load_dword v53, v21, s[76:79], s27 offen offset:0
    buffer_load_dword v54, v22, s[76:79], s27 offen offset:0
    buffer_load_dword v55, v23, s[76:79], s27 offen offset:0
    buffer_load_dword v56, v24, s[76:79], s27 offen offset:0
    buffer_load_dword v57, v25, s[76:79], s27 offen offset:0
    buffer_load_dword v58, v26, s[76:79], s27 offen offset:0
    buffer_load_dword v59, v27, s[76:79], s27 offen offset:0
    s_add_u32 s27, s27, 262144
    s_waitcnt vmcnt(40)
    v_perm_b32 v152, v61, v60, s92
    v_perm_b32 v153, v63, v62, s92
    v_perm_b32 v154, v65, v64, s92
    v_perm_b32 v155, v67, v66, s92
    v_perm_b32 v160, v61, v60, s93
    v_perm_b32 v161, v63, v62, s93
    v_perm_b32 v162, v65, v64, s93
    v_perm_b32 v163, v67, v66, s93
    buffer_load_dword v60, v20, s[76:79], s27 offen offset:0
    buffer_load_dword v61, v21, s[76:79], s27 offen offset:0
    buffer_load_dword v62, v22, s[76:79], s27 offen offset:0
    buffer_load_dword v63, v23, s[76:79], s27 offen offset:0
    buffer_load_dword v64, v24, s[76:79], s27 offen offset:0
    buffer_load_dword v65, v25, s[76:79], s27 offen offset:0
    buffer_load_dword v66, v26, s[76:79], s27 offen offset:0
    buffer_load_dword v67, v27, s[76:79], s27 offen offset:0
    s_add_u32 s27, s27, 262144
    s_waitcnt vmcnt(40)
    v_perm_b32 v156, v69, v68, s92
    v_perm_b32 v157, v71, v70, s92
    v_perm_b32 v158, v73, v72, s92
    v_perm_b32 v159, v75, v74, s92
    v_perm_b32 v164, v69, v68, s93
    v_perm_b32 v165, v71, v70, s93
    v_perm_b32 v166, v73, v72, s93
    v_perm_b32 v167, v75, v74, s93
    buffer_load_dword v68, v20, s[76:79], s27 offen offset:0
    buffer_load_dword v69, v21, s[76:79], s27 offen offset:0
    buffer_load_dword v70, v22, s[76:79], s27 offen offset:0
    buffer_load_dword v71, v23, s[76:79], s27 offen offset:0
    buffer_load_dword v72, v24, s[76:79], s27 offen offset:0
    buffer_load_dword v73, v25, s[76:79], s27 offen offset:0
    buffer_load_dword v74, v26, s[76:79], s27 offen offset:0
    buffer_load_dword v75, v27, s[76:79], s27 offen offset:0
    s_add_u32 s27, s27, 262144
    s_waitcnt vmcnt(40)
    v_perm_b32 v176, v29, v28, s92
    v_perm_b32 v177, v31, v30, s92
    v_perm_b32 v178, v33, v32, s92
    v_perm_b32 v179, v35, v34, s92
    v_perm_b32 v12, v29, v28, s93
    v_perm_b32 v13, v31, v30, s93
    v_perm_b32 v14, v33, v32, s93
    v_perm_b32 v15, v35, v34, s93
    ds_write_b128 v0, v[12:15] offset:10240
    buffer_load_dword v28, v20, s[76:79], s27 offen offset:0
    buffer_load_dword v29, v21, s[76:79], s27 offen offset:0
    buffer_load_dword v30, v22, s[76:79], s27 offen offset:0
    buffer_load_dword v31, v23, s[76:79], s27 offen offset:0
    buffer_load_dword v32, v24, s[76:79], s27 offen offset:0
    buffer_load_dword v33, v25, s[76:79], s27 offen offset:0
    buffer_load_dword v34, v26, s[76:79], s27 offen offset:0
    buffer_load_dword v35, v27, s[76:79], s27 offen offset:0
    s_add_u32 s27, s27, 262144
    s_waitcnt vmcnt(40)
    v_perm_b32 v180, v37, v36, s92
    v_perm_b32 v181, v39, v38, s92
    v_perm_b32 v182, v41, v40, s92
    v_perm_b32 v183, v43, v42, s92
    v_perm_b32 v16, v37, v36, s93
    v_perm_b32 v17, v39, v38, s93
    v_perm_b32 v18, v41, v40, s93
    v_perm_b32 v19, v43, v42, s93
    ds_write_b128 v0, v[16:19] offset:11264
    buffer_load_dword v36, v20, s[76:79], s27 offen offset:0
    buffer_load_dword v37, v21, s[76:79], s27 offen offset:0
    buffer_load_dword v38, v22, s[76:79], s27 offen offset:0
    buffer_load_dword v39, v23, s[76:79], s27 offen offset:0
    buffer_load_dword v40, v24, s[76:79], s27 offen offset:0
    buffer_load_dword v41, v25, s[76:79], s27 offen offset:0
    buffer_load_dword v42, v26, s[76:79], s27 offen offset:0
    buffer_load_dword v43, v27, s[76:79], s27 offen offset:0
    s_add_u32 s27, s27, 262144
    s_waitcnt vmcnt(40)
    v_perm_b32 v12, v45, v44, s92
    v_perm_b32 v13, v47, v46, s92
    v_perm_b32 v14, v49, v48, s92
    v_perm_b32 v15, v51, v50, s92
    ds_write_b128 v0, v[12:15] offset:12288
    v_perm_b32 v200, v45, v44, s93
    v_perm_b32 v201, v47, v46, s93
    v_perm_b32 v202, v49, v48, s93
    v_perm_b32 v203, v51, v50, s93
    buffer_load_dword v44, v20, s[76:79], s27 offen offset:0
    buffer_load_dword v45, v21, s[76:79], s27 offen offset:0
    buffer_load_dword v46, v22, s[76:79], s27 offen offset:0
    buffer_load_dword v47, v23, s[76:79], s27 offen offset:0
    buffer_load_dword v48, v24, s[76:79], s27 offen offset:0
    buffer_load_dword v49, v25, s[76:79], s27 offen offset:0
    buffer_load_dword v50, v26, s[76:79], s27 offen offset:0
    buffer_load_dword v51, v27, s[76:79], s27 offen offset:0
    s_add_u32 s27, s27, 262144
    s_waitcnt vmcnt(40)
    v_perm_b32 v16, v53, v52, s92
    v_perm_b32 v17, v55, v54, s92
    v_perm_b32 v18, v57, v56, s92
    v_perm_b32 v19, v59, v58, s92
    ds_write_b128 v0, v[16:19] offset:13312
    v_perm_b32 v204, v53, v52, s93
    v_perm_b32 v205, v55, v54, s93
    v_perm_b32 v206, v57, v56, s93
    v_perm_b32 v207, v59, v58, s93
    buffer_load_dword v52, v20, s[76:79], s27 offen offset:0
    buffer_load_dword v53, v21, s[76:79], s27 offen offset:0
    buffer_load_dword v54, v22, s[76:79], s27 offen offset:0
    buffer_load_dword v55, v23, s[76:79], s27 offen offset:0
    buffer_load_dword v56, v24, s[76:79], s27 offen offset:0
    buffer_load_dword v57, v25, s[76:79], s27 offen offset:0
    buffer_load_dword v58, v26, s[76:79], s27 offen offset:0
    buffer_load_dword v59, v27, s[76:79], s27 offen offset:0
    s_add_u32 s27, s27, 262144
    s_mov_b32 s27, s45
    s_waitcnt vmcnt(40)
    v_perm_b32 v216, v61, v60, s92
    v_perm_b32 v217, v63, v62, s92
    v_perm_b32 v218, v65, v64, s92
    v_perm_b32 v219, v67, v66, s92
    v_perm_b32 v224, v61, v60, s93
    v_perm_b32 v225, v63, v62, s93
    v_perm_b32 v226, v65, v64, s93
    v_perm_b32 v227, v67, v66, s93
    buffer_load_dword v60, v20, s[80:83], s27 offen offset:0
    buffer_load_dword v61, v21, s[80:83], s27 offen offset:0
    buffer_load_dword v62, v22, s[80:83], s27 offen offset:0
    buffer_load_dword v63, v23, s[80:83], s27 offen offset:0
    buffer_load_dword v64, v24, s[80:83], s27 offen offset:0
    buffer_load_dword v65, v25, s[80:83], s27 offen offset:0
    buffer_load_dword v66, v26, s[80:83], s27 offen offset:0
    buffer_load_dword v67, v27, s[80:83], s27 offen offset:0
    s_add_u32 s27, s27, 262144
    s_waitcnt vmcnt(40)
    v_perm_b32 v220, v69, v68, s92
    v_perm_b32 v221, v71, v70, s92
    v_perm_b32 v222, v73, v72, s92
    v_perm_b32 v223, v75, v74, s92
    v_perm_b32 v228, v69, v68, s93
    v_perm_b32 v229, v71, v70, s93
    v_perm_b32 v230, v73, v72, s93
    v_perm_b32 v231, v75, v74, s93
    buffer_load_dword v68, v20, s[80:83], s27 offen offset:0
    buffer_load_dword v69, v21, s[80:83], s27 offen offset:0
    buffer_load_dword v70, v22, s[80:83], s27 offen offset:0
    buffer_load_dword v71, v23, s[80:83], s27 offen offset:0
    buffer_load_dword v72, v24, s[80:83], s27 offen offset:0
    buffer_load_dword v73, v25, s[80:83], s27 offen offset:0
    buffer_load_dword v74, v26, s[80:83], s27 offen offset:0
    buffer_load_dword v75, v27, s[80:83], s27 offen offset:0
    s_add_u32 s27, s27, 262144
    s_waitcnt vmcnt(40)
    v_perm_b32 v240, v29, v28, s92
    v_perm_b32 v241, v31, v30, s92
    v_perm_b32 v242, v33, v32, s92
    v_perm_b32 v243, v35, v34, s92
    v_perm_b32 v12, v29, v28, s93
    v_perm_b32 v13, v31, v30, s93
    v_perm_b32 v14, v33, v32, s93
    v_perm_b32 v15, v35, v34, s93
    ds_write_b128 v0, v[12:15] offset:18432
    buffer_load_dword v28, v20, s[80:83], s27 offen offset:0
    buffer_load_dword v29, v21, s[80:83], s27 offen offset:0
    buffer_load_dword v30, v22, s[80:83], s27 offen offset:0
    buffer_load_dword v31, v23, s[80:83], s27 offen offset:0
    buffer_load_dword v32, v24, s[80:83], s27 offen offset:0
    buffer_load_dword v33, v25, s[80:83], s27 offen offset:0
    buffer_load_dword v34, v26, s[80:83], s27 offen offset:0
    buffer_load_dword v35, v27, s[80:83], s27 offen offset:0
    s_add_u32 s27, s27, 262144
    s_waitcnt vmcnt(40)
    v_perm_b32 v244, v37, v36, s92
    v_perm_b32 v245, v39, v38, s92
    v_perm_b32 v246, v41, v40, s92
    v_perm_b32 v247, v43, v42, s92
    v_perm_b32 v16, v37, v36, s93
    v_perm_b32 v17, v39, v38, s93
    v_perm_b32 v18, v41, v40, s93
    v_perm_b32 v19, v43, v42, s93
    ds_write_b128 v0, v[16:19] offset:19456
    buffer_load_dword v36, v20, s[80:83], s27 offen offset:0
    buffer_load_dword v37, v21, s[80:83], s27 offen offset:0
    buffer_load_dword v38, v22, s[80:83], s27 offen offset:0
    buffer_load_dword v39, v23, s[80:83], s27 offen offset:0
    buffer_load_dword v40, v24, s[80:83], s27 offen offset:0
    buffer_load_dword v41, v25, s[80:83], s27 offen offset:0
    buffer_load_dword v42, v26, s[80:83], s27 offen offset:0
    buffer_load_dword v43, v27, s[80:83], s27 offen offset:0
    s_add_u32 s27, s27, 262144
    s_waitcnt vmcnt(40)
    v_perm_b32 v12, v45, v44, s92
    v_perm_b32 v13, v47, v46, s92
    v_perm_b32 v14, v49, v48, s92
    v_perm_b32 v15, v51, v50, s92
    v_accvgpr_write_b32 a8, v12
    v_accvgpr_write_b32 a9, v13
    v_accvgpr_write_b32 a10, v14
    v_accvgpr_write_b32 a11, v15
    v_perm_b32 v16, v45, v44, s93
    v_perm_b32 v17, v47, v46, s93
    v_perm_b32 v18, v49, v48, s93
    v_perm_b32 v19, v51, v50, s93
    ds_write_b128 v0, v[16:19] offset:20480
    buffer_load_dword v44, v20, s[80:83], s27 offen offset:0
    buffer_load_dword v45, v21, s[80:83], s27 offen offset:0
    buffer_load_dword v46, v22, s[80:83], s27 offen offset:0
    buffer_load_dword v47, v23, s[80:83], s27 offen offset:0
    buffer_load_dword v48, v24, s[80:83], s27 offen offset:0
    buffer_load_dword v49, v25, s[80:83], s27 offen offset:0
    buffer_load_dword v50, v26, s[80:83], s27 offen offset:0
    buffer_load_dword v51, v27, s[80:83], s27 offen offset:0
    s_add_u32 s27, s27, 262144
    s_waitcnt vmcnt(40)
    v_perm_b32 v12, v53, v52, s92
    v_perm_b32 v13, v55, v54, s92
    v_perm_b32 v14, v57, v56, s92
    v_perm_b32 v15, v59, v58, s92
    v_accvgpr_write_b32 a12, v12
    v_accvgpr_write_b32 a13, v13
    v_accvgpr_write_b32 a14, v14
    v_accvgpr_write_b32 a15, v15
    v_perm_b32 v16, v53, v52, s93
    v_perm_b32 v17, v55, v54, s93
    v_perm_b32 v18, v57, v56, s93
    v_perm_b32 v19, v59, v58, s93
    ds_write_b128 v0, v[16:19] offset:21504
    buffer_load_dword v52, v20, s[80:83], s27 offen offset:0
    buffer_load_dword v53, v21, s[80:83], s27 offen offset:0
    buffer_load_dword v54, v22, s[80:83], s27 offen offset:0
    buffer_load_dword v55, v23, s[80:83], s27 offen offset:0
    buffer_load_dword v56, v24, s[80:83], s27 offen offset:0
    buffer_load_dword v57, v25, s[80:83], s27 offen offset:0
    buffer_load_dword v58, v26, s[80:83], s27 offen offset:0
    buffer_load_dword v59, v27, s[80:83], s27 offen offset:0
    s_add_u32 s27, s27, 262144
    s_waitcnt vmcnt(40)
    v_perm_b32 v12, v61, v60, s92
    v_perm_b32 v13, v63, v62, s92
    v_perm_b32 v14, v65, v64, s92
    v_perm_b32 v15, v67, v66, s92
    buffer_store_dwordx4 v[12:15], v1, s[4:7], s53 offen offset:0
    v_perm_b32 v16, v61, v60, s93
    v_perm_b32 v17, v63, v62, s93
    v_perm_b32 v18, v65, v64, s93
    v_perm_b32 v19, v67, v66, s93
    buffer_store_dwordx4 v[16:19], v1, s[4:7], s54 offen offset:0
    buffer_load_dword v60, v20, s[80:83], s27 offen offset:0
    buffer_load_dword v61, v21, s[80:83], s27 offen offset:0
    buffer_load_dword v62, v22, s[80:83], s27 offen offset:0
    buffer_load_dword v63, v23, s[80:83], s27 offen offset:0
    buffer_load_dword v64, v24, s[80:83], s27 offen offset:0
    buffer_load_dword v65, v25, s[80:83], s27 offen offset:0
    buffer_load_dword v66, v26, s[80:83], s27 offen offset:0
    buffer_load_dword v67, v27, s[80:83], s27 offen offset:0
    s_add_u32 s27, s27, 262144
    s_waitcnt vmcnt(42)
    v_perm_b32 v12, v69, v68, s92
    v_perm_b32 v13, v71, v70, s92
    v_perm_b32 v14, v73, v72, s92
    v_perm_b32 v15, v75, v74, s92
    buffer_store_dwordx4 v[12:15], v1, s[4:7], s53 offen offset:1024
    v_perm_b32 v16, v69, v68, s93
    v_perm_b32 v17, v71, v70, s93
    v_perm_b32 v18, v73, v72, s93
    v_perm_b32 v19, v75, v74, s93
    buffer_store_dwordx4 v[16:19], v1, s[4:7], s54 offen offset:1024
    buffer_load_dword v68, v20, s[80:83], s27 offen offset:0
    buffer_load_dword v69, v21, s[80:83], s27 offen offset:0
    buffer_load_dword v70, v22, s[80:83], s27 offen offset:0
    buffer_load_dword v71, v23, s[80:83], s27 offen offset:0
    buffer_load_dword v72, v24, s[80:83], s27 offen offset:0
    buffer_load_dword v73, v25, s[80:83], s27 offen offset:0
    buffer_load_dword v74, v26, s[80:83], s27 offen offset:0
    buffer_load_dword v75, v27, s[80:83], s27 offen offset:0
    s_add_u32 s27, s27, 262144
    s_waitcnt vmcnt(44)
    v_perm_b32 v12, v29, v28, s92
    v_perm_b32 v13, v31, v30, s92
    v_perm_b32 v14, v33, v32, s92
    v_perm_b32 v15, v35, v34, s92
    v_accvgpr_write_b32 a16, v12
    v_accvgpr_write_b32 a17, v13
    v_accvgpr_write_b32 a18, v14
    v_accvgpr_write_b32 a19, v15
    v_perm_b32 v16, v29, v28, s93
    v_perm_b32 v17, v31, v30, s93
    v_perm_b32 v18, v33, v32, s93
    v_perm_b32 v19, v35, v34, s93
    v_accvgpr_write_b32 a24, v16
    v_accvgpr_write_b32 a25, v17
    v_accvgpr_write_b32 a26, v18
    v_accvgpr_write_b32 a27, v19
    buffer_load_dword v28, v20, s[80:83], s27 offen offset:0
    buffer_load_dword v29, v21, s[80:83], s27 offen offset:0
    buffer_load_dword v30, v22, s[80:83], s27 offen offset:0
    buffer_load_dword v31, v23, s[80:83], s27 offen offset:0
    buffer_load_dword v32, v24, s[80:83], s27 offen offset:0
    buffer_load_dword v33, v25, s[80:83], s27 offen offset:0
    buffer_load_dword v34, v26, s[80:83], s27 offen offset:0
    buffer_load_dword v35, v27, s[80:83], s27 offen offset:0
    s_add_u32 s27, s27, 262144
    s_waitcnt vmcnt(44)
    v_perm_b32 v12, v37, v36, s92
    v_perm_b32 v13, v39, v38, s92
    v_perm_b32 v14, v41, v40, s92
    v_perm_b32 v15, v43, v42, s92
    v_accvgpr_write_b32 a20, v12
    v_accvgpr_write_b32 a21, v13
    v_accvgpr_write_b32 a22, v14
    v_accvgpr_write_b32 a23, v15
    v_perm_b32 v16, v37, v36, s93
    v_perm_b32 v17, v39, v38, s93
    v_perm_b32 v18, v41, v40, s93
    v_perm_b32 v19, v43, v42, s93
    v_accvgpr_write_b32 a28, v16
    v_accvgpr_write_b32 a29, v17
    v_accvgpr_write_b32 a30, v18
    v_accvgpr_write_b32 a31, v19
    buffer_load_dword v36, v20, s[80:83], s27 offen offset:0
    buffer_load_dword v37, v21, s[80:83], s27 offen offset:0
    buffer_load_dword v38, v22, s[80:83], s27 offen offset:0
    buffer_load_dword v39, v23, s[80:83], s27 offen offset:0
    buffer_load_dword v40, v24, s[80:83], s27 offen offset:0
    buffer_load_dword v41, v25, s[80:83], s27 offen offset:0
    buffer_load_dword v42, v26, s[80:83], s27 offen offset:0
    buffer_load_dword v43, v27, s[80:83], s27 offen offset:0
    s_add_u32 s27, s27, 262144
    s_waitcnt vmcnt(44)
    v_perm_b32 v12, v45, v44, s92
    v_perm_b32 v13, v47, v46, s92
    v_perm_b32 v14, v49, v48, s92
    v_perm_b32 v15, v51, v50, s92
    v_accvgpr_write_b32 a32, v12
    v_accvgpr_write_b32 a33, v13
    v_accvgpr_write_b32 a34, v14
    v_accvgpr_write_b32 a35, v15
    v_perm_b32 v16, v45, v44, s93
    v_perm_b32 v17, v47, v46, s93
    v_perm_b32 v18, v49, v48, s93
    v_perm_b32 v19, v51, v50, s93
    v_accvgpr_write_b32 a40, v16
    v_accvgpr_write_b32 a41, v17
    v_accvgpr_write_b32 a42, v18
    v_accvgpr_write_b32 a43, v19
    buffer_load_dword v44, v20, s[80:83], s27 offen offset:0
    buffer_load_dword v45, v21, s[80:83], s27 offen offset:0
    buffer_load_dword v46, v22, s[80:83], s27 offen offset:0
    buffer_load_dword v47, v23, s[80:83], s27 offen offset:0
    buffer_load_dword v48, v24, s[80:83], s27 offen offset:0
    buffer_load_dword v49, v25, s[80:83], s27 offen offset:0
    buffer_load_dword v50, v26, s[80:83], s27 offen offset:0
    buffer_load_dword v51, v27, s[80:83], s27 offen offset:0
    s_add_u32 s27, s27, 262144
    s_waitcnt vmcnt(44)
    v_perm_b32 v12, v53, v52, s92
    v_perm_b32 v13, v55, v54, s92
    v_perm_b32 v14, v57, v56, s92
    v_perm_b32 v15, v59, v58, s92
    v_accvgpr_write_b32 a36, v12
    v_accvgpr_write_b32 a37, v13
    v_accvgpr_write_b32 a38, v14
    v_accvgpr_write_b32 a39, v15
    v_perm_b32 v16, v53, v52, s93
    v_perm_b32 v17, v55, v54, s93
    v_perm_b32 v18, v57, v56, s93
    v_perm_b32 v19, v59, v58, s93
    v_accvgpr_write_b32 a44, v16
    v_accvgpr_write_b32 a45, v17
    v_accvgpr_write_b32 a46, v18
    v_accvgpr_write_b32 a47, v19
    buffer_load_dword v52, v20, s[80:83], s27 offen offset:0
    buffer_load_dword v53, v21, s[80:83], s27 offen offset:0
    buffer_load_dword v54, v22, s[80:83], s27 offen offset:0
    buffer_load_dword v55, v23, s[80:83], s27 offen offset:0
    buffer_load_dword v56, v24, s[80:83], s27 offen offset:0
    buffer_load_dword v57, v25, s[80:83], s27 offen offset:0
    buffer_load_dword v58, v26, s[80:83], s27 offen offset:0
    buffer_load_dword v59, v27, s[80:83], s27 offen offset:0
    s_add_u32 s27, s27, 262144
    s_waitcnt vmcnt(42)
    v_perm_b32 v12, v61, v60, s92
    v_perm_b32 v13, v63, v62, s92
    v_perm_b32 v14, v65, v64, s92
    v_perm_b32 v15, v67, v66, s92
    v_accvgpr_write_b32 a48, v12
    v_accvgpr_write_b32 a49, v13
    v_accvgpr_write_b32 a50, v14
    v_accvgpr_write_b32 a51, v15
    v_perm_b32 v16, v61, v60, s93
    v_perm_b32 v17, v63, v62, s93
    v_perm_b32 v18, v65, v64, s93
    v_perm_b32 v19, v67, v66, s93
    v_accvgpr_write_b32 a56, v16
    v_accvgpr_write_b32 a57, v17
    v_accvgpr_write_b32 a58, v18
    v_accvgpr_write_b32 a59, v19
    buffer_load_dword v60, v20, s[80:83], s27 offen offset:0
    buffer_load_dword v61, v21, s[80:83], s27 offen offset:0
    buffer_load_dword v62, v22, s[80:83], s27 offen offset:0
    buffer_load_dword v63, v23, s[80:83], s27 offen offset:0
    buffer_load_dword v64, v24, s[80:83], s27 offen offset:0
    buffer_load_dword v65, v25, s[80:83], s27 offen offset:0
    buffer_load_dword v66, v26, s[80:83], s27 offen offset:0
    buffer_load_dword v67, v27, s[80:83], s27 offen offset:0
    s_add_u32 s27, s27, 262144
    s_waitcnt vmcnt(40)
    v_perm_b32 v12, v69, v68, s92
    v_perm_b32 v13, v71, v70, s92
    v_perm_b32 v14, v73, v72, s92
    v_perm_b32 v15, v75, v74, s92
    v_accvgpr_write_b32 a52, v12
    v_accvgpr_write_b32 a53, v13
    v_accvgpr_write_b32 a54, v14
    v_accvgpr_write_b32 a55, v15
    v_perm_b32 v16, v69, v68, s93
    v_perm_b32 v17, v71, v70, s93
    v_perm_b32 v18, v73, v72, s93
    v_perm_b32 v19, v75, v74, s93
    v_accvgpr_write_b32 a60, v16
    v_accvgpr_write_b32 a61, v17
    v_accvgpr_write_b32 a62, v18
    v_accvgpr_write_b32 a63, v19
    buffer_load_dword v68, v20, s[80:83], s27 offen offset:0
    buffer_load_dword v69, v21, s[80:83], s27 offen offset:0
    buffer_load_dword v70, v22, s[80:83], s27 offen offset:0
    buffer_load_dword v71, v23, s[80:83], s27 offen offset:0
    buffer_load_dword v72, v24, s[80:83], s27 offen offset:0
    buffer_load_dword v73, v25, s[80:83], s27 offen offset:0
    buffer_load_dword v74, v26, s[80:83], s27 offen offset:0
    buffer_load_dword v75, v27, s[80:83], s27 offen offset:0
    s_add_u32 s27, s27, 262144
    s_waitcnt vmcnt(40)
    v_perm_b32 v12, v29, v28, s92
    v_perm_b32 v13, v31, v30, s92
    v_perm_b32 v14, v33, v32, s92
    v_perm_b32 v15, v35, v34, s92
    v_accvgpr_write_b32 a64, v12
    v_accvgpr_write_b32 a65, v13
    v_accvgpr_write_b32 a66, v14
    v_accvgpr_write_b32 a67, v15
    v_perm_b32 v16, v29, v28, s93
    v_perm_b32 v17, v31, v30, s93
    v_perm_b32 v18, v33, v32, s93
    v_perm_b32 v19, v35, v34, s93
    v_accvgpr_write_b32 a72, v16
    v_accvgpr_write_b32 a73, v17
    v_accvgpr_write_b32 a74, v18
    v_accvgpr_write_b32 a75, v19
    buffer_load_dword v28, v20, s[80:83], s27 offen offset:0
    buffer_load_dword v29, v21, s[80:83], s27 offen offset:0
    buffer_load_dword v30, v22, s[80:83], s27 offen offset:0
    buffer_load_dword v31, v23, s[80:83], s27 offen offset:0
    buffer_load_dword v32, v24, s[80:83], s27 offen offset:0
    buffer_load_dword v33, v25, s[80:83], s27 offen offset:0
    buffer_load_dword v34, v26, s[80:83], s27 offen offset:0
    buffer_load_dword v35, v27, s[80:83], s27 offen offset:0
    s_add_u32 s27, s27, 262144
    s_waitcnt vmcnt(40)
    v_perm_b32 v12, v37, v36, s92
    v_perm_b32 v13, v39, v38, s92
    v_perm_b32 v14, v41, v40, s92
    v_perm_b32 v15, v43, v42, s92
    v_accvgpr_write_b32 a68, v12
    v_accvgpr_write_b32 a69, v13
    v_accvgpr_write_b32 a70, v14
    v_accvgpr_write_b32 a71, v15
    v_perm_b32 v16, v37, v36, s93
    v_perm_b32 v17, v39, v38, s93
    v_perm_b32 v18, v41, v40, s93
    v_perm_b32 v19, v43, v42, s93
    v_accvgpr_write_b32 a76, v16
    v_accvgpr_write_b32 a77, v17
    v_accvgpr_write_b32 a78, v18
    v_accvgpr_write_b32 a79, v19
    buffer_load_dword v36, v20, s[80:83], s27 offen offset:0
    buffer_load_dword v37, v21, s[80:83], s27 offen offset:0
    buffer_load_dword v38, v22, s[80:83], s27 offen offset:0
    buffer_load_dword v39, v23, s[80:83], s27 offen offset:0
    buffer_load_dword v40, v24, s[80:83], s27 offen offset:0
    buffer_load_dword v41, v25, s[80:83], s27 offen offset:0
    buffer_load_dword v42, v26, s[80:83], s27 offen offset:0
    buffer_load_dword v43, v27, s[80:83], s27 offen offset:0
    s_add_u32 s27, s27, 262144
    s_waitcnt vmcnt(40)
    v_perm_b32 v12, v45, v44, s92
    v_perm_b32 v13, v47, v46, s92
    v_perm_b32 v14, v49, v48, s92
    v_perm_b32 v15, v51, v50, s92
    v_accvgpr_write_b32 a80, v12
    v_accvgpr_write_b32 a81, v13
    v_accvgpr_write_b32 a82, v14
    v_accvgpr_write_b32 a83, v15
    v_perm_b32 v16, v45, v44, s93
    v_perm_b32 v17, v47, v46, s93
    v_perm_b32 v18, v49, v48, s93
    v_perm_b32 v19, v51, v50, s93
    v_accvgpr_write_b32 a88, v16
    v_accvgpr_write_b32 a89, v17
    v_accvgpr_write_b32 a90, v18
    v_accvgpr_write_b32 a91, v19
    buffer_load_dword v44, v20, s[80:83], s27 offen offset:0
    buffer_load_dword v45, v21, s[80:83], s27 offen offset:0
    buffer_load_dword v46, v22, s[80:83], s27 offen offset:0
    buffer_load_dword v47, v23, s[80:83], s27 offen offset:0
    buffer_load_dword v48, v24, s[80:83], s27 offen offset:0
    buffer_load_dword v49, v25, s[80:83], s27 offen offset:0
    buffer_load_dword v50, v26, s[80:83], s27 offen offset:0
    buffer_load_dword v51, v27, s[80:83], s27 offen offset:0
    s_add_u32 s27, s27, 262144
    s_waitcnt vmcnt(40)
    v_perm_b32 v12, v53, v52, s92
    v_perm_b32 v13, v55, v54, s92
    v_perm_b32 v14, v57, v56, s92
    v_perm_b32 v15, v59, v58, s92
    v_accvgpr_write_b32 a84, v12
    v_accvgpr_write_b32 a85, v13
    v_accvgpr_write_b32 a86, v14
    v_accvgpr_write_b32 a87, v15
    v_perm_b32 v16, v53, v52, s93
    v_perm_b32 v17, v55, v54, s93
    v_perm_b32 v18, v57, v56, s93
    v_perm_b32 v19, v59, v58, s93
    v_accvgpr_write_b32 a92, v16
    v_accvgpr_write_b32 a93, v17
    v_accvgpr_write_b32 a94, v18
    v_accvgpr_write_b32 a95, v19
    buffer_load_dword v52, v20, s[80:83], s27 offen offset:0
    buffer_load_dword v53, v21, s[80:83], s27 offen offset:0
    buffer_load_dword v54, v22, s[80:83], s27 offen offset:0
    buffer_load_dword v55, v23, s[80:83], s27 offen offset:0
    buffer_load_dword v56, v24, s[80:83], s27 offen offset:0
    buffer_load_dword v57, v25, s[80:83], s27 offen offset:0
    buffer_load_dword v58, v26, s[80:83], s27 offen offset:0
    buffer_load_dword v59, v27, s[80:83], s27 offen offset:0
    s_add_u32 s27, s27, 262144
    s_waitcnt vmcnt(40)
    v_perm_b32 v12, v61, v60, s92
    v_perm_b32 v13, v63, v62, s92
    v_perm_b32 v14, v65, v64, s92
    v_perm_b32 v15, v67, v66, s92
    v_accvgpr_write_b32 a96, v12
    v_accvgpr_write_b32 a97, v13
    v_accvgpr_write_b32 a98, v14
    v_accvgpr_write_b32 a99, v15
    v_perm_b32 v16, v61, v60, s93
    v_perm_b32 v17, v63, v62, s93
    v_perm_b32 v18, v65, v64, s93
    v_perm_b32 v19, v67, v66, s93
    v_accvgpr_write_b32 a104, v16
    v_accvgpr_write_b32 a105, v17
    v_accvgpr_write_b32 a106, v18
    v_accvgpr_write_b32 a107, v19
    buffer_load_dword v60, v20, s[80:83], s27 offen offset:0
    buffer_load_dword v61, v21, s[80:83], s27 offen offset:0
    buffer_load_dword v62, v22, s[80:83], s27 offen offset:0
    buffer_load_dword v63, v23, s[80:83], s27 offen offset:0
    buffer_load_dword v64, v24, s[80:83], s27 offen offset:0
    buffer_load_dword v65, v25, s[80:83], s27 offen offset:0
    buffer_load_dword v66, v26, s[80:83], s27 offen offset:0
    buffer_load_dword v67, v27, s[80:83], s27 offen offset:0
    s_add_u32 s27, s27, 262144
    s_waitcnt vmcnt(40)
    v_perm_b32 v12, v69, v68, s92
    v_perm_b32 v13, v71, v70, s92
    v_perm_b32 v14, v73, v72, s92
    v_perm_b32 v15, v75, v74, s92
    v_accvgpr_write_b32 a100, v12
    v_accvgpr_write_b32 a101, v13
    v_accvgpr_write_b32 a102, v14
    v_accvgpr_write_b32 a103, v15
    v_perm_b32 v16, v69, v68, s93
    v_perm_b32 v17, v71, v70, s93
    v_perm_b32 v18, v73, v72, s93
    v_perm_b32 v19, v75, v74, s93
    v_accvgpr_write_b32 a108, v16
    v_accvgpr_write_b32 a109, v17
    v_accvgpr_write_b32 a110, v18
    v_accvgpr_write_b32 a111, v19
    buffer_load_dword v68, v20, s[80:83], s27 offen offset:0
    buffer_load_dword v69, v21, s[80:83], s27 offen offset:0
    buffer_load_dword v70, v22, s[80:83], s27 offen offset:0
    buffer_load_dword v71, v23, s[80:83], s27 offen offset:0
    buffer_load_dword v72, v24, s[80:83], s27 offen offset:0
    buffer_load_dword v73, v25, s[80:83], s27 offen offset:0
    buffer_load_dword v74, v26, s[80:83], s27 offen offset:0
    buffer_load_dword v75, v27, s[80:83], s27 offen offset:0
    s_add_u32 s27, s27, 262144
    s_waitcnt vmcnt(40)
    v_perm_b32 v12, v29, v28, s92
    v_perm_b32 v13, v31, v30, s92
    v_perm_b32 v14, v33, v32, s92
    v_perm_b32 v15, v35, v34, s92
    v_accvgpr_write_b32 a112, v12
    v_accvgpr_write_b32 a113, v13
    v_accvgpr_write_b32 a114, v14
    v_accvgpr_write_b32 a115, v15
    v_perm_b32 v16, v29, v28, s93
    v_perm_b32 v17, v31, v30, s93
    v_perm_b32 v18, v33, v32, s93
    v_perm_b32 v19, v35, v34, s93
    v_accvgpr_write_b32 a120, v16
    v_accvgpr_write_b32 a121, v17
    v_accvgpr_write_b32 a122, v18
    v_accvgpr_write_b32 a123, v19
    buffer_load_dword v28, v10, s[84:87], s95 offen offset:0
    buffer_load_dword v29, v10, s[84:87], s95 offen offset:1280
    buffer_load_dword v30, v10, s[84:87], s95 offen offset:2560
    buffer_load_dword v31, v10, s[84:87], s95 offen offset:3840
    buffer_load_dword v32, v76, s[84:87], s95 offen offset:0
    buffer_load_dword v33, v76, s[84:87], s95 offen offset:1280
    buffer_load_dword v34, v76, s[84:87], s95 offen offset:2560
    buffer_load_dword v35, v76, s[84:87], s95 offen offset:3840
    s_add_u32 s95, s95, 64
    s_waitcnt vmcnt(40)
    v_perm_b32 v12, v37, v36, s92
    v_perm_b32 v13, v39, v38, s92
    v_perm_b32 v14, v41, v40, s92
    v_perm_b32 v15, v43, v42, s92
    v_accvgpr_write_b32 a116, v12
    v_accvgpr_write_b32 a117, v13
    v_accvgpr_write_b32 a118, v14
    v_accvgpr_write_b32 a119, v15
    v_perm_b32 v16, v37, v36, s93
    v_perm_b32 v17, v39, v38, s93
    v_perm_b32 v18, v41, v40, s93
    v_perm_b32 v19, v43, v42, s93
    v_accvgpr_write_b32 a124, v16
    v_accvgpr_write_b32 a125, v17
    v_accvgpr_write_b32 a126, v18
    v_accvgpr_write_b32 a127, v19
    buffer_load_dword v36, v10, s[84:87], s95 offen offset:0
    buffer_load_dword v37, v10, s[84:87], s95 offen offset:1280
    buffer_load_dword v38, v10, s[84:87], s95 offen offset:2560
    buffer_load_dword v39, v10, s[84:87], s95 offen offset:3840
    buffer_load_dword v40, v76, s[84:87], s95 offen offset:0
    buffer_load_dword v41, v76, s[84:87], s95 offen offset:1280
    buffer_load_dword v42, v76, s[84:87], s95 offen offset:2560
    buffer_load_dword v43, v76, s[84:87], s95 offen offset:3840
    s_add_u32 s95, s95, 64
    s_waitcnt vmcnt(40)
    v_perm_b32 v12, v45, v44, s92
    v_perm_b32 v13, v47, v46, s92
    v_perm_b32 v14, v49, v48, s92
    v_perm_b32 v15, v51, v50, s92
    v_accvgpr_write_b32 a128, v12
    v_accvgpr_write_b32 a129, v13
    v_accvgpr_write_b32 a130, v14
    v_accvgpr_write_b32 a131, v15
    v_perm_b32 v16, v45, v44, s93
    v_perm_b32 v17, v47, v46, s93
    v_perm_b32 v18, v49, v48, s93
    v_perm_b32 v19, v51, v50, s93
    v_accvgpr_write_b32 a136, v16
    v_accvgpr_write_b32 a137, v17
    v_accvgpr_write_b32 a138, v18
    v_accvgpr_write_b32 a139, v19
    buffer_load_dword v44, v10, s[84:87], s95 offen offset:0
    buffer_load_dword v45, v10, s[84:87], s95 offen offset:1280
    buffer_load_dword v46, v10, s[84:87], s95 offen offset:2560
    buffer_load_dword v47, v10, s[84:87], s95 offen offset:3840
    buffer_load_dword v48, v76, s[84:87], s95 offen offset:0
    buffer_load_dword v49, v76, s[84:87], s95 offen offset:1280
    buffer_load_dword v50, v76, s[84:87], s95 offen offset:2560
    buffer_load_dword v51, v76, s[84:87], s95 offen offset:3840
    s_add_u32 s95, s95, 64
    s_waitcnt vmcnt(40)
    v_perm_b32 v12, v53, v52, s92
    v_perm_b32 v13, v55, v54, s92
    v_perm_b32 v14, v57, v56, s92
    v_perm_b32 v15, v59, v58, s92
    v_accvgpr_write_b32 a132, v12
    v_accvgpr_write_b32 a133, v13
    v_accvgpr_write_b32 a134, v14
    v_accvgpr_write_b32 a135, v15
    v_perm_b32 v16, v53, v52, s93
    v_perm_b32 v17, v55, v54, s93
    v_perm_b32 v18, v57, v56, s93
    v_perm_b32 v19, v59, v58, s93
    v_accvgpr_write_b32 a140, v16
    v_accvgpr_write_b32 a141, v17
    v_accvgpr_write_b32 a142, v18
    v_accvgpr_write_b32 a143, v19
    buffer_load_dword v52, v10, s[84:87], s95 offen offset:0
    buffer_load_dword v53, v10, s[84:87], s95 offen offset:1280
    buffer_load_dword v54, v10, s[84:87], s95 offen offset:2560
    buffer_load_dword v55, v10, s[84:87], s95 offen offset:3840
    buffer_load_dword v56, v76, s[84:87], s95 offen offset:0
    buffer_load_dword v57, v76, s[84:87], s95 offen offset:1280
    buffer_load_dword v58, v76, s[84:87], s95 offen offset:2560
    buffer_load_dword v59, v76, s[84:87], s95 offen offset:3840
    s_add_u32 s95, s95, 64
    s_waitcnt vmcnt(40)
    v_perm_b32 v12, v61, v60, s92
    v_perm_b32 v13, v63, v62, s92
    v_perm_b32 v14, v65, v64, s92
    v_perm_b32 v15, v67, v66, s92
    v_accvgpr_write_b32 a144, v12
    v_accvgpr_write_b32 a145, v13
    v_accvgpr_write_b32 a146, v14
    v_accvgpr_write_b32 a147, v15
    v_perm_b32 v16, v61, v60, s93
    v_perm_b32 v17, v63, v62, s93
    v_perm_b32 v18, v65, v64, s93
    v_perm_b32 v19, v67, v66, s93
    v_accvgpr_write_b32 a152, v16
    v_accvgpr_write_b32 a153, v17
    v_accvgpr_write_b32 a154, v18
    v_accvgpr_write_b32 a155, v19
    buffer_load_dword v60, v10, s[84:87], s95 offen offset:0
    buffer_load_dword v61, v10, s[84:87], s95 offen offset:1280
    buffer_load_dword v62, v10, s[84:87], s95 offen offset:2560
    buffer_load_dword v63, v10, s[84:87], s95 offen offset:3840
    buffer_load_dword v64, v76, s[84:87], s95 offen offset:0
    buffer_load_dword v65, v76, s[84:87], s95 offen offset:1280
    buffer_load_dword v66, v76, s[84:87], s95 offen offset:2560
    buffer_load_dword v67, v76, s[84:87], s95 offen offset:3840
    s_add_u32 s95, s95, 40704
    s_waitcnt vmcnt(40)
    v_perm_b32 v12, v69, v68, s92
    v_perm_b32 v13, v71, v70, s92
    v_perm_b32 v14, v73, v72, s92
    v_perm_b32 v15, v75, v74, s92
    v_accvgpr_write_b32 a148, v12
    v_accvgpr_write_b32 a149, v13
    v_accvgpr_write_b32 a150, v14
    v_accvgpr_write_b32 a151, v15
    v_perm_b32 v16, v69, v68, s93
    v_perm_b32 v17, v71, v70, s93
    v_perm_b32 v18, v73, v72, s93
    v_perm_b32 v19, v75, v74, s93
    v_accvgpr_write_b32 a156, v16
    v_accvgpr_write_b32 a157, v17
    v_accvgpr_write_b32 a158, v18
    v_accvgpr_write_b32 a159, v19
    buffer_load_dword v68, v10, s[84:87], s95 offen offset:0
    buffer_load_dword v69, v10, s[84:87], s95 offen offset:1280
    buffer_load_dword v70, v10, s[84:87], s95 offen offset:2560
    buffer_load_dword v71, v10, s[84:87], s95 offen offset:3840
    buffer_load_dword v72, v76, s[84:87], s95 offen offset:0
    buffer_load_dword v73, v76, s[84:87], s95 offen offset:1280
    buffer_load_dword v74, v76, s[84:87], s95 offen offset:2560
    buffer_load_dword v75, v76, s[84:87], s95 offen offset:3840
    s_add_u32 s95, s95, 64
    s_waitcnt vmcnt(40)
    v_perm_b32 v12, v29, v28, s92
    v_perm_b32 v13, v31, v30, s92
    v_perm_b32 v14, v33, v32, s92
    v_perm_b32 v15, v35, v34, s92
    buffer_store_dwordx4 v[12:15], v1, s[4:7], s55 offen offset:0
    v_perm_b32 v16, v29, v28, s93
    v_perm_b32 v17, v31, v30, s93
    v_perm_b32 v18, v33, v32, s93
    v_perm_b32 v19, v35, v34, s93
    buffer_store_dwordx4 v[16:19], v1, s[4:7], s56 offen offset:0
    buffer_load_dword v28, v10, s[84:87], s95 offen offset:0
    buffer_load_dword v29, v10, s[84:87], s95 offen offset:1280
    buffer_load_dword v30, v10, s[84:87], s95 offen offset:2560
    buffer_load_dword v31, v10, s[84:87], s95 offen offset:3840
    buffer_load_dword v32, v76, s[84:87], s95 offen offset:0
    buffer_load_dword v33, v76, s[84:87], s95 offen offset:1280
    buffer_load_dword v34, v76, s[84:87], s95 offen offset:2560
    buffer_load_dword v35, v76, s[84:87], s95 offen offset:3840
    s_add_u32 s95, s95, 64
    s_waitcnt vmcnt(42)
    v_perm_b32 v12, v37, v36, s92
    v_perm_b32 v13, v39, v38, s92
    v_perm_b32 v14, v41, v40, s92
    v_perm_b32 v15, v43, v42, s92
    v_accvgpr_write_b32 a168, v12
    v_accvgpr_write_b32 a169, v13
    v_accvgpr_write_b32 a170, v14
    v_accvgpr_write_b32 a171, v15
    v_perm_b32 v16, v37, v36, s93
    v_perm_b32 v17, v39, v38, s93
    v_perm_b32 v18, v41, v40, s93
    v_perm_b32 v19, v43, v42, s93
    v_accvgpr_write_b32 a176, v16
    v_accvgpr_write_b32 a177, v17
    v_accvgpr_write_b32 a178, v18
    v_accvgpr_write_b32 a179, v19
    buffer_load_dword v36, v10, s[84:87], s95 offen offset:0
    buffer_load_dword v37, v10, s[84:87], s95 offen offset:1280
    buffer_load_dword v38, v10, s[84:87], s95 offen offset:2560
    buffer_load_dword v39, v10, s[84:87], s95 offen offset:3840
    buffer_load_dword v40, v76, s[84:87], s95 offen offset:0
    buffer_load_dword v41, v76, s[84:87], s95 offen offset:1280
    buffer_load_dword v42, v76, s[84:87], s95 offen offset:2560
    buffer_load_dword v43, v76, s[84:87], s95 offen offset:3840
    s_add_u32 s95, s95, 64
    s_waitcnt vmcnt(42)
    v_perm_b32 v12, v45, v44, s92
    v_perm_b32 v13, v47, v46, s92
    v_perm_b32 v14, v49, v48, s92
    v_perm_b32 v15, v51, v50, s92
    v_accvgpr_write_b32 a192, v12
    v_accvgpr_write_b32 a193, v13
    v_accvgpr_write_b32 a194, v14
    v_accvgpr_write_b32 a195, v15
    v_perm_b32 v16, v45, v44, s93
    v_perm_b32 v17, v47, v46, s93
    v_perm_b32 v18, v49, v48, s93
    v_perm_b32 v19, v51, v50, s93
    ds_write_b128 v0, v[16:19] offset:26624
    buffer_load_dword v44, v10, s[84:87], s95 offen offset:0
    buffer_load_dword v45, v10, s[84:87], s95 offen offset:1280
    buffer_load_dword v46, v10, s[84:87], s95 offen offset:2560
    buffer_load_dword v47, v10, s[84:87], s95 offen offset:3840
    buffer_load_dword v48, v76, s[84:87], s95 offen offset:0
    buffer_load_dword v49, v76, s[84:87], s95 offen offset:1280
    buffer_load_dword v50, v76, s[84:87], s95 offen offset:2560
    buffer_load_dword v51, v76, s[84:87], s95 offen offset:3840
    s_add_u32 s95, s95, 64
    s_waitcnt vmcnt(42)
    v_perm_b32 v12, v53, v52, s92
    v_perm_b32 v13, v55, v54, s92
    v_perm_b32 v14, v57, v56, s92
    v_perm_b32 v15, v59, v58, s92
    ds_write_b128 v0, v[12:15] offset:28672
    v_perm_b32 v16, v53, v52, s93
    v_perm_b32 v17, v55, v54, s93
    v_perm_b32 v18, v57, v56, s93
    v_perm_b32 v19, v59, v58, s93
    v_accvgpr_write_b32 a216, v16
    v_accvgpr_write_b32 a217, v17
    v_accvgpr_write_b32 a218, v18
    v_accvgpr_write_b32 a219, v19
    buffer_load_dword v52, v10, s[84:87], s95 offen offset:0
    buffer_load_dword v53, v10, s[84:87], s95 offen offset:1280
    buffer_load_dword v54, v10, s[84:87], s95 offen offset:2560
    buffer_load_dword v55, v10, s[84:87], s95 offen offset:3840
    buffer_load_dword v56, v76, s[84:87], s95 offen offset:0
    buffer_load_dword v57, v76, s[84:87], s95 offen offset:1280
    buffer_load_dword v58, v76, s[84:87], s95 offen offset:2560
    buffer_load_dword v59, v76, s[84:87], s95 offen offset:3840
    s_add_u32 s95, s95, 40704
    s_waitcnt vmcnt(42)
    v_perm_b32 v12, v61, v60, s92
    v_perm_b32 v13, v63, v62, s92
    v_perm_b32 v14, v65, v64, s92
    v_perm_b32 v15, v67, v66, s92
    v_accvgpr_write_b32 a232, v12
    v_accvgpr_write_b32 a233, v13
    v_accvgpr_write_b32 a234, v14
    v_accvgpr_write_b32 a235, v15
    v_perm_b32 v16, v61, v60, s93
    v_perm_b32 v17, v63, v62, s93
    v_perm_b32 v18, v65, v64, s93
    v_perm_b32 v19, v67, v66, s93
    v_accvgpr_write_b32 a240, v16
    v_accvgpr_write_b32 a241, v17
    v_accvgpr_write_b32 a242, v18
    v_accvgpr_write_b32 a243, v19
    buffer_load_dword v60, v10, s[84:87], s95 offen offset:0
    buffer_load_dword v61, v10, s[84:87], s95 offen offset:1280
    buffer_load_dword v62, v10, s[84:87], s95 offen offset:2560
    buffer_load_dword v63, v10, s[84:87], s95 offen offset:3840
    buffer_load_dword v64, v76, s[84:87], s95 offen offset:0
    buffer_load_dword v65, v76, s[84:87], s95 offen offset:1280
    buffer_load_dword v66, v76, s[84:87], s95 offen offset:2560
    buffer_load_dword v67, v76, s[84:87], s95 offen offset:3840
    s_add_u32 s95, s95, 64
    s_waitcnt vmcnt(42)
    v_perm_b32 v12, v69, v68, s92
    v_perm_b32 v13, v71, v70, s92
    v_perm_b32 v14, v73, v72, s92
    v_perm_b32 v15, v75, v74, s92
    buffer_store_dwordx4 v[12:15], v1, s[4:7], s55 offen offset:1024
    v_perm_b32 v16, v69, v68, s93
    v_perm_b32 v17, v71, v70, s93
    v_perm_b32 v18, v73, v72, s93
    v_perm_b32 v19, v75, v74, s93
    buffer_store_dwordx4 v[16:19], v1, s[4:7], s56 offen offset:1024
    buffer_load_dword v68, v10, s[84:87], s95 offen offset:0
    buffer_load_dword v69, v10, s[84:87], s95 offen offset:1280
    buffer_load_dword v70, v10, s[84:87], s95 offen offset:2560
    buffer_load_dword v71, v10, s[84:87], s95 offen offset:3840
    buffer_load_dword v72, v76, s[84:87], s95 offen offset:0
    buffer_load_dword v73, v76, s[84:87], s95 offen offset:1280
    buffer_load_dword v74, v76, s[84:87], s95 offen offset:2560
    buffer_load_dword v75, v76, s[84:87], s95 offen offset:3840
    s_add_u32 s95, s95, 64
    s_waitcnt vmcnt(42)
    v_perm_b32 v12, v29, v28, s92
    v_perm_b32 v13, v31, v30, s92
    v_perm_b32 v14, v33, v32, s92
    v_perm_b32 v15, v35, v34, s92
    v_accvgpr_write_b32 a172, v12
    v_accvgpr_write_b32 a173, v13
    v_accvgpr_write_b32 a174, v14
    v_accvgpr_write_b32 a175, v15
    v_perm_b32 v16, v29, v28, s93
    v_perm_b32 v17, v31, v30, s93
    v_perm_b32 v18, v33, v32, s93
    v_perm_b32 v19, v35, v34, s93
    v_accvgpr_write_b32 a180, v16
    v_accvgpr_write_b32 a181, v17
    v_accvgpr_write_b32 a182, v18
    v_accvgpr_write_b32 a183, v19
    buffer_load_dword v28, v10, s[84:87], s95 offen offset:0
    buffer_load_dword v29, v10, s[84:87], s95 offen offset:1280
    buffer_load_dword v30, v10, s[84:87], s95 offen offset:2560
    buffer_load_dword v31, v10, s[84:87], s95 offen offset:3840
    buffer_load_dword v32, v76, s[84:87], s95 offen offset:0
    buffer_load_dword v33, v76, s[84:87], s95 offen offset:1280
    buffer_load_dword v34, v76, s[84:87], s95 offen offset:2560
    buffer_load_dword v35, v76, s[84:87], s95 offen offset:3840
    s_add_u32 s95, s95, 64
    s_waitcnt vmcnt(42)
    v_perm_b32 v12, v37, v36, s92
    v_perm_b32 v13, v39, v38, s92
    v_perm_b32 v14, v41, v40, s92
    v_perm_b32 v15, v43, v42, s92
    v_accvgpr_write_b32 a196, v12
    v_accvgpr_write_b32 a197, v13
    v_accvgpr_write_b32 a198, v14
    v_accvgpr_write_b32 a199, v15
    v_perm_b32 v16, v37, v36, s93
    v_perm_b32 v17, v39, v38, s93
    v_perm_b32 v18, v41, v40, s93
    v_perm_b32 v19, v43, v42, s93
    ds_write_b128 v0, v[16:19] offset:27648
    buffer_load_dword v36, v10, s[84:87], s95 offen offset:0
    buffer_load_dword v37, v10, s[84:87], s95 offen offset:1280
    buffer_load_dword v38, v10, s[84:87], s95 offen offset:2560
    buffer_load_dword v39, v10, s[84:87], s95 offen offset:3840
    buffer_load_dword v40, v76, s[84:87], s95 offen offset:0
    buffer_load_dword v41, v76, s[84:87], s95 offen offset:1280
    buffer_load_dword v42, v76, s[84:87], s95 offen offset:2560
    buffer_load_dword v43, v76, s[84:87], s95 offen offset:3840
    s_add_u32 s95, s95, 64
    s_waitcnt vmcnt(42)
    v_perm_b32 v12, v45, v44, s92
    v_perm_b32 v13, v47, v46, s92
    v_perm_b32 v14, v49, v48, s92
    v_perm_b32 v15, v51, v50, s92
    ds_write_b128 v0, v[12:15] offset:29696
    v_perm_b32 v16, v45, v44, s93
    v_perm_b32 v17, v47, v46, s93
    v_perm_b32 v18, v49, v48, s93
    v_perm_b32 v19, v51, v50, s93
    v_accvgpr_write_b32 a220, v16
    v_accvgpr_write_b32 a221, v17
    v_accvgpr_write_b32 a222, v18
    v_accvgpr_write_b32 a223, v19
    buffer_load_dword v44, v10, s[84:87], s95 offen offset:0
    buffer_load_dword v45, v10, s[84:87], s95 offen offset:1280
    buffer_load_dword v46, v10, s[84:87], s95 offen offset:2560
    buffer_load_dword v47, v10, s[84:87], s95 offen offset:3840
    buffer_load_dword v48, v76, s[84:87], s95 offen offset:0
    buffer_load_dword v49, v76, s[84:87], s95 offen offset:1280
    buffer_load_dword v50, v76, s[84:87], s95 offen offset:2560
    buffer_load_dword v51, v76, s[84:87], s95 offen offset:3840
    s_add_u32 s95, s95, 40704
    s_waitcnt vmcnt(42)
    v_perm_b32 v12, v53, v52, s92
    v_perm_b32 v13, v55, v54, s92
    v_perm_b32 v14, v57, v56, s92
    v_perm_b32 v15, v59, v58, s92
    v_accvgpr_write_b32 a236, v12
    v_accvgpr_write_b32 a237, v13
    v_accvgpr_write_b32 a238, v14
    v_accvgpr_write_b32 a239, v15
    v_perm_b32 v16, v53, v52, s93
    v_perm_b32 v17, v55, v54, s93
    v_perm_b32 v18, v57, v56, s93
    v_perm_b32 v19, v59, v58, s93
    v_accvgpr_write_b32 a244, v16
    v_accvgpr_write_b32 a245, v17
    v_accvgpr_write_b32 a246, v18
    v_accvgpr_write_b32 a247, v19
    buffer_load_dword v52, v10, s[84:87], s95 offen offset:0
    buffer_load_dword v53, v10, s[84:87], s95 offen offset:1280
    buffer_load_dword v54, v10, s[84:87], s95 offen offset:2560
    buffer_load_dword v55, v10, s[84:87], s95 offen offset:3840
    buffer_load_dword v56, v76, s[84:87], s95 offen offset:0
    buffer_load_dword v57, v76, s[84:87], s95 offen offset:1280
    buffer_load_dword v58, v76, s[84:87], s95 offen offset:2560
    buffer_load_dword v59, v76, s[84:87], s95 offen offset:3840
    s_add_u32 s95, s95, 64
    s_waitcnt vmcnt(42)
    v_perm_b32 v12, v61, v60, s92
    v_perm_b32 v13, v63, v62, s92
    v_perm_b32 v14, v65, v64, s92
    v_perm_b32 v15, v67, v66, s92
    v_accvgpr_write_b32 a160, v12
    v_accvgpr_write_b32 a161, v13
    v_accvgpr_write_b32 a162, v14
    v_accvgpr_write_b32 a163, v15
    v_perm_b32 v16, v61, v60, s93
    v_perm_b32 v17, v63, v62, s93
    v_perm_b32 v18, v65, v64, s93
    v_perm_b32 v19, v67, v66, s93
    ds_write_b128 v0, v[16:19] offset:22528
    buffer_load_dword v60, v10, s[84:87], s95 offen offset:0
    buffer_load_dword v61, v10, s[84:87], s95 offen offset:1280
    buffer_load_dword v62, v10, s[84:87], s95 offen offset:2560
    buffer_load_dword v63, v10, s[84:87], s95 offen offset:3840
    buffer_load_dword v64, v76, s[84:87], s95 offen offset:0
    buffer_load_dword v65, v76, s[84:87], s95 offen offset:1280
    buffer_load_dword v66, v76, s[84:87], s95 offen offset:2560
    buffer_load_dword v67, v76, s[84:87], s95 offen offset:3840
    s_add_u32 s95, s95, 64
    s_waitcnt vmcnt(40)
    v_perm_b32 v12, v69, v68, s92
    v_perm_b32 v13, v71, v70, s92
    v_perm_b32 v14, v73, v72, s92
    v_perm_b32 v15, v75, v74, s92
    ds_write_b128 v0, v[12:15] offset:24576
    v_perm_b32 v16, v69, v68, s93
    v_perm_b32 v17, v71, v70, s93
    v_perm_b32 v18, v73, v72, s93
    v_perm_b32 v19, v75, v74, s93
    v_accvgpr_write_b32 a184, v16
    v_accvgpr_write_b32 a185, v17
    v_accvgpr_write_b32 a186, v18
    v_accvgpr_write_b32 a187, v19
    buffer_load_dword v68, v10, s[84:87], s95 offen offset:0
    buffer_load_dword v69, v10, s[84:87], s95 offen offset:1280
    buffer_load_dword v70, v10, s[84:87], s95 offen offset:2560
    buffer_load_dword v71, v10, s[84:87], s95 offen offset:3840
    buffer_load_dword v72, v76, s[84:87], s95 offen offset:0
    buffer_load_dword v73, v76, s[84:87], s95 offen offset:1280
    buffer_load_dword v74, v76, s[84:87], s95 offen offset:2560
    buffer_load_dword v75, v76, s[84:87], s95 offen offset:3840
    s_add_u32 s95, s95, 64
    s_waitcnt vmcnt(40)
    v_perm_b32 v12, v29, v28, s92
    v_perm_b32 v13, v31, v30, s92
    v_perm_b32 v14, v33, v32, s92
    v_perm_b32 v15, v35, v34, s92
    v_accvgpr_write_b32 a200, v12
    v_accvgpr_write_b32 a201, v13
    v_accvgpr_write_b32 a202, v14
    v_accvgpr_write_b32 a203, v15
    v_perm_b32 v16, v29, v28, s93
    v_perm_b32 v17, v31, v30, s93
    v_perm_b32 v18, v33, v32, s93
    v_perm_b32 v19, v35, v34, s93
    v_accvgpr_write_b32 a208, v16
    v_accvgpr_write_b32 a209, v17
    v_accvgpr_write_b32 a210, v18
    v_accvgpr_write_b32 a211, v19
    buffer_load_dword v28, v10, s[84:87], s95 offen offset:0
    buffer_load_dword v29, v10, s[84:87], s95 offen offset:1280
    buffer_load_dword v30, v10, s[84:87], s95 offen offset:2560
    buffer_load_dword v31, v10, s[84:87], s95 offen offset:3840
    buffer_load_dword v32, v76, s[84:87], s95 offen offset:0
    buffer_load_dword v33, v76, s[84:87], s95 offen offset:1280
    buffer_load_dword v34, v76, s[84:87], s95 offen offset:2560
    buffer_load_dword v35, v76, s[84:87], s95 offen offset:3840
    s_add_u32 s95, s95, 64
    s_waitcnt vmcnt(40)
    v_perm_b32 v12, v37, v36, s92
    v_perm_b32 v13, v39, v38, s92
    v_perm_b32 v14, v41, v40, s92
    v_perm_b32 v15, v43, v42, s92
    v_accvgpr_write_b32 a224, v12
    v_accvgpr_write_b32 a225, v13
    v_accvgpr_write_b32 a226, v14
    v_accvgpr_write_b32 a227, v15
    v_perm_b32 v16, v37, v36, s93
    v_perm_b32 v17, v39, v38, s93
    v_perm_b32 v18, v41, v40, s93
    v_perm_b32 v19, v43, v42, s93
    ds_write_b128 v0, v[16:19] offset:30720
    buffer_load_dword v36, v10, s[84:87], s95 offen offset:0
    buffer_load_dword v37, v10, s[84:87], s95 offen offset:1280
    buffer_load_dword v38, v10, s[84:87], s95 offen offset:2560
    buffer_load_dword v39, v10, s[84:87], s95 offen offset:3840
    buffer_load_dword v40, v76, s[84:87], s95 offen offset:0
    buffer_load_dword v41, v76, s[84:87], s95 offen offset:1280
    buffer_load_dword v42, v76, s[84:87], s95 offen offset:2560
    buffer_load_dword v43, v76, s[84:87], s95 offen offset:3840
    s_add_u32 s95, s95, 40704
    s_waitcnt vmcnt(40)
    v_perm_b32 v12, v45, v44, s92
    v_perm_b32 v13, v47, v46, s92
    v_perm_b32 v14, v49, v48, s92
    v_perm_b32 v15, v51, v50, s92
    ds_write_b128 v0, v[12:15] offset:32768
    v_perm_b32 v16, v45, v44, s93
    v_perm_b32 v17, v47, v46, s93
    v_perm_b32 v18, v49, v48, s93
    v_perm_b32 v19, v51, v50, s93
    v_accvgpr_write_b32 a248, v16
    v_accvgpr_write_b32 a249, v17
    v_accvgpr_write_b32 a250, v18
    v_accvgpr_write_b32 a251, v19
    s_waitcnt vmcnt(32)
    v_perm_b32 v12, v53, v52, s92
    v_perm_b32 v13, v55, v54, s92
    v_perm_b32 v14, v57, v56, s92
    v_perm_b32 v15, v59, v58, s92
    v_accvgpr_write_b32 a164, v12
    v_accvgpr_write_b32 a165, v13
    v_accvgpr_write_b32 a166, v14
    v_accvgpr_write_b32 a167, v15
    v_perm_b32 v16, v53, v52, s93
    v_perm_b32 v17, v55, v54, s93
    v_perm_b32 v18, v57, v56, s93
    v_perm_b32 v19, v59, v58, s93
    ds_write_b128 v0, v[16:19] offset:23552
    s_waitcnt vmcnt(24)
    v_perm_b32 v12, v61, v60, s92
    v_perm_b32 v13, v63, v62, s92
    v_perm_b32 v14, v65, v64, s92
    v_perm_b32 v15, v67, v66, s92
    ds_write_b128 v0, v[12:15] offset:25600
    v_perm_b32 v16, v61, v60, s93
    v_perm_b32 v17, v63, v62, s93
    v_perm_b32 v18, v65, v64, s93
    v_perm_b32 v19, v67, v66, s93
    v_accvgpr_write_b32 a188, v16
    v_accvgpr_write_b32 a189, v17
    v_accvgpr_write_b32 a190, v18
    v_accvgpr_write_b32 a191, v19
    s_waitcnt vmcnt(16)
    v_perm_b32 v12, v69, v68, s92
    v_perm_b32 v13, v71, v70, s92
    v_perm_b32 v14, v73, v72, s92
    v_perm_b32 v15, v75, v74, s92
    v_accvgpr_write_b32 a204, v12
    v_accvgpr_write_b32 a205, v13
    v_accvgpr_write_b32 a206, v14
    v_accvgpr_write_b32 a207, v15
    v_perm_b32 v16, v69, v68, s93
    v_perm_b32 v17, v71, v70, s93
    v_perm_b32 v18, v73, v72, s93
    v_perm_b32 v19, v75, v74, s93
    v_accvgpr_write_b32 a212, v16
    v_accvgpr_write_b32 a213, v17
    v_accvgpr_write_b32 a214, v18
    v_accvgpr_write_b32 a215, v19
    s_waitcnt vmcnt(8)
    v_perm_b32 v12, v29, v28, s92
    v_perm_b32 v13, v31, v30, s92
    v_perm_b32 v14, v33, v32, s92
    v_perm_b32 v15, v35, v34, s92
    v_accvgpr_write_b32 a228, v12
    v_accvgpr_write_b32 a229, v13
    v_accvgpr_write_b32 a230, v14
    v_accvgpr_write_b32 a231, v15
    v_perm_b32 v16, v29, v28, s93
    v_perm_b32 v17, v31, v30, s93
    v_perm_b32 v18, v33, v32, s93
    v_perm_b32 v19, v35, v34, s93
    ds_write_b128 v0, v[16:19] offset:31744
    s_waitcnt vmcnt(0)
    v_perm_b32 v12, v37, v36, s92
    v_perm_b32 v13, v39, v38, s92
    v_perm_b32 v14, v41, v40, s92
    v_perm_b32 v15, v43, v42, s92
    ds_write_b128 v0, v[12:15] offset:33792
    v_perm_b32 v16, v37, v36, s93
    v_perm_b32 v17, v39, v38, s93
    v_perm_b32 v18, v41, v40, s93
    v_perm_b32 v19, v43, v42, s93
    v_accvgpr_write_b32 a252, v16
    v_accvgpr_write_b32 a253, v17
    v_accvgpr_write_b32 a254, v18
    v_accvgpr_write_b32 a255, v19
    s_waitcnt lgkmcnt(0)
    s_lshl_b32 s3, s11, 2
    s_mov_b32 s35, 0
WI_5:
    buffer_load_dword v11, off, s[96:99], 0 offset:128 sc1
    s_waitcnt vmcnt(0)
    v_cmp_le_u32 vcc, 256, v11
    s_cbranch_vccnz WO_6
    s_sleep 4
    s_add_u32 s35, s35, 1
    s_cmp_lt_u32 s35, 200000
    s_cbranch_scc1 WI_5
    s_branch F_CH
WO_6:
    s_mov_b32 m0, s37
    s_mov_b32 s29, 0
    s_lshr_b32 s43, s9, 1
    s_lshl_b32 s43, s43, 12
    s_lshl_b32 s27, s9, 11
    s_add_u32 s43, s43, s27
    s_mov_b32 s25, 0
    s_add_u32 s23, s20, s94
    s_add_u32 s20, s20, 524288
    s_add_u32 s38, s38, 64
    buffer_load_dwordx4 v[56:59], v1, s[4:7], s48 offen
    buffer_load_dwordx4 v[60:63], v1, s[4:7], s48 offen offset:1024
    buffer_load_dwordx4 v[64:67], v1, s[4:7], s49 offen
    buffer_load_dwordx4 v[68:71], v1, s[4:7], s49 offen offset:1024
    buffer_load_dwordx4 v[48:51], v1, s[4:7], s50 offen
    buffer_load_dwordx4 v[52:55], v1, s[4:7], s50 offen offset:1024
    buffer_load_dwordx4 v[28:31], v1, s[4:7], s51 offen
    buffer_load_dwordx4 v[32:35], v1, s[4:7], s51 offen offset:1024
    buffer_load_dwordx4 v[72:75], v1, s[4:7], s52 offen
    buffer_load_dwordx4 v[76:79], v1, s[4:7], s52 offen offset:1024
    v_mov_b32 v10, 0
    s_lshl_b32 s27, s11, 4
    buffer_load_dword v11, off, s[96:99], s27 sc1
    s_waitcnt vmcnt(0)
    v_cmp_gt_u32 vcc, 32, v11
    s_cbranch_vccnz CH_SLOW_7
CH_STEP_8:
    s_cmp_lg_u32 s25, 0
    s_cbranch_scc1 CH_KOK_10
    s_sub_u32 s27, s38, 64
    s_mov_b32 s35, 0
    v_lshrrev_b32 v11, 2, v1
    s_mov_b64 exec, 0xf000f
CH_KVP_11:
    buffer_load_dword v10, v11, s[4:7], s27 offen sc1
    s_waitcnt vmcnt(0)
    v_cmp_eq_u32 vcc, 0, v10
    s_and_b32 s44, vcc_lo, 15
    s_cbranch_scc0 CH_KVO_12
    s_add_u32 s35, s35, 1
    s_cmp_lt_u32 s35, 200000
    s_cbranch_scc1 CH_KVP_11
    s_branch F_CH
CH_KVO_12:
    s_mov_b64 exec, -1
    s_sub_u32 s27, s20, 524288
    s_add_u32 s21, s27, 1024
    buffer_load_dwordx4 v9, s[4:7], s27 offen sc1 lds
    buffer_load_dwordx4 v9, s[4:7], s21 offen offset:1024 sc1 lds
CH_KOK_10:
    s_add_u32 s27, s12, s46
    v_lshrrev_b32 v11, 1, v1
    s_mov_b32 s35, 0
    v_mov_b64 v[12:13], 0
    v_mov_b64 v[14:15], 0
    v_mov_b64 v[16:17], 0
    v_mov_b64 v[18:19], 0
    v_mov_b64 v[20:21], 0
    v_mov_b64 v[22:23], 0
    v_mov_b64 v[24:25], 0
    v_mov_b64 v[26:27], 0
    s_mov_b64 vcc, -1
CH_PM_13:
    s_add_u32 s35, s35, 1
    s_cmp_ge_u32 s35, 200000
    s_cbranch_scc1 F_CH
    s_mov_b64 exec, vcc
    buffer_load_dwordx4 v[36:39], v1, s[4:7], s27 offen sc1
    buffer_load_dwordx4 v[40:43], v1, s[4:7], s27 offen offset:1024 sc1
    buffer_load_dwordx2 v[44:45], v11, s[4:7], s27 offen offset:2048 sc1
    s_mov_b64 exec, -1
    s_waitcnt vmcnt(1)
    v_max3_u32 v46, v36, v37, v38
    v_max3_u32 v47, v39, v40, v41
    v_max3_u32 v46, v46, v42, v43
    s_waitcnt vmcnt(0)
    v_max3_u32 v47, v47, v44, v45
    v_max_u32 v46, v46, v47
    v_cmp_eq_u32 vcc, -1, v46
    v_add_u32 v46, s46, v1
    v_add_u32 v47, s46, v11
    s_cbranch_vccnz CH_PM_13
    ds_write_b128 v46, v[36:39] offset:0
    ds_write_b128 v46, v[40:43] offset:1024
    ds_write_b64 v47, v[44:45] offset:2048
CH_PMO_16:
    v_cmp_eq_u32 vcc, 0, v10
    s_and_b32 s27, vcc_lo, 0xf0000
    s_cselect_b32 s25, 0, 1
    s_cmp_ge_u32 s10, 63
    s_cselect_b32 s25, 0, s25
    s_sub_u32 s27, s20, 524288
    s_cmp_lg_u32 s25, 0
    s_cselect_b32 s28, s20, s27
    s_mov_b32 s36, s29
    s_mov_b32 s29, s25
    s_waitcnt lgkmcnt(0)
    s_barrier
    ds_read_b128 v[44:47], v1 offset:0
    ds_read_b128 v[36:39], v1 offset:1024
    ds_read_b128 v[40:43], v1 offset:2048
    v_mov_b32 v11, -1
    s_cmp_eq_u32 s22, 0
    s_cbranch_scc1 CH_RA_17
    s_mov_b64 exec, s[30:31]
    buffer_store_dword v11, v7, s[4:7], s14 offen
    s_mov_b64 exec, -1
CH_RA_17:
    s_waitcnt lgkmcnt(2)
    v_smfmac_f32_16x16x64_bf16 v[12:15], v[44:47], v[72:79], v2
    v_smfmac_f32_16x16x64_bf16 v[16:19], v[44:47], v[56:63], v2
    v_smfmac_f32_16x16x64_bf16 v[20:23], v[44:47], v[64:71], v2
    v_smfmac_f32_16x16x64_bf16 v[24:27], v[44:47], v[48:55], v2
    ds_read_b128 v[48:51], v0 offset:0
    ds_read_b128 v[52:55], v0 offset:1024
    buffer_load_dwordx4 v[56:59], v1, s[4:7], s53 offen
    ds_read_b128 v[44:47], v1 offset:3072
    s_waitcnt lgkmcnt(4)
    v_smfmac_f32_16x16x64_bf16 v[12:15], v[36:39], v[28:35], v2
    ds_read_b128 v[28:31], v0 offset:2048
    ds_read_b128 v[32:35], v0 offset:3072
    v_smfmac_f32_16x16x64_bf16 v[16:19], v[36:39], v[80:87], v2
    buffer_load_dwordx4 v[60:63], v1, s[4:7], s53 offen offset:1024
    v_smfmac_f32_16x16x64_bf16 v[20:23], v[36:39], v[88:95], v2
    v_smfmac_f32_16x16x64_bf16 v[24:27], v[36:39], v[96:103], v2
    buffer_load_dwordx4 v[64:67], v1, s[4:7], s54 offen
    ds_read_b128 v[36:39], v1 offset:4096
    s_waitcnt lgkmcnt(6)
    v_smfmac_f32_16x16x64_bf16 v[12:15], v[40:43], v[104:111], v2
    s_waitcnt lgkmcnt(4)
    v_smfmac_f32_16x16x64_bf16 v[16:19], v[40:43], v[48:55], v2
    ds_read_b128 v[48:51], v0 offset:4096
    ds_read_b128 v[52:55], v0 offset:5120
    buffer_load_dwordx4 v[68:71], v1, s[4:7], s54 offen offset:1024
    v_smfmac_f32_16x16x64_bf16 v[20:23], v[40:43], v[112:119], v2
    s_waitcnt lgkmcnt(3)
    v_smfmac_f32_16x16x64_bf16 v[24:27], v[40:43], v[28:35], v2
    ds_read_b128 v[28:31], v0 offset:6144
    ds_read_b128 v[32:35], v0 offset:7168
    buffer_load_dwordx4 v[72:75], v8, s[4:7], s23 offen offset:0 sc1
    ds_read_b128 v[40:43], v1 offset:5120
    v_smfmac_f32_16x16x64_bf16 v[12:15], v[44:47], v[120:127], v2
    v_smfmac_f32_16x16x64_bf16 v[16:19], v[44:47], v[128:135], v2
    buffer_load_dwordx4 v[76:79], v8, s[4:7], s23 offen offset:2048 sc1
    s_waitcnt lgkmcnt(3)
    v_smfmac_f32_16x16x64_bf16 v[20:23], v[44:47], v[48:55], v2
    ds_read_b128 v[48:51], v0 offset:8192
    ds_read_b128 v[52:55], v0 offset:9216
    v_smfmac_f32_16x16x64_bf16 v[24:27], v[44:47], v[136:143], v2
    buffer_load_dword v10, v7, s[4:7], s13 offen sc1
    ds_read_b128 v[44:47], v1 offset:6144
    v_smfmac_f32_16x16x64_bf16 v[12:15], v[36:39], v[144:151], v2
    s_waitcnt lgkmcnt(4)
    v_smfmac_f32_16x16x64_bf16 v[16:19], v[36:39], v[28:35], v2
    ds_read_b128 v[28:31], v0 offset:10240
    ds_read_b128 v[32:35], v0 offset:11264
    v_lshlrev_b32 v11, 3, v1
    s_add_u32 s27, s28, s43
    s_mov_b64 exec, 0xffff
    buffer_load_dword v10, v11, s[4:7], s27 offen sc1
    s_mov_b64 exec, -1
    v_smfmac_f32_16x16x64_bf16 v[20:23], v[36:39], v[152:159], v2
    v_smfmac_f32_16x16x64_bf16 v[24:27], v[36:39], v[160:167], v2
    s_mov_b64 exec, 1
    buffer_store_dword v2, off, s[4:7], s39 sc1
    s_mov_b64 exec, -1
    ds_read_b128 v[36:39], v1 offset:7168
    s_waitcnt lgkmcnt(6)
    s_waitcnt lgkmcnt(4)
    v_smfmac_f32_16x16x64_bf16 v[12:15], v[40:43], v[48:55], v2
    ds_read_b128 v[48:51], v0 offset:12288
    ds_read_b128 v[52:55], v0 offset:13312
    v_smfmac_f32_16x16x64_bf16 v[16:19], v[40:43], v[168:175], v2
    v_lshrrev_b32 v11, 2, v1
    s_mov_b64 exec, 0xf000f
    buffer_load_dword v10, v11, s[4:7], s38 offen sc1
    s_mov_b64 exec, -1
    s_add_u32 s38, s38, 64
    v_smfmac_f32_16x16x64_bf16 v[20:23], v[40:43], v[176:183], v2
    s_waitcnt lgkmcnt(3)
    v_smfmac_f32_16x16x64_bf16 v[24:27], v[40:43], v[28:35], v2
    ds_read_b128 v[28:31], v0 offset:14336
    ds_read_b128 v[32:35], v0 offset:15360
    ds_read_b128 v[40:43], v1 offset:8192
    v_smfmac_f32_16x16x64_bf16 v[12:15], v[44:47], v[184:191], v2
    v_smfmac_f32_16x16x64_bf16 v[16:19], v[44:47], v[192:199], v2
    s_waitcnt lgkmcnt(3)
    v_smfmac_f32_16x16x64_bf16 v[20:23], v[44:47], v[48:55], v2
    ds_read_b128 v[48:51], v0 offset:16384
    ds_read_b128 v[52:55], v0 offset:17408
    v_smfmac_f32_16x16x64_bf16 v[24:27], v[44:47], v[200:207], v2
    ds_read_b128 v[44:47], v1 offset:9216
    v_smfmac_f32_16x16x64_bf16 v[12:15], v[36:39], v[208:215], v2
    s_waitcnt lgkmcnt(4)
    v_smfmac_f32_16x16x64_bf16 v[16:19], v[36:39], v[28:35], v2
    ds_read_b128 v[28:31], v0 offset:18432
    ds_read_b128 v[32:35], v0 offset:19456
    v_smfmac_f32_16x16x64_bf16 v[20:23], v[36:39], v[216:223], v2
    v_smfmac_f32_16x16x64_bf16 v[24:27], v[36:39], v[224:231], v2
    ds_read_b128 v[36:39], v1 offset:0
    s_waitcnt lgkmcnt(6)
    s_waitcnt lgkmcnt(4)
    v_smfmac_f32_16x16x64_bf16 v[12:15], v[40:43], v[48:55], v2
    ds_read_b128 v[48:51], v0 offset:20480
    ds_read_b128 v[52:55], v0 offset:21504
    v_smfmac_f32_16x16x64_bf16 v[16:19], v[40:43], v[232:239], v2
    v_smfmac_f32_16x16x64_bf16 v[20:23], v[40:43], v[240:247], v2
    s_waitcnt lgkmcnt(3)
    v_smfmac_f32_16x16x64_bf16 v[24:27], v[40:43], v[28:35], v2
    ds_read_b128 v[40:43], v1 offset:1024
    v_smfmac_f32_16x16x64_bf16 v[12:15], v[44:47], v[248:255], v2
    v_mov_b64 v[28:29], 0
    v_smfmac_f32_16x16x64_bf16 v[16:19], v[44:47], a[0:7], v2
    v_mov_b64 v[30:31], 0
    v_smfmac_f32_16x16x64_bf16 v[20:23], v[44:47], a[8:15], v2
    v_mov_b64 v[32:33], 0
    s_waitcnt lgkmcnt(1)
    v_smfmac_f32_16x16x64_bf16 v[24:27], v[44:47], v[48:55], v2
    v_mov_b64 v[34:35], 0
    s_waitcnt vmcnt(8)
    v_smfmac_f32_16x16x64_bf16 v[28:31], v[36:39], v[56:63], v2
    ds_read_b128 v[48:51], v1 offset:14336
    ds_read_b128 v[52:55], v1 offset:18432
    v_pk_add_f32 v[12:13], v[12:13], v[14:15]
    v_pk_add_f32 v[16:17], v[16:17], v[18:19]
    v_pk_mul_f32 v[12:13], v[12:13], s[40:41]
    v_pk_mul_f32 v[16:17], v[16:17], s[40:41]
    v_cvt_pk_bf16_f32 v12, v12, v16
    v_cvt_pk_bf16_f32 v13, v13, v17
    ds_write2_b32 v3, v12, v13 offset0:0 offset1:4
    v_pk_add_f32 v[20:21], v[20:21], v[22:23]
    v_pk_add_f32 v[24:25], v[24:25], v[26:27]
    v_cvt_pk_bf16_f32 v20, v20, v24
    v_cvt_pk_bf16_f32 v21, v21, v25
    ds_write2_b32 v3, v20, v21 offset0:128 offset1:132
    s_waitcnt vmcnt(6)
    v_smfmac_f32_16x16x64_bf16 v[32:35], v[36:39], v[64:71], v2
    ds_read_b128 v[36:39], v1 offset:2048
    s_waitcnt lgkmcnt(1)
    s_barrier
    ds_read_b128 v[12:15], v4 offset:10240
    ds_read_b128 v[16:19], v4 offset:10752
    v_smfmac_f32_16x16x64_bf16 v[28:31], v[40:43], a[16:23], v2
    v_smfmac_f32_16x16x64_bf16 v[32:35], v[40:43], a[24:31], v2
    ds_read_b128 v[40:43], v1 offset:3072
    s_waitcnt lgkmcnt(3)
    v_smfmac_f32_16x16x64_bf16 v[28:31], v[36:39], a[32:39], v2
    v_smfmac_f32_16x16x64_bf16 v[32:35], v[36:39], a[40:47], v2
    ds_read_b128 v[36:39], v1 offset:4096
    s_waitcnt lgkmcnt(3)
    v_mfma_f32_16x16x32_bf16 v[20:23], v[48:51], v[12:15], 0
    ds_read_b128 v[48:51], v1 offset:15360
    v_mfma_f32_16x16x32_bf16 v[24:27], v[52:55], v[12:15], 0
    ds_read_b128 v[52:55], v1 offset:19456
    s_waitcnt lgkmcnt(4)
    v_mfma_f32_16x16x32_bf16 v[44:47], v[16:19], v[12:15], 0
    ds_read_b128 v[12:15], v4 offset:11264
    ds_read_b128 v[16:19], v4 offset:11776
    buffer_load_dwordx4 v[56:59], v1, s[4:7], s55 offen
    s_waitcnt lgkmcnt(5)
    v_smfmac_f32_16x16x64_bf16 v[28:31], v[40:43], a[48:55], v2
    v_smfmac_f32_16x16x64_bf16 v[32:35], v[40:43], a[56:63], v2
    ds_read_b128 v[40:43], v1 offset:5120
    s_waitcnt lgkmcnt(5)
    v_smfmac_f32_16x16x64_bf16 v[28:31], v[36:39], a[64:71], v2
    s_waitcnt lgkmcnt(2)
    v_mfma_f32_16x16x32_bf16 v[20:23], v[48:51], v[12:15], v[20:23]
    ds_read_b128 v[48:51], v1 offset:16384
    v_mfma_f32_16x16x32_bf16 v[24:27], v[52:55], v[12:15], v[24:27]
    ds_read_b128 v[52:55], v1 offset:20480
    s_waitcnt lgkmcnt(3)
    v_mfma_f32_16x16x32_bf16 v[44:47], v[16:19], v[12:15], v[44:47]
    ds_read_b128 v[12:15], v4 offset:12288
    ds_read_b128 v[16:19], v4 offset:12800
    buffer_load_dwordx4 v[60:63], v1, s[4:7], s55 offen offset:1024
    v_smfmac_f32_16x16x64_bf16 v[32:35], v[36:39], a[72:79], v2
    ds_read_b128 v[36:39], v1 offset:6144
    s_waitcnt lgkmcnt(5)
    v_smfmac_f32_16x16x64_bf16 v[28:31], v[40:43], a[80:87], v2
    v_smfmac_f32_16x16x64_bf16 v[32:35], v[40:43], a[88:95], v2
    ds_read_b128 v[40:43], v1 offset:7168
    s_waitcnt lgkmcnt(3)
    v_mfma_f32_16x16x32_bf16 v[20:23], v[48:51], v[12:15], v[20:23]
    ds_read_b128 v[48:51], v1 offset:17408
    v_mfma_f32_16x16x32_bf16 v[24:27], v[52:55], v[12:15], v[24:27]
    ds_read_b128 v[52:55], v1 offset:21504
    s_waitcnt lgkmcnt(4)
    v_mfma_f32_16x16x32_bf16 v[44:47], v[16:19], v[12:15], v[44:47]
    ds_read_b128 v[12:15], v4 offset:13312
    ds_read_b128 v[16:19], v4 offset:13824
    buffer_load_dwordx4 v[64:67], v1, s[4:7], s56 offen
    s_waitcnt lgkmcnt(5)
    v_smfmac_f32_16x16x64_bf16 v[28:31], v[36:39], a[96:103], v2
    v_smfmac_f32_16x16x64_bf16 v[32:35], v[36:39], a[104:111], v2
    ds_read_b128 v[36:39], v1 offset:8192
    s_waitcnt lgkmcnt(5)
    v_smfmac_f32_16x16x64_bf16 v[28:31], v[40:43], a[112:119], v2
    s_waitcnt lgkmcnt(2)
    v_mfma_f32_16x16x32_bf16 v[20:23], v[48:51], v[12:15], v[20:23]
    v_mfma_f32_16x16x32_bf16 v[24:27], v[52:55], v[12:15], v[24:27]
    s_waitcnt lgkmcnt(1)
    v_mfma_f32_16x16x32_bf16 v[44:47], v[16:19], v[12:15], v[44:47]
    buffer_load_dwordx4 v[68:71], v1, s[4:7], s56 offen offset:1024
    v_smfmac_f32_16x16x64_bf16 v[32:35], v[40:43], a[120:127], v2
    ds_read_b128 v[40:43], v1 offset:9216
    s_waitcnt lgkmcnt(1)
    v_smfmac_f32_16x16x64_bf16 v[28:31], v[36:39], a[128:135], v2
    v_max3_f32 v12, v20, v21, v22
    v_max3_f32 v13, v23, v24, v25
    v_max3_f32 v12, v12, v26, v27
    v_max3_f32 v13, v13, v44, v45
    v_max_f32 v12, v12, v13
    v_max_f32 v13, v12, v13
    v_smfmac_f32_16x16x64_bf16 v[32:35], v[36:39], a[136:143], v2
    v_mov_b32 v49, 0
    v_permlane32_swap_b32 v12, v13
    v_max_f32 v12, v12, v13
    v_max_f32 v13, v12, v13
    s_waitcnt lgkmcnt(0)
    v_smfmac_f32_16x16x64_bf16 v[28:31], v[40:43], a[144:151], v2
    v_mov_b32 v50, 0
    v_permlane16_swap_b32 v12, v13
    v_max_f32 v12, v12, v13
    ds_read2_b32 v[52:53], v3 offset0:128 offset1:132
    v_pk_add_f32 v[20:21], v[20:21], v[12:13] op_sel_hi:[1,0] neg_lo:[0,1] neg_hi:[0,1]
    v_smfmac_f32_16x16x64_bf16 v[32:35], v[40:43], a[152:159], v2
    v_pk_add_f32 v[22:23], v[22:23], v[12:13] op_sel_hi:[1,0] neg_lo:[0,1] neg_hi:[0,1]
    v_pk_add_f32 v[24:25], v[24:25], v[12:13] op_sel_hi:[1,0] neg_lo:[0,1] neg_hi:[0,1]
    v_pk_add_f32 v[26:27], v[26:27], v[12:13] op_sel_hi:[1,0] neg_lo:[0,1] neg_hi:[0,1]
    v_pk_add_f32 v[44:45], v[44:45], v[12:13] op_sel_hi:[1,0] neg_lo:[0,1] neg_hi:[0,1]
    v_exp_f32 v20, v20
    v_exp_f32 v21, v21
    v_exp_f32 v22, v22
    v_exp_f32 v23, v23
    v_cvt_pk_bf16_f32 v16, v20, v21
    v_exp_f32 v24, v24
    v_exp_f32 v25, v25
    v_cvt_pk_bf16_f32 v17, v22, v23
    v_exp_f32 v26, v26
    v_exp_f32 v27, v27
    v_cvt_pk_bf16_f32 v18, v24, v25
    v_exp_f32 v44, v44
    v_exp_f32 v45, v45
    v_cvt_pk_bf16_f32 v19, v26, v27
    v_cvt_pk_bf16_f32 v48, v44, v45
    v_cvt_pk_bf16_f32 v51, v44, v45
    s_waitcnt vmcnt(8)
    v_mfma_f32_16x16x32_bf16 v[36:39], v[72:75], v[16:19], 0
    v_pk_add_f32 v[12:13], v[20:21], v[22:23]
    v_pk_add_f32 v[14:15], v[24:25], v[26:27]
    v_mfma_f32_16x16x32_bf16 v[40:43], v[76:79], v[16:19], 0
    v_pk_add_f32 v[28:29], v[28:29], v[30:31]
    v_pk_add_f32 v[32:33], v[32:33], v[34:35]
    v_cvt_pk_bf16_f32 v54, v28, v29
    v_cvt_pk_bf16_f32 v55, v32, v33
    v_pk_add_f32 v[12:13], v[12:13], v[44:45]
    v_pk_add_f32 v[12:13], v[12:13], v[14:15]
    v_mfma_f32_16x16x16_bf16 v[36:39], v[54:55], v[48:49], v[36:39]
    v_add_f32 v14, v12, v13
    v_add_f32 v12, v12, v13
    v_mfma_f32_16x16x16_bf16 v[40:43], v[54:55], v[50:51], v[40:43]
    ds_read_b128 v[72:75], v0 offset:22528
    ds_read_b128 v[76:79], v0 offset:23552
    v_permlane32_swap_b32 v12, v14
    v_add_f32 v13, v12, v14
    v_add_f32 v12, v12, v14
    v_mov_b64 v[28:29], 0
    v_mov_b64 v[30:31], 0
    v_permlane16_swap_b32 v12, v13
    v_add_f32 v12, v12, v13
    v_rcp_f32 v12, v12
    v_cndmask_b32 v44, v37, v36, s[32:33]
    v_cndmask_b32 v45, v41, v40, s[32:33]
    v_cndmask_b32 v46, v39, v38, s[32:33]
    v_cndmask_b32 v47, v43, v42, s[32:33]
    v_pk_mul_f32 v[44:45], v[44:45], v[12:13] op_sel_hi:[1,0]
    v_pk_mul_f32 v[46:47], v[46:47], v[12:13] op_sel_hi:[1,0]
    v_cvt_pk_bf16_f32 v44, v44, v45
    v_cvt_pk_bf16_f32 v45, v46, v47
    ds_write_b64 v5, v[44:45]
    s_waitcnt lgkmcnt(3)
    buffer_store_dwordx4 v[52:55], v1, s[4:7], s15 offen sc1
    s_cmp_ge_u32 s10, 63
    s_cbranch_scc1 CH_END_9
    v_mov_b64 v[32:33], 0
    v_mov_b64 v[34:35], 0
    s_waitcnt vmcnt(5)
    v_cmp_eq_u32 vcc, 0, v10
    v_lshrrev_b32 v11, 1, v1
    s_and_b32 s27, vcc_lo, 15
    s_cselect_b32 s25, 0, 1
    s_cselect_b32 s28, s28, s20
    s_add_u32 s21, s28, 1024
    s_waitcnt lgkmcnt(0)
    s_barrier
    ds_read_b128 v[36:39], v1 offset:22528
    ds_read_b128 v[40:43], v1 offset:23552
    ds_read_b128 v[48:51], v0 offset:24576
    ds_read_b128 v[52:55], v0 offset:25600
    s_cmp_eq_u32 s29, 0
    s_cbranch_scc1 NT_18
    buffer_load_dwordx4 v9, s[4:7], s28 offen sc1 nt lds
NT_19:
    v_mov_b64 v[20:21], 0
    v_mov_b64 v[22:23], 0
    v_mov_b64 v[24:25], 0
    v_mov_b64 v[26:27], 0
    s_cmp_eq_u32 s29, 0
    s_cbranch_scc1 NT_20
    buffer_load_dwordx4 v9, s[4:7], s21 offen offset:1024 sc1 nt lds
NT_21:
    s_waitcnt lgkmcnt(3)
    s_waitcnt vmcnt(5)
    v_smfmac_f32_16x16x64_bf16 v[28:31], v[36:39], v[56:63], v2
    v_mov_b64 v[12:13], 0
    s_waitcnt vmcnt(3)
    v_smfmac_f32_16x16x64_bf16 v[32:35], v[36:39], v[64:71], v2
    v_mov_b64 v[14:15], 0
    s_waitcnt lgkmcnt(2)
    v_smfmac_f32_16x16x64_bf16 v[28:31], v[40:43], a[160:167], v2
    v_mov_b64 v[16:17], 0
    v_smfmac_f32_16x16x64_bf16 v[32:35], v[40:43], v[72:79], v2
    ds_read_b128 v[72:75], v0 offset:26624
    ds_read_b128 v[76:79], v0 offset:27648
    v_mov_b64 v[18:19], 0
    v_smfmac_f32_16x16x64_bf16 v[20:23], v[36:39], a[168:175], v2
    v_smfmac_f32_16x16x64_bf16 v[24:27], v[36:39], a[176:183], v2
    buffer_load_dwordx4 v[56:59], v1, s[4:7], s48 offen
    s_waitcnt lgkmcnt(2)
    v_smfmac_f32_16x16x64_bf16 v[20:23], v[40:43], v[48:55], v2
    ds_read_b128 v[48:51], v0 offset:28672
    ds_read_b128 v[52:55], v0 offset:29696
    v_pk_add_f32 v[28:29], v[28:29], v[30:31]
    v_pk_add_f32 v[32:33], v[32:33], v[34:35]
    v_smfmac_f32_16x16x64_bf16 v[24:27], v[40:43], a[184:191], v2
    buffer_load_dwordx4 v[64:67], v1, s[4:7], s49 offen
    v_cvt_pk_bf16_f32 v44, v28, v32
    v_cvt_pk_bf16_f32 v45, v29, v33
    v_smfmac_f32_16x16x64_bf16 v[12:15], v[36:39], a[192:199], v2
    v_bfi_b32 v44, 1, s26, v44
    v_mov_b64 v[28:29], 0
    s_waitcnt lgkmcnt(2)
    v_smfmac_f32_16x16x64_bf16 v[16:19], v[36:39], v[72:79], v2
    ds_read_b128 v[72:75], v0 offset:30720
    ds_read_b128 v[76:79], v0 offset:31744
    buffer_load_dwordx4 v[60:63], v1, s[4:7], s48 offen offset:1024
    v_mov_b64 v[30:31], 0
    v_mov_b64 v[32:33], 0
    v_smfmac_f32_16x16x64_bf16 v[12:15], v[40:43], a[200:207], v2
    v_mov_b64 v[34:35], 0
    v_pk_add_f32 v[20:21], v[20:21], v[22:23]
    v_smfmac_f32_16x16x64_bf16 v[16:19], v[40:43], a[208:215], v2
    buffer_load_dwordx4 v[68:71], v1, s[4:7], s49 offen offset:1024
    v_pk_add_f32 v[24:25], v[24:25], v[26:27]
    v_cvt_pk_bf16_f32 v46, v20, v24
    s_waitcnt lgkmcnt(2)
    v_smfmac_f32_16x16x64_bf16 v[28:31], v[36:39], v[48:55], v2
    ds_read_b128 v[48:51], v0 offset:32768
    ds_read_b128 v[52:55], v0 offset:33792
    v_cvt_pk_bf16_f32 v47, v21, v25
    v_bfi_b32 v46, 1, s26, v46
    v_smfmac_f32_16x16x64_bf16 v[32:35], v[36:39], a[216:223], v2
    buffer_store_dwordx4 v[44:47], v1, s[4:7], s24 offen offset:0
    v_mov_b64 v[20:21], 0
    v_smfmac_f32_16x16x64_bf16 v[28:31], v[40:43], a[224:231], v2
    v_mov_b64 v[22:23], 0
    v_mov_b64 v[24:25], 0
    s_waitcnt lgkmcnt(2)
    v_smfmac_f32_16x16x64_bf16 v[32:35], v[40:43], v[72:79], v2
    v_mov_b64 v[26:27], 0
    v_pk_add_f32 v[12:13], v[12:13], v[14:15]
    v_smfmac_f32_16x16x64_bf16 v[20:23], v[36:39], a[232:239], v2
    v_pk_add_f32 v[16:17], v[16:17], v[18:19]
    v_cvt_pk_bf16_f32 v44, v12, v16
    v_smfmac_f32_16x16x64_bf16 v[24:27], v[36:39], a[240:247], v2
    v_cvt_pk_bf16_f32 v45, v13, v17
    v_bfi_b32 v44, 1, s26, v44
    s_waitcnt lgkmcnt(0)
    v_smfmac_f32_16x16x64_bf16 v[20:23], v[40:43], v[48:55], v2
    v_pk_add_f32 v[28:29], v[28:29], v[30:31]
    v_pk_add_f32 v[32:33], v[32:33], v[34:35]
    v_smfmac_f32_16x16x64_bf16 v[24:27], v[40:43], a[248:255], v2
    v_cvt_pk_bf16_f32 v46, v28, v32
    v_cvt_pk_bf16_f32 v47, v29, v33
    v_bfi_b32 v46, 1, s26, v46
    buffer_store_dwordx4 v[44:47], v1, s[4:7], s24 offen offset:1024
    s_nop 0
    v_pk_add_f32 v[20:21], v[20:21], v[22:23]
    s_nop 1
    v_pk_add_f32 v[24:25], v[24:25], v[26:27]
    v_cvt_pk_bf16_f32 v44, v20, v24
    v_cvt_pk_bf16_f32 v45, v21, v25
    v_bfi_b32 v44, 1, s26, v44
    buffer_store_dwordx2 v[44:45], v11, s[4:7], s24 offen offset:2048
    s_barrier
    s_cmp_eq_u32 s22, 0
    s_cbranch_scc1 CH_NG_22
    v_mov_b64 v[36:37], 0
    v_mov_b64 v[38:39], 0
    s_mov_b32 exec_lo, 0x10001
    s_mov_b32 exec_hi, 0x10001
    v_mov_b32 v36, 0x3f80
    s_mov_b32 exec_lo, 0x20002
    s_mov_b32 exec_hi, 0x20002
    v_mov_b32 v36, 1.0
    s_mov_b32 exec_lo, 0x100010
    s_mov_b32 exec_hi, 0x100010
    v_mov_b32 v37, 0x3f80
    s_mov_b32 exec_lo, 0x200020
    s_mov_b32 exec_hi, 0x200020
    v_mov_b32 v37, 1.0
    s_mov_b32 exec_lo, 0x1000100
    s_mov_b32 exec_hi, 0x1000100
    v_mov_b32 v38, 0x3f80
    s_mov_b32 exec_lo, 0x2000200
    s_mov_b32 exec_hi, 0x2000200
    v_mov_b32 v38, 1.0
    s_mov_b32 exec_lo, 0x10001000
    s_mov_b32 exec_hi, 0x10001000
    v_mov_b32 v39, 0x3f80
    s_mov_b32 exec_lo, 0x20002000
    s_mov_b32 exec_hi, 0x20002000
    v_mov_b32 v39, 1.0
    s_mov_b64 exec, -1
    s_sleep 4
    buffer_load_dwordx4 v[12:15], v6, s[4:7], s16 offen sc1
    buffer_load_dwordx4 v[16:19], v6, s[4:7], s17 offen sc1
    buffer_load_dwordx4 v[20:23], v6, s[4:7], s18 offen sc1
    buffer_load_dwordx4 v[24:27], v6, s[4:7], s19 offen sc1
    buffer_load_dwordx4 v[72:75], v1, s[4:7], s52 offen
    buffer_load_dwordx4 v[76:79], v1, s[4:7], s52 offen offset:1024
    s_mov_b32 s35, 1
    s_waitcnt vmcnt(5)
    v_mfma_f32_16x16x32_bf16 v[40:43], v[36:39], v[12:15], 0
    v_bitop3_b32 v44, v12, v14, s26 bitop3:0x7e
    s_waitcnt vmcnt(4)
    v_mfma_f32_16x16x32_bf16 v[40:43], v[36:39], v[16:19], v[40:43]
    v_bitop3_b32 v45, v16, v18, s26 bitop3:0x7e
    s_waitcnt vmcnt(3)
    v_mfma_f32_16x16x32_bf16 v[40:43], v[36:39], v[20:23], v[40:43]
    v_bitop3_b32 v46, v20, v22, s26 bitop3:0x7e
    s_waitcnt vmcnt(2)
    v_mfma_f32_16x16x32_bf16 v[40:43], v[36:39], v[24:27], v[40:43]
    v_bitop3_b32 v47, v24, v26, s26 bitop3:0x7e
    v_or3_b32 v44, v44, v45, v46
    v_bitop3_b32 v44, v44, v47, 1 bitop3:0xa8
    v_cmp_ne_u32 vcc, 0, v44
    s_cbranch_vccnz CH_GA_26
    s_nop 2
    v_add_f32_dpp v40, v40, v40 row_ror:8 row_mask:0xf bank_mask:0xf
    v_add_f32_dpp v41, v41, v41 row_ror:8 row_mask:0xf bank_mask:0xf
    v_cvt_pk_bf16_f32 v40, v40, v41
    v_min_u32 v40, -2, v40
    s_mov_b64 exec, s[30:31]
    buffer_store_dword v40, v7, s[4:7], s13 offen
    s_mov_b64 exec, -1
    s_branch CH_GO_25
CH_GA_26:
    s_mov_b64 exec, vcc
    buffer_load_dwordx4 v[12:15], v6, s[4:7], s16 offen sc1
    buffer_load_dwordx4 v[16:19], v6, s[4:7], s17 offen sc1
    buffer_load_dwordx4 v[20:23], v6, s[4:7], s18 offen sc1
    buffer_load_dwordx4 v[24:27], v6, s[4:7], s19 offen sc1
    s_mov_b64 exec, -1
    buffer_load_dwordx4 v[48:51], v1, s[4:7], s50 offen
    buffer_load_dwordx4 v[52:55], v1, s[4:7], s50 offen offset:1024
    s_mov_b32 s35, 2
    s_waitcnt vmcnt(5)
    v_mfma_f32_16x16x32_bf16 v[40:43], v[36:39], v[12:15], 0
    v_bitop3_b32 v44, v12, v14, s26 bitop3:0x7e
    s_waitcnt vmcnt(4)
    v_mfma_f32_16x16x32_bf16 v[40:43], v[36:39], v[16:19], v[40:43]
    v_bitop3_b32 v45, v16, v18, s26 bitop3:0x7e
    s_waitcnt vmcnt(3)
    v_mfma_f32_16x16x32_bf16 v[40:43], v[36:39], v[20:23], v[40:43]
    v_bitop3_b32 v46, v20, v22, s26 bitop3:0x7e
    s_waitcnt vmcnt(2)
    v_mfma_f32_16x16x32_bf16 v[40:43], v[36:39], v[24:27], v[40:43]
    v_bitop3_b32 v47, v24, v26, s26 bitop3:0x7e
    v_or3_b32 v44, v44, v45, v46
    v_bitop3_b32 v44, v44, v47, 1 bitop3:0xa8
    v_cmp_ne_u32 vcc, 0, v44
    s_cbranch_vccnz CH_GA_27
    s_nop 2
    v_add_f32_dpp v40, v40, v40 row_ror:8 row_mask:0xf bank_mask:0xf
    v_add_f32_dpp v41, v41, v41 row_ror:8 row_mask:0xf bank_mask:0xf
    v_cvt_pk_bf16_f32 v40, v40, v41
    v_min_u32 v40, -2, v40
    s_mov_b64 exec, s[30:31]
    buffer_store_dword v40, v7, s[4:7], s13 offen
    s_mov_b64 exec, -1
    s_branch CH_GO_25
CH_GA_27:
    s_mov_b64 exec, vcc
    buffer_load_dwordx4 v[12:15], v6, s[4:7], s16 offen sc1
    buffer_load_dwordx4 v[16:19], v6, s[4:7], s17 offen sc1
    buffer_load_dwordx4 v[20:23], v6, s[4:7], s18 offen sc1
    buffer_load_dwordx4 v[24:27], v6, s[4:7], s19 offen sc1
    s_mov_b64 exec, -1
    buffer_load_dwordx4 v[28:31], v1, s[4:7], s51 offen
    buffer_load_dwordx4 v[32:35], v1, s[4:7], s51 offen offset:1024
    s_mov_b32 s35, 3
    s_waitcnt vmcnt(5)
    v_mfma_f32_16x16x32_bf16 v[40:43], v[36:39], v[12:15], 0
    v_bitop3_b32 v44, v12, v14, s26 bitop3:0x7e
    s_waitcnt vmcnt(4)
    v_mfma_f32_16x16x32_bf16 v[40:43], v[36:39], v[16:19], v[40:43]
    v_bitop3_b32 v45, v16, v18, s26 bitop3:0x7e
    s_waitcnt vmcnt(3)
    v_mfma_f32_16x16x32_bf16 v[40:43], v[36:39], v[20:23], v[40:43]
    v_bitop3_b32 v46, v20, v22, s26 bitop3:0x7e
    s_waitcnt vmcnt(2)
    v_mfma_f32_16x16x32_bf16 v[40:43], v[36:39], v[24:27], v[40:43]
    v_bitop3_b32 v47, v24, v26, s26 bitop3:0x7e
    v_or3_b32 v44, v44, v45, v46
    v_bitop3_b32 v44, v44, v47, 1 bitop3:0xa8
    v_cmp_ne_u32 vcc, 0, v44
    s_cbranch_vccnz CH_GA_28
    s_nop 2
    v_add_f32_dpp v40, v40, v40 row_ror:8 row_mask:0xf bank_mask:0xf
    v_add_f32_dpp v41, v41, v41 row_ror:8 row_mask:0xf bank_mask:0xf
    v_cvt_pk_bf16_f32 v40, v40, v41
    v_min_u32 v40, -2, v40
    s_mov_b64 exec, s[30:31]
    buffer_store_dword v40, v7, s[4:7], s13 offen
    s_mov_b64 exec, -1
    s_branch CH_GO_25
CH_GA_28:
CH_G_24:
    s_add_u32 s35, s35, 1
    s_cmp_ge_u32 s35, 200000
    s_cbranch_scc1 F_CH
    s_mov_b64 exec, vcc
    buffer_load_dwordx4 v[12:15], v6, s[4:7], s16 offen sc1
    buffer_load_dwordx4 v[16:19], v6, s[4:7], s17 offen sc1
    buffer_load_dwordx4 v[20:23], v6, s[4:7], s18 offen sc1
    buffer_load_dwordx4 v[24:27], v6, s[4:7], s19 offen sc1
    s_mov_b64 exec, -1
    s_waitcnt vmcnt(3)
    v_mfma_f32_16x16x32_bf16 v[40:43], v[36:39], v[12:15], 0
    v_bitop3_b32 v44, v12, v14, s26 bitop3:0x7e
    s_waitcnt vmcnt(2)
    v_mfma_f32_16x16x32_bf16 v[40:43], v[36:39], v[16:19], v[40:43]
    v_bitop3_b32 v45, v16, v18, s26 bitop3:0x7e
    s_waitcnt vmcnt(1)
    v_mfma_f32_16x16x32_bf16 v[40:43], v[36:39], v[20:23], v[40:43]
    v_bitop3_b32 v46, v20, v22, s26 bitop3:0x7e
    s_waitcnt vmcnt(0)
    v_mfma_f32_16x16x32_bf16 v[40:43], v[36:39], v[24:27], v[40:43]
    v_bitop3_b32 v47, v24, v26, s26 bitop3:0x7e
    v_or3_b32 v44, v44, v45, v46
    v_bitop3_b32 v44, v44, v47, 1 bitop3:0xa8
    v_cmp_ne_u32 vcc, 0, v44
    s_cbranch_vccnz CH_G_24
    s_nop 2
    v_add_f32_dpp v40, v40, v40 row_ror:8 row_mask:0xf bank_mask:0xf
    v_add_f32_dpp v41, v41, v41 row_ror:8 row_mask:0xf bank_mask:0xf
    v_cvt_pk_bf16_f32 v40, v40, v41
    v_min_u32 v40, -2, v40
    s_mov_b64 exec, s[30:31]
    buffer_store_dword v40, v7, s[4:7], s13 offen
    s_mov_b64 exec, -1
CH_GO_25:
    s_cmp_gt_u32 s35, 1
    s_cbranch_scc1 CH_RS_29
    buffer_load_dwordx4 v[48:51], v1, s[4:7], s50 offen
    buffer_load_dwordx4 v[52:55], v1, s[4:7], s50 offen offset:1024
CH_RS_29:
    s_cmp_gt_u32 s35, 2
    s_cbranch_scc1 CH_RS_30
    buffer_load_dwordx4 v[28:31], v1, s[4:7], s51 offen
    buffer_load_dwordx4 v[32:35], v1, s[4:7], s51 offen offset:1024
CH_RS_30:
    s_branch CH_NG2_23
CH_NG_22:
    buffer_load_dwordx4 v[72:75], v1, s[4:7], s52 offen
    buffer_load_dwordx4 v[76:79], v1, s[4:7], s52 offen offset:1024
    s_waitcnt vmcnt(0)
    buffer_load_dwordx4 v[48:51], v1, s[4:7], s50 offen
    buffer_load_dwordx4 v[52:55], v1, s[4:7], s50 offen offset:1024
    s_waitcnt vmcnt(0)
    buffer_load_dwordx4 v[28:31], v1, s[4:7], s51 offen
    buffer_load_dwordx4 v[32:35], v1, s[4:7], s51 offen offset:1024
    s_waitcnt vmcnt(0)
CH_NG2_23:
    s_mov_b32 s27, s12
    s_mov_b32 s12, s13
    s_mov_b32 s13, s14
    s_mov_b32 s14, s27
    s_add_u32 s23, s20, s94
    s_add_u32 s20, s20, 524288
    s_add_u32 s15, s15, 131072
    s_mov_b32 s39, s34
    s_add_u32 s34, s34, 64
    s_add_u32 s42, s42, 64
    s_xor_b32 s26, s26, 1
    s_add_u32 s10, s10, 1
    s_branch CH_STEP_8
CH_END_9:
    s_lshl_b32 s3, s11, 2
    s_mov_b32 s39, s34
    s_waitcnt vmcnt(0)
    s_mov_b64 exec, 1
    buffer_store_dword v2, off, s[4:7], s39 sc1
    s_endpgm
CH_SLOW_7:
CH_STEP_31:
    s_cmp_lg_u32 s25, 0
    s_cbranch_scc1 CH_KOK_33
    s_sub_u32 s27, s38, 64
    s_mov_b32 s35, 0
    v_lshrrev_b32 v11, 2, v1
    s_mov_b64 exec, 0xf000f
CH_KVP_34:
    buffer_load_dword v10, v11, s[4:7], s27 offen sc1
    s_waitcnt vmcnt(0)
    v_cmp_eq_u32 vcc, 0, v10
    s_and_b32 s44, vcc_lo, 15
    s_cbranch_scc0 CH_KVO_35
    s_add_u32 s35, s35, 1
    s_cmp_lt_u32 s35, 200000
    s_cbranch_scc1 CH_KVP_34
    s_branch F_CH
CH_KVO_35:
    s_mov_b64 exec, -1
    s_sub_u32 s27, s20, 524288
    s_add_u32 s21, s27, 1024
    buffer_load_dwordx4 v9, s[4:7], s27 offen sc1 lds
    buffer_load_dwordx4 v9, s[4:7], s21 offen offset:1024 sc1 lds
CH_KOK_33:
    s_add_u32 s27, s12, s46
    v_lshrrev_b32 v11, 1, v1
    s_mov_b32 s35, 0
    v_mov_b64 v[12:13], 0
    v_mov_b64 v[14:15], 0
    v_mov_b64 v[16:17], 0
    v_mov_b64 v[18:19], 0
    v_mov_b64 v[20:21], 0
    v_mov_b64 v[22:23], 0
    v_mov_b64 v[24:25], 0
    v_mov_b64 v[26:27], 0
    s_mov_b64 vcc, -1
CH_PM_36:
    s_add_u32 s35, s35, 1
    s_cmp_ge_u32 s35, 200000
    s_cbranch_scc1 F_CH
    s_mov_b64 exec, vcc
    buffer_load_dwordx4 v[36:39], v1, s[4:7], s27 offen sc1
    buffer_load_dwordx4 v[40:43], v1, s[4:7], s27 offen offset:1024 sc1
    buffer_load_dwordx2 v[44:45], v11, s[4:7], s27 offen offset:2048 sc1
    s_mov_b64 exec, -1
    s_waitcnt vmcnt(1)
    v_max3_u32 v46, v36, v37, v38
    v_max3_u32 v47, v39, v40, v41
    v_max3_u32 v46, v46, v42, v43
    s_waitcnt vmcnt(0)
    v_max3_u32 v47, v47, v44, v45
    v_max_u32 v46, v46, v47
    v_cmp_eq_u32 vcc, -1, v46
    v_add_u32 v46, s46, v1
    v_add_u32 v47, s46, v11
    s_cbranch_vccnz CH_PM_36
    ds_write_b128 v46, v[36:39] offset:0
    ds_write_b128 v46, v[40:43] offset:1024
    ds_write_b64 v47, v[44:45] offset:2048
CH_PMO_39:
    v_cmp_eq_u32 vcc, 0, v10
    s_and_b32 s27, vcc_lo, 0xf0000
    s_cselect_b32 s25, 0, 1
    s_cmp_ge_u32 s10, 63
    s_cselect_b32 s25, 0, s25
    s_sub_u32 s27, s20, 524288
    s_cmp_lg_u32 s25, 0
    s_cselect_b32 s28, s20, s27
    s_mov_b32 s36, s29
    s_mov_b32 s29, s25
    s_waitcnt lgkmcnt(0)
    s_barrier
    ds_read_b128 v[44:47], v1 offset:0
    ds_read_b128 v[36:39], v1 offset:1024
    ds_read_b128 v[40:43], v1 offset:2048
    v_mov_b32 v11, -1
    s_cmp_eq_u32 s22, 0
    s_cbranch_scc1 CH_RA_40
    s_mov_b64 exec, s[30:31]
    buffer_store_dword v11, v7, s[4:7], s14 offen sc1
    s_mov_b64 exec, -1
CH_RA_40:
    s_waitcnt lgkmcnt(2)
    v_smfmac_f32_16x16x64_bf16 v[12:15], v[44:47], v[72:79], v2
    v_smfmac_f32_16x16x64_bf16 v[16:19], v[44:47], v[56:63], v2
    v_smfmac_f32_16x16x64_bf16 v[20:23], v[44:47], v[64:71], v2
    v_smfmac_f32_16x16x64_bf16 v[24:27], v[44:47], v[48:55], v2
    ds_read_b128 v[48:51], v0 offset:0
    ds_read_b128 v[52:55], v0 offset:1024
    buffer_load_dwordx4 v[56:59], v1, s[4:7], s53 offen
    ds_read_b128 v[44:47], v1 offset:3072
    s_waitcnt lgkmcnt(4)
    v_smfmac_f32_16x16x64_bf16 v[12:15], v[36:39], v[28:35], v2
    ds_read_b128 v[28:31], v0 offset:2048
    ds_read_b128 v[32:35], v0 offset:3072
    v_smfmac_f32_16x16x64_bf16 v[16:19], v[36:39], v[80:87], v2
    buffer_load_dwordx4 v[60:63], v1, s[4:7], s53 offen offset:1024
    v_smfmac_f32_16x16x64_bf16 v[20:23], v[36:39], v[88:95], v2
    v_smfmac_f32_16x16x64_bf16 v[24:27], v[36:39], v[96:103], v2
    buffer_load_dwordx4 v[64:67], v1, s[4:7], s54 offen
    ds_read_b128 v[36:39], v1 offset:4096
    s_waitcnt lgkmcnt(6)
    v_smfmac_f32_16x16x64_bf16 v[12:15], v[40:43], v[104:111], v2
    s_waitcnt lgkmcnt(4)
    v_smfmac_f32_16x16x64_bf16 v[16:19], v[40:43], v[48:55], v2
    ds_read_b128 v[48:51], v0 offset:4096
    ds_read_b128 v[52:55], v0 offset:5120
    buffer_load_dwordx4 v[68:71], v1, s[4:7], s54 offen offset:1024
    v_smfmac_f32_16x16x64_bf16 v[20:23], v[40:43], v[112:119], v2
    s_waitcnt lgkmcnt(3)
    v_smfmac_f32_16x16x64_bf16 v[24:27], v[40:43], v[28:35], v2
    ds_read_b128 v[28:31], v0 offset:6144
    ds_read_b128 v[32:35], v0 offset:7168
    buffer_load_dwordx4 v[72:75], v8, s[4:7], s23 offen offset:0 sc1
    ds_read_b128 v[40:43], v1 offset:5120
    v_smfmac_f32_16x16x64_bf16 v[12:15], v[44:47], v[120:127], v2
    v_smfmac_f32_16x16x64_bf16 v[16:19], v[44:47], v[128:135], v2
    buffer_load_dwordx4 v[76:79], v8, s[4:7], s23 offen offset:2048 sc1
    s_waitcnt lgkmcnt(3)
    v_smfmac_f32_16x16x64_bf16 v[20:23], v[44:47], v[48:55], v2
    ds_read_b128 v[48:51], v0 offset:8192
    ds_read_b128 v[52:55], v0 offset:9216
    v_smfmac_f32_16x16x64_bf16 v[24:27], v[44:47], v[136:143], v2
    buffer_load_dword v10, v7, s[4:7], s13 offen sc1
    ds_read_b128 v[44:47], v1 offset:6144
    v_smfmac_f32_16x16x64_bf16 v[12:15], v[36:39], v[144:151], v2
    s_waitcnt lgkmcnt(4)
    v_smfmac_f32_16x16x64_bf16 v[16:19], v[36:39], v[28:35], v2
    ds_read_b128 v[28:31], v0 offset:10240
    ds_read_b128 v[32:35], v0 offset:11264
    v_lshlrev_b32 v11, 3, v1
    s_add_u32 s27, s28, s43
    s_mov_b64 exec, 0xffff
    buffer_load_dword v10, v11, s[4:7], s27 offen sc1
    s_mov_b64 exec, -1
    v_smfmac_f32_16x16x64_bf16 v[20:23], v[36:39], v[152:159], v2
    v_smfmac_f32_16x16x64_bf16 v[24:27], v[36:39], v[160:167], v2
    s_mov_b64 exec, 1
    buffer_store_dword v2, off, s[4:7], s39 sc1
    s_mov_b64 exec, -1
    ds_read_b128 v[36:39], v1 offset:7168
    s_waitcnt lgkmcnt(6)
    s_waitcnt lgkmcnt(4)
    v_smfmac_f32_16x16x64_bf16 v[12:15], v[40:43], v[48:55], v2
    ds_read_b128 v[48:51], v0 offset:12288
    ds_read_b128 v[52:55], v0 offset:13312
    v_smfmac_f32_16x16x64_bf16 v[16:19], v[40:43], v[168:175], v2
    v_lshrrev_b32 v11, 2, v1
    s_mov_b64 exec, 0xf000f
    buffer_load_dword v10, v11, s[4:7], s38 offen sc1
    s_mov_b64 exec, -1
    s_add_u32 s38, s38, 64
    v_smfmac_f32_16x16x64_bf16 v[20:23], v[40:43], v[176:183], v2
    s_waitcnt lgkmcnt(3)
    v_smfmac_f32_16x16x64_bf16 v[24:27], v[40:43], v[28:35], v2
    ds_read_b128 v[28:31], v0 offset:14336
    ds_read_b128 v[32:35], v0 offset:15360
    ds_read_b128 v[40:43], v1 offset:8192
    v_smfmac_f32_16x16x64_bf16 v[12:15], v[44:47], v[184:191], v2
    v_smfmac_f32_16x16x64_bf16 v[16:19], v[44:47], v[192:199], v2
    s_waitcnt lgkmcnt(3)
    v_smfmac_f32_16x16x64_bf16 v[20:23], v[44:47], v[48:55], v2
    ds_read_b128 v[48:51], v0 offset:16384
    ds_read_b128 v[52:55], v0 offset:17408
    v_smfmac_f32_16x16x64_bf16 v[24:27], v[44:47], v[200:207], v2
    ds_read_b128 v[44:47], v1 offset:9216
    v_smfmac_f32_16x16x64_bf16 v[12:15], v[36:39], v[208:215], v2
    s_waitcnt lgkmcnt(4)
    v_smfmac_f32_16x16x64_bf16 v[16:19], v[36:39], v[28:35], v2
    ds_read_b128 v[28:31], v0 offset:18432
    ds_read_b128 v[32:35], v0 offset:19456
    v_smfmac_f32_16x16x64_bf16 v[20:23], v[36:39], v[216:223], v2
    v_smfmac_f32_16x16x64_bf16 v[24:27], v[36:39], v[224:231], v2
    ds_read_b128 v[36:39], v1 offset:0
    s_waitcnt lgkmcnt(6)
    s_waitcnt lgkmcnt(4)
    v_smfmac_f32_16x16x64_bf16 v[12:15], v[40:43], v[48:55], v2
    ds_read_b128 v[48:51], v0 offset:20480
    ds_read_b128 v[52:55], v0 offset:21504
    v_smfmac_f32_16x16x64_bf16 v[16:19], v[40:43], v[232:239], v2
    v_smfmac_f32_16x16x64_bf16 v[20:23], v[40:43], v[240:247], v2
    s_waitcnt lgkmcnt(3)
    v_smfmac_f32_16x16x64_bf16 v[24:27], v[40:43], v[28:35], v2
    ds_read_b128 v[40:43], v1 offset:1024
    v_smfmac_f32_16x16x64_bf16 v[12:15], v[44:47], v[248:255], v2
    v_mov_b64 v[28:29], 0
    v_smfmac_f32_16x16x64_bf16 v[16:19], v[44:47], a[0:7], v2
    v_mov_b64 v[30:31], 0
    v_smfmac_f32_16x16x64_bf16 v[20:23], v[44:47], a[8:15], v2
    v_mov_b64 v[32:33], 0
    s_waitcnt lgkmcnt(1)
    v_smfmac_f32_16x16x64_bf16 v[24:27], v[44:47], v[48:55], v2
    v_mov_b64 v[34:35], 0
    s_waitcnt vmcnt(8)
    v_smfmac_f32_16x16x64_bf16 v[28:31], v[36:39], v[56:63], v2
    ds_read_b128 v[48:51], v1 offset:14336
    ds_read_b128 v[52:55], v1 offset:18432
    v_pk_add_f32 v[12:13], v[12:13], v[14:15]
    v_pk_add_f32 v[16:17], v[16:17], v[18:19]
    v_pk_mul_f32 v[12:13], v[12:13], s[40:41]
    v_pk_mul_f32 v[16:17], v[16:17], s[40:41]
    v_cvt_pk_bf16_f32 v12, v12, v16
    v_cvt_pk_bf16_f32 v13, v13, v17
    ds_write2_b32 v3, v12, v13 offset0:0 offset1:4
    v_pk_add_f32 v[20:21], v[20:21], v[22:23]
    v_pk_add_f32 v[24:25], v[24:25], v[26:27]
    v_cvt_pk_bf16_f32 v20, v20, v24
    v_cvt_pk_bf16_f32 v21, v21, v25
    ds_write2_b32 v3, v20, v21 offset0:128 offset1:132
    s_waitcnt vmcnt(6)
    v_smfmac_f32_16x16x64_bf16 v[32:35], v[36:39], v[64:71], v2
    ds_read_b128 v[36:39], v1 offset:2048
    s_waitcnt lgkmcnt(1)
    s_barrier
    ds_read_b128 v[12:15], v4 offset:10240
    ds_read_b128 v[16:19], v4 offset:10752
    v_smfmac_f32_16x16x64_bf16 v[28:31], v[40:43], a[16:23], v2
    v_smfmac_f32_16x16x64_bf16 v[32:35], v[40:43], a[24:31], v2
    ds_read_b128 v[40:43], v1 offset:3072
    s_waitcnt lgkmcnt(3)
    v_smfmac_f32_16x16x64_bf16 v[28:31], v[36:39], a[32:39], v2
    v_smfmac_f32_16x16x64_bf16 v[32:35], v[36:39], a[40:47], v2
    ds_read_b128 v[36:39], v1 offset:4096
    s_waitcnt lgkmcnt(3)
    v_mfma_f32_16x16x32_bf16 v[20:23], v[48:51], v[12:15], 0
    ds_read_b128 v[48:51], v1 offset:15360
    v_mfma_f32_16x16x32_bf16 v[24:27], v[52:55], v[12:15], 0
    ds_read_b128 v[52:55], v1 offset:19456
    s_waitcnt lgkmcnt(4)
    v_mfma_f32_16x16x32_bf16 v[44:47], v[16:19], v[12:15], 0
    ds_read_b128 v[12:15], v4 offset:11264
    ds_read_b128 v[16:19], v4 offset:11776
    buffer_load_dwordx4 v[56:59], v1, s[4:7], s55 offen
    s_waitcnt lgkmcnt(5)
    v_smfmac_f32_16x16x64_bf16 v[28:31], v[40:43], a[48:55], v2
    v_smfmac_f32_16x16x64_bf16 v[32:35], v[40:43], a[56:63], v2
    ds_read_b128 v[40:43], v1 offset:5120
    s_waitcnt lgkmcnt(5)
    v_smfmac_f32_16x16x64_bf16 v[28:31], v[36:39], a[64:71], v2
    s_waitcnt lgkmcnt(2)
    v_mfma_f32_16x16x32_bf16 v[20:23], v[48:51], v[12:15], v[20:23]
    ds_read_b128 v[48:51], v1 offset:16384
    v_mfma_f32_16x16x32_bf16 v[24:27], v[52:55], v[12:15], v[24:27]
    ds_read_b128 v[52:55], v1 offset:20480
    s_waitcnt lgkmcnt(3)
    v_mfma_f32_16x16x32_bf16 v[44:47], v[16:19], v[12:15], v[44:47]
    ds_read_b128 v[12:15], v4 offset:12288
    ds_read_b128 v[16:19], v4 offset:12800
    buffer_load_dwordx4 v[60:63], v1, s[4:7], s55 offen offset:1024
    v_smfmac_f32_16x16x64_bf16 v[32:35], v[36:39], a[72:79], v2
    ds_read_b128 v[36:39], v1 offset:6144
    s_waitcnt lgkmcnt(5)
    v_smfmac_f32_16x16x64_bf16 v[28:31], v[40:43], a[80:87], v2
    v_smfmac_f32_16x16x64_bf16 v[32:35], v[40:43], a[88:95], v2
    ds_read_b128 v[40:43], v1 offset:7168
    s_waitcnt lgkmcnt(3)
    v_mfma_f32_16x16x32_bf16 v[20:23], v[48:51], v[12:15], v[20:23]
    ds_read_b128 v[48:51], v1 offset:17408
    v_mfma_f32_16x16x32_bf16 v[24:27], v[52:55], v[12:15], v[24:27]
    ds_read_b128 v[52:55], v1 offset:21504
    s_waitcnt lgkmcnt(4)
    v_mfma_f32_16x16x32_bf16 v[44:47], v[16:19], v[12:15], v[44:47]
    ds_read_b128 v[12:15], v4 offset:13312
    ds_read_b128 v[16:19], v4 offset:13824
    buffer_load_dwordx4 v[64:67], v1, s[4:7], s56 offen
    s_waitcnt lgkmcnt(5)
    v_smfmac_f32_16x16x64_bf16 v[28:31], v[36:39], a[96:103], v2
    v_smfmac_f32_16x16x64_bf16 v[32:35], v[36:39], a[104:111], v2
    ds_read_b128 v[36:39], v1 offset:8192
    s_waitcnt lgkmcnt(5)
    v_smfmac_f32_16x16x64_bf16 v[28:31], v[40:43], a[112:119], v2
    s_waitcnt lgkmcnt(2)
    v_mfma_f32_16x16x32_bf16 v[20:23], v[48:51], v[12:15], v[20:23]
    v_mfma_f32_16x16x32_bf16 v[24:27], v[52:55], v[12:15], v[24:27]
    s_waitcnt lgkmcnt(1)
    v_mfma_f32_16x16x32_bf16 v[44:47], v[16:19], v[12:15], v[44:47]
    buffer_load_dwordx4 v[68:71], v1, s[4:7], s56 offen offset:1024
    v_smfmac_f32_16x16x64_bf16 v[32:35], v[40:43], a[120:127], v2
    ds_read_b128 v[40:43], v1 offset:9216
    s_waitcnt lgkmcnt(1)
    v_smfmac_f32_16x16x64_bf16 v[28:31], v[36:39], a[128:135], v2
    v_max3_f32 v12, v20, v21, v22
    v_max3_f32 v13, v23, v24, v25
    v_max3_f32 v12, v12, v26, v27
    v_max3_f32 v13, v13, v44, v45
    v_max_f32 v12, v12, v13
    v_max_f32 v13, v12, v13
    v_smfmac_f32_16x16x64_bf16 v[32:35], v[36:39], a[136:143], v2
    v_mov_b32 v49, 0
    v_permlane32_swap_b32 v12, v13
    v_max_f32 v12, v12, v13
    v_max_f32 v13, v12, v13
    s_waitcnt lgkmcnt(0)
    v_smfmac_f32_16x16x64_bf16 v[28:31], v[40:43], a[144:151], v2
    v_mov_b32 v50, 0
    v_permlane16_swap_b32 v12, v13
    v_max_f32 v12, v12, v13
    ds_read2_b32 v[52:53], v3 offset0:128 offset1:132
    v_pk_add_f32 v[20:21], v[20:21], v[12:13] op_sel_hi:[1,0] neg_lo:[0,1] neg_hi:[0,1]
    v_smfmac_f32_16x16x64_bf16 v[32:35], v[40:43], a[152:159], v2
    v_pk_add_f32 v[22:23], v[22:23], v[12:13] op_sel_hi:[1,0] neg_lo:[0,1] neg_hi:[0,1]
    v_pk_add_f32 v[24:25], v[24:25], v[12:13] op_sel_hi:[1,0] neg_lo:[0,1] neg_hi:[0,1]
    v_pk_add_f32 v[26:27], v[26:27], v[12:13] op_sel_hi:[1,0] neg_lo:[0,1] neg_hi:[0,1]
    v_pk_add_f32 v[44:45], v[44:45], v[12:13] op_sel_hi:[1,0] neg_lo:[0,1] neg_hi:[0,1]
    v_exp_f32 v20, v20
    v_exp_f32 v21, v21
    v_exp_f32 v22, v22
    v_exp_f32 v23, v23
    v_cvt_pk_bf16_f32 v16, v20, v21
    v_exp_f32 v24, v24
    v_exp_f32 v25, v25
    v_cvt_pk_bf16_f32 v17, v22, v23
    v_exp_f32 v26, v26
    v_exp_f32 v27, v27
    v_cvt_pk_bf16_f32 v18, v24, v25
    v_exp_f32 v44, v44
    v_exp_f32 v45, v45
    v_cvt_pk_bf16_f32 v19, v26, v27
    v_cvt_pk_bf16_f32 v48, v44, v45
    v_cvt_pk_bf16_f32 v51, v44, v45
    s_waitcnt vmcnt(8)
    v_mfma_f32_16x16x32_bf16 v[36:39], v[72:75], v[16:19], 0
    v_pk_add_f32 v[12:13], v[20:21], v[22:23]
    v_pk_add_f32 v[14:15], v[24:25], v[26:27]
    v_mfma_f32_16x16x32_bf16 v[40:43], v[76:79], v[16:19], 0
    v_pk_add_f32 v[28:29], v[28:29], v[30:31]
    v_pk_add_f32 v[32:33], v[32:33], v[34:35]
    v_cvt_pk_bf16_f32 v54, v28, v29
    v_cvt_pk_bf16_f32 v55, v32, v33
    v_pk_add_f32 v[12:13], v[12:13], v[44:45]
    v_pk_add_f32 v[12:13], v[12:13], v[14:15]
    v_mfma_f32_16x16x16_bf16 v[36:39], v[54:55], v[48:49], v[36:39]
    v_add_f32 v14, v12, v13
    v_add_f32 v12, v12, v13
    v_mfma_f32_16x16x16_bf16 v[40:43], v[54:55], v[50:51], v[40:43]
    ds_read_b128 v[72:75], v0 offset:22528
    ds_read_b128 v[76:79], v0 offset:23552
    v_permlane32_swap_b32 v12, v14
    v_add_f32 v13, v12, v14
    v_add_f32 v12, v12, v14
    v_mov_b64 v[28:29], 0
    v_mov_b64 v[30:31], 0
    v_permlane16_swap_b32 v12, v13
    v_add_f32 v12, v12, v13
    v_rcp_f32 v12, v12
    v_cndmask_b32 v44, v37, v36, s[32:33]
    v_cndmask_b32 v45, v41, v40, s[32:33]
    v_cndmask_b32 v46, v39, v38, s[32:33]
    v_cndmask_b32 v47, v43, v42, s[32:33]
    v_pk_mul_f32 v[44:45], v[44:45], v[12:13] op_sel_hi:[1,0]
    v_pk_mul_f32 v[46:47], v[46:47], v[12:13] op_sel_hi:[1,0]
    v_cvt_pk_bf16_f32 v44, v44, v45
    v_cvt_pk_bf16_f32 v45, v46, v47
    ds_write_b64 v5, v[44:45]
    s_waitcnt lgkmcnt(3)
    buffer_store_dwordx4 v[52:55], v1, s[4:7], s15 offen sc1
    s_cmp_ge_u32 s10, 63
    s_cbranch_scc1 CH_END_32
    v_mov_b64 v[32:33], 0
    v_mov_b64 v[34:35], 0
    s_waitcnt vmcnt(5)
    v_cmp_eq_u32 vcc, 0, v10
    v_lshrrev_b32 v11, 1, v1
    s_and_b32 s27, vcc_lo, 15
    s_cselect_b32 s25, 0, 1
    s_cselect_b32 s28, s28, s20
    s_add_u32 s21, s28, 1024
    s_waitcnt lgkmcnt(0)
    s_barrier
    ds_read_b128 v[36:39], v1 offset:22528
    ds_read_b128 v[40:43], v1 offset:23552
    ds_read_b128 v[48:51], v0 offset:24576
    ds_read_b128 v[52:55], v0 offset:25600
    s_cmp_eq_u32 s29, 0
    s_cbranch_scc1 NT_41
    buffer_load_dwordx4 v9, s[4:7], s28 offen sc1 nt lds
NT_42:
    v_mov_b64 v[20:21], 0
    v_mov_b64 v[22:23], 0
    v_mov_b64 v[24:25], 0
    v_mov_b64 v[26:27], 0
    s_cmp_eq_u32 s29, 0
    s_cbranch_scc1 NT_43
    buffer_load_dwordx4 v9, s[4:7], s21 offen offset:1024 sc1 nt lds
NT_44:
    s_waitcnt lgkmcnt(3)
    s_waitcnt vmcnt(5)
    v_smfmac_f32_16x16x64_bf16 v[28:31], v[36:39], v[56:63], v2
    v_mov_b64 v[12:13], 0
    s_waitcnt vmcnt(3)
    v_smfmac_f32_16x16x64_bf16 v[32:35], v[36:39], v[64:71], v2
    v_mov_b64 v[14:15], 0
    s_waitcnt lgkmcnt(2)
    v_smfmac_f32_16x16x64_bf16 v[28:31], v[40:43], a[160:167], v2
    v_mov_b64 v[16:17], 0
    v_smfmac_f32_16x16x64_bf16 v[32:35], v[40:43], v[72:79], v2
    ds_read_b128 v[72:75], v0 offset:26624
    ds_read_b128 v[76:79], v0 offset:27648
    v_mov_b64 v[18:19], 0
    v_smfmac_f32_16x16x64_bf16 v[20:23], v[36:39], a[168:175], v2
    v_smfmac_f32_16x16x64_bf16 v[24:27], v[36:39], a[176:183], v2
    buffer_load_dwordx4 v[56:59], v1, s[4:7], s48 offen
    s_waitcnt lgkmcnt(2)
    v_smfmac_f32_16x16x64_bf16 v[20:23], v[40:43], v[48:55], v2
    ds_read_b128 v[48:51], v0 offset:28672
    ds_read_b128 v[52:55], v0 offset:29696
    v_pk_add_f32 v[28:29], v[28:29], v[30:31]
    v_pk_add_f32 v[32:33], v[32:33], v[34:35]
    v_smfmac_f32_16x16x64_bf16 v[24:27], v[40:43], a[184:191], v2
    buffer_load_dwordx4 v[64:67], v1, s[4:7], s49 offen
    v_cvt_pk_bf16_f32 v44, v28, v32
    v_cvt_pk_bf16_f32 v45, v29, v33
    v_smfmac_f32_16x16x64_bf16 v[12:15], v[36:39], a[192:199], v2
    v_bfi_b32 v44, 1, s26, v44
    v_mov_b64 v[28:29], 0
    s_waitcnt lgkmcnt(2)
    v_smfmac_f32_16x16x64_bf16 v[16:19], v[36:39], v[72:79], v2
    ds_read_b128 v[72:75], v0 offset:30720
    ds_read_b128 v[76:79], v0 offset:31744
    buffer_load_dwordx4 v[60:63], v1, s[4:7], s48 offen offset:1024
    v_mov_b64 v[30:31], 0
    v_mov_b64 v[32:33], 0
    v_smfmac_f32_16x16x64_bf16 v[12:15], v[40:43], a[200:207], v2
    v_mov_b64 v[34:35], 0
    v_pk_add_f32 v[20:21], v[20:21], v[22:23]
    v_smfmac_f32_16x16x64_bf16 v[16:19], v[40:43], a[208:215], v2
    buffer_load_dwordx4 v[68:71], v1, s[4:7], s49 offen offset:1024
    v_pk_add_f32 v[24:25], v[24:25], v[26:27]
    v_cvt_pk_bf16_f32 v46, v20, v24
    s_waitcnt lgkmcnt(2)
    v_smfmac_f32_16x16x64_bf16 v[28:31], v[36:39], v[48:55], v2
    ds_read_b128 v[48:51], v0 offset:32768
    ds_read_b128 v[52:55], v0 offset:33792
    v_cvt_pk_bf16_f32 v47, v21, v25
    v_bfi_b32 v46, 1, s26, v46
    v_smfmac_f32_16x16x64_bf16 v[32:35], v[36:39], a[216:223], v2
    buffer_store_dwordx4 v[44:47], v1, s[4:7], s24 offen offset:0 sc1
    v_mov_b64 v[20:21], 0
    v_smfmac_f32_16x16x64_bf16 v[28:31], v[40:43], a[224:231], v2
    v_mov_b64 v[22:23], 0
    v_mov_b64 v[24:25], 0
    s_waitcnt lgkmcnt(2)
    v_smfmac_f32_16x16x64_bf16 v[32:35], v[40:43], v[72:79], v2
    v_mov_b64 v[26:27], 0
    v_pk_add_f32 v[12:13], v[12:13], v[14:15]
    v_smfmac_f32_16x16x64_bf16 v[20:23], v[36:39], a[232:239], v2
    v_pk_add_f32 v[16:17], v[16:17], v[18:19]
    v_cvt_pk_bf16_f32 v44, v12, v16
    v_smfmac_f32_16x16x64_bf16 v[24:27], v[36:39], a[240:247], v2
    v_cvt_pk_bf16_f32 v45, v13, v17
    v_bfi_b32 v44, 1, s26, v44
    s_waitcnt lgkmcnt(0)
    v_smfmac_f32_16x16x64_bf16 v[20:23], v[40:43], v[48:55], v2
    v_pk_add_f32 v[28:29], v[28:29], v[30:31]
    v_pk_add_f32 v[32:33], v[32:33], v[34:35]
    v_smfmac_f32_16x16x64_bf16 v[24:27], v[40:43], a[248:255], v2
    v_cvt_pk_bf16_f32 v46, v28, v32
    v_cvt_pk_bf16_f32 v47, v29, v33
    v_bfi_b32 v46, 1, s26, v46
    buffer_store_dwordx4 v[44:47], v1, s[4:7], s24 offen offset:1024 sc1
    s_nop 0
    v_pk_add_f32 v[20:21], v[20:21], v[22:23]
    s_nop 1
    v_pk_add_f32 v[24:25], v[24:25], v[26:27]
    v_cvt_pk_bf16_f32 v44, v20, v24
    v_cvt_pk_bf16_f32 v45, v21, v25
    v_bfi_b32 v44, 1, s26, v44
    buffer_store_dwordx2 v[44:45], v11, s[4:7], s24 offen offset:2048 sc1
    s_barrier
    s_cmp_eq_u32 s22, 0
    s_cbranch_scc1 CH_NG_45
    v_mov_b64 v[36:37], 0
    v_mov_b64 v[38:39], 0
    s_mov_b32 exec_lo, 0x10001
    s_mov_b32 exec_hi, 0x10001
    v_mov_b32 v36, 0x3f80
    s_mov_b32 exec_lo, 0x20002
    s_mov_b32 exec_hi, 0x20002
    v_mov_b32 v36, 1.0
    s_mov_b32 exec_lo, 0x100010
    s_mov_b32 exec_hi, 0x100010
    v_mov_b32 v37, 0x3f80
    s_mov_b32 exec_lo, 0x200020
    s_mov_b32 exec_hi, 0x200020
    v_mov_b32 v37, 1.0
    s_mov_b32 exec_lo, 0x1000100
    s_mov_b32 exec_hi, 0x1000100
    v_mov_b32 v38, 0x3f80
    s_mov_b32 exec_lo, 0x2000200
    s_mov_b32 exec_hi, 0x2000200
    v_mov_b32 v38, 1.0
    s_mov_b32 exec_lo, 0x10001000
    s_mov_b32 exec_hi, 0x10001000
    v_mov_b32 v39, 0x3f80
    s_mov_b32 exec_lo, 0x20002000
    s_mov_b32 exec_hi, 0x20002000
    v_mov_b32 v39, 1.0
    s_mov_b64 exec, -1
    s_sleep 4
    buffer_load_dwordx4 v[12:15], v6, s[4:7], s16 offen sc1
    buffer_load_dwordx4 v[16:19], v6, s[4:7], s17 offen sc1
    buffer_load_dwordx4 v[20:23], v6, s[4:7], s18 offen sc1
    buffer_load_dwordx4 v[24:27], v6, s[4:7], s19 offen sc1
    buffer_load_dwordx4 v[72:75], v1, s[4:7], s52 offen
    buffer_load_dwordx4 v[76:79], v1, s[4:7], s52 offen offset:1024
    s_mov_b32 s35, 1
    s_waitcnt vmcnt(5)
    v_mfma_f32_16x16x32_bf16 v[40:43], v[36:39], v[12:15], 0
    v_bitop3_b32 v44, v12, v14, s26 bitop3:0x7e
    s_waitcnt vmcnt(4)
    v_mfma_f32_16x16x32_bf16 v[40:43], v[36:39], v[16:19], v[40:43]
    v_bitop3_b32 v45, v16, v18, s26 bitop3:0x7e
    s_waitcnt vmcnt(3)
    v_mfma_f32_16x16x32_bf16 v[40:43], v[36:39], v[20:23], v[40:43]
    v_bitop3_b32 v46, v20, v22, s26 bitop3:0x7e
    s_waitcnt vmcnt(2)
    v_mfma_f32_16x16x32_bf16 v[40:43], v[36:39], v[24:27], v[40:43]
    v_bitop3_b32 v47, v24, v26, s26 bitop3:0x7e
    v_or3_b32 v44, v44, v45, v46
    v_bitop3_b32 v44, v44, v47, 1 bitop3:0xa8
    v_cmp_ne_u32 vcc, 0, v44
    s_cbranch_vccnz CH_GA_49
    s_nop 2
    v_add_f32_dpp v40, v40, v40 row_ror:8 row_mask:0xf bank_mask:0xf
    v_add_f32_dpp v41, v41, v41 row_ror:8 row_mask:0xf bank_mask:0xf
    v_cvt_pk_bf16_f32 v40, v40, v41
    v_min_u32 v40, -2, v40
    s_mov_b64 exec, s[30:31]
    buffer_store_dword v40, v7, s[4:7], s13 offen sc1
    s_mov_b64 exec, -1
    s_branch CH_GO_48
CH_GA_49:
    s_mov_b64 exec, vcc
    buffer_load_dwordx4 v[12:15], v6, s[4:7], s16 offen sc1
    buffer_load_dwordx4 v[16:19], v6, s[4:7], s17 offen sc1
    buffer_load_dwordx4 v[20:23], v6, s[4:7], s18 offen sc1
    buffer_load_dwordx4 v[24:27], v6, s[4:7], s19 offen sc1
    s_mov_b64 exec, -1
    buffer_load_dwordx4 v[48:51], v1, s[4:7], s50 offen
    buffer_load_dwordx4 v[52:55], v1, s[4:7], s50 offen offset:1024
    s_mov_b32 s35, 2
    s_waitcnt vmcnt(5)
    v_mfma_f32_16x16x32_bf16 v[40:43], v[36:39], v[12:15], 0
    v_bitop3_b32 v44, v12, v14, s26 bitop3:0x7e
    s_waitcnt vmcnt(4)
    v_mfma_f32_16x16x32_bf16 v[40:43], v[36:39], v[16:19], v[40:43]
    v_bitop3_b32 v45, v16, v18, s26 bitop3:0x7e
    s_waitcnt vmcnt(3)
    v_mfma_f32_16x16x32_bf16 v[40:43], v[36:39], v[20:23], v[40:43]
    v_bitop3_b32 v46, v20, v22, s26 bitop3:0x7e
    s_waitcnt vmcnt(2)
    v_mfma_f32_16x16x32_bf16 v[40:43], v[36:39], v[24:27], v[40:43]
    v_bitop3_b32 v47, v24, v26, s26 bitop3:0x7e
    v_or3_b32 v44, v44, v45, v46
    v_bitop3_b32 v44, v44, v47, 1 bitop3:0xa8
    v_cmp_ne_u32 vcc, 0, v44
    s_cbranch_vccnz CH_GA_50
    s_nop 2
    v_add_f32_dpp v40, v40, v40 row_ror:8 row_mask:0xf bank_mask:0xf
    v_add_f32_dpp v41, v41, v41 row_ror:8 row_mask:0xf bank_mask:0xf
    v_cvt_pk_bf16_f32 v40, v40, v41
    v_min_u32 v40, -2, v40
    s_mov_b64 exec, s[30:31]
    buffer_store_dword v40, v7, s[4:7], s13 offen sc1
    s_mov_b64 exec, -1
    s_branch CH_GO_48
CH_GA_50:
    s_mov_b64 exec, vcc
    buffer_load_dwordx4 v[12:15], v6, s[4:7], s16 offen sc1
    buffer_load_dwordx4 v[16:19], v6, s[4:7], s17 offen sc1
    buffer_load_dwordx4 v[20:23], v6, s[4:7], s18 offen sc1
    buffer_load_dwordx4 v[24:27], v6, s[4:7], s19 offen sc1
    s_mov_b64 exec, -1
    buffer_load_dwordx4 v[28:31], v1, s[4:7], s51 offen
    buffer_load_dwordx4 v[32:35], v1, s[4:7], s51 offen offset:1024
    s_mov_b32 s35, 3
    s_waitcnt vmcnt(5)
    v_mfma_f32_16x16x32_bf16 v[40:43], v[36:39], v[12:15], 0
    v_bitop3_b32 v44, v12, v14, s26 bitop3:0x7e
    s_waitcnt vmcnt(4)
    v_mfma_f32_16x16x32_bf16 v[40:43], v[36:39], v[16:19], v[40:43]
    v_bitop3_b32 v45, v16, v18, s26 bitop3:0x7e
    s_waitcnt vmcnt(3)
    v_mfma_f32_16x16x32_bf16 v[40:43], v[36:39], v[20:23], v[40:43]
    v_bitop3_b32 v46, v20, v22, s26 bitop3:0x7e
    s_waitcnt vmcnt(2)
    v_mfma_f32_16x16x32_bf16 v[40:43], v[36:39], v[24:27], v[40:43]
    v_bitop3_b32 v47, v24, v26, s26 bitop3:0x7e
    v_or3_b32 v44, v44, v45, v46
    v_bitop3_b32 v44, v44, v47, 1 bitop3:0xa8
    v_cmp_ne_u32 vcc, 0, v44
    s_cbranch_vccnz CH_GA_51
    s_nop 2
    v_add_f32_dpp v40, v40, v40 row_ror:8 row_mask:0xf bank_mask:0xf
    v_add_f32_dpp v41, v41, v41 row_ror:8 row_mask:0xf bank_mask:0xf
    v_cvt_pk_bf16_f32 v40, v40, v41
    v_min_u32 v40, -2, v40
    s_mov_b64 exec, s[30:31]
    buffer_store_dword v40, v7, s[4:7], s13 offen sc1
    s_mov_b64 exec, -1
    s_branch CH_GO_48
CH_GA_51:
CH_G_47:
    s_add_u32 s35, s35, 1
    s_cmp_ge_u32 s35, 200000
    s_cbranch_scc1 F_CH
    s_mov_b64 exec, vcc
    buffer_load_dwordx4 v[12:15], v6, s[4:7], s16 offen sc1
    buffer_load_dwordx4 v[16:19], v6, s[4:7], s17 offen sc1
    buffer_load_dwordx4 v[20:23], v6, s[4:7], s18 offen sc1
    buffer_load_dwordx4 v[24:27], v6, s[4:7], s19 offen sc1
    s_mov_b64 exec, -1
    s_waitcnt vmcnt(3)
    v_mfma_f32_16x16x32_bf16 v[40:43], v[36:39], v[12:15], 0
    v_bitop3_b32 v44, v12, v14, s26 bitop3:0x7e
    s_waitcnt vmcnt(2)
    v_mfma_f32_16x16x32_bf16 v[40:43], v[36:39], v[16:19], v[40:43]
    v_bitop3_b32 v45, v16, v18, s26 bitop3:0x7e
    s_waitcnt vmcnt(1)
    v_mfma_f32_16x16x32_bf16 v[40:43], v[36:39], v[20:23], v[40:43]
    v_bitop3_b32 v46, v20, v22, s26 bitop3:0x7e
    s_waitcnt vmcnt(0)
    v_mfma_f32_16x16x32_bf16 v[40:43], v[36:39], v[24:27], v[40:43]
    v_bitop3_b32 v47, v24, v26, s26 bitop3:0x7e
    v_or3_b32 v44, v44, v45, v46
    v_bitop3_b32 v44, v44, v47, 1 bitop3:0xa8
    v_cmp_ne_u32 vcc, 0, v44
    s_cbranch_vccnz CH_G_47
    s_nop 2
    v_add_f32_dpp v40, v40, v40 row_ror:8 row_mask:0xf bank_mask:0xf
    v_add_f32_dpp v41, v41, v41 row_ror:8 row_mask:0xf bank_mask:0xf
    v_cvt_pk_bf16_f32 v40, v40, v41
    v_min_u32 v40, -2, v40
    s_mov_b64 exec, s[30:31]
    buffer_store_dword v40, v7, s[4:7], s13 offen sc1
    s_mov_b64 exec, -1
CH_GO_48:
    s_cmp_gt_u32 s35, 1
    s_cbranch_scc1 CH_RS_52
    buffer_load_dwordx4 v[48:51], v1, s[4:7], s50 offen
    buffer_load_dwordx4 v[52:55], v1, s[4:7], s50 offen offset:1024
CH_RS_52:
    s_cmp_gt_u32 s35, 2
    s_cbranch_scc1 CH_RS_53
    buffer_load_dwordx4 v[28:31], v1, s[4:7], s51 offen
    buffer_load_dwordx4 v[32:35], v1, s[4:7], s51 offen offset:1024
CH_RS_53:
    s_branch CH_NG2_46
CH_NG_45:
    buffer_load_dwordx4 v[72:75], v1, s[4:7], s52 offen
    buffer_load_dwordx4 v[76:79], v1, s[4:7], s52 offen offset:1024
    s_waitcnt vmcnt(0)
    buffer_load_dwordx4 v[48:51], v1, s[4:7], s50 offen
    buffer_load_dwordx4 v[52:55], v1, s[4:7], s50 offen offset:1024
    s_waitcnt vmcnt(0)
    buffer_load_dwordx4 v[28:31], v1, s[4:7], s51 offen
    buffer_load_dwordx4 v[32:35], v1, s[4:7], s51 offen offset:1024
    s_waitcnt vmcnt(0)
CH_NG2_46:
    s_mov_b32 s27, s12
    s_mov_b32 s12, s13
    s_mov_b32 s13, s14
    s_mov_b32 s14, s27
    s_add_u32 s23, s20, s94
    s_add_u32 s20, s20, 524288
    s_add_u32 s15, s15, 131072
    s_mov_b32 s39, s34
    s_add_u32 s34, s34, 64
    s_add_u32 s42, s42, 64
    s_xor_b32 s26, s26, 1
    s_add_u32 s10, s10, 1
    s_branch CH_STEP_31
CH_END_32:
    s_lshl_b32 s3, s11, 2
    s_mov_b32 s39, s34
    s_waitcnt vmcnt(0)
    s_mov_b64 exec, 1
    buffer_store_dword v2, off, s[4:7], s39 sc1
    s_endpgm
NT_18:
    buffer_load_dwordx4 v9, s[4:7], s28 offen sc1 lds
    s_branch NT_19
NT_20:
    buffer_load_dwordx4 v9, s[4:7], s21 offen offset:1024 sc1 lds
    s_branch NT_21
NT_41:
    buffer_load_dwordx4 v9, s[4:7], s28 offen sc1 lds
    s_branch NT_42
NT_43:
    buffer_load_dwordx4 v9, s[4:7], s21 offen offset:1024 sc1 lds
    s_branch NT_44
F_CH:
    s_endpgm
.p2align 6
R_KV:
    v_lshrrev_b32 v2, 6, v0
    v_and_b32 v0, 63, v0
    v_readfirstlane_b32 s9, v2
    v_lshlrev_b32 v1, 4, v0
    v_lshlrev_b32 v11, 2, v0
    v_mov_b32 v2, v1
    v_and_b32 v6, 31, v0
    v_lshrrev_b32 v7, 5, v0
    v_lshlrev_b32 v4, 5, v6
    s_lshl_b32 s21, s9, 8
    s_add_u32 s21, s21, 83968
    v_lshlrev_b32 v3, 2, v6
    v_add_u32 v3, s21, v3
    v_lshlrev_b32 v5, 4, v7
    v_add_u32 v5, s21, v5
    s_mov_b32 s10, 0
    s_mov_b32 s18, 0
    s_mov_b32 s19, 0
    s_mov_b32 s25, 1
    s_mul_i32 s20, s9, 10240
    s_lshl_b32 s23, s8, 2
    s_add_u32 s23, s23, s9
    s_mul_i32 s12, s11, 5242880
    s_mov_b32 s14, 0x3ff
    s_mov_b32 s15, 0
    s_mul_i32 s17, s11, 32768
    s_add_u32 s13, s17, 155385856
    s_mul_i32 s16, s11, 33554432
    s_lshl_b32 s21, s8, 14
    s_add_u32 s16, s16, s21
    s_and_b32 s21, s9, 1
    s_lshl_b32 s21, s21, 13
    s_add_u32 s16, s16, s21
    s_lshr_b32 s21, s9, 1
    s_lshl_b32 s21, s21, 12
    s_add_u32 s16, s16, s21
    s_add_u32 s16, s16, 0
    s_mul_i32 s17, s11, 131072
    s_mul_i32 s21, s8, 4080
    s_add_u32 s17, s17, s21
    s_add_u32 s17, s17, 155451392
    s_lshl_b32 s21, s8, 1
    s_and_b32 s22, s9, 1
    s_add_u32 s21, s21, s22
    s_lshl_b32 s22, s21, 7
    s_lshl_b32 s36, s11, 17
    s_add_u32 s36, s36, 155975680
    s_add_u32 s12, s12, 116391936
    s_lshl_b32 s21, s9, 7
    s_add_u32 s13, s13, s21
    s_add_u32 s12, s12, s20
    s_lshl_b32 s21, s23, 2
    s_add_u32 s17, s17, s21
    s_lshl_b32 s21, s8, 12
    s_mul_i32 s26, s11, 131072
    s_add_u32 s21, s21, s26
    s_add_u32 s21, s21, 155713024
    s_sub_u32 s21, s21, s13
    v_writelane_b32 v11, s21, 10
    v_mov_b32 v12, 0
    s_mov_b32 s21, -448
    v_writelane_b32 v12, s21, 10
    s_cmp_ge_u32 s9, 2
    s_cbranch_scc1 T1_SRC_54
    s_load_dwordx2 s[88:89], s[0:1], 24
    s_mov_b32 s90, 5242880
    s_mov_b32 s91, 0x00020000
    s_mov_b32 s92, 0x05040100
    s_mov_b32 s93, 0x07060302
    s_waitcnt lgkmcnt(0)
    s_branch T1_SRC_55
T1_SRC_54:
    s_load_dwordx2 s[88:89], s[0:1], 32
    s_mov_b32 s90, 5242880
    s_mov_b32 s91, 0x00020000
    s_mov_b32 s92, 0x05040100
    s_mov_b32 s93, 0x07060302
    s_waitcnt lgkmcnt(0)
T1_SRC_55:
    v_mul_u32_u24 v8, 65536, v7
    v_lshl_add_u32 v8, v6, 2, v8
    v_add_u32 v48, 0, v8
    v_add_u32 v49, 8192, v8
    v_add_u32 v50, 16384, v8
    v_add_u32 v51, 24576, v8
    v_add_u32 v52, 32768, v8
    v_add_u32 v53, 40960, v8
    v_add_u32 v54, 49152, v8
    v_add_u32 v55, 57344, v8
    buffer_load_dword v64, v48, s[88:91], s22 offen offset:0
    buffer_load_dword v65, v49, s[88:91], s22 offen offset:0
    buffer_load_dword v66, v50, s[88:91], s22 offen offset:0
    buffer_load_dword v67, v51, s[88:91], s22 offen offset:0
    buffer_load_dword v68, v52, s[88:91], s22 offen offset:0
    buffer_load_dword v69, v53, s[88:91], s22 offen offset:0
    buffer_load_dword v70, v54, s[88:91], s22 offen offset:0
    buffer_load_dword v71, v55, s[88:91], s22 offen offset:0
    s_add_u32 s22, s22, 131072
    buffer_load_dword v72, v48, s[88:91], s22 offen offset:0
    buffer_load_dword v73, v49, s[88:91], s22 offen offset:0
    buffer_load_dword v74, v50, s[88:91], s22 offen offset:0
    buffer_load_dword v75, v51, s[88:91], s22 offen offset:0
    buffer_load_dword v76, v52, s[88:91], s22 offen offset:0
    buffer_load_dword v77, v53, s[88:91], s22 offen offset:0
    buffer_load_dword v78, v54, s[88:91], s22 offen offset:0
    buffer_load_dword v79, v55, s[88:91], s22 offen offset:0
    s_add_u32 s22, s22, 131072
    buffer_load_dword v80, v48, s[88:91], s22 offen offset:0
    buffer_load_dword v81, v49, s[88:91], s22 offen offset:0
    buffer_load_dword v82, v50, s[88:91], s22 offen offset:0
    buffer_load_dword v83, v51, s[88:91], s22 offen offset:0
    buffer_load_dword v84, v52, s[88:91], s22 offen offset:0
    buffer_load_dword v85, v53, s[88:91], s22 offen offset:0
    buffer_load_dword v86, v54, s[88:91], s22 offen offset:0
    buffer_load_dword v87, v55, s[88:91], s22 offen offset:0
    s_add_u32 s22, s22, 131072
    buffer_load_dword v88, v48, s[88:91], s22 offen offset:0
    buffer_load_dword v89, v49, s[88:91], s22 offen offset:0
    buffer_load_dword v90, v50, s[88:91], s22 offen offset:0
    buffer_load_dword v91, v51, s[88:91], s22 offen offset:0
    buffer_load_dword v92, v52, s[88:91], s22 offen offset:0
    buffer_load_dword v93, v53, s[88:91], s22 offen offset:0
    buffer_load_dword v94, v54, s[88:91], s22 offen offset:0
    buffer_load_dword v95, v55, s[88:91], s22 offen offset:0
    s_add_u32 s22, s22, 131072
    buffer_load_dword v96, v48, s[88:91], s22 offen offset:0
    buffer_load_dword v97, v49, s[88:91], s22 offen offset:0
    buffer_load_dword v98, v50, s[88:91], s22 offen offset:0
    buffer_load_dword v99, v51, s[88:91], s22 offen offset:0
    buffer_load_dword v100, v52, s[88:91], s22 offen offset:0
    buffer_load_dword v101, v53, s[88:91], s22 offen offset:0
    buffer_load_dword v102, v54, s[88:91], s22 offen offset:0
    buffer_load_dword v103, v55, s[88:91], s22 offen offset:0
    s_add_u32 s22, s22, 131072
    buffer_load_dword v104, v48, s[88:91], s22 offen offset:0
    buffer_load_dword v105, v49, s[88:91], s22 offen offset:0
    buffer_load_dword v106, v50, s[88:91], s22 offen offset:0
    buffer_load_dword v107, v51, s[88:91], s22 offen offset:0
    buffer_load_dword v108, v52, s[88:91], s22 offen offset:0
    buffer_load_dword v109, v53, s[88:91], s22 offen offset:0
    buffer_load_dword v110, v54, s[88:91], s22 offen offset:0
    buffer_load_dword v111, v55, s[88:91], s22 offen offset:0
    s_add_u32 s22, s22, 131072
    buffer_load_dword v112, v48, s[88:91], s22 offen offset:0
    buffer_load_dword v113, v49, s[88:91], s22 offen offset:0
    buffer_load_dword v114, v50, s[88:91], s22 offen offset:0
    buffer_load_dword v115, v51, s[88:91], s22 offen offset:0
    buffer_load_dword v116, v52, s[88:91], s22 offen offset:0
    buffer_load_dword v117, v53, s[88:91], s22 offen offset:0
    buffer_load_dword v118, v54, s[88:91], s22 offen offset:0
    buffer_load_dword v119, v55, s[88:91], s22 offen offset:0
    s_add_u32 s22, s22, 131072
    s_waitcnt vmcnt(48)
    v_perm_b32 v56, v65, v64, s92
    v_perm_b32 v57, v67, v66, s92
    v_perm_b32 v58, v69, v68, s92
    v_perm_b32 v59, v71, v70, s92
    v_accvgpr_write_b32 a0, v56
    v_accvgpr_write_b32 a1, v57
    v_accvgpr_write_b32 a2, v58
    v_accvgpr_write_b32 a3, v59
    v_perm_b32 v60, v65, v64, s93
    v_perm_b32 v61, v67, v66, s93
    v_perm_b32 v62, v69, v68, s93
    v_perm_b32 v63, v71, v70, s93
    v_accvgpr_write_b32 a160, v60
    v_accvgpr_write_b32 a161, v61
    v_accvgpr_write_b32 a162, v62
    v_accvgpr_write_b32 a163, v63
    buffer_load_dword v64, v48, s[88:91], s22 offen offset:0
    buffer_load_dword v65, v49, s[88:91], s22 offen offset:0
    buffer_load_dword v66, v50, s[88:91], s22 offen offset:0
    buffer_load_dword v67, v51, s[88:91], s22 offen offset:0
    buffer_load_dword v68, v52, s[88:91], s22 offen offset:0
    buffer_load_dword v69, v53, s[88:91], s22 offen offset:0
    buffer_load_dword v70, v54, s[88:91], s22 offen offset:0
    buffer_load_dword v71, v55, s[88:91], s22 offen offset:0
    s_add_u32 s22, s22, 131072
    s_waitcnt vmcnt(48)
    v_perm_b32 v56, v73, v72, s92
    v_perm_b32 v57, v75, v74, s92
    v_perm_b32 v58, v77, v76, s92
    v_perm_b32 v59, v79, v78, s92
    v_accvgpr_write_b32 a4, v56
    v_accvgpr_write_b32 a5, v57
    v_accvgpr_write_b32 a6, v58
    v_accvgpr_write_b32 a7, v59
    v_perm_b32 v60, v73, v72, s93
    v_perm_b32 v61, v75, v74, s93
    v_perm_b32 v62, v77, v76, s93
    v_perm_b32 v63, v79, v78, s93
    v_accvgpr_write_b32 a164, v60
    v_accvgpr_write_b32 a165, v61
    v_accvgpr_write_b32 a166, v62
    v_accvgpr_write_b32 a167, v63
    buffer_load_dword v72, v48, s[88:91], s22 offen offset:0
    buffer_load_dword v73, v49, s[88:91], s22 offen offset:0
    buffer_load_dword v74, v50, s[88:91], s22 offen offset:0
    buffer_load_dword v75, v51, s[88:91], s22 offen offset:0
    buffer_load_dword v76, v52, s[88:91], s22 offen offset:0
    buffer_load_dword v77, v53, s[88:91], s22 offen offset:0
    buffer_load_dword v78, v54, s[88:91], s22 offen offset:0
    buffer_load_dword v79, v55, s[88:91], s22 offen offset:0
    s_add_u32 s22, s22, 131072
    s_waitcnt vmcnt(48)
    v_perm_b32 v56, v81, v80, s92
    v_perm_b32 v57, v83, v82, s92
    v_perm_b32 v58, v85, v84, s92
    v_perm_b32 v59, v87, v86, s92
    v_accvgpr_write_b32 a8, v56
    v_accvgpr_write_b32 a9, v57
    v_accvgpr_write_b32 a10, v58
    v_accvgpr_write_b32 a11, v59
    v_perm_b32 v60, v81, v80, s93
    v_perm_b32 v61, v83, v82, s93
    v_perm_b32 v62, v85, v84, s93
    v_perm_b32 v63, v87, v86, s93
    v_accvgpr_write_b32 a168, v60
    v_accvgpr_write_b32 a169, v61
    v_accvgpr_write_b32 a170, v62
    v_accvgpr_write_b32 a171, v63
    buffer_load_dword v80, v48, s[88:91], s22 offen offset:0
    buffer_load_dword v81, v49, s[88:91], s22 offen offset:0
    buffer_load_dword v82, v50, s[88:91], s22 offen offset:0
    buffer_load_dword v83, v51, s[88:91], s22 offen offset:0
    buffer_load_dword v84, v52, s[88:91], s22 offen offset:0
    buffer_load_dword v85, v53, s[88:91], s22 offen offset:0
    buffer_load_dword v86, v54, s[88:91], s22 offen offset:0
    buffer_load_dword v87, v55, s[88:91], s22 offen offset:0
    s_add_u32 s22, s22, 131072
    s_waitcnt vmcnt(48)
    v_perm_b32 v56, v89, v88, s92
    v_perm_b32 v57, v91, v90, s92
    v_perm_b32 v58, v93, v92, s92
    v_perm_b32 v59, v95, v94, s92
    v_accvgpr_write_b32 a12, v56
    v_accvgpr_write_b32 a13, v57
    v_accvgpr_write_b32 a14, v58
    v_accvgpr_write_b32 a15, v59
    v_perm_b32 v60, v89, v88, s93
    v_perm_b32 v61, v91, v90, s93
    v_perm_b32 v62, v93, v92, s93
    v_perm_b32 v63, v95, v94, s93
    v_accvgpr_write_b32 a172, v60
    v_accvgpr_write_b32 a173, v61
    v_accvgpr_write_b32 a174, v62
    v_accvgpr_write_b32 a175, v63
    buffer_load_dword v88, v48, s[88:91], s22 offen offset:0
    buffer_load_dword v89, v49, s[88:91], s22 offen offset:0
    buffer_load_dword v90, v50, s[88:91], s22 offen offset:0
    buffer_load_dword v91, v51, s[88:91], s22 offen offset:0
    buffer_load_dword v92, v52, s[88:91], s22 offen offset:0
    buffer_load_dword v93, v53, s[88:91], s22 offen offset:0
    buffer_load_dword v94, v54, s[88:91], s22 offen offset:0
    buffer_load_dword v95, v55, s[88:91], s22 offen offset:0
    s_add_u32 s22, s22, 131072
    s_waitcnt vmcnt(48)
    v_perm_b32 v56, v97, v96, s92
    v_perm_b32 v57, v99, v98, s92
    v_perm_b32 v58, v101, v100, s92
    v_perm_b32 v59, v103, v102, s92
    v_accvgpr_write_b32 a16, v56
    v_accvgpr_write_b32 a17, v57
    v_accvgpr_write_b32 a18, v58
    v_accvgpr_write_b32 a19, v59
    v_perm_b32 v60, v97, v96, s93
    v_perm_b32 v61, v99, v98, s93
    v_perm_b32 v62, v101, v100, s93
    v_perm_b32 v63, v103, v102, s93
    v_accvgpr_write_b32 a176, v60
    v_accvgpr_write_b32 a177, v61
    v_accvgpr_write_b32 a178, v62
    v_accvgpr_write_b32 a179, v63
    buffer_load_dword v96, v48, s[88:91], s22 offen offset:0
    buffer_load_dword v97, v49, s[88:91], s22 offen offset:0
    buffer_load_dword v98, v50, s[88:91], s22 offen offset:0
    buffer_load_dword v99, v51, s[88:91], s22 offen offset:0
    buffer_load_dword v100, v52, s[88:91], s22 offen offset:0
    buffer_load_dword v101, v53, s[88:91], s22 offen offset:0
    buffer_load_dword v102, v54, s[88:91], s22 offen offset:0
    buffer_load_dword v103, v55, s[88:91], s22 offen offset:0
    s_add_u32 s22, s22, 131072
    s_waitcnt vmcnt(48)
    v_perm_b32 v56, v105, v104, s92
    v_perm_b32 v57, v107, v106, s92
    v_perm_b32 v58, v109, v108, s92
    v_perm_b32 v59, v111, v110, s92
    v_accvgpr_write_b32 a20, v56
    v_accvgpr_write_b32 a21, v57
    v_accvgpr_write_b32 a22, v58
    v_accvgpr_write_b32 a23, v59
    v_perm_b32 v60, v105, v104, s93
    v_perm_b32 v61, v107, v106, s93
    v_perm_b32 v62, v109, v108, s93
    v_perm_b32 v63, v111, v110, s93
    v_accvgpr_write_b32 a180, v60
    v_accvgpr_write_b32 a181, v61
    v_accvgpr_write_b32 a182, v62
    v_accvgpr_write_b32 a183, v63
    buffer_load_dword v104, v48, s[88:91], s22 offen offset:0
    buffer_load_dword v105, v49, s[88:91], s22 offen offset:0
    buffer_load_dword v106, v50, s[88:91], s22 offen offset:0
    buffer_load_dword v107, v51, s[88:91], s22 offen offset:0
    buffer_load_dword v108, v52, s[88:91], s22 offen offset:0
    buffer_load_dword v109, v53, s[88:91], s22 offen offset:0
    buffer_load_dword v110, v54, s[88:91], s22 offen offset:0
    buffer_load_dword v111, v55, s[88:91], s22 offen offset:0
    s_add_u32 s22, s22, 131072
    s_waitcnt vmcnt(48)
    v_perm_b32 v56, v113, v112, s92
    v_perm_b32 v57, v115, v114, s92
    v_perm_b32 v58, v117, v116, s92
    v_perm_b32 v59, v119, v118, s92
    v_accvgpr_write_b32 a24, v56
    v_accvgpr_write_b32 a25, v57
    v_accvgpr_write_b32 a26, v58
    v_accvgpr_write_b32 a27, v59
    v_perm_b32 v60, v113, v112, s93
    v_perm_b32 v61, v115, v114, s93
    v_perm_b32 v62, v117, v116, s93
    v_perm_b32 v63, v119, v118, s93
    v_accvgpr_write_b32 a184, v60
    v_accvgpr_write_b32 a185, v61
    v_accvgpr_write_b32 a186, v62
    v_accvgpr_write_b32 a187, v63
    buffer_load_dword v112, v48, s[88:91], s22 offen offset:0
    buffer_load_dword v113, v49, s[88:91], s22 offen offset:0
    buffer_load_dword v114, v50, s[88:91], s22 offen offset:0
    buffer_load_dword v115, v51, s[88:91], s22 offen offset:0
    buffer_load_dword v116, v52, s[88:91], s22 offen offset:0
    buffer_load_dword v117, v53, s[88:91], s22 offen offset:0
    buffer_load_dword v118, v54, s[88:91], s22 offen offset:0
    buffer_load_dword v119, v55, s[88:91], s22 offen offset:0
    s_add_u32 s22, s22, 131072
    s_waitcnt vmcnt(48)
    v_perm_b32 v56, v65, v64, s92
    v_perm_b32 v57, v67, v66, s92
    v_perm_b32 v58, v69, v68, s92
    v_perm_b32 v59, v71, v70, s92
    v_accvgpr_write_b32 a28, v56
    v_accvgpr_write_b32 a29, v57
    v_accvgpr_write_b32 a30, v58
    v_accvgpr_write_b32 a31, v59
    v_perm_b32 v60, v65, v64, s93
    v_perm_b32 v61, v67, v66, s93
    v_perm_b32 v62, v69, v68, s93
    v_perm_b32 v63, v71, v70, s93
    v_accvgpr_write_b32 a188, v60
    v_accvgpr_write_b32 a189, v61
    v_accvgpr_write_b32 a190, v62
    v_accvgpr_write_b32 a191, v63
    buffer_load_dword v64, v48, s[88:91], s22 offen offset:0
    buffer_load_dword v65, v49, s[88:91], s22 offen offset:0
    buffer_load_dword v66, v50, s[88:91], s22 offen offset:0
    buffer_load_dword v67, v51, s[88:91], s22 offen offset:0
    buffer_load_dword v68, v52, s[88:91], s22 offen offset:0
    buffer_load_dword v69, v53, s[88:91], s22 offen offset:0
    buffer_load_dword v70, v54, s[88:91], s22 offen offset:0
    buffer_load_dword v71, v55, s[88:91], s22 offen offset:0
    s_add_u32 s22, s22, 131072
    s_waitcnt vmcnt(48)
    v_perm_b32 v56, v73, v72, s92
    v_perm_b32 v57, v75, v74, s92
    v_perm_b32 v58, v77, v76, s92
    v_perm_b32 v59, v79, v78, s92
    v_accvgpr_write_b32 a32, v56
    v_accvgpr_write_b32 a33, v57
    v_accvgpr_write_b32 a34, v58
    v_accvgpr_write_b32 a35, v59
    v_perm_b32 v60, v73, v72, s93
    v_perm_b32 v61, v75, v74, s93
    v_perm_b32 v62, v77, v76, s93
    v_perm_b32 v63, v79, v78, s93
    v_accvgpr_write_b32 a192, v60
    v_accvgpr_write_b32 a193, v61
    v_accvgpr_write_b32 a194, v62
    v_accvgpr_write_b32 a195, v63
    buffer_load_dword v72, v48, s[88:91], s22 offen offset:0
    buffer_load_dword v73, v49, s[88:91], s22 offen offset:0
    buffer_load_dword v74, v50, s[88:91], s22 offen offset:0
    buffer_load_dword v75, v51, s[88:91], s22 offen offset:0
    buffer_load_dword v76, v52, s[88:91], s22 offen offset:0
    buffer_load_dword v77, v53, s[88:91], s22 offen offset:0
    buffer_load_dword v78, v54, s[88:91], s22 offen offset:0
    buffer_load_dword v79, v55, s[88:91], s22 offen offset:0
    s_add_u32 s22, s22, 131072
    s_waitcnt vmcnt(48)
    v_perm_b32 v56, v81, v80, s92
    v_perm_b32 v57, v83, v82, s92
    v_perm_b32 v58, v85, v84, s92
    v_perm_b32 v59, v87, v86, s92
    v_accvgpr_write_b32 a36, v56
    v_accvgpr_write_b32 a37, v57
    v_accvgpr_write_b32 a38, v58
    v_accvgpr_write_b32 a39, v59
    v_perm_b32 v60, v81, v80, s93
    v_perm_b32 v61, v83, v82, s93
    v_perm_b32 v62, v85, v84, s93
    v_perm_b32 v63, v87, v86, s93
    v_accvgpr_write_b32 a196, v60
    v_accvgpr_write_b32 a197, v61
    v_accvgpr_write_b32 a198, v62
    v_accvgpr_write_b32 a199, v63
    buffer_load_dword v80, v48, s[88:91], s22 offen offset:0
    buffer_load_dword v81, v49, s[88:91], s22 offen offset:0
    buffer_load_dword v82, v50, s[88:91], s22 offen offset:0
    buffer_load_dword v83, v51, s[88:91], s22 offen offset:0
    buffer_load_dword v84, v52, s[88:91], s22 offen offset:0
    buffer_load_dword v85, v53, s[88:91], s22 offen offset:0
    buffer_load_dword v86, v54, s[88:91], s22 offen offset:0
    buffer_load_dword v87, v55, s[88:91], s22 offen offset:0
    s_add_u32 s22, s22, 131072
    s_waitcnt vmcnt(48)
    v_perm_b32 v56, v89, v88, s92
    v_perm_b32 v57, v91, v90, s92
    v_perm_b32 v58, v93, v92, s92
    v_perm_b32 v59, v95, v94, s92
    v_accvgpr_write_b32 a40, v56
    v_accvgpr_write_b32 a41, v57
    v_accvgpr_write_b32 a42, v58
    v_accvgpr_write_b32 a43, v59
    v_perm_b32 v60, v89, v88, s93
    v_perm_b32 v61, v91, v90, s93
    v_perm_b32 v62, v93, v92, s93
    v_perm_b32 v63, v95, v94, s93
    v_accvgpr_write_b32 a200, v60
    v_accvgpr_write_b32 a201, v61
    v_accvgpr_write_b32 a202, v62
    v_accvgpr_write_b32 a203, v63
    buffer_load_dword v88, v48, s[88:91], s22 offen offset:0
    buffer_load_dword v89, v49, s[88:91], s22 offen offset:0
    buffer_load_dword v90, v50, s[88:91], s22 offen offset:0
    buffer_load_dword v91, v51, s[88:91], s22 offen offset:0
    buffer_load_dword v92, v52, s[88:91], s22 offen offset:0
    buffer_load_dword v93, v53, s[88:91], s22 offen offset:0
    buffer_load_dword v94, v54, s[88:91], s22 offen offset:0
    buffer_load_dword v95, v55, s[88:91], s22 offen offset:0
    s_add_u32 s22, s22, 131072
    s_waitcnt vmcnt(48)
    v_perm_b32 v56, v97, v96, s92
    v_perm_b32 v57, v99, v98, s92
    v_perm_b32 v58, v101, v100, s92
    v_perm_b32 v59, v103, v102, s92
    v_accvgpr_write_b32 a44, v56
    v_accvgpr_write_b32 a45, v57
    v_accvgpr_write_b32 a46, v58
    v_accvgpr_write_b32 a47, v59
    v_perm_b32 v60, v97, v96, s93
    v_perm_b32 v61, v99, v98, s93
    v_perm_b32 v62, v101, v100, s93
    v_perm_b32 v63, v103, v102, s93
    v_accvgpr_write_b32 a204, v60
    v_accvgpr_write_b32 a205, v61
    v_accvgpr_write_b32 a206, v62
    v_accvgpr_write_b32 a207, v63
    buffer_load_dword v96, v48, s[88:91], s22 offen offset:0
    buffer_load_dword v97, v49, s[88:91], s22 offen offset:0
    buffer_load_dword v98, v50, s[88:91], s22 offen offset:0
    buffer_load_dword v99, v51, s[88:91], s22 offen offset:0
    buffer_load_dword v100, v52, s[88:91], s22 offen offset:0
    buffer_load_dword v101, v53, s[88:91], s22 offen offset:0
    buffer_load_dword v102, v54, s[88:91], s22 offen offset:0
    buffer_load_dword v103, v55, s[88:91], s22 offen offset:0
    s_add_u32 s22, s22, 131072
    s_waitcnt vmcnt(48)
    v_perm_b32 v56, v105, v104, s92
    v_perm_b32 v57, v107, v106, s92
    v_perm_b32 v58, v109, v108, s92
    v_perm_b32 v59, v111, v110, s92
    v_accvgpr_write_b32 a48, v56
    v_accvgpr_write_b32 a49, v57
    v_accvgpr_write_b32 a50, v58
    v_accvgpr_write_b32 a51, v59
    v_perm_b32 v60, v105, v104, s93
    v_perm_b32 v61, v107, v106, s93
    v_perm_b32 v62, v109, v108, s93
    v_perm_b32 v63, v111, v110, s93
    v_accvgpr_write_b32 a208, v60
    v_accvgpr_write_b32 a209, v61
    v_accvgpr_write_b32 a210, v62
    v_accvgpr_write_b32 a211, v63
    buffer_load_dword v104, v48, s[88:91], s22 offen offset:0
    buffer_load_dword v105, v49, s[88:91], s22 offen offset:0
    buffer_load_dword v106, v50, s[88:91], s22 offen offset:0
    buffer_load_dword v107, v51, s[88:91], s22 offen offset:0
    buffer_load_dword v108, v52, s[88:91], s22 offen offset:0
    buffer_load_dword v109, v53, s[88:91], s22 offen offset:0
    buffer_load_dword v110, v54, s[88:91], s22 offen offset:0
    buffer_load_dword v111, v55, s[88:91], s22 offen offset:0
    s_add_u32 s22, s22, 131072
    s_waitcnt vmcnt(48)
    v_perm_b32 v56, v113, v112, s92
    v_perm_b32 v57, v115, v114, s92
    v_perm_b32 v58, v117, v116, s92
    v_perm_b32 v59, v119, v118, s92
    v_accvgpr_write_b32 a52, v56
    v_accvgpr_write_b32 a53, v57
    v_accvgpr_write_b32 a54, v58
    v_accvgpr_write_b32 a55, v59
    v_perm_b32 v60, v113, v112, s93
    v_perm_b32 v61, v115, v114, s93
    v_perm_b32 v62, v117, v116, s93
    v_perm_b32 v63, v119, v118, s93
    v_accvgpr_write_b32 a212, v60
    v_accvgpr_write_b32 a213, v61
    v_accvgpr_write_b32 a214, v62
    v_accvgpr_write_b32 a215, v63
    buffer_load_dword v112, v48, s[88:91], s22 offen offset:0
    buffer_load_dword v113, v49, s[88:91], s22 offen offset:0
    buffer_load_dword v114, v50, s[88:91], s22 offen offset:0
    buffer_load_dword v115, v51, s[88:91], s22 offen offset:0
    buffer_load_dword v116, v52, s[88:91], s22 offen offset:0
    buffer_load_dword v117, v53, s[88:91], s22 offen offset:0
    buffer_load_dword v118, v54, s[88:91], s22 offen offset:0
    buffer_load_dword v119, v55, s[88:91], s22 offen offset:0
    s_add_u32 s22, s22, 131072
    s_waitcnt vmcnt(48)
    v_perm_b32 v56, v65, v64, s92
    v_perm_b32 v57, v67, v66, s92
    v_perm_b32 v58, v69, v68, s92
    v_perm_b32 v59, v71, v70, s92
    v_accvgpr_write_b32 a56, v56
    v_accvgpr_write_b32 a57, v57
    v_accvgpr_write_b32 a58, v58
    v_accvgpr_write_b32 a59, v59
    v_perm_b32 v60, v65, v64, s93
    v_perm_b32 v61, v67, v66, s93
    v_perm_b32 v62, v69, v68, s93
    v_perm_b32 v63, v71, v70, s93
    v_accvgpr_write_b32 a216, v60
    v_accvgpr_write_b32 a217, v61
    v_accvgpr_write_b32 a218, v62
    v_accvgpr_write_b32 a219, v63
    buffer_load_dword v64, v48, s[88:91], s22 offen offset:0
    buffer_load_dword v65, v49, s[88:91], s22 offen offset:0
    buffer_load_dword v66, v50, s[88:91], s22 offen offset:0
    buffer_load_dword v67, v51, s[88:91], s22 offen offset:0
    buffer_load_dword v68, v52, s[88:91], s22 offen offset:0
    buffer_load_dword v69, v53, s[88:91], s22 offen offset:0
    buffer_load_dword v70, v54, s[88:91], s22 offen offset:0
    buffer_load_dword v71, v55, s[88:91], s22 offen offset:0
    s_add_u32 s22, s22, 131072
    s_waitcnt vmcnt(48)
    v_perm_b32 v56, v73, v72, s92
    v_perm_b32 v57, v75, v74, s92
    v_perm_b32 v58, v77, v76, s92
    v_perm_b32 v59, v79, v78, s92
    v_accvgpr_write_b32 a60, v56
    v_accvgpr_write_b32 a61, v57
    v_accvgpr_write_b32 a62, v58
    v_accvgpr_write_b32 a63, v59
    v_perm_b32 v60, v73, v72, s93
    v_perm_b32 v61, v75, v74, s93
    v_perm_b32 v62, v77, v76, s93
    v_perm_b32 v63, v79, v78, s93
    v_accvgpr_write_b32 a220, v60
    v_accvgpr_write_b32 a221, v61
    v_accvgpr_write_b32 a222, v62
    v_accvgpr_write_b32 a223, v63
    buffer_load_dword v72, v48, s[88:91], s22 offen offset:0
    buffer_load_dword v73, v49, s[88:91], s22 offen offset:0
    buffer_load_dword v74, v50, s[88:91], s22 offen offset:0
    buffer_load_dword v75, v51, s[88:91], s22 offen offset:0
    buffer_load_dword v76, v52, s[88:91], s22 offen offset:0
    buffer_load_dword v77, v53, s[88:91], s22 offen offset:0
    buffer_load_dword v78, v54, s[88:91], s22 offen offset:0
    buffer_load_dword v79, v55, s[88:91], s22 offen offset:0
    s_add_u32 s22, s22, 131072
    s_waitcnt vmcnt(48)
    v_perm_b32 v56, v81, v80, s92
    v_perm_b32 v57, v83, v82, s92
    v_perm_b32 v58, v85, v84, s92
    v_perm_b32 v59, v87, v86, s92
    v_accvgpr_write_b32 a64, v56
    v_accvgpr_write_b32 a65, v57
    v_accvgpr_write_b32 a66, v58
    v_accvgpr_write_b32 a67, v59
    v_perm_b32 v60, v81, v80, s93
    v_perm_b32 v61, v83, v82, s93
    v_perm_b32 v62, v85, v84, s93
    v_perm_b32 v63, v87, v86, s93
    v_accvgpr_write_b32 a224, v60
    v_accvgpr_write_b32 a225, v61
    v_accvgpr_write_b32 a226, v62
    v_accvgpr_write_b32 a227, v63
    buffer_load_dword v80, v48, s[88:91], s22 offen offset:0
    buffer_load_dword v81, v49, s[88:91], s22 offen offset:0
    buffer_load_dword v82, v50, s[88:91], s22 offen offset:0
    buffer_load_dword v83, v51, s[88:91], s22 offen offset:0
    buffer_load_dword v84, v52, s[88:91], s22 offen offset:0
    buffer_load_dword v85, v53, s[88:91], s22 offen offset:0
    buffer_load_dword v86, v54, s[88:91], s22 offen offset:0
    buffer_load_dword v87, v55, s[88:91], s22 offen offset:0
    s_add_u32 s22, s22, 131072
    s_waitcnt vmcnt(48)
    v_perm_b32 v56, v89, v88, s92
    v_perm_b32 v57, v91, v90, s92
    v_perm_b32 v58, v93, v92, s92
    v_perm_b32 v59, v95, v94, s92
    v_accvgpr_write_b32 a68, v56
    v_accvgpr_write_b32 a69, v57
    v_accvgpr_write_b32 a70, v58
    v_accvgpr_write_b32 a71, v59
    v_perm_b32 v60, v89, v88, s93
    v_perm_b32 v61, v91, v90, s93
    v_perm_b32 v62, v93, v92, s93
    v_perm_b32 v63, v95, v94, s93
    v_accvgpr_write_b32 a228, v60
    v_accvgpr_write_b32 a229, v61
    v_accvgpr_write_b32 a230, v62
    v_accvgpr_write_b32 a231, v63
    buffer_load_dword v88, v48, s[88:91], s22 offen offset:0
    buffer_load_dword v89, v49, s[88:91], s22 offen offset:0
    buffer_load_dword v90, v50, s[88:91], s22 offen offset:0
    buffer_load_dword v91, v51, s[88:91], s22 offen offset:0
    buffer_load_dword v92, v52, s[88:91], s22 offen offset:0
    buffer_load_dword v93, v53, s[88:91], s22 offen offset:0
    buffer_load_dword v94, v54, s[88:91], s22 offen offset:0
    buffer_load_dword v95, v55, s[88:91], s22 offen offset:0
    s_add_u32 s22, s22, 131072
    s_waitcnt vmcnt(48)
    v_perm_b32 v56, v97, v96, s92
    v_perm_b32 v57, v99, v98, s92
    v_perm_b32 v58, v101, v100, s92
    v_perm_b32 v59, v103, v102, s92
    v_accvgpr_write_b32 a72, v56
    v_accvgpr_write_b32 a73, v57
    v_accvgpr_write_b32 a74, v58
    v_accvgpr_write_b32 a75, v59
    v_perm_b32 v60, v97, v96, s93
    v_perm_b32 v61, v99, v98, s93
    v_perm_b32 v62, v101, v100, s93
    v_perm_b32 v63, v103, v102, s93
    v_accvgpr_write_b32 a232, v60
    v_accvgpr_write_b32 a233, v61
    v_accvgpr_write_b32 a234, v62
    v_accvgpr_write_b32 a235, v63
    buffer_load_dword v96, v48, s[88:91], s22 offen offset:0
    buffer_load_dword v97, v49, s[88:91], s22 offen offset:0
    buffer_load_dword v98, v50, s[88:91], s22 offen offset:0
    buffer_load_dword v99, v51, s[88:91], s22 offen offset:0
    buffer_load_dword v100, v52, s[88:91], s22 offen offset:0
    buffer_load_dword v101, v53, s[88:91], s22 offen offset:0
    buffer_load_dword v102, v54, s[88:91], s22 offen offset:0
    buffer_load_dword v103, v55, s[88:91], s22 offen offset:0
    s_add_u32 s22, s22, 131072
    s_waitcnt vmcnt(48)
    v_perm_b32 v56, v105, v104, s92
    v_perm_b32 v57, v107, v106, s92
    v_perm_b32 v58, v109, v108, s92
    v_perm_b32 v59, v111, v110, s92
    v_accvgpr_write_b32 a76, v56
    v_accvgpr_write_b32 a77, v57
    v_accvgpr_write_b32 a78, v58
    v_accvgpr_write_b32 a79, v59
    v_perm_b32 v60, v105, v104, s93
    v_perm_b32 v61, v107, v106, s93
    v_perm_b32 v62, v109, v108, s93
    v_perm_b32 v63, v111, v110, s93
    v_accvgpr_write_b32 a236, v60
    v_accvgpr_write_b32 a237, v61
    v_accvgpr_write_b32 a238, v62
    v_accvgpr_write_b32 a239, v63
    buffer_load_dword v104, v48, s[88:91], s22 offen offset:0
    buffer_load_dword v105, v49, s[88:91], s22 offen offset:0
    buffer_load_dword v106, v50, s[88:91], s22 offen offset:0
    buffer_load_dword v107, v51, s[88:91], s22 offen offset:0
    buffer_load_dword v108, v52, s[88:91], s22 offen offset:0
    buffer_load_dword v109, v53, s[88:91], s22 offen offset:0
    buffer_load_dword v110, v54, s[88:91], s22 offen offset:0
    buffer_load_dword v111, v55, s[88:91], s22 offen offset:0
    s_add_u32 s22, s22, 131072
    s_waitcnt vmcnt(48)
    v_perm_b32 v56, v113, v112, s92
    v_perm_b32 v57, v115, v114, s92
    v_perm_b32 v58, v117, v116, s92
    v_perm_b32 v59, v119, v118, s92
    v_accvgpr_write_b32 a80, v56
    v_accvgpr_write_b32 a81, v57
    v_accvgpr_write_b32 a82, v58
    v_accvgpr_write_b32 a83, v59
    v_perm_b32 v60, v113, v112, s93
    v_perm_b32 v61, v115, v114, s93
    v_perm_b32 v62, v117, v116, s93
    v_perm_b32 v63, v119, v118, s93
    v_accvgpr_write_b32 a240, v60
    v_accvgpr_write_b32 a241, v61
    v_accvgpr_write_b32 a242, v62
    v_accvgpr_write_b32 a243, v63
    buffer_load_dword v112, v48, s[88:91], s22 offen offset:0
    buffer_load_dword v113, v49, s[88:91], s22 offen offset:0
    buffer_load_dword v114, v50, s[88:91], s22 offen offset:0
    buffer_load_dword v115, v51, s[88:91], s22 offen offset:0
    buffer_load_dword v116, v52, s[88:91], s22 offen offset:0
    buffer_load_dword v117, v53, s[88:91], s22 offen offset:0
    buffer_load_dword v118, v54, s[88:91], s22 offen offset:0
    buffer_load_dword v119, v55, s[88:91], s22 offen offset:0
    s_add_u32 s22, s22, 131072
    s_waitcnt vmcnt(48)
    v_perm_b32 v56, v65, v64, s92
    v_perm_b32 v57, v67, v66, s92
    v_perm_b32 v58, v69, v68, s92
    v_perm_b32 v59, v71, v70, s92
    v_accvgpr_write_b32 a84, v56
    v_accvgpr_write_b32 a85, v57
    v_accvgpr_write_b32 a86, v58
    v_accvgpr_write_b32 a87, v59
    v_perm_b32 v60, v65, v64, s93
    v_perm_b32 v61, v67, v66, s93
    v_perm_b32 v62, v69, v68, s93
    v_perm_b32 v63, v71, v70, s93
    v_accvgpr_write_b32 a244, v60
    v_accvgpr_write_b32 a245, v61
    v_accvgpr_write_b32 a246, v62
    v_accvgpr_write_b32 a247, v63
    buffer_load_dword v64, v48, s[88:91], s22 offen offset:0
    buffer_load_dword v65, v49, s[88:91], s22 offen offset:0
    buffer_load_dword v66, v50, s[88:91], s22 offen offset:0
    buffer_load_dword v67, v51, s[88:91], s22 offen offset:0
    buffer_load_dword v68, v52, s[88:91], s22 offen offset:0
    buffer_load_dword v69, v53, s[88:91], s22 offen offset:0
    buffer_load_dword v70, v54, s[88:91], s22 offen offset:0
    buffer_load_dword v71, v55, s[88:91], s22 offen offset:0
    s_add_u32 s22, s22, 131072
    s_waitcnt vmcnt(48)
    v_perm_b32 v56, v73, v72, s92
    v_perm_b32 v57, v75, v74, s92
    v_perm_b32 v58, v77, v76, s92
    v_perm_b32 v59, v79, v78, s92
    v_accvgpr_write_b32 a88, v56
    v_accvgpr_write_b32 a89, v57
    v_accvgpr_write_b32 a90, v58
    v_accvgpr_write_b32 a91, v59
    v_perm_b32 v60, v73, v72, s93
    v_perm_b32 v61, v75, v74, s93
    v_perm_b32 v62, v77, v76, s93
    v_perm_b32 v63, v79, v78, s93
    v_accvgpr_write_b32 a248, v60
    v_accvgpr_write_b32 a249, v61
    v_accvgpr_write_b32 a250, v62
    v_accvgpr_write_b32 a251, v63
    buffer_load_dword v72, v48, s[88:91], s22 offen offset:0
    buffer_load_dword v73, v49, s[88:91], s22 offen offset:0
    buffer_load_dword v74, v50, s[88:91], s22 offen offset:0
    buffer_load_dword v75, v51, s[88:91], s22 offen offset:0
    buffer_load_dword v76, v52, s[88:91], s22 offen offset:0
    buffer_load_dword v77, v53, s[88:91], s22 offen offset:0
    buffer_load_dword v78, v54, s[88:91], s22 offen offset:0
    buffer_load_dword v79, v55, s[88:91], s22 offen offset:0
    s_add_u32 s22, s22, 131072
    s_waitcnt vmcnt(48)
    v_perm_b32 v56, v81, v80, s92
    v_perm_b32 v57, v83, v82, s92
    v_perm_b32 v58, v85, v84, s92
    v_perm_b32 v59, v87, v86, s92
    v_accvgpr_write_b32 a92, v56
    v_accvgpr_write_b32 a93, v57
    v_accvgpr_write_b32 a94, v58
    v_accvgpr_write_b32 a95, v59
    v_perm_b32 v60, v81, v80, s93
    v_perm_b32 v61, v83, v82, s93
    v_perm_b32 v62, v85, v84, s93
    v_perm_b32 v63, v87, v86, s93
    v_accvgpr_write_b32 a252, v60
    v_accvgpr_write_b32 a253, v61
    v_accvgpr_write_b32 a254, v62
    v_accvgpr_write_b32 a255, v63
    buffer_load_dword v80, v48, s[88:91], s22 offen offset:0
    buffer_load_dword v81, v49, s[88:91], s22 offen offset:0
    buffer_load_dword v82, v50, s[88:91], s22 offen offset:0
    buffer_load_dword v83, v51, s[88:91], s22 offen offset:0
    buffer_load_dword v84, v52, s[88:91], s22 offen offset:0
    buffer_load_dword v85, v53, s[88:91], s22 offen offset:0
    buffer_load_dword v86, v54, s[88:91], s22 offen offset:0
    buffer_load_dword v87, v55, s[88:91], s22 offen offset:0
    s_add_u32 s22, s22, 131072
    s_waitcnt vmcnt(48)
    v_perm_b32 v56, v89, v88, s92
    v_perm_b32 v57, v91, v90, s92
    v_perm_b32 v58, v93, v92, s92
    v_perm_b32 v59, v95, v94, s92
    v_accvgpr_write_b32 a96, v56
    v_accvgpr_write_b32 a97, v57
    v_accvgpr_write_b32 a98, v58
    v_accvgpr_write_b32 a99, v59
    v_perm_b32 v192, v89, v88, s93
    v_perm_b32 v193, v91, v90, s93
    v_perm_b32 v194, v93, v92, s93
    v_perm_b32 v195, v95, v94, s93
    buffer_load_dword v88, v48, s[88:91], s22 offen offset:0
    buffer_load_dword v89, v49, s[88:91], s22 offen offset:0
    buffer_load_dword v90, v50, s[88:91], s22 offen offset:0
    buffer_load_dword v91, v51, s[88:91], s22 offen offset:0
    buffer_load_dword v92, v52, s[88:91], s22 offen offset:0
    buffer_load_dword v93, v53, s[88:91], s22 offen offset:0
    buffer_load_dword v94, v54, s[88:91], s22 offen offset:0
    buffer_load_dword v95, v55, s[88:91], s22 offen offset:0
    s_add_u32 s22, s22, 131072
    s_waitcnt vmcnt(48)
    v_perm_b32 v60, v97, v96, s92
    v_perm_b32 v61, v99, v98, s92
    v_perm_b32 v62, v101, v100, s92
    v_perm_b32 v63, v103, v102, s92
    v_accvgpr_write_b32 a100, v60
    v_accvgpr_write_b32 a101, v61
    v_accvgpr_write_b32 a102, v62
    v_accvgpr_write_b32 a103, v63
    v_perm_b32 v196, v97, v96, s93
    v_perm_b32 v197, v99, v98, s93
    v_perm_b32 v198, v101, v100, s93
    v_perm_b32 v199, v103, v102, s93
    buffer_load_dword v96, v48, s[88:91], s22 offen offset:0
    buffer_load_dword v97, v49, s[88:91], s22 offen offset:0
    buffer_load_dword v98, v50, s[88:91], s22 offen offset:0
    buffer_load_dword v99, v51, s[88:91], s22 offen offset:0
    buffer_load_dword v100, v52, s[88:91], s22 offen offset:0
    buffer_load_dword v101, v53, s[88:91], s22 offen offset:0
    buffer_load_dword v102, v54, s[88:91], s22 offen offset:0
    buffer_load_dword v103, v55, s[88:91], s22 offen offset:0
    s_add_u32 s22, s22, 131072
    s_waitcnt vmcnt(48)
    v_perm_b32 v56, v105, v104, s92
    v_perm_b32 v57, v107, v106, s92
    v_perm_b32 v58, v109, v108, s92
    v_perm_b32 v59, v111, v110, s92
    v_accvgpr_write_b32 a104, v56
    v_accvgpr_write_b32 a105, v57
    v_accvgpr_write_b32 a106, v58
    v_accvgpr_write_b32 a107, v59
    v_perm_b32 v200, v105, v104, s93
    v_perm_b32 v201, v107, v106, s93
    v_perm_b32 v202, v109, v108, s93
    v_perm_b32 v203, v111, v110, s93
    buffer_load_dword v104, v48, s[88:91], s22 offen offset:0
    buffer_load_dword v105, v49, s[88:91], s22 offen offset:0
    buffer_load_dword v106, v50, s[88:91], s22 offen offset:0
    buffer_load_dword v107, v51, s[88:91], s22 offen offset:0
    buffer_load_dword v108, v52, s[88:91], s22 offen offset:0
    buffer_load_dword v109, v53, s[88:91], s22 offen offset:0
    buffer_load_dword v110, v54, s[88:91], s22 offen offset:0
    buffer_load_dword v111, v55, s[88:91], s22 offen offset:0
    s_add_u32 s22, s22, 131072
    s_waitcnt vmcnt(48)
    v_perm_b32 v60, v113, v112, s92
    v_perm_b32 v61, v115, v114, s92
    v_perm_b32 v62, v117, v116, s92
    v_perm_b32 v63, v119, v118, s92
    v_accvgpr_write_b32 a108, v60
    v_accvgpr_write_b32 a109, v61
    v_accvgpr_write_b32 a110, v62
    v_accvgpr_write_b32 a111, v63
    v_perm_b32 v204, v113, v112, s93
    v_perm_b32 v205, v115, v114, s93
    v_perm_b32 v206, v117, v116, s93
    v_perm_b32 v207, v119, v118, s93
    buffer_load_dword v112, v48, s[88:91], s22 offen offset:0
    buffer_load_dword v113, v49, s[88:91], s22 offen offset:0
    buffer_load_dword v114, v50, s[88:91], s22 offen offset:0
    buffer_load_dword v115, v51, s[88:91], s22 offen offset:0
    buffer_load_dword v116, v52, s[88:91], s22 offen offset:0
    buffer_load_dword v117, v53, s[88:91], s22 offen offset:0
    buffer_load_dword v118, v54, s[88:91], s22 offen offset:0
    buffer_load_dword v119, v55, s[88:91], s22 offen offset:0
    s_add_u32 s22, s22, 131072
    s_waitcnt vmcnt(48)
    v_perm_b32 v56, v65, v64, s92
    v_perm_b32 v57, v67, v66, s92
    v_perm_b32 v58, v69, v68, s92
    v_perm_b32 v59, v71, v70, s92
    v_accvgpr_write_b32 a112, v56
    v_accvgpr_write_b32 a113, v57
    v_accvgpr_write_b32 a114, v58
    v_accvgpr_write_b32 a115, v59
    v_perm_b32 v208, v65, v64, s93
    v_perm_b32 v209, v67, v66, s93
    v_perm_b32 v210, v69, v68, s93
    v_perm_b32 v211, v71, v70, s93
    buffer_load_dword v64, v48, s[88:91], s22 offen offset:0
    buffer_load_dword v65, v49, s[88:91], s22 offen offset:0
    buffer_load_dword v66, v50, s[88:91], s22 offen offset:0
    buffer_load_dword v67, v51, s[88:91], s22 offen offset:0
    buffer_load_dword v68, v52, s[88:91], s22 offen offset:0
    buffer_load_dword v69, v53, s[88:91], s22 offen offset:0
    buffer_load_dword v70, v54, s[88:91], s22 offen offset:0
    buffer_load_dword v71, v55, s[88:91], s22 offen offset:0
    s_add_u32 s22, s22, 131072
    s_waitcnt vmcnt(48)
    v_perm_b32 v60, v73, v72, s92
    v_perm_b32 v61, v75, v74, s92
    v_perm_b32 v62, v77, v76, s92
    v_perm_b32 v63, v79, v78, s92
    v_accvgpr_write_b32 a116, v60
    v_accvgpr_write_b32 a117, v61
    v_accvgpr_write_b32 a118, v62
    v_accvgpr_write_b32 a119, v63
    v_perm_b32 v212, v73, v72, s93
    v_perm_b32 v213, v75, v74, s93
    v_perm_b32 v214, v77, v76, s93
    v_perm_b32 v215, v79, v78, s93
    buffer_load_dword v72, v48, s[88:91], s22 offen offset:0
    buffer_load_dword v73, v49, s[88:91], s22 offen offset:0
    buffer_load_dword v74, v50, s[88:91], s22 offen offset:0
    buffer_load_dword v75, v51, s[88:91], s22 offen offset:0
    buffer_load_dword v76, v52, s[88:91], s22 offen offset:0
    buffer_load_dword v77, v53, s[88:91], s22 offen offset:0
    buffer_load_dword v78, v54, s[88:91], s22 offen offset:0
    buffer_load_dword v79, v55, s[88:91], s22 offen offset:0
    s_add_u32 s22, s22, 131072
    s_waitcnt vmcnt(48)
    v_perm_b32 v56, v81, v80, s92
    v_perm_b32 v57, v83, v82, s92
    v_perm_b32 v58, v85, v84, s92
    v_perm_b32 v59, v87, v86, s92
    v_accvgpr_write_b32 a120, v56
    v_accvgpr_write_b32 a121, v57
    v_accvgpr_write_b32 a122, v58
    v_accvgpr_write_b32 a123, v59
    v_perm_b32 v216, v81, v80, s93
    v_perm_b32 v217, v83, v82, s93
    v_perm_b32 v218, v85, v84, s93
    v_perm_b32 v219, v87, v86, s93
    buffer_load_dword v80, v48, s[88:91], s22 offen offset:0
    buffer_load_dword v81, v49, s[88:91], s22 offen offset:0
    buffer_load_dword v82, v50, s[88:91], s22 offen offset:0
    buffer_load_dword v83, v51, s[88:91], s22 offen offset:0
    buffer_load_dword v84, v52, s[88:91], s22 offen offset:0
    buffer_load_dword v85, v53, s[88:91], s22 offen offset:0
    buffer_load_dword v86, v54, s[88:91], s22 offen offset:0
    buffer_load_dword v87, v55, s[88:91], s22 offen offset:0
    s_add_u32 s22, s22, 131072
    s_waitcnt vmcnt(48)
    v_perm_b32 v60, v89, v88, s92
    v_perm_b32 v61, v91, v90, s92
    v_perm_b32 v62, v93, v92, s92
    v_perm_b32 v63, v95, v94, s92
    v_accvgpr_write_b32 a124, v60
    v_accvgpr_write_b32 a125, v61
    v_accvgpr_write_b32 a126, v62
    v_accvgpr_write_b32 a127, v63
    v_perm_b32 v220, v89, v88, s93
    v_perm_b32 v221, v91, v90, s93
    v_perm_b32 v222, v93, v92, s93
    v_perm_b32 v223, v95, v94, s93
    buffer_load_dword v88, v48, s[88:91], s22 offen offset:0
    buffer_load_dword v89, v49, s[88:91], s22 offen offset:0
    buffer_load_dword v90, v50, s[88:91], s22 offen offset:0
    buffer_load_dword v91, v51, s[88:91], s22 offen offset:0
    buffer_load_dword v92, v52, s[88:91], s22 offen offset:0
    buffer_load_dword v93, v53, s[88:91], s22 offen offset:0
    buffer_load_dword v94, v54, s[88:91], s22 offen offset:0
    buffer_load_dword v95, v55, s[88:91], s22 offen offset:0
    s_add_u32 s22, s22, 131072
    s_waitcnt vmcnt(48)
    v_perm_b32 v56, v97, v96, s92
    v_perm_b32 v57, v99, v98, s92
    v_perm_b32 v58, v101, v100, s92
    v_perm_b32 v59, v103, v102, s92
    v_accvgpr_write_b32 a128, v56
    v_accvgpr_write_b32 a129, v57
    v_accvgpr_write_b32 a130, v58
    v_accvgpr_write_b32 a131, v59
    v_perm_b32 v224, v97, v96, s93
    v_perm_b32 v225, v99, v98, s93
    v_perm_b32 v226, v101, v100, s93
    v_perm_b32 v227, v103, v102, s93
    buffer_load_dword v96, v48, s[88:91], s22 offen offset:0
    buffer_load_dword v97, v49, s[88:91], s22 offen offset:0
    buffer_load_dword v98, v50, s[88:91], s22 offen offset:0
    buffer_load_dword v99, v51, s[88:91], s22 offen offset:0
    buffer_load_dword v100, v52, s[88:91], s22 offen offset:0
    buffer_load_dword v101, v53, s[88:91], s22 offen offset:0
    buffer_load_dword v102, v54, s[88:91], s22 offen offset:0
    buffer_load_dword v103, v55, s[88:91], s22 offen offset:0
    s_add_u32 s22, s22, 131072
    s_waitcnt vmcnt(48)
    v_perm_b32 v60, v105, v104, s92
    v_perm_b32 v61, v107, v106, s92
    v_perm_b32 v62, v109, v108, s92
    v_perm_b32 v63, v111, v110, s92
    v_accvgpr_write_b32 a132, v60
    v_accvgpr_write_b32 a133, v61
    v_accvgpr_write_b32 a134, v62
    v_accvgpr_write_b32 a135, v63
    v_perm_b32 v228, v105, v104, s93
    v_perm_b32 v229, v107, v106, s93
    v_perm_b32 v230, v109, v108, s93
    v_perm_b32 v231, v111, v110, s93
    s_waitcnt vmcnt(40)
    v_perm_b32 v56, v113, v112, s92
    v_perm_b32 v57, v115, v114, s92
    v_perm_b32 v58, v117, v116, s92
    v_perm_b32 v59, v119, v118, s92
    v_accvgpr_write_b32 a136, v56
    v_accvgpr_write_b32 a137, v57
    v_accvgpr_write_b32 a138, v58
    v_accvgpr_write_b32 a139, v59
    v_perm_b32 v232, v113, v112, s93
    v_perm_b32 v233, v115, v114, s93
    v_perm_b32 v234, v117, v116, s93
    v_perm_b32 v235, v119, v118, s93
    s_waitcnt vmcnt(32)
    v_perm_b32 v60, v65, v64, s92
    v_perm_b32 v61, v67, v66, s92
    v_perm_b32 v62, v69, v68, s92
    v_perm_b32 v63, v71, v70, s92
    v_accvgpr_write_b32 a140, v60
    v_accvgpr_write_b32 a141, v61
    v_accvgpr_write_b32 a142, v62
    v_accvgpr_write_b32 a143, v63
    v_perm_b32 v236, v65, v64, s93
    v_perm_b32 v237, v67, v66, s93
    v_perm_b32 v238, v69, v68, s93
    v_perm_b32 v239, v71, v70, s93
    s_waitcnt vmcnt(24)
    v_perm_b32 v56, v73, v72, s92
    v_perm_b32 v57, v75, v74, s92
    v_perm_b32 v58, v77, v76, s92
    v_perm_b32 v59, v79, v78, s92
    v_accvgpr_write_b32 a144, v56
    v_accvgpr_write_b32 a145, v57
    v_accvgpr_write_b32 a146, v58
    v_accvgpr_write_b32 a147, v59
    v_perm_b32 v240, v73, v72, s93
    v_perm_b32 v241, v75, v74, s93
    v_perm_b32 v242, v77, v76, s93
    v_perm_b32 v243, v79, v78, s93
    s_waitcnt vmcnt(16)
    v_perm_b32 v60, v81, v80, s92
    v_perm_b32 v61, v83, v82, s92
    v_perm_b32 v62, v85, v84, s92
    v_perm_b32 v63, v87, v86, s92
    v_accvgpr_write_b32 a148, v60
    v_accvgpr_write_b32 a149, v61
    v_accvgpr_write_b32 a150, v62
    v_accvgpr_write_b32 a151, v63
    v_perm_b32 v244, v81, v80, s93
    v_perm_b32 v245, v83, v82, s93
    v_perm_b32 v246, v85, v84, s93
    v_perm_b32 v247, v87, v86, s93
    s_waitcnt vmcnt(8)
    v_perm_b32 v56, v89, v88, s92
    v_perm_b32 v57, v91, v90, s92
    v_perm_b32 v58, v93, v92, s92
    v_perm_b32 v59, v95, v94, s92
    v_accvgpr_write_b32 a152, v56
    v_accvgpr_write_b32 a153, v57
    v_accvgpr_write_b32 a154, v58
    v_accvgpr_write_b32 a155, v59
    v_perm_b32 v248, v89, v88, s93
    v_perm_b32 v249, v91, v90, s93
    v_perm_b32 v250, v93, v92, s93
    v_perm_b32 v251, v95, v94, s93
    s_waitcnt vmcnt(0)
    v_perm_b32 v60, v97, v96, s92
    v_perm_b32 v61, v99, v98, s92
    v_perm_b32 v62, v101, v100, s92
    v_perm_b32 v63, v103, v102, s92
    v_accvgpr_write_b32 a156, v60
    v_accvgpr_write_b32 a157, v61
    v_accvgpr_write_b32 a158, v62
    v_accvgpr_write_b32 a159, v63
    v_perm_b32 v252, v97, v96, s93
    v_perm_b32 v253, v99, v98, s93
    v_perm_b32 v254, v101, v100, s93
    v_perm_b32 v255, v103, v102, s93
    s_mov_b32 s24, 0
WI_56:
    buffer_load_dword v8, off, s[96:99], 0 offset:128 sc1
    s_waitcnt vmcnt(0)
    v_cmp_le_u32 vcc, 256, v8
    s_cbranch_vccnz WO_57
    s_sleep 4
    s_add_u32 s24, s24, 1
    s_cmp_lt_u32 s24, 200000
    s_cbranch_scc1 WI_56
    s_branch F_KV
WO_57:
    v_mov_b32 v16, 0x3f803f80
    v_mov_b32 v17, 0x3f803f80
    v_mov_b32 v18, 0x3f803f80
    v_mov_b32 v19, 0x3f803f80
    v_mov_b32 v7, 1
    s_cmp_ge_u32 s9, 2
    s_cbranch_scc1 T1_VW_58
    v_mfma_f32_32x32x16_bf16 v[160:175], a[0:3], v[16:19], 0
    v_mfma_f32_32x32x16_bf16 v[176:191], a[160:163], v[16:19], 0
    v_mfma_f32_32x32x16_bf16 v[160:175], a[4:7], v[16:19], v[160:175]
    v_mfma_f32_32x32x16_bf16 v[176:191], a[164:167], v[16:19], v[176:191]
    v_mfma_f32_32x32x16_bf16 v[160:175], a[8:11], v[16:19], v[160:175]
    v_mfma_f32_32x32x16_bf16 v[176:191], a[168:171], v[16:19], v[176:191]
    v_mfma_f32_32x32x16_bf16 v[160:175], a[12:15], v[16:19], v[160:175]
    v_mfma_f32_32x32x16_bf16 v[176:191], a[172:175], v[16:19], v[176:191]
    v_mfma_f32_32x32x16_bf16 v[160:175], a[16:19], v[16:19], v[160:175]
    v_mfma_f32_32x32x16_bf16 v[176:191], a[176:179], v[16:19], v[176:191]
    v_mfma_f32_32x32x16_bf16 v[160:175], a[20:23], v[16:19], v[160:175]
    v_mfma_f32_32x32x16_bf16 v[176:191], a[180:183], v[16:19], v[176:191]
    v_mfma_f32_32x32x16_bf16 v[160:175], a[24:27], v[16:19], v[160:175]
    v_mfma_f32_32x32x16_bf16 v[176:191], a[184:187], v[16:19], v[176:191]
    v_mfma_f32_32x32x16_bf16 v[160:175], a[28:31], v[16:19], v[160:175]
    v_mfma_f32_32x32x16_bf16 v[176:191], a[188:191], v[16:19], v[176:191]
    v_mfma_f32_32x32x16_bf16 v[160:175], a[32:35], v[16:19], v[160:175]
    v_mfma_f32_32x32x16_bf16 v[176:191], a[192:195], v[16:19], v[176:191]
    v_mfma_f32_32x32x16_bf16 v[160:175], a[36:39], v[16:19], v[160:175]
    v_mfma_f32_32x32x16_bf16 v[176:191], a[196:199], v[16:19], v[176:191]
    v_mfma_f32_32x32x16_bf16 v[160:175], a[40:43], v[16:19], v[160:175]
    v_mfma_f32_32x32x16_bf16 v[176:191], a[200:203], v[16:19], v[176:191]
    v_mfma_f32_32x32x16_bf16 v[160:175], a[44:47], v[16:19], v[160:175]
    v_mfma_f32_32x32x16_bf16 v[176:191], a[204:207], v[16:19], v[176:191]
    v_mfma_f32_32x32x16_bf16 v[160:175], a[48:51], v[16:19], v[160:175]
    v_mfma_f32_32x32x16_bf16 v[176:191], a[208:211], v[16:19], v[176:191]
    v_mfma_f32_32x32x16_bf16 v[160:175], a[52:55], v[16:19], v[160:175]
    v_mfma_f32_32x32x16_bf16 v[176:191], a[212:215], v[16:19], v[176:191]
    v_mfma_f32_32x32x16_bf16 v[160:175], a[56:59], v[16:19], v[160:175]
    v_mfma_f32_32x32x16_bf16 v[176:191], a[216:219], v[16:19], v[176:191]
    v_mfma_f32_32x32x16_bf16 v[160:175], a[60:63], v[16:19], v[160:175]
    v_mfma_f32_32x32x16_bf16 v[176:191], a[220:223], v[16:19], v[176:191]
    v_mfma_f32_32x32x16_bf16 v[160:175], a[64:67], v[16:19], v[160:175]
    v_mfma_f32_32x32x16_bf16 v[176:191], a[224:227], v[16:19], v[176:191]
    v_mfma_f32_32x32x16_bf16 v[160:175], a[68:71], v[16:19], v[160:175]
    v_mfma_f32_32x32x16_bf16 v[176:191], a[228:231], v[16:19], v[176:191]
    v_mfma_f32_32x32x16_bf16 v[160:175], a[72:75], v[16:19], v[160:175]
    v_mfma_f32_32x32x16_bf16 v[176:191], a[232:235], v[16:19], v[176:191]
    v_mfma_f32_32x32x16_bf16 v[160:175], a[76:79], v[16:19], v[160:175]
    v_mfma_f32_32x32x16_bf16 v[176:191], a[236:239], v[16:19], v[176:191]
    v_mfma_f32_32x32x16_bf16 v[160:175], a[80:83], v[16:19], v[160:175]
    v_mfma_f32_32x32x16_bf16 v[176:191], a[240:243], v[16:19], v[176:191]
    v_mfma_f32_32x32x16_bf16 v[160:175], a[84:87], v[16:19], v[160:175]
    v_mfma_f32_32x32x16_bf16 v[176:191], a[244:247], v[16:19], v[176:191]
    v_mfma_f32_32x32x16_bf16 v[160:175], a[88:91], v[16:19], v[160:175]
    v_mfma_f32_32x32x16_bf16 v[176:191], a[248:251], v[16:19], v[176:191]
    v_mfma_f32_32x32x16_bf16 v[160:175], a[92:95], v[16:19], v[160:175]
    v_mfma_f32_32x32x16_bf16 v[176:191], a[252:255], v[16:19], v[176:191]
    v_mfma_f32_32x32x16_bf16 v[160:175], a[96:99], v[16:19], v[160:175]
    v_mfma_f32_32x32x16_bf16 v[176:191], v[192:195], v[16:19], v[176:191]
    v_mfma_f32_32x32x16_bf16 v[160:175], a[100:103], v[16:19], v[160:175]
    v_mfma_f32_32x32x16_bf16 v[176:191], v[196:199], v[16:19], v[176:191]
    v_mfma_f32_32x32x16_bf16 v[160:175], a[104:107], v[16:19], v[160:175]
    v_mfma_f32_32x32x16_bf16 v[176:191], v[200:203], v[16:19], v[176:191]
    v_mfma_f32_32x32x16_bf16 v[160:175], a[108:111], v[16:19], v[160:175]
    v_mfma_f32_32x32x16_bf16 v[176:191], v[204:207], v[16:19], v[176:191]
    v_mfma_f32_32x32x16_bf16 v[160:175], a[112:115], v[16:19], v[160:175]
    v_mfma_f32_32x32x16_bf16 v[176:191], v[208:211], v[16:19], v[176:191]
    v_mfma_f32_32x32x16_bf16 v[160:175], a[116:119], v[16:19], v[160:175]
    v_mfma_f32_32x32x16_bf16 v[176:191], v[212:215], v[16:19], v[176:191]
    v_mfma_f32_32x32x16_bf16 v[160:175], a[120:123], v[16:19], v[160:175]
    v_mfma_f32_32x32x16_bf16 v[176:191], v[216:219], v[16:19], v[176:191]
    v_mfma_f32_32x32x16_bf16 v[160:175], a[124:127], v[16:19], v[160:175]
    v_mfma_f32_32x32x16_bf16 v[176:191], v[220:223], v[16:19], v[176:191]
    v_mfma_f32_32x32x16_bf16 v[160:175], a[128:131], v[16:19], v[160:175]
    v_mfma_f32_32x32x16_bf16 v[176:191], v[224:227], v[16:19], v[176:191]
    v_mfma_f32_32x32x16_bf16 v[160:175], a[132:135], v[16:19], v[160:175]
    v_mfma_f32_32x32x16_bf16 v[176:191], v[228:231], v[16:19], v[176:191]
    v_mfma_f32_32x32x16_bf16 v[160:175], a[136:139], v[16:19], v[160:175]
    v_mfma_f32_32x32x16_bf16 v[176:191], v[232:235], v[16:19], v[176:191]
    v_mfma_f32_32x32x16_bf16 v[160:175], a[140:143], v[16:19], v[160:175]
    v_mfma_f32_32x32x16_bf16 v[176:191], v[236:239], v[16:19], v[176:191]
    v_mfma_f32_32x32x16_bf16 v[160:175], a[144:147], v[16:19], v[160:175]
    v_mfma_f32_32x32x16_bf16 v[176:191], v[240:243], v[16:19], v[176:191]
    v_mfma_f32_32x32x16_bf16 v[160:175], a[148:151], v[16:19], v[160:175]
    v_mfma_f32_32x32x16_bf16 v[176:191], v[244:247], v[16:19], v[176:191]
    v_mfma_f32_32x32x16_bf16 v[160:175], a[152:155], v[16:19], v[160:175]
    v_mfma_f32_32x32x16_bf16 v[176:191], v[248:251], v[16:19], v[176:191]
    v_mfma_f32_32x32x16_bf16 v[160:175], a[156:159], v[16:19], v[160:175]
    v_mfma_f32_32x32x16_bf16 v[176:191], v[252:255], v[16:19], v[176:191]
T1_ITEM_59:
    s_cmp_lg_u32 s18, 0
    s_cbranch_scc1 T1_HAVE_60
    s_mov_b32 s24, 0
    s_mov_b64 exec, s[14:15]
    buffer_load_dword v8, v11, s[4:7], s13 offen sc1
    s_waitcnt vmcnt(0)
    v_cmp_eq_u32 vcc, 0, v8
    s_cmp_eq_u32 s19, 0
    s_cbranch_scc1 NF_64
    s_mov_b64 exec, 1
    buffer_store_dword v7, off, s[4:7], s34 sc1
    s_mov_b64 exec, -1
    s_mov_b32 s19, 0
NF_64:
    s_cbranch_vccz PO_63
    s_mov_b64 exec, s[14:15]
PL_62:
    buffer_load_dword v8, v11, s[4:7], s13 offen sc1
    s_waitcnt vmcnt(0)
    v_cmp_eq_u32 vcc, 0, v8
    s_cbranch_vccz PO_63
    s_sleep 2
    s_add_u32 s24, s24, 1
    s_cmp_lt_u32 s24, 200000
    s_cbranch_scc1 PL_62
    s_branch F_KV
PO_63:
    s_mov_b64 exec, -1
    s_add_u32 m0, s20, 0
    s_add_u32 s22, s12, 0
    buffer_load_dwordx4 v1, s[4:7], s22 offen offset:0 sc1 lds
    buffer_load_dwordx4 v1, s[4:7], s22 offen offset:1024 sc1 lds
    buffer_load_dwordx4 v1, s[4:7], s22 offen offset:2048 sc1 lds
    buffer_load_dwordx4 v1, s[4:7], s22 offen offset:3072 sc1 lds
    s_add_u32 m0, s20, 4096
    s_add_u32 s22, s12, 4096
    buffer_load_dwordx4 v1, s[4:7], s22 offen offset:0 sc1 lds
    buffer_load_dwordx4 v1, s[4:7], s22 offen offset:1024 sc1 lds
    buffer_load_dwordx4 v1, s[4:7], s22 offen offset:2048 sc1 lds
    buffer_load_dwordx4 v1, s[4:7], s22 offen offset:3072 sc1 lds
    s_add_u32 m0, s20, 8192
    s_add_u32 s22, s12, 8192
    buffer_load_dwordx4 v1, s[4:7], s22 offen offset:0 sc1 lds
    buffer_load_dwordx4 v1, s[4:7], s22 offen offset:1024 sc1 lds
    s_mov_b32 s18, 1
    s_waitcnt vmcnt(6)
    s_branch T1_GO_61
T1_HAVE_60:
    s_cmp_eq_u32 s35, 0
    s_cbranch_scc1 T1_H2_65
    s_add_u32 m0, s20, 0
    s_add_u32 s22, s12, 0
    buffer_load_dwordx4 v1, s[4:7], s22 offen offset:0 sc1 lds
    buffer_load_dwordx4 v1, s[4:7], s22 offen offset:1024 sc1 lds
    buffer_load_dwordx4 v1, s[4:7], s22 offen offset:2048 sc1 lds
    buffer_load_dwordx4 v1, s[4:7], s22 offen offset:3072 sc1 lds
    s_add_u32 m0, s20, 4096
    s_add_u32 s22, s12, 4096
    buffer_load_dwordx4 v1, s[4:7], s22 offen offset:0 sc1 lds
    buffer_load_dwordx4 v1, s[4:7], s22 offen offset:1024 sc1 lds
    buffer_load_dwordx4 v1, s[4:7], s22 offen offset:2048 sc1 lds
    buffer_load_dwordx4 v1, s[4:7], s22 offen offset:3072 sc1 lds
    s_add_u32 m0, s20, 8192
    s_add_u32 s22, s12, 8192
    buffer_load_dwordx4 v1, s[4:7], s22 offen offset:0 sc1 lds
    buffer_load_dwordx4 v1, s[4:7], s22 offen offset:1024 sc1 lds
    s_mov_b32 s18, 1
    s_waitcnt vmcnt(10)
    s_cmp_eq_u32 s19, 0
    s_cbranch_scc1 NF_66
    s_mov_b64 exec, 1
    buffer_store_dword v7, off, s[4:7], s34 sc1
    s_mov_b64 exec, -1
    s_mov_b32 s19, 0
NF_66:
    s_waitcnt vmcnt(7)
    s_branch T1_GO_61
T1_H2_65:
    s_waitcnt vmcnt(4)
T1_GO_61:
    s_barrier
    ds_read_b128 v[16:19], v2 offset:0
    ds_read_b128 v[20:23], v2 offset:10240
    ds_read_b128 v[24:27], v2 offset:20480
    s_mov_b32 s18, 0
    s_add_u32 s12, s12, 40960
    s_add_u32 s13, s13, 512
    s_sub_u32 s21, s20, 40960
    s_add_u32 s22, s20, 40960
    s_cmp_ge_u32 s20, 40960
    s_cselect_b32 s20, s21, s22
    s_mov_b32 s35, 0
    v_add_u32 v11, v11, v12
    s_cmp_ge_u32 s10, 7
    s_cselect_b32 s14, 0x7ff, s14
    s_waitcnt lgkmcnt(2)
    v_mfma_f32_32x32x16_bf16 v[128:143], a[0:3], v[16:19], 0
    s_mov_b64 exec, s[14:15]
    buffer_load_dword v8, v11, s[4:7], s13 offen sc1
    s_mov_b64 exec, -1
    v_mfma_f32_32x32x16_bf16 v[144:159], a[160:163], v[16:19], 0
    ds_read_b128 v[28:31], v2 offset:30720
    s_waitcnt lgkmcnt(2)
    v_mfma_f32_32x32x16_bf16 v[128:143], a[40:43], v[20:23], v[128:143]
    v_mfma_f32_32x32x16_bf16 v[144:159], a[200:203], v[20:23], v[144:159]
    ds_read_b128 v[16:19], v2 offset:1024
    s_waitcnt lgkmcnt(2)
    v_mfma_f32_32x32x16_bf16 v[128:143], a[80:83], v[24:27], v[128:143]
    v_mfma_f32_32x32x16_bf16 v[144:159], a[240:243], v[24:27], v[144:159]
    ds_read_b128 v[20:23], v2 offset:11264
    s_waitcnt lgkmcnt(2)
    v_mfma_f32_32x32x16_bf16 v[128:143], a[120:123], v[28:31], v[128:143]
    v_mfma_f32_32x32x16_bf16 v[144:159], v[216:219], v[28:31], v[144:159]
    ds_read_b128 v[24:27], v2 offset:21504
    s_waitcnt lgkmcnt(2)
    v_mfma_f32_32x32x16_bf16 v[128:143], a[4:7], v[16:19], v[128:143]
    v_mfma_f32_32x32x16_bf16 v[144:159], a[164:167], v[16:19], v[144:159]
    ds_read_b128 v[28:31], v2 offset:31744
    s_waitcnt lgkmcnt(2)
    v_mfma_f32_32x32x16_bf16 v[128:143], a[44:47], v[20:23], v[128:143]
    v_mfma_f32_32x32x16_bf16 v[144:159], a[204:207], v[20:23], v[144:159]
    ds_read_b128 v[16:19], v2 offset:2048
    s_waitcnt lgkmcnt(2)
    v_mfma_f32_32x32x16_bf16 v[128:143], a[84:87], v[24:27], v[128:143]
    v_mfma_f32_32x32x16_bf16 v[144:159], a[244:247], v[24:27], v[144:159]
    ds_read_b128 v[20:23], v2 offset:12288
    s_waitcnt lgkmcnt(2)
    v_mfma_f32_32x32x16_bf16 v[128:143], a[124:127], v[28:31], v[128:143]
    v_mfma_f32_32x32x16_bf16 v[144:159], v[220:223], v[28:31], v[144:159]
    ds_read_b128 v[24:27], v2 offset:22528
    s_waitcnt lgkmcnt(2)
    v_mfma_f32_32x32x16_bf16 v[128:143], a[8:11], v[16:19], v[128:143]
    v_mfma_f32_32x32x16_bf16 v[144:159], a[168:171], v[16:19], v[144:159]
    ds_read_b128 v[28:31], v2 offset:32768
    s_waitcnt lgkmcnt(2)
    v_mfma_f32_32x32x16_bf16 v[128:143], a[48:51], v[20:23], v[128:143]
    v_mfma_f32_32x32x16_bf16 v[144:159], a[208:211], v[20:23], v[144:159]
    ds_read_b128 v[16:19], v2 offset:3072
    s_waitcnt lgkmcnt(2)
    v_mfma_f32_32x32x16_bf16 v[128:143], a[88:91], v[24:27], v[128:143]
    v_mfma_f32_32x32x16_bf16 v[144:159], a[248:251], v[24:27], v[144:159]
    ds_read_b128 v[20:23], v2 offset:13312
    s_waitcnt lgkmcnt(2)
    v_mfma_f32_32x32x16_bf16 v[128:143], a[128:131], v[28:31], v[128:143]
    s_waitcnt vmcnt(0)
    s_cmp_eq_u32 s19, 0
    s_cbranch_scc1 NF_67
    s_mov_b64 exec, 1
    buffer_store_dword v7, off, s[4:7], s34 sc1
    s_mov_b64 exec, -1
    s_mov_b32 s19, 0
NF_67:
    s_cmp_lg_u32 s18, 0
    s_cbranch_scc1 CK_68
    s_cmp_ge_u32 s10, 63
    s_cbranch_scc1 CK_68
    v_cmp_eq_u32 vcc, 0, v8
    s_and_b64 vcc, vcc, s[14:15]
    s_cbranch_scc1 CK_68
    s_mov_b32 s18, 1
CK_68:
    s_barrier
    v_mfma_f32_32x32x16_bf16 v[144:159], v[224:227], v[28:31], v[144:159]
    ds_read_b128 v[24:27], v2 offset:23552
    s_waitcnt lgkmcnt(2)
    v_mfma_f32_32x32x16_bf16 v[128:143], a[12:15], v[16:19], v[128:143]
    s_cmp_eq_u32 s18, 0
    s_cbranch_scc1 PC_69
    s_add_u32 m0, s20, 0
    s_add_u32 s22, s12, 0
    buffer_load_dwordx4 v1, s[4:7], s22 offen offset:0 sc1 lds
PC_69:
    v_mfma_f32_32x32x16_bf16 v[144:159], a[172:175], v[16:19], v[144:159]
    ds_read_b128 v[28:31], v2 offset:33792
    s_waitcnt lgkmcnt(2)
    v_mfma_f32_32x32x16_bf16 v[128:143], a[52:55], v[20:23], v[128:143]
    s_cmp_eq_u32 s18, 0
    s_cbranch_scc1 PC_70
    buffer_load_dwordx4 v1, s[4:7], s22 offen offset:1024 sc1 lds
PC_70:
    v_mfma_f32_32x32x16_bf16 v[144:159], a[212:215], v[20:23], v[144:159]
    ds_read_b128 v[16:19], v2 offset:4096
    s_waitcnt lgkmcnt(2)
    v_mfma_f32_32x32x16_bf16 v[128:143], a[92:95], v[24:27], v[128:143]
    s_cmp_eq_u32 s18, 0
    s_cbranch_scc1 PC_71
    buffer_load_dwordx4 v1, s[4:7], s22 offen offset:2048 sc1 lds
PC_71:
    v_mfma_f32_32x32x16_bf16 v[144:159], a[252:255], v[24:27], v[144:159]
    ds_read_b128 v[20:23], v2 offset:14336
    s_waitcnt lgkmcnt(2)
    v_mfma_f32_32x32x16_bf16 v[128:143], a[132:135], v[28:31], v[128:143]
    s_cmp_eq_u32 s18, 0
    s_cbranch_scc1 PC_72
    buffer_load_dwordx4 v1, s[4:7], s22 offen offset:3072 sc1 lds
PC_72:
    v_mfma_f32_32x32x16_bf16 v[144:159], v[228:231], v[28:31], v[144:159]
    ds_read_b128 v[24:27], v2 offset:24576
    s_waitcnt lgkmcnt(2)
    v_mfma_f32_32x32x16_bf16 v[128:143], a[16:19], v[16:19], v[128:143]
    s_cmp_eq_u32 s18, 0
    s_cbranch_scc1 PC_73
    s_add_u32 m0, s20, 4096
    s_add_u32 s22, s12, 4096
    buffer_load_dwordx4 v1, s[4:7], s22 offen offset:0 sc1 lds
PC_73:
    v_mfma_f32_32x32x16_bf16 v[144:159], a[176:179], v[16:19], v[144:159]
    ds_read_b128 v[28:31], v2 offset:34816
    s_waitcnt lgkmcnt(2)
    v_mfma_f32_32x32x16_bf16 v[128:143], a[56:59], v[20:23], v[128:143]
    s_cmp_eq_u32 s18, 0
    s_cbranch_scc1 PC_74
    buffer_load_dwordx4 v1, s[4:7], s22 offen offset:1024 sc1 lds
PC_74:
    v_mfma_f32_32x32x16_bf16 v[144:159], a[216:219], v[20:23], v[144:159]
    ds_read_b128 v[16:19], v2 offset:5120
    s_waitcnt lgkmcnt(2)
    v_mfma_f32_32x32x16_bf16 v[128:143], a[96:99], v[24:27], v[128:143]
    s_cmp_eq_u32 s18, 0
    s_cbranch_scc1 PC_75
    buffer_load_dwordx4 v1, s[4:7], s22 offen offset:2048 sc1 lds
PC_75:
    v_mfma_f32_32x32x16_bf16 v[144:159], v[192:195], v[24:27], v[144:159]
    ds_read_b128 v[20:23], v2 offset:15360
    s_waitcnt lgkmcnt(2)
    v_mfma_f32_32x32x16_bf16 v[128:143], a[136:139], v[28:31], v[128:143]
    s_cmp_eq_u32 s18, 0
    s_cbranch_scc1 PC_76
    buffer_load_dwordx4 v1, s[4:7], s22 offen offset:3072 sc1 lds
PC_76:
    v_mfma_f32_32x32x16_bf16 v[144:159], v[232:235], v[28:31], v[144:159]
    ds_read_b128 v[24:27], v2 offset:25600
    s_waitcnt lgkmcnt(2)
    v_mfma_f32_32x32x16_bf16 v[128:143], a[20:23], v[16:19], v[128:143]
    s_cmp_eq_u32 s18, 0
    s_cbranch_scc1 PC_77
    s_add_u32 m0, s20, 8192
    s_add_u32 s22, s12, 8192
    buffer_load_dwordx4 v1, s[4:7], s22 offen offset:0 sc1 lds
PC_77:
    v_mfma_f32_32x32x16_bf16 v[144:159], a[180:183], v[16:19], v[144:159]
    ds_read_b128 v[28:31], v2 offset:35840
    s_waitcnt lgkmcnt(2)
    v_mfma_f32_32x32x16_bf16 v[128:143], a[60:63], v[20:23], v[128:143]
    s_cmp_eq_u32 s18, 0
    s_cbranch_scc1 PC_78
    buffer_load_dwordx4 v1, s[4:7], s22 offen offset:1024 sc1 lds
PC_78:
    v_mfma_f32_32x32x16_bf16 v[144:159], a[220:223], v[20:23], v[144:159]
    ds_read_b128 v[16:19], v2 offset:6144
    s_waitcnt lgkmcnt(2)
    v_mfma_f32_32x32x16_bf16 v[128:143], a[100:103], v[24:27], v[128:143]
    v_mfma_f32_32x32x16_bf16 v[144:159], v[196:199], v[24:27], v[144:159]
    ds_read_b128 v[20:23], v2 offset:16384
    s_waitcnt lgkmcnt(2)
    v_mfma_f32_32x32x16_bf16 v[128:143], a[140:143], v[28:31], v[128:143]
    v_mfma_f32_32x32x16_bf16 v[144:159], v[236:239], v[28:31], v[144:159]
    ds_read_b128 v[24:27], v2 offset:26624
    s_waitcnt lgkmcnt(2)
    v_mfma_f32_32x32x16_bf16 v[128:143], a[24:27], v[16:19], v[128:143]
    v_mfma_f32_32x32x16_bf16 v[144:159], a[184:187], v[16:19], v[144:159]
    ds_read_b128 v[28:31], v2 offset:36864
    s_waitcnt lgkmcnt(2)
    v_mfma_f32_32x32x16_bf16 v[128:143], a[64:67], v[20:23], v[128:143]
    buffer_load_dwordx4 v[92:95], v4, s[4:7], s36 offen sc1
    buffer_load_dwordx4 v[96:99], v4, s[4:7], s36 offen offset:16 sc1
    v_mfma_f32_32x32x16_bf16 v[144:159], a[224:227], v[20:23], v[144:159]
    ds_read_b128 v[16:19], v2 offset:7168
    s_waitcnt lgkmcnt(2)
    v_mfma_f32_32x32x16_bf16 v[128:143], a[104:107], v[24:27], v[128:143]
    v_mfma_f32_32x32x16_bf16 v[144:159], v[200:203], v[24:27], v[144:159]
    ds_read_b128 v[20:23], v2 offset:17408
    s_waitcnt lgkmcnt(2)
    v_mfma_f32_32x32x16_bf16 v[128:143], a[144:147], v[28:31], v[128:143]
    v_mfma_f32_32x32x16_bf16 v[144:159], v[240:243], v[28:31], v[144:159]
    ds_read_b128 v[24:27], v2 offset:27648
    s_cmp_ge_u32 s10, 63
    s_cselect_b32 s21, 1, s18
    s_cmp_lg_u32 s21, 0
    s_cbranch_scc1 SK_79
    s_mov_b64 exec, s[14:15]
    buffer_load_dword v8, v11, s[4:7], s13 offen sc1
    s_mov_b64 exec, -1
SK_79:
    s_waitcnt lgkmcnt(2)
    v_mfma_f32_32x32x16_bf16 v[128:143], a[28:31], v[16:19], v[128:143]
    v_mfma_f32_32x32x16_bf16 v[144:159], a[188:191], v[16:19], v[144:159]
    ds_read_b128 v[28:31], v2 offset:37888
    s_waitcnt lgkmcnt(2)
    v_mfma_f32_32x32x16_bf16 v[128:143], a[68:71], v[20:23], v[128:143]
    v_mfma_f32_32x32x16_bf16 v[144:159], a[228:231], v[20:23], v[144:159]
    ds_read_b128 v[16:19], v2 offset:8192
    s_waitcnt lgkmcnt(2)
    v_mfma_f32_32x32x16_bf16 v[128:143], a[108:111], v[24:27], v[128:143]
    v_mfma_f32_32x32x16_bf16 v[144:159], v[204:207], v[24:27], v[144:159]
    ds_read_b128 v[20:23], v2 offset:18432
    s_waitcnt lgkmcnt(2)
    v_mfma_f32_32x32x16_bf16 v[128:143], a[148:151], v[28:31], v[128:143]
    v_mfma_f32_32x32x16_bf16 v[144:159], v[244:247], v[28:31], v[144:159]
    ds_read_b128 v[24:27], v2 offset:28672
    s_waitcnt lgkmcnt(2)
    v_mfma_f32_32x32x16_bf16 v[128:143], a[32:35], v[16:19], v[128:143]
    v_mfma_f32_32x32x16_bf16 v[144:159], a[192:195], v[16:19], v[144:159]
    ds_read_b128 v[28:31], v2 offset:38912
    s_waitcnt lgkmcnt(2)
    v_mfma_f32_32x32x16_bf16 v[128:143], a[72:75], v[20:23], v[128:143]
    v_mfma_f32_32x32x16_bf16 v[144:159], a[232:235], v[20:23], v[144:159]
    ds_read_b128 v[16:19], v2 offset:9216
    s_waitcnt lgkmcnt(2)
    v_mfma_f32_32x32x16_bf16 v[128:143], a[112:115], v[24:27], v[128:143]
    v_mfma_f32_32x32x16_bf16 v[144:159], v[208:211], v[24:27], v[144:159]
    ds_read_b128 v[20:23], v2 offset:19456
    s_waitcnt lgkmcnt(2)
    v_mfma_f32_32x32x16_bf16 v[128:143], a[152:155], v[28:31], v[128:143]
    s_waitcnt vmcnt(0)
    v_min3_u32 v40, v93, v95, v97
    v_min_u32 v40, v40, v99
    v_cmp_eq_u32 vcc, 0, v40
    s_cmp_eq_u64 vcc, 0
    s_cselect_b32 s30, 1, 0
    v_mfma_f32_32x32x16_bf16 v[144:159], v[248:251], v[28:31], v[144:159]
    ds_read_b128 v[24:27], v2 offset:29696
    s_cmp_ge_u32 s10, 63
    s_cselect_b32 s21, 1, s18
    s_cmp_lg_u32 s21, 0
    s_cbranch_scc1 SK_80
    s_waitcnt vmcnt(0)
    s_cmp_eq_u32 s19, 0
    s_cbranch_scc1 NF_81
    s_mov_b64 exec, 1
    buffer_store_dword v7, off, s[4:7], s34 sc1
    s_mov_b64 exec, -1
    s_mov_b32 s19, 0
NF_81:
    s_cmp_lg_u32 s18, 0
    s_cbranch_scc1 CK_82
    s_cmp_ge_u32 s10, 63
    s_cbranch_scc1 CK_82
    v_cmp_eq_u32 vcc, 0, v8
    s_and_b64 vcc, vcc, s[14:15]
    s_cbranch_scc1 CK_82
    s_mov_b32 s18, 1
CK_82:
    s_mov_b32 s35, s18
SK_80:
    s_waitcnt lgkmcnt(2)
    v_mfma_f32_32x32x16_bf16 v[128:143], a[36:39], v[16:19], v[128:143]
    v_add_f32 v92, v92, v94
    v_add_f32 v93, v93, v95
    v_add_f32 v96, v96, v98
    v_add_f32 v97, v97, v99
    v_mfma_f32_32x32x16_bf16 v[144:159], a[196:199], v[16:19], v[144:159]
    ds_read_b128 v[28:31], v2 offset:39936
    v_add_f32 v92, v92, v96
    v_add_f32 v93, v93, v97
    v_mul_f32 v92, 0x3acccccd, v92
    v_mul_f32 v93, 0x3acccccd, v93
    s_waitcnt lgkmcnt(2)
    v_mfma_f32_32x32x16_bf16 v[128:143], a[76:79], v[20:23], v[128:143]
    v_fma_f32 v93, -v92, v92, v93
    v_max_f32 v93, 0, v93
    v_cvt_pk_bf16_f32 v92, v92, v93
    v_lshlrev_b32 v37, 16, v92
    v_mfma_f32_32x32x16_bf16 v[144:159], a[236:239], v[20:23], v[144:159]
    v_and_b32 v93, 0xffff0000, v92
    v_xor_b32 v37, 0x80000000, v37
    v_add_f32 v93, 0x3727c5ac, v93
    v_cvt_pk_bf16_f32 v93, v93, v93
    s_waitcnt lgkmcnt(1)
    v_mfma_f32_32x32x16_bf16 v[128:143], a[116:119], v[24:27], v[128:143]
    v_lshlrev_b32 v93, 16, v93
    v_sqrt_f32 v93, v93
    s_nop 0
    v_cvt_pk_bf16_f32 v93, v93, v93
    v_lshlrev_b32 v93, 16, v93
    v_mfma_f32_32x32x16_bf16 v[144:159], v[212:215], v[24:27], v[144:159]
    v_rcp_f32 v36, v93
    s_waitcnt lgkmcnt(0)
    v_mfma_f32_32x32x16_bf16 v[128:143], a[156:159], v[28:31], v[128:143]
    v_mfma_f32_32x32x16_bf16 v[144:159], v[252:255], v[28:31], v[144:159]
    s_cmp_lg_u32 s30, 0
    s_cbranch_scc1 SO_84
    s_mov_b32 s24, 0
SP_83:
    s_add_u32 s24, s24, 1
    s_cmp_ge_u32 s24, 200000
    s_cbranch_scc1 F_KV
    buffer_load_dwordx4 v[92:95], v4, s[4:7], s36 offen sc1
    buffer_load_dwordx4 v[96:99], v4, s[4:7], s36 offen offset:16 sc1
    s_waitcnt vmcnt(0)
    v_min3_u32 v40, v93, v95, v97
    v_min_u32 v40, v40, v99
    v_cmp_eq_u32 vcc, 0, v40
    s_cbranch_vccnz SP_83
    v_add_f32 v92, v92, v94
    v_add_f32 v93, v93, v95
    v_add_f32 v96, v96, v98
    v_add_f32 v97, v97, v99
    v_add_f32 v92, v92, v96
    v_add_f32 v93, v93, v97
    v_mul_f32 v92, 0x3acccccd, v92
    v_mul_f32 v93, 0x3acccccd, v93
    v_fma_f32 v93, -v92, v92, v93
    v_max_f32 v93, 0, v93
    v_cvt_pk_bf16_f32 v92, v92, v93
    v_lshlrev_b32 v37, 16, v92
    v_and_b32 v93, 0xffff0000, v92
    v_xor_b32 v37, 0x80000000, v37
    v_add_f32 v93, 0x3727c5ac, v93
    v_cvt_pk_bf16_f32 v93, v93, v93
    v_lshlrev_b32 v93, 16, v93
    v_sqrt_f32 v93, v93
    s_nop 0
    v_cvt_pk_bf16_f32 v93, v93, v93
    v_lshlrev_b32 v93, 16, v93
    v_rcp_f32 v36, v93
SO_84:
    s_cmp_ge_u32 s20, 40960
    s_cselect_b32 s21, 81920, 0
    s_sub_u32 s21, s21, 40960
    v_add_u32 v2, s21, v2
    s_nop 4
    v_pk_fma_f32 v[128:129], v[160:161], v[36:37], v[128:129] op_sel:[0,1,0] op_sel_hi:[1,1,1]
    v_pk_mul_f32 v[128:129], v[128:129], v[36:37] op_sel_hi:[1,0]
    v_pk_fma_f32 v[130:131], v[162:163], v[36:37], v[130:131] op_sel:[0,1,0] op_sel_hi:[1,1,1]
    v_pk_mul_f32 v[130:131], v[130:131], v[36:37] op_sel_hi:[1,0]
    v_pk_fma_f32 v[144:145], v[176:177], v[36:37], v[144:145] op_sel:[0,1,0] op_sel_hi:[1,1,1]
    v_pk_mul_f32 v[144:145], v[144:145], v[36:37] op_sel_hi:[1,0]
    v_pk_fma_f32 v[146:147], v[178:179], v[36:37], v[146:147] op_sel:[0,1,0] op_sel_hi:[1,1,1]
    v_pk_mul_f32 v[146:147], v[146:147], v[36:37] op_sel_hi:[1,0]
    v_cvt_pk_bf16_f32 v76, v128, v144
    v_cvt_pk_bf16_f32 v77, v129, v145
    v_cvt_pk_bf16_f32 v78, v130, v146
    v_cvt_pk_bf16_f32 v79, v131, v147
    buffer_store_dwordx4 v[76:79], v1, s[4:7], s16 offen offset:0 sc1
    v_pk_fma_f32 v[132:133], v[164:165], v[36:37], v[132:133] op_sel:[0,1,0] op_sel_hi:[1,1,1]
    v_pk_mul_f32 v[132:133], v[132:133], v[36:37] op_sel_hi:[1,0]
    v_pk_fma_f32 v[134:135], v[166:167], v[36:37], v[134:135] op_sel:[0,1,0] op_sel_hi:[1,1,1]
    v_pk_mul_f32 v[134:135], v[134:135], v[36:37] op_sel_hi:[1,0]
    v_pk_fma_f32 v[148:149], v[180:181], v[36:37], v[148:149] op_sel:[0,1,0] op_sel_hi:[1,1,1]
    v_pk_mul_f32 v[148:149], v[148:149], v[36:37] op_sel_hi:[1,0]
    v_pk_fma_f32 v[150:151], v[182:183], v[36:37], v[150:151] op_sel:[0,1,0] op_sel_hi:[1,1,1]
    v_pk_mul_f32 v[150:151], v[150:151], v[36:37] op_sel_hi:[1,0]
    v_cvt_pk_bf16_f32 v80, v132, v148
    v_cvt_pk_bf16_f32 v81, v133, v149
    v_cvt_pk_bf16_f32 v82, v134, v150
    v_cvt_pk_bf16_f32 v83, v135, v151
    buffer_store_dwordx4 v[80:83], v1, s[4:7], s16 offen offset:1024 sc1
    v_pk_fma_f32 v[136:137], v[168:169], v[36:37], v[136:137] op_sel:[0,1,0] op_sel_hi:[1,1,1]
    v_pk_mul_f32 v[136:137], v[136:137], v[36:37] op_sel_hi:[1,0]
    v_pk_fma_f32 v[138:139], v[170:171], v[36:37], v[138:139] op_sel:[0,1,0] op_sel_hi:[1,1,1]
    v_pk_mul_f32 v[138:139], v[138:139], v[36:37] op_sel_hi:[1,0]
    v_pk_fma_f32 v[152:153], v[184:185], v[36:37], v[152:153] op_sel:[0,1,0] op_sel_hi:[1,1,1]
    v_pk_mul_f32 v[152:153], v[152:153], v[36:37] op_sel_hi:[1,0]
    v_pk_fma_f32 v[154:155], v[186:187], v[36:37], v[154:155] op_sel:[0,1,0] op_sel_hi:[1,1,1]
    v_pk_mul_f32 v[154:155], v[154:155], v[36:37] op_sel_hi:[1,0]
    v_cvt_pk_bf16_f32 v84, v136, v152
    v_cvt_pk_bf16_f32 v85, v137, v153
    v_cvt_pk_bf16_f32 v86, v138, v154
    v_cvt_pk_bf16_f32 v87, v139, v155
    buffer_store_dwordx4 v[84:87], v1, s[4:7], s16 offen offset:2048 sc1
    v_pk_fma_f32 v[140:141], v[172:173], v[36:37], v[140:141] op_sel:[0,1,0] op_sel_hi:[1,1,1]
    v_pk_mul_f32 v[140:141], v[140:141], v[36:37] op_sel_hi:[1,0]
    v_pk_fma_f32 v[142:143], v[174:175], v[36:37], v[142:143] op_sel:[0,1,0] op_sel_hi:[1,1,1]
    v_pk_mul_f32 v[142:143], v[142:143], v[36:37] op_sel_hi:[1,0]
    v_pk_fma_f32 v[156:157], v[188:189], v[36:37], v[156:157] op_sel:[0,1,0] op_sel_hi:[1,1,1]
    v_pk_mul_f32 v[156:157], v[156:157], v[36:37] op_sel_hi:[1,0]
    v_pk_fma_f32 v[158:159], v[190:191], v[36:37], v[158:159] op_sel:[0,1,0] op_sel_hi:[1,1,1]
    v_pk_mul_f32 v[158:159], v[158:159], v[36:37] op_sel_hi:[1,0]
    v_cvt_pk_bf16_f32 v88, v140, v156
    v_cvt_pk_bf16_f32 v89, v141, v157
    v_cvt_pk_bf16_f32 v90, v142, v158
    v_cvt_pk_bf16_f32 v91, v143, v159
    buffer_store_dwordx4 v[88:91], v1, s[4:7], s16 offen offset:3072 sc1
    s_mov_b64 exec, -1
    s_mov_b32 s19, s25
    s_mov_b32 s34, s17
    s_add_u32 s17, s17, 64
    s_add_u32 s36, s36, 1024
    s_add_u32 s16, s16, 524288
    s_add_u32 s10, s10, 1
    s_cmp_lt_u32 s10, 64
    s_cbranch_scc1 T1_ITEM_59
    s_waitcnt vmcnt(0)
    s_cmp_eq_u32 s19, 0
    s_cbranch_scc1 NF_85
    s_mov_b64 exec, 1
    buffer_store_dword v7, off, s[4:7], s34 sc1
    s_mov_b64 exec, -1
    s_mov_b32 s19, 0
NF_85:
    s_endpgm
T1_VW_58:
    v_mfma_f32_32x32x16_bf16 v[160:175], v[16:19], a[0:3], 0
    v_mfma_f32_32x32x16_bf16 v[176:191], v[16:19], a[160:163], 0
    v_mfma_f32_32x32x16_bf16 v[160:175], v[16:19], a[4:7], v[160:175]
    v_mfma_f32_32x32x16_bf16 v[176:191], v[16:19], a[164:167], v[176:191]
    v_mfma_f32_32x32x16_bf16 v[160:175], v[16:19], a[8:11], v[160:175]
    v_mfma_f32_32x32x16_bf16 v[176:191], v[16:19], a[168:171], v[176:191]
    v_mfma_f32_32x32x16_bf16 v[160:175], v[16:19], a[12:15], v[160:175]
    v_mfma_f32_32x32x16_bf16 v[176:191], v[16:19], a[172:175], v[176:191]
    v_mfma_f32_32x32x16_bf16 v[160:175], v[16:19], a[16:19], v[160:175]
    v_mfma_f32_32x32x16_bf16 v[176:191], v[16:19], a[176:179], v[176:191]
    v_mfma_f32_32x32x16_bf16 v[160:175], v[16:19], a[20:23], v[160:175]
    v_mfma_f32_32x32x16_bf16 v[176:191], v[16:19], a[180:183], v[176:191]
    v_mfma_f32_32x32x16_bf16 v[160:175], v[16:19], a[24:27], v[160:175]
    v_mfma_f32_32x32x16_bf16 v[176:191], v[16:19], a[184:187], v[176:191]
    v_mfma_f32_32x32x16_bf16 v[160:175], v[16:19], a[28:31], v[160:175]
    v_mfma_f32_32x32x16_bf16 v[176:191], v[16:19], a[188:191], v[176:191]
    v_mfma_f32_32x32x16_bf16 v[160:175], v[16:19], a[32:35], v[160:175]
    v_mfma_f32_32x32x16_bf16 v[176:191], v[16:19], a[192:195], v[176:191]
    v_mfma_f32_32x32x16_bf16 v[160:175], v[16:19], a[36:39], v[160:175]
    v_mfma_f32_32x32x16_bf16 v[176:191], v[16:19], a[196:199], v[176:191]
    v_mfma_f32_32x32x16_bf16 v[160:175], v[16:19], a[40:43], v[160:175]
    v_mfma_f32_32x32x16_bf16 v[176:191], v[16:19], a[200:203], v[176:191]
    v_mfma_f32_32x32x16_bf16 v[160:175], v[16:19], a[44:47], v[160:175]
    v_mfma_f32_32x32x16_bf16 v[176:191], v[16:19], a[204:207], v[176:191]
    v_mfma_f32_32x32x16_bf16 v[160:175], v[16:19], a[48:51], v[160:175]
    v_mfma_f32_32x32x16_bf16 v[176:191], v[16:19], a[208:211], v[176:191]
    v_mfma_f32_32x32x16_bf16 v[160:175], v[16:19], a[52:55], v[160:175]
    v_mfma_f32_32x32x16_bf16 v[176:191], v[16:19], a[212:215], v[176:191]
    v_mfma_f32_32x32x16_bf16 v[160:175], v[16:19], a[56:59], v[160:175]
    v_mfma_f32_32x32x16_bf16 v[176:191], v[16:19], a[216:219], v[176:191]
    v_mfma_f32_32x32x16_bf16 v[160:175], v[16:19], a[60:63], v[160:175]
    v_mfma_f32_32x32x16_bf16 v[176:191], v[16:19], a[220:223], v[176:191]
    v_mfma_f32_32x32x16_bf16 v[160:175], v[16:19], a[64:67], v[160:175]
    v_mfma_f32_32x32x16_bf16 v[176:191], v[16:19], a[224:227], v[176:191]
    v_mfma_f32_32x32x16_bf16 v[160:175], v[16:19], a[68:71], v[160:175]
    v_mfma_f32_32x32x16_bf16 v[176:191], v[16:19], a[228:231], v[176:191]
    v_mfma_f32_32x32x16_bf16 v[160:175], v[16:19], a[72:75], v[160:175]
    v_mfma_f32_32x32x16_bf16 v[176:191], v[16:19], a[232:235], v[176:191]
    v_mfma_f32_32x32x16_bf16 v[160:175], v[16:19], a[76:79], v[160:175]
    v_mfma_f32_32x32x16_bf16 v[176:191], v[16:19], a[236:239], v[176:191]
    v_mfma_f32_32x32x16_bf16 v[160:175], v[16:19], a[80:83], v[160:175]
    v_mfma_f32_32x32x16_bf16 v[176:191], v[16:19], a[240:243], v[176:191]
    v_mfma_f32_32x32x16_bf16 v[160:175], v[16:19], a[84:87], v[160:175]
    v_mfma_f32_32x32x16_bf16 v[176:191], v[16:19], a[244:247], v[176:191]
    v_mfma_f32_32x32x16_bf16 v[160:175], v[16:19], a[88:91], v[160:175]
    v_mfma_f32_32x32x16_bf16 v[176:191], v[16:19], a[248:251], v[176:191]
    v_mfma_f32_32x32x16_bf16 v[160:175], v[16:19], a[92:95], v[160:175]
    v_mfma_f32_32x32x16_bf16 v[176:191], v[16:19], a[252:255], v[176:191]
    v_mfma_f32_32x32x16_bf16 v[160:175], v[16:19], a[96:99], v[160:175]
    v_mfma_f32_32x32x16_bf16 v[176:191], v[16:19], v[192:195], v[176:191]
    v_mfma_f32_32x32x16_bf16 v[160:175], v[16:19], a[100:103], v[160:175]
    v_mfma_f32_32x32x16_bf16 v[176:191], v[16:19], v[196:199], v[176:191]
    v_mfma_f32_32x32x16_bf16 v[160:175], v[16:19], a[104:107], v[160:175]
    v_mfma_f32_32x32x16_bf16 v[176:191], v[16:19], v[200:203], v[176:191]
    v_mfma_f32_32x32x16_bf16 v[160:175], v[16:19], a[108:111], v[160:175]
    v_mfma_f32_32x32x16_bf16 v[176:191], v[16:19], v[204:207], v[176:191]
    v_mfma_f32_32x32x16_bf16 v[160:175], v[16:19], a[112:115], v[160:175]
    v_mfma_f32_32x32x16_bf16 v[176:191], v[16:19], v[208:211], v[176:191]
    v_mfma_f32_32x32x16_bf16 v[160:175], v[16:19], a[116:119], v[160:175]
    v_mfma_f32_32x32x16_bf16 v[176:191], v[16:19], v[212:215], v[176:191]
    v_mfma_f32_32x32x16_bf16 v[160:175], v[16:19], a[120:123], v[160:175]
    v_mfma_f32_32x32x16_bf16 v[176:191], v[16:19], v[216:219], v[176:191]
    v_mfma_f32_32x32x16_bf16 v[160:175], v[16:19], a[124:127], v[160:175]
    v_mfma_f32_32x32x16_bf16 v[176:191], v[16:19], v[220:223], v[176:191]
    v_mfma_f32_32x32x16_bf16 v[160:175], v[16:19], a[128:131], v[160:175]
    v_mfma_f32_32x32x16_bf16 v[176:191], v[16:19], v[224:227], v[176:191]
    v_mfma_f32_32x32x16_bf16 v[160:175], v[16:19], a[132:135], v[160:175]
    v_mfma_f32_32x32x16_bf16 v[176:191], v[16:19], v[228:231], v[176:191]
    v_mfma_f32_32x32x16_bf16 v[160:175], v[16:19], a[136:139], v[160:175]
    v_mfma_f32_32x32x16_bf16 v[176:191], v[16:19], v[232:235], v[176:191]
    v_mfma_f32_32x32x16_bf16 v[160:175], v[16:19], a[140:143], v[160:175]
    v_mfma_f32_32x32x16_bf16 v[176:191], v[16:19], v[236:239], v[176:191]
    v_mfma_f32_32x32x16_bf16 v[160:175], v[16:19], a[144:147], v[160:175]
    v_mfma_f32_32x32x16_bf16 v[176:191], v[16:19], v[240:243], v[176:191]
    v_mfma_f32_32x32x16_bf16 v[160:175], v[16:19], a[148:151], v[160:175]
    v_mfma_f32_32x32x16_bf16 v[176:191], v[16:19], v[244:247], v[176:191]
    v_mfma_f32_32x32x16_bf16 v[160:175], v[16:19], a[152:155], v[160:175]
    v_mfma_f32_32x32x16_bf16 v[176:191], v[16:19], v[248:251], v[176:191]
    v_mfma_f32_32x32x16_bf16 v[160:175], v[16:19], a[156:159], v[160:175]
    v_mfma_f32_32x32x16_bf16 v[176:191], v[16:19], v[252:255], v[176:191]
T1_ITEM_86:
    s_cmp_lg_u32 s18, 0
    s_cbranch_scc1 T1_HAVE_87
    s_mov_b32 s24, 0
    s_mov_b64 exec, s[14:15]
    buffer_load_dword v8, v11, s[4:7], s13 offen sc1
    s_waitcnt vmcnt(0)
    v_cmp_eq_u32 vcc, 0, v8
    s_cmp_eq_u32 s19, 0
    s_cbranch_scc1 NF_91
    s_mov_b64 exec, 1
    buffer_store_dword v7, off, s[4:7], s34 sc1
    s_mov_b64 exec, -1
    s_mov_b32 s19, 0
NF_91:
    s_cbranch_vccz PO_90
    s_mov_b64 exec, s[14:15]
PL_89:
    buffer_load_dword v8, v11, s[4:7], s13 offen sc1
    s_waitcnt vmcnt(0)
    v_cmp_eq_u32 vcc, 0, v8
    s_cbranch_vccz PO_90
    s_sleep 2
    s_add_u32 s24, s24, 1
    s_cmp_lt_u32 s24, 200000
    s_cbranch_scc1 PL_89
    s_branch F_KV
PO_90:
    s_mov_b64 exec, -1
    s_add_u32 m0, s20, 0
    s_add_u32 s22, s12, 0
    buffer_load_dwordx4 v1, s[4:7], s22 offen offset:0 sc1 lds
    buffer_load_dwordx4 v1, s[4:7], s22 offen offset:1024 sc1 lds
    buffer_load_dwordx4 v1, s[4:7], s22 offen offset:2048 sc1 lds
    buffer_load_dwordx4 v1, s[4:7], s22 offen offset:3072 sc1 lds
    s_add_u32 m0, s20, 4096
    s_add_u32 s22, s12, 4096
    buffer_load_dwordx4 v1, s[4:7], s22 offen offset:0 sc1 lds
    buffer_load_dwordx4 v1, s[4:7], s22 offen offset:1024 sc1 lds
    buffer_load_dwordx4 v1, s[4:7], s22 offen offset:2048 sc1 lds
    buffer_load_dwordx4 v1, s[4:7], s22 offen offset:3072 sc1 lds
    s_add_u32 m0, s20, 8192
    s_add_u32 s22, s12, 8192
    buffer_load_dwordx4 v1, s[4:7], s22 offen offset:0 sc1 lds
    buffer_load_dwordx4 v1, s[4:7], s22 offen offset:1024 sc1 lds
    s_mov_b32 s18, 1
    s_waitcnt vmcnt(6)
    s_branch T1_GO_88
T1_HAVE_87:
    s_cmp_eq_u32 s35, 0
    s_cbranch_scc1 T1_H2_92
    s_add_u32 m0, s20, 0
    s_add_u32 s22, s12, 0
    buffer_load_dwordx4 v1, s[4:7], s22 offen offset:0 sc1 lds
    buffer_load_dwordx4 v1, s[4:7], s22 offen offset:1024 sc1 lds
    buffer_load_dwordx4 v1, s[4:7], s22 offen offset:2048 sc1 lds
    buffer_load_dwordx4 v1, s[4:7], s22 offen offset:3072 sc1 lds
    s_add_u32 m0, s20, 4096
    s_add_u32 s22, s12, 4096
    buffer_load_dwordx4 v1, s[4:7], s22 offen offset:0 sc1 lds
    buffer_load_dwordx4 v1, s[4:7], s22 offen offset:1024 sc1 lds
    buffer_load_dwordx4 v1, s[4:7], s22 offen offset:2048 sc1 lds
    buffer_load_dwordx4 v1, s[4:7], s22 offen offset:3072 sc1 lds
    s_add_u32 m0, s20, 8192
    s_add_u32 s22, s12, 8192
    buffer_load_dwordx4 v1, s[4:7], s22 offen offset:0 sc1 lds
    buffer_load_dwordx4 v1, s[4:7], s22 offen offset:1024 sc1 lds
    s_mov_b32 s18, 1
    s_waitcnt vmcnt(10)
    s_cmp_eq_u32 s19, 0
    s_cbranch_scc1 NF_93
    s_mov_b64 exec, 1
    buffer_store_dword v7, off, s[4:7], s34 sc1
    s_mov_b64 exec, -1
    s_mov_b32 s19, 0
NF_93:
    s_waitcnt vmcnt(7)
    s_branch T1_GO_88
T1_H2_92:
    s_waitcnt vmcnt(4)
T1_GO_88:
    s_barrier
    ds_read_b128 v[16:19], v2 offset:0
    ds_read_b128 v[20:23], v2 offset:10240
    ds_read_b128 v[24:27], v2 offset:20480
    s_mov_b32 s18, 0
    s_add_u32 s12, s12, 40960
    s_add_u32 s13, s13, 512
    s_sub_u32 s21, s20, 40960
    s_add_u32 s22, s20, 40960
    s_cmp_ge_u32 s20, 40960
    s_cselect_b32 s20, s21, s22
    s_mov_b32 s35, 0
    v_add_u32 v11, v11, v12
    s_cmp_ge_u32 s10, 7
    s_cselect_b32 s14, 0x7ff, s14
    s_waitcnt lgkmcnt(2)
    v_mfma_f32_32x32x16_bf16 v[128:143], v[16:19], a[0:3], 0
    s_mov_b64 exec, s[14:15]
    buffer_load_dword v8, v11, s[4:7], s13 offen sc1
    s_mov_b64 exec, -1
    v_mfma_f32_32x32x16_bf16 v[144:159], v[16:19], a[160:163], 0
    ds_read_b128 v[28:31], v2 offset:30720
    s_waitcnt lgkmcnt(2)
    v_mfma_f32_32x32x16_bf16 v[128:143], v[20:23], a[40:43], v[128:143]
    v_mfma_f32_32x32x16_bf16 v[144:159], v[20:23], a[200:203], v[144:159]
    ds_read_b128 v[16:19], v2 offset:1024
    s_waitcnt lgkmcnt(2)
    v_mfma_f32_32x32x16_bf16 v[128:143], v[24:27], a[80:83], v[128:143]
    v_mfma_f32_32x32x16_bf16 v[144:159], v[24:27], a[240:243], v[144:159]
    ds_read_b128 v[20:23], v2 offset:11264
    s_waitcnt lgkmcnt(2)
    v_mfma_f32_32x32x16_bf16 v[128:143], v[28:31], a[120:123], v[128:143]
    v_mfma_f32_32x32x16_bf16 v[144:159], v[28:31], v[216:219], v[144:159]
    ds_read_b128 v[24:27], v2 offset:21504
    s_waitcnt lgkmcnt(2)
    v_mfma_f32_32x32x16_bf16 v[128:143], v[16:19], a[4:7], v[128:143]
    v_mfma_f32_32x32x16_bf16 v[144:159], v[16:19], a[164:167], v[144:159]
    ds_read_b128 v[28:31], v2 offset:31744
    s_waitcnt lgkmcnt(2)
    v_mfma_f32_32x32x16_bf16 v[128:143], v[20:23], a[44:47], v[128:143]
    v_mfma_f32_32x32x16_bf16 v[144:159], v[20:23], a[204:207], v[144:159]
    ds_read_b128 v[16:19], v2 offset:2048
    s_waitcnt lgkmcnt(2)
    v_mfma_f32_32x32x16_bf16 v[128:143], v[24:27], a[84:87], v[128:143]
    v_mfma_f32_32x32x16_bf16 v[144:159], v[24:27], a[244:247], v[144:159]
    ds_read_b128 v[20:23], v2 offset:12288
    s_waitcnt lgkmcnt(2)
    v_mfma_f32_32x32x16_bf16 v[128:143], v[28:31], a[124:127], v[128:143]
    v_mfma_f32_32x32x16_bf16 v[144:159], v[28:31], v[220:223], v[144:159]
    ds_read_b128 v[24:27], v2 offset:22528
    s_waitcnt lgkmcnt(2)
    v_mfma_f32_32x32x16_bf16 v[128:143], v[16:19], a[8:11], v[128:143]
    v_mfma_f32_32x32x16_bf16 v[144:159], v[16:19], a[168:171], v[144:159]
    ds_read_b128 v[28:31], v2 offset:32768
    s_waitcnt lgkmcnt(2)
    v_mfma_f32_32x32x16_bf16 v[128:143], v[20:23], a[48:51], v[128:143]
    v_mfma_f32_32x32x16_bf16 v[144:159], v[20:23], a[208:211], v[144:159]
    ds_read_b128 v[16:19], v2 offset:3072
    s_waitcnt lgkmcnt(2)
    v_mfma_f32_32x32x16_bf16 v[128:143], v[24:27], a[88:91], v[128:143]
    v_mfma_f32_32x32x16_bf16 v[144:159], v[24:27], a[248:251], v[144:159]
    ds_read_b128 v[20:23], v2 offset:13312
    s_waitcnt lgkmcnt(2)
    v_mfma_f32_32x32x16_bf16 v[128:143], v[28:31], a[128:131], v[128:143]
    s_waitcnt vmcnt(0)
    s_cmp_eq_u32 s19, 0
    s_cbranch_scc1 NF_94
    s_mov_b64 exec, 1
    buffer_store_dword v7, off, s[4:7], s34 sc1
    s_mov_b64 exec, -1
    s_mov_b32 s19, 0
NF_94:
    s_cmp_lg_u32 s18, 0
    s_cbranch_scc1 CK_95
    s_cmp_ge_u32 s10, 63
    s_cbranch_scc1 CK_95
    v_cmp_eq_u32 vcc, 0, v8
    s_and_b64 vcc, vcc, s[14:15]
    s_cbranch_scc1 CK_95
    s_mov_b32 s18, 1
CK_95:
    s_barrier
    v_mfma_f32_32x32x16_bf16 v[144:159], v[28:31], v[224:227], v[144:159]
    ds_read_b128 v[24:27], v2 offset:23552
    s_waitcnt lgkmcnt(2)
    v_mfma_f32_32x32x16_bf16 v[128:143], v[16:19], a[12:15], v[128:143]
    s_cmp_eq_u32 s18, 0
    s_cbranch_scc1 PC_96
    s_add_u32 m0, s20, 0
    s_add_u32 s22, s12, 0
    buffer_load_dwordx4 v1, s[4:7], s22 offen offset:0 sc1 lds
PC_96:
    v_mfma_f32_32x32x16_bf16 v[144:159], v[16:19], a[172:175], v[144:159]
    ds_read_b128 v[28:31], v2 offset:33792
    s_waitcnt lgkmcnt(2)
    v_mfma_f32_32x32x16_bf16 v[128:143], v[20:23], a[52:55], v[128:143]
    s_cmp_eq_u32 s18, 0
    s_cbranch_scc1 PC_97
    buffer_load_dwordx4 v1, s[4:7], s22 offen offset:1024 sc1 lds
PC_97:
    v_mfma_f32_32x32x16_bf16 v[144:159], v[20:23], a[212:215], v[144:159]
    ds_read_b128 v[16:19], v2 offset:4096
    s_waitcnt lgkmcnt(2)
    v_mfma_f32_32x32x16_bf16 v[128:143], v[24:27], a[92:95], v[128:143]
    s_cmp_eq_u32 s18, 0
    s_cbranch_scc1 PC_98
    buffer_load_dwordx4 v1, s[4:7], s22 offen offset:2048 sc1 lds
PC_98:
    v_mfma_f32_32x32x16_bf16 v[144:159], v[24:27], a[252:255], v[144:159]
    ds_read_b128 v[20:23], v2 offset:14336
    s_waitcnt lgkmcnt(2)
    v_mfma_f32_32x32x16_bf16 v[128:143], v[28:31], a[132:135], v[128:143]
    s_cmp_eq_u32 s18, 0
    s_cbranch_scc1 PC_99
    buffer_load_dwordx4 v1, s[4:7], s22 offen offset:3072 sc1 lds
PC_99:
    v_mfma_f32_32x32x16_bf16 v[144:159], v[28:31], v[228:231], v[144:159]
    ds_read_b128 v[24:27], v2 offset:24576
    s_waitcnt lgkmcnt(2)
    v_mfma_f32_32x32x16_bf16 v[128:143], v[16:19], a[16:19], v[128:143]
    s_cmp_eq_u32 s18, 0
    s_cbranch_scc1 PC_100
    s_add_u32 m0, s20, 4096
    s_add_u32 s22, s12, 4096
    buffer_load_dwordx4 v1, s[4:7], s22 offen offset:0 sc1 lds
PC_100:
    v_mfma_f32_32x32x16_bf16 v[144:159], v[16:19], a[176:179], v[144:159]
    ds_read_b128 v[28:31], v2 offset:34816
    s_waitcnt lgkmcnt(2)
    v_mfma_f32_32x32x16_bf16 v[128:143], v[20:23], a[56:59], v[128:143]
    s_cmp_eq_u32 s18, 0
    s_cbranch_scc1 PC_101
    buffer_load_dwordx4 v1, s[4:7], s22 offen offset:1024 sc1 lds
PC_101:
    v_mfma_f32_32x32x16_bf16 v[144:159], v[20:23], a[216:219], v[144:159]
    ds_read_b128 v[16:19], v2 offset:5120
    s_waitcnt lgkmcnt(2)
    v_mfma_f32_32x32x16_bf16 v[128:143], v[24:27], a[96:99], v[128:143]
    s_cmp_eq_u32 s18, 0
    s_cbranch_scc1 PC_102
    buffer_load_dwordx4 v1, s[4:7], s22 offen offset:2048 sc1 lds
PC_102:
    v_mfma_f32_32x32x16_bf16 v[144:159], v[24:27], v[192:195], v[144:159]
    ds_read_b128 v[20:23], v2 offset:15360
    s_waitcnt lgkmcnt(2)
    v_mfma_f32_32x32x16_bf16 v[128:143], v[28:31], a[136:139], v[128:143]
    s_cmp_eq_u32 s18, 0
    s_cbranch_scc1 PC_103
    buffer_load_dwordx4 v1, s[4:7], s22 offen offset:3072 sc1 lds
PC_103:
    v_mfma_f32_32x32x16_bf16 v[144:159], v[28:31], v[232:235], v[144:159]
    ds_read_b128 v[24:27], v2 offset:25600
    s_waitcnt lgkmcnt(2)
    v_mfma_f32_32x32x16_bf16 v[128:143], v[16:19], a[20:23], v[128:143]
    s_cmp_eq_u32 s18, 0
    s_cbranch_scc1 PC_104
    s_add_u32 m0, s20, 8192
    s_add_u32 s22, s12, 8192
    buffer_load_dwordx4 v1, s[4:7], s22 offen offset:0 sc1 lds
PC_104:
    v_mfma_f32_32x32x16_bf16 v[144:159], v[16:19], a[180:183], v[144:159]
    ds_read_b128 v[28:31], v2 offset:35840
    s_waitcnt lgkmcnt(2)
    v_mfma_f32_32x32x16_bf16 v[128:143], v[20:23], a[60:63], v[128:143]
    s_cmp_eq_u32 s18, 0
    s_cbranch_scc1 PC_105
    buffer_load_dwordx4 v1, s[4:7], s22 offen offset:1024 sc1 lds
PC_105:
    v_mfma_f32_32x32x16_bf16 v[144:159], v[20:23], a[220:223], v[144:159]
    ds_read_b128 v[16:19], v2 offset:6144
    s_waitcnt lgkmcnt(2)
    v_mfma_f32_32x32x16_bf16 v[128:143], v[24:27], a[100:103], v[128:143]
    v_mfma_f32_32x32x16_bf16 v[144:159], v[24:27], v[196:199], v[144:159]
    ds_read_b128 v[20:23], v2 offset:16384
    s_waitcnt lgkmcnt(2)
    v_mfma_f32_32x32x16_bf16 v[128:143], v[28:31], a[140:143], v[128:143]
    v_mfma_f32_32x32x16_bf16 v[144:159], v[28:31], v[236:239], v[144:159]
    ds_read_b128 v[24:27], v2 offset:26624
    s_waitcnt lgkmcnt(2)
    v_mfma_f32_32x32x16_bf16 v[128:143], v[16:19], a[24:27], v[128:143]
    v_mfma_f32_32x32x16_bf16 v[144:159], v[16:19], a[184:187], v[144:159]
    ds_read_b128 v[28:31], v2 offset:36864
    s_waitcnt lgkmcnt(2)
    v_mfma_f32_32x32x16_bf16 v[128:143], v[20:23], a[64:67], v[128:143]
    buffer_load_dwordx4 v[92:95], v4, s[4:7], s36 offen sc1
    buffer_load_dwordx4 v[96:99], v4, s[4:7], s36 offen offset:16 sc1
    v_mfma_f32_32x32x16_bf16 v[144:159], v[20:23], a[224:227], v[144:159]
    ds_read_b128 v[16:19], v2 offset:7168
    s_waitcnt lgkmcnt(2)
    v_mfma_f32_32x32x16_bf16 v[128:143], v[24:27], a[104:107], v[128:143]
    v_mfma_f32_32x32x16_bf16 v[144:159], v[24:27], v[200:203], v[144:159]
    ds_read_b128 v[20:23], v2 offset:17408
    s_waitcnt lgkmcnt(2)
    v_mfma_f32_32x32x16_bf16 v[128:143], v[28:31], a[144:147], v[128:143]
    v_mfma_f32_32x32x16_bf16 v[144:159], v[28:31], v[240:243], v[144:159]
    ds_read_b128 v[24:27], v2 offset:27648
    s_cmp_ge_u32 s10, 63
    s_cselect_b32 s21, 1, s18
    s_cmp_lg_u32 s21, 0
    s_cbranch_scc1 SK_106
    s_mov_b64 exec, s[14:15]
    buffer_load_dword v8, v11, s[4:7], s13 offen sc1
    s_mov_b64 exec, -1
SK_106:
    s_waitcnt lgkmcnt(2)
    v_mfma_f32_32x32x16_bf16 v[128:143], v[16:19], a[28:31], v[128:143]
    v_mfma_f32_32x32x16_bf16 v[144:159], v[16:19], a[188:191], v[144:159]
    ds_read_b128 v[28:31], v2 offset:37888
    s_waitcnt lgkmcnt(2)
    v_mfma_f32_32x32x16_bf16 v[128:143], v[20:23], a[68:71], v[128:143]
    v_mfma_f32_32x32x16_bf16 v[144:159], v[20:23], a[228:231], v[144:159]
    ds_read_b128 v[16:19], v2 offset:8192
    s_waitcnt lgkmcnt(2)
    v_mfma_f32_32x32x16_bf16 v[128:143], v[24:27], a[108:111], v[128:143]
    v_mfma_f32_32x32x16_bf16 v[144:159], v[24:27], v[204:207], v[144:159]
    ds_read_b128 v[20:23], v2 offset:18432
    s_waitcnt lgkmcnt(2)
    v_mfma_f32_32x32x16_bf16 v[128:143], v[28:31], a[148:151], v[128:143]
    v_mfma_f32_32x32x16_bf16 v[144:159], v[28:31], v[244:247], v[144:159]
    ds_read_b128 v[24:27], v2 offset:28672
    s_waitcnt lgkmcnt(2)
    v_mfma_f32_32x32x16_bf16 v[128:143], v[16:19], a[32:35], v[128:143]
    v_mfma_f32_32x32x16_bf16 v[144:159], v[16:19], a[192:195], v[144:159]
    ds_read_b128 v[28:31], v2 offset:38912
    s_waitcnt lgkmcnt(2)
    v_mfma_f32_32x32x16_bf16 v[128:143], v[20:23], a[72:75], v[128:143]
    v_mfma_f32_32x32x16_bf16 v[144:159], v[20:23], a[232:235], v[144:159]
    ds_read_b128 v[16:19], v2 offset:9216
    s_waitcnt lgkmcnt(2)
    v_mfma_f32_32x32x16_bf16 v[128:143], v[24:27], a[112:115], v[128:143]
    v_mfma_f32_32x32x16_bf16 v[144:159], v[24:27], v[208:211], v[144:159]
    ds_read_b128 v[20:23], v2 offset:19456
    s_waitcnt lgkmcnt(2)
    v_mfma_f32_32x32x16_bf16 v[128:143], v[28:31], a[152:155], v[128:143]
    s_waitcnt vmcnt(0)
    v_min3_u32 v40, v93, v95, v97
    v_min_u32 v40, v40, v99
    v_cmp_eq_u32 vcc, 0, v40
    s_cmp_eq_u64 vcc, 0
    s_cselect_b32 s30, 1, 0
    v_mfma_f32_32x32x16_bf16 v[144:159], v[28:31], v[248:251], v[144:159]
    ds_read_b128 v[24:27], v2 offset:29696
    s_cmp_ge_u32 s10, 63
    s_cselect_b32 s21, 1, s18
    s_cmp_lg_u32 s21, 0
    s_cbranch_scc1 SK_107
    s_waitcnt vmcnt(0)
    s_cmp_eq_u32 s19, 0
    s_cbranch_scc1 NF_108
    s_mov_b64 exec, 1
    buffer_store_dword v7, off, s[4:7], s34 sc1
    s_mov_b64 exec, -1
    s_mov_b32 s19, 0
NF_108:
    s_cmp_lg_u32 s18, 0
    s_cbranch_scc1 CK_109
    s_cmp_ge_u32 s10, 63
    s_cbranch_scc1 CK_109
    v_cmp_eq_u32 vcc, 0, v8
    s_and_b64 vcc, vcc, s[14:15]
    s_cbranch_scc1 CK_109
    s_mov_b32 s18, 1
CK_109:
    s_mov_b32 s35, s18
SK_107:
    s_waitcnt lgkmcnt(2)
    v_mfma_f32_32x32x16_bf16 v[128:143], v[16:19], a[36:39], v[128:143]
    v_add_f32 v92, v92, v94
    v_add_f32 v93, v93, v95
    v_add_f32 v96, v96, v98
    v_add_f32 v97, v97, v99
    v_mfma_f32_32x32x16_bf16 v[144:159], v[16:19], a[196:199], v[144:159]
    ds_read_b128 v[28:31], v2 offset:39936
    v_add_f32 v92, v92, v96
    v_add_f32 v93, v93, v97
    v_mul_f32 v92, 0x3acccccd, v92
    v_mul_f32 v93, 0x3acccccd, v93
    s_waitcnt lgkmcnt(2)
    v_mfma_f32_32x32x16_bf16 v[128:143], v[20:23], a[76:79], v[128:143]
    v_fma_f32 v93, -v92, v92, v93
    v_max_f32 v93, 0, v93
    v_cvt_pk_bf16_f32 v92, v92, v93
    v_lshlrev_b32 v37, 16, v92
    v_mfma_f32_32x32x16_bf16 v[144:159], v[20:23], a[236:239], v[144:159]
    v_and_b32 v93, 0xffff0000, v92
    v_xor_b32 v37, 0x80000000, v37
    v_add_f32 v93, 0x3727c5ac, v93
    v_cvt_pk_bf16_f32 v93, v93, v93
    s_waitcnt lgkmcnt(1)
    v_mfma_f32_32x32x16_bf16 v[128:143], v[24:27], a[116:119], v[128:143]
    v_lshlrev_b32 v93, 16, v93
    v_sqrt_f32 v93, v93
    s_nop 0
    v_cvt_pk_bf16_f32 v93, v93, v93
    v_lshlrev_b32 v93, 16, v93
    v_mfma_f32_32x32x16_bf16 v[144:159], v[24:27], v[212:215], v[144:159]
    v_rcp_f32 v36, v93
    s_nop 0
    v_mul_f32 v37, v37, v36
    s_waitcnt lgkmcnt(0)
    v_mfma_f32_32x32x16_bf16 v[128:143], v[28:31], a[156:159], v[128:143]
    ds_write2_b32 v3, v36, v37 offset0:0 offset1:32
    ds_read_b128 v[44:47], v5 offset:0
    ds_read_b128 v[60:63], v5 offset:128
    ds_read_b128 v[48:51], v5 offset:32
    ds_read_b128 v[64:67], v5 offset:160
    ds_read_b128 v[52:55], v5 offset:64
    ds_read_b128 v[68:71], v5 offset:192
    ds_read_b128 v[56:59], v5 offset:96
    ds_read_b128 v[72:75], v5 offset:224
    v_mfma_f32_32x32x16_bf16 v[144:159], v[28:31], v[252:255], v[144:159]
    s_cmp_lg_u32 s30, 0
    s_cbranch_scc1 SO_111
    s_mov_b32 s24, 0
SP_110:
    s_add_u32 s24, s24, 1
    s_cmp_ge_u32 s24, 200000
    s_cbranch_scc1 F_KV
    buffer_load_dwordx4 v[92:95], v4, s[4:7], s36 offen sc1
    buffer_load_dwordx4 v[96:99], v4, s[4:7], s36 offen offset:16 sc1
    s_waitcnt vmcnt(0)
    v_min3_u32 v40, v93, v95, v97
    v_min_u32 v40, v40, v99
    v_cmp_eq_u32 vcc, 0, v40
    s_cbranch_vccnz SP_110
    v_add_f32 v92, v92, v94
    v_add_f32 v93, v93, v95
    v_add_f32 v96, v96, v98
    v_add_f32 v97, v97, v99
    v_add_f32 v92, v92, v96
    v_add_f32 v93, v93, v97
    v_mul_f32 v92, 0x3acccccd, v92
    v_mul_f32 v93, 0x3acccccd, v93
    v_fma_f32 v93, -v92, v92, v93
    v_max_f32 v93, 0, v93
    v_cvt_pk_bf16_f32 v92, v92, v93
    v_lshlrev_b32 v37, 16, v92
    v_and_b32 v93, 0xffff0000, v92
    v_xor_b32 v37, 0x80000000, v37
    v_add_f32 v93, 0x3727c5ac, v93
    v_cvt_pk_bf16_f32 v93, v93, v93
    v_lshlrev_b32 v93, 16, v93
    v_sqrt_f32 v93, v93
    s_nop 0
    v_cvt_pk_bf16_f32 v93, v93, v93
    v_lshlrev_b32 v93, 16, v93
    v_rcp_f32 v36, v93
    s_nop 0
    v_mul_f32 v37, v37, v36
    s_waitcnt lgkmcnt(0)
    ds_write2_b32 v3, v36, v37 offset0:0 offset1:32
    ds_read_b128 v[44:47], v5 offset:0
    ds_read_b128 v[60:63], v5 offset:128
    ds_read_b128 v[48:51], v5 offset:32
    ds_read_b128 v[64:67], v5 offset:160
    ds_read_b128 v[52:55], v5 offset:64
    ds_read_b128 v[68:71], v5 offset:192
    ds_read_b128 v[56:59], v5 offset:96
    ds_read_b128 v[72:75], v5 offset:224
SO_111:
    s_cmp_ge_u32 s20, 40960
    s_cselect_b32 s21, 81920, 0
    s_sub_u32 s21, s21, 40960
    v_add_u32 v2, s21, v2
    s_waitcnt lgkmcnt(0)
    v_pk_mul_f32 v[128:129], v[128:129], v[44:45]
    v_pk_fma_f32 v[128:129], v[60:61], v[160:161], v[128:129]
    v_cvt_pk_bf16_f32 v76, v128, v129
    v_pk_mul_f32 v[130:131], v[130:131], v[46:47]
    v_pk_fma_f32 v[130:131], v[62:63], v[160:161], v[130:131]
    v_cvt_pk_bf16_f32 v77, v130, v131
    v_pk_mul_f32 v[132:133], v[132:133], v[48:49]
    v_pk_fma_f32 v[132:133], v[64:65], v[160:161], v[132:133]
    v_cvt_pk_bf16_f32 v78, v132, v133
    v_pk_mul_f32 v[134:135], v[134:135], v[50:51]
    v_pk_fma_f32 v[134:135], v[66:67], v[160:161], v[134:135]
    v_cvt_pk_bf16_f32 v79, v134, v135
    buffer_store_dwordx4 v[76:79], v1, s[4:7], s16 offen offset:0 sc1
    v_pk_mul_f32 v[136:137], v[136:137], v[52:53]
    v_pk_fma_f32 v[136:137], v[68:69], v[160:161], v[136:137]
    v_cvt_pk_bf16_f32 v80, v136, v137
    v_pk_mul_f32 v[138:139], v[138:139], v[54:55]
    v_pk_fma_f32 v[138:139], v[70:71], v[160:161], v[138:139]
    v_cvt_pk_bf16_f32 v81, v138, v139
    v_pk_mul_f32 v[140:141], v[140:141], v[56:57]
    v_pk_fma_f32 v[140:141], v[72:73], v[160:161], v[140:141]
    v_cvt_pk_bf16_f32 v82, v140, v141
    v_pk_mul_f32 v[142:143], v[142:143], v[58:59]
    v_pk_fma_f32 v[142:143], v[74:75], v[160:161], v[142:143]
    v_cvt_pk_bf16_f32 v83, v142, v143
    buffer_store_dwordx4 v[80:83], v1, s[4:7], s16 offen offset:1024 sc1
    v_pk_mul_f32 v[144:145], v[144:145], v[44:45]
    v_pk_fma_f32 v[144:145], v[60:61], v[176:177], v[144:145]
    v_cvt_pk_bf16_f32 v84, v144, v145
    v_pk_mul_f32 v[146:147], v[146:147], v[46:47]
    v_pk_fma_f32 v[146:147], v[62:63], v[176:177], v[146:147]
    v_cvt_pk_bf16_f32 v85, v146, v147
    v_pk_mul_f32 v[148:149], v[148:149], v[48:49]
    v_pk_fma_f32 v[148:149], v[64:65], v[176:177], v[148:149]
    v_cvt_pk_bf16_f32 v86, v148, v149
    v_pk_mul_f32 v[150:151], v[150:151], v[50:51]
    v_pk_fma_f32 v[150:151], v[66:67], v[176:177], v[150:151]
    v_cvt_pk_bf16_f32 v87, v150, v151
    buffer_store_dwordx4 v[84:87], v1, s[4:7], s16 offen offset:2048 sc1
    v_pk_mul_f32 v[152:153], v[152:153], v[52:53]
    v_pk_fma_f32 v[152:153], v[68:69], v[176:177], v[152:153]
    v_cvt_pk_bf16_f32 v88, v152, v153
    v_pk_mul_f32 v[154:155], v[154:155], v[54:55]
    v_pk_fma_f32 v[154:155], v[70:71], v[176:177], v[154:155]
    v_cvt_pk_bf16_f32 v89, v154, v155
    v_pk_mul_f32 v[156:157], v[156:157], v[56:57]
    v_pk_fma_f32 v[156:157], v[72:73], v[176:177], v[156:157]
    v_cvt_pk_bf16_f32 v90, v156, v157
    v_pk_mul_f32 v[158:159], v[158:159], v[58:59]
    v_pk_fma_f32 v[158:159], v[74:75], v[176:177], v[158:159]
    v_cvt_pk_bf16_f32 v91, v158, v159
    buffer_store_dwordx4 v[88:91], v1, s[4:7], s16 offen offset:3072 sc1
    s_mov_b64 exec, -1
    s_mov_b32 s19, s25
    s_mov_b32 s34, s17
    s_add_u32 s17, s17, 64
    s_add_u32 s36, s36, 1024
    s_add_u32 s16, s16, 524288
    s_add_u32 s10, s10, 1
    s_cmp_lt_u32 s10, 64
    s_cbranch_scc1 T1_ITEM_86
    s_waitcnt vmcnt(0)
    s_cmp_eq_u32 s19, 0
    s_cbranch_scc1 NF_112
    s_mov_b64 exec, 1
    buffer_store_dword v7, off, s[4:7], s34 sc1
    s_mov_b64 exec, -1
    s_mov_b32 s19, 0
NF_112:
    s_endpgm
F_KV:
    s_endpgm
.p2align 6
R_Q:
    v_lshrrev_b32 v2, 6, v0
    v_and_b32 v0, 63, v0
    v_readfirstlane_b32 s9, v2
    v_lshlrev_b32 v1, 4, v0
    v_lshlrev_b32 v11, 2, v0
    v_mov_b32 v2, v1
    v_and_b32 v6, 31, v0
    v_lshrrev_b32 v7, 5, v0
    v_lshlrev_b32 v4, 5, v6
    s_lshl_b32 s21, s9, 8
    s_add_u32 s21, s21, 83968
    v_lshlrev_b32 v3, 2, v6
    v_add_u32 v3, s21, v3
    v_lshlrev_b32 v5, 4, v7
    v_add_u32 v5, s21, v5
    s_mov_b32 s10, 0
    s_mov_b32 s18, 0
    s_mov_b32 s19, 0
    s_mov_b32 s25, 1
    s_mul_i32 s20, s9, 10240
    s_lshl_b32 s23, s8, 2
    s_add_u32 s23, s23, s9
    s_mul_i32 s12, s11, 5242880
    s_mov_b32 s14, 0x3ff
    s_mov_b32 s15, 0
    s_mul_i32 s17, s11, 32768
    s_add_u32 s13, s17, 155385856
    s_mul_i32 s16, s11, 16777216
    s_lshl_b32 s21, s23, 12
    s_add_u32 s16, s16, s21
    s_add_u32 s16, s16, 164765696
    s_mul_i32 s17, s11, 131072
    s_lshr_b32 s21, s23, 1
    s_mul_i32 s21, s21, 4088
    s_add_u32 s17, s17, s21
    s_add_u32 s17, s17, 155451408
    s_lshl_b32 s22, s23, 7
    s_lshl_b32 s36, s11, 17
    s_add_u32 s36, s36, 155975680
    s_add_u32 s12, s12, 116391936
    s_lshl_b32 s21, s9, 7
    s_add_u32 s13, s13, s21
    s_add_u32 s12, s12, s20
    s_lshl_b32 s21, s23, 2
    s_add_u32 s17, s17, s21
    s_lshl_b32 s21, s8, 13
    s_mul_i32 s26, s11, 131072
    s_add_u32 s21, s21, s26
    s_add_u32 s21, s21, 155713024
    s_sub_u32 s21, s21, s13
    v_writelane_b32 v11, s21, 10
    v_mov_b32 v12, 0
    s_mov_b32 s21, -448
    v_writelane_b32 v12, s21, 10
    s_load_dwordx2 s[88:89], s[0:1], 16
    s_mov_b32 s90, 5242880
    s_mov_b32 s91, 0x00020000
    s_mov_b32 s92, 0x05040100
    s_mov_b32 s93, 0x07060302
    s_waitcnt lgkmcnt(0)
    v_mul_u32_u24 v8, 65536, v7
    v_lshl_add_u32 v8, v6, 2, v8
    v_add_u32 v48, 0, v8
    v_add_u32 v49, 8192, v8
    v_add_u32 v50, 16384, v8
    v_add_u32 v51, 24576, v8
    v_add_u32 v52, 32768, v8
    v_add_u32 v53, 40960, v8
    v_add_u32 v54, 49152, v8
    v_add_u32 v55, 57344, v8
    buffer_load_dword v64, v48, s[88:91], s22 offen offset:0
    buffer_load_dword v65, v49, s[88:91], s22 offen offset:0
    buffer_load_dword v66, v50, s[88:91], s22 offen offset:0
    buffer_load_dword v67, v51, s[88:91], s22 offen offset:0
    buffer_load_dword v68, v52, s[88:91], s22 offen offset:0
    buffer_load_dword v69, v53, s[88:91], s22 offen offset:0
    buffer_load_dword v70, v54, s[88:91], s22 offen offset:0
    buffer_load_dword v71, v55, s[88:91], s22 offen offset:0
    s_add_u32 s22, s22, 131072
    buffer_load_dword v72, v48, s[88:91], s22 offen offset:0
    buffer_load_dword v73, v49, s[88:91], s22 offen offset:0
    buffer_load_dword v74, v50, s[88:91], s22 offen offset:0
    buffer_load_dword v75, v51, s[88:91], s22 offen offset:0
    buffer_load_dword v76, v52, s[88:91], s22 offen offset:0
    buffer_load_dword v77, v53, s[88:91], s22 offen offset:0
    buffer_load_dword v78, v54, s[88:91], s22 offen offset:0
    buffer_load_dword v79, v55, s[88:91], s22 offen offset:0
    s_add_u32 s22, s22, 131072
    buffer_load_dword v80, v48, s[88:91], s22 offen offset:0
    buffer_load_dword v81, v49, s[88:91], s22 offen offset:0
    buffer_load_dword v82, v50, s[88:91], s22 offen offset:0
    buffer_load_dword v83, v51, s[88:91], s22 offen offset:0
    buffer_load_dword v84, v52, s[88:91], s22 offen offset:0
    buffer_load_dword v85, v53, s[88:91], s22 offen offset:0
    buffer_load_dword v86, v54, s[88:91], s22 offen offset:0
    buffer_load_dword v87, v55, s[88:91], s22 offen offset:0
    s_add_u32 s22, s22, 131072
    buffer_load_dword v88, v48, s[88:91], s22 offen offset:0
    buffer_load_dword v89, v49, s[88:91], s22 offen offset:0
    buffer_load_dword v90, v50, s[88:91], s22 offen offset:0
    buffer_load_dword v91, v51, s[88:91], s22 offen offset:0
    buffer_load_dword v92, v52, s[88:91], s22 offen offset:0
    buffer_load_dword v93, v53, s[88:91], s22 offen offset:0
    buffer_load_dword v94, v54, s[88:91], s22 offen offset:0
    buffer_load_dword v95, v55, s[88:91], s22 offen offset:0
    s_add_u32 s22, s22, 131072
    buffer_load_dword v96, v48, s[88:91], s22 offen offset:0
    buffer_load_dword v97, v49, s[88:91], s22 offen offset:0
    buffer_load_dword v98, v50, s[88:91], s22 offen offset:0
    buffer_load_dword v99, v51, s[88:91], s22 offen offset:0
    buffer_load_dword v100, v52, s[88:91], s22 offen offset:0
    buffer_load_dword v101, v53, s[88:91], s22 offen offset:0
    buffer_load_dword v102, v54, s[88:91], s22 offen offset:0
    buffer_load_dword v103, v55, s[88:91], s22 offen offset:0
    s_add_u32 s22, s22, 131072
    buffer_load_dword v104, v48, s[88:91], s22 offen offset:0
    buffer_load_dword v105, v49, s[88:91], s22 offen offset:0
    buffer_load_dword v106, v50, s[88:91], s22 offen offset:0
    buffer_load_dword v107, v51, s[88:91], s22 offen offset:0
    buffer_load_dword v108, v52, s[88:91], s22 offen offset:0
    buffer_load_dword v109, v53, s[88:91], s22 offen offset:0
    buffer_load_dword v110, v54, s[88:91], s22 offen offset:0
    buffer_load_dword v111, v55, s[88:91], s22 offen offset:0
    s_add_u32 s22, s22, 131072
    buffer_load_dword v112, v48, s[88:91], s22 offen offset:0
    buffer_load_dword v113, v49, s[88:91], s22 offen offset:0
    buffer_load_dword v114, v50, s[88:91], s22 offen offset:0
    buffer_load_dword v115, v51, s[88:91], s22 offen offset:0
    buffer_load_dword v116, v52, s[88:91], s22 offen offset:0
    buffer_load_dword v117, v53, s[88:91], s22 offen offset:0
    buffer_load_dword v118, v54, s[88:91], s22 offen offset:0
    buffer_load_dword v119, v55, s[88:91], s22 offen offset:0
    s_add_u32 s22, s22, 131072
    s_waitcnt vmcnt(48)
    v_perm_b32 v56, v65, v64, s92
    v_perm_b32 v57, v67, v66, s92
    v_perm_b32 v58, v69, v68, s92
    v_perm_b32 v59, v71, v70, s92
    v_accvgpr_write_b32 a0, v56
    v_accvgpr_write_b32 a1, v57
    v_accvgpr_write_b32 a2, v58
    v_accvgpr_write_b32 a3, v59
    v_perm_b32 v60, v65, v64, s93
    v_perm_b32 v61, v67, v66, s93
    v_perm_b32 v62, v69, v68, s93
    v_perm_b32 v63, v71, v70, s93
    v_accvgpr_write_b32 a160, v60
    v_accvgpr_write_b32 a161, v61
    v_accvgpr_write_b32 a162, v62
    v_accvgpr_write_b32 a163, v63
    buffer_load_dword v64, v48, s[88:91], s22 offen offset:0
    buffer_load_dword v65, v49, s[88:91], s22 offen offset:0
    buffer_load_dword v66, v50, s[88:91], s22 offen offset:0
    buffer_load_dword v67, v51, s[88:91], s22 offen offset:0
    buffer_load_dword v68, v52, s[88:91], s22 offen offset:0
    buffer_load_dword v69, v53, s[88:91], s22 offen offset:0
    buffer_load_dword v70, v54, s[88:91], s22 offen offset:0
    buffer_load_dword v71, v55, s[88:91], s22 offen offset:0
    s_add_u32 s22, s22, 131072
    s_waitcnt vmcnt(48)
    v_perm_b32 v56, v73, v72, s92
    v_perm_b32 v57, v75, v74, s92
    v_perm_b32 v58, v77, v76, s92
    v_perm_b32 v59, v79, v78, s92
    v_accvgpr_write_b32 a4, v56
    v_accvgpr_write_b32 a5, v57
    v_accvgpr_write_b32 a6, v58
    v_accvgpr_write_b32 a7, v59
    v_perm_b32 v60, v73, v72, s93
    v_perm_b32 v61, v75, v74, s93
    v_perm_b32 v62, v77, v76, s93
    v_perm_b32 v63, v79, v78, s93
    v_accvgpr_write_b32 a164, v60
    v_accvgpr_write_b32 a165, v61
    v_accvgpr_write_b32 a166, v62
    v_accvgpr_write_b32 a167, v63
    buffer_load_dword v72, v48, s[88:91], s22 offen offset:0
    buffer_load_dword v73, v49, s[88:91], s22 offen offset:0
    buffer_load_dword v74, v50, s[88:91], s22 offen offset:0
    buffer_load_dword v75, v51, s[88:91], s22 offen offset:0
    buffer_load_dword v76, v52, s[88:91], s22 offen offset:0
    buffer_load_dword v77, v53, s[88:91], s22 offen offset:0
    buffer_load_dword v78, v54, s[88:91], s22 offen offset:0
    buffer_load_dword v79, v55, s[88:91], s22 offen offset:0
    s_add_u32 s22, s22, 131072
    s_waitcnt vmcnt(48)
    v_perm_b32 v56, v81, v80, s92
    v_perm_b32 v57, v83, v82, s92
    v_perm_b32 v58, v85, v84, s92
    v_perm_b32 v59, v87, v86, s92
    v_accvgpr_write_b32 a8, v56
    v_accvgpr_write_b32 a9, v57
    v_accvgpr_write_b32 a10, v58
    v_accvgpr_write_b32 a11, v59
    v_perm_b32 v60, v81, v80, s93
    v_perm_b32 v61, v83, v82, s93
    v_perm_b32 v62, v85, v84, s93
    v_perm_b32 v63, v87, v86, s93
    v_accvgpr_write_b32 a168, v60
    v_accvgpr_write_b32 a169, v61
    v_accvgpr_write_b32 a170, v62
    v_accvgpr_write_b32 a171, v63
    buffer_load_dword v80, v48, s[88:91], s22 offen offset:0
    buffer_load_dword v81, v49, s[88:91], s22 offen offset:0
    buffer_load_dword v82, v50, s[88:91], s22 offen offset:0
    buffer_load_dword v83, v51, s[88:91], s22 offen offset:0
    buffer_load_dword v84, v52, s[88:91], s22 offen offset:0
    buffer_load_dword v85, v53, s[88:91], s22 offen offset:0
    buffer_load_dword v86, v54, s[88:91], s22 offen offset:0
    buffer_load_dword v87, v55, s[88:91], s22 offen offset:0
    s_add_u32 s22, s22, 131072
    s_waitcnt vmcnt(48)
    v_perm_b32 v56, v89, v88, s92
    v_perm_b32 v57, v91, v90, s92
    v_perm_b32 v58, v93, v92, s92
    v_perm_b32 v59, v95, v94, s92
    v_accvgpr_write_b32 a12, v56
    v_accvgpr_write_b32 a13, v57
    v_accvgpr_write_b32 a14, v58
    v_accvgpr_write_b32 a15, v59
    v_perm_b32 v60, v89, v88, s93
    v_perm_b32 v61, v91, v90, s93
    v_perm_b32 v62, v93, v92, s93
    v_perm_b32 v63, v95, v94, s93
    v_accvgpr_write_b32 a172, v60
    v_accvgpr_write_b32 a173, v61
    v_accvgpr_write_b32 a174, v62
    v_accvgpr_write_b32 a175, v63
    buffer_load_dword v88, v48, s[88:91], s22 offen offset:0
    buffer_load_dword v89, v49, s[88:91], s22 offen offset:0
    buffer_load_dword v90, v50, s[88:91], s22 offen offset:0
    buffer_load_dword v91, v51, s[88:91], s22 offen offset:0
    buffer_load_dword v92, v52, s[88:91], s22 offen offset:0
    buffer_load_dword v93, v53, s[88:91], s22 offen offset:0
    buffer_load_dword v94, v54, s[88:91], s22 offen offset:0
    buffer_load_dword v95, v55, s[88:91], s22 offen offset:0
    s_add_u32 s22, s22, 131072
    s_waitcnt vmcnt(48)
    v_perm_b32 v56, v97, v96, s92
    v_perm_b32 v57, v99, v98, s92
    v_perm_b32 v58, v101, v100, s92
    v_perm_b32 v59, v103, v102, s92
    v_accvgpr_write_b32 a16, v56
    v_accvgpr_write_b32 a17, v57
    v_accvgpr_write_b32 a18, v58
    v_accvgpr_write_b32 a19, v59
    v_perm_b32 v60, v97, v96, s93
    v_perm_b32 v61, v99, v98, s93
    v_perm_b32 v62, v101, v100, s93
    v_perm_b32 v63, v103, v102, s93
    v_accvgpr_write_b32 a176, v60
    v_accvgpr_write_b32 a177, v61
    v_accvgpr_write_b32 a178, v62
    v_accvgpr_write_b32 a179, v63
    buffer_load_dword v96, v48, s[88:91], s22 offen offset:0
    buffer_load_dword v97, v49, s[88:91], s22 offen offset:0
    buffer_load_dword v98, v50, s[88:91], s22 offen offset:0
    buffer_load_dword v99, v51, s[88:91], s22 offen offset:0
    buffer_load_dword v100, v52, s[88:91], s22 offen offset:0
    buffer_load_dword v101, v53, s[88:91], s22 offen offset:0
    buffer_load_dword v102, v54, s[88:91], s22 offen offset:0
    buffer_load_dword v103, v55, s[88:91], s22 offen offset:0
    s_add_u32 s22, s22, 131072
    s_waitcnt vmcnt(48)
    v_perm_b32 v56, v105, v104, s92
    v_perm_b32 v57, v107, v106, s92
    v_perm_b32 v58, v109, v108, s92
    v_perm_b32 v59, v111, v110, s92
    v_accvgpr_write_b32 a20, v56
    v_accvgpr_write_b32 a21, v57
    v_accvgpr_write_b32 a22, v58
    v_accvgpr_write_b32 a23, v59
    v_perm_b32 v60, v105, v104, s93
    v_perm_b32 v61, v107, v106, s93
    v_perm_b32 v62, v109, v108, s93
    v_perm_b32 v63, v111, v110, s93
    v_accvgpr_write_b32 a180, v60
    v_accvgpr_write_b32 a181, v61
    v_accvgpr_write_b32 a182, v62
    v_accvgpr_write_b32 a183, v63
    buffer_load_dword v104, v48, s[88:91], s22 offen offset:0
    buffer_load_dword v105, v49, s[88:91], s22 offen offset:0
    buffer_load_dword v106, v50, s[88:91], s22 offen offset:0
    buffer_load_dword v107, v51, s[88:91], s22 offen offset:0
    buffer_load_dword v108, v52, s[88:91], s22 offen offset:0
    buffer_load_dword v109, v53, s[88:91], s22 offen offset:0
    buffer_load_dword v110, v54, s[88:91], s22 offen offset:0
    buffer_load_dword v111, v55, s[88:91], s22 offen offset:0
    s_add_u32 s22, s22, 131072
    s_waitcnt vmcnt(48)
    v_perm_b32 v56, v113, v112, s92
    v_perm_b32 v57, v115, v114, s92
    v_perm_b32 v58, v117, v116, s92
    v_perm_b32 v59, v119, v118, s92
    v_accvgpr_write_b32 a24, v56
    v_accvgpr_write_b32 a25, v57
    v_accvgpr_write_b32 a26, v58
    v_accvgpr_write_b32 a27, v59
    v_perm_b32 v60, v113, v112, s93
    v_perm_b32 v61, v115, v114, s93
    v_perm_b32 v62, v117, v116, s93
    v_perm_b32 v63, v119, v118, s93
    v_accvgpr_write_b32 a184, v60
    v_accvgpr_write_b32 a185, v61
    v_accvgpr_write_b32 a186, v62
    v_accvgpr_write_b32 a187, v63
    buffer_load_dword v112, v48, s[88:91], s22 offen offset:0
    buffer_load_dword v113, v49, s[88:91], s22 offen offset:0
    buffer_load_dword v114, v50, s[88:91], s22 offen offset:0
    buffer_load_dword v115, v51, s[88:91], s22 offen offset:0
    buffer_load_dword v116, v52, s[88:91], s22 offen offset:0
    buffer_load_dword v117, v53, s[88:91], s22 offen offset:0
    buffer_load_dword v118, v54, s[88:91], s22 offen offset:0
    buffer_load_dword v119, v55, s[88:91], s22 offen offset:0
    s_add_u32 s22, s22, 131072
    s_waitcnt vmcnt(48)
    v_perm_b32 v56, v65, v64, s92
    v_perm_b32 v57, v67, v66, s92
    v_perm_b32 v58, v69, v68, s92
    v_perm_b32 v59, v71, v70, s92
    v_accvgpr_write_b32 a28, v56
    v_accvgpr_write_b32 a29, v57
    v_accvgpr_write_b32 a30, v58
    v_accvgpr_write_b32 a31, v59
    v_perm_b32 v60, v65, v64, s93
    v_perm_b32 v61, v67, v66, s93
    v_perm_b32 v62, v69, v68, s93
    v_perm_b32 v63, v71, v70, s93
    v_accvgpr_write_b32 a188, v60
    v_accvgpr_write_b32 a189, v61
    v_accvgpr_write_b32 a190, v62
    v_accvgpr_write_b32 a191, v63
    buffer_load_dword v64, v48, s[88:91], s22 offen offset:0
    buffer_load_dword v65, v49, s[88:91], s22 offen offset:0
    buffer_load_dword v66, v50, s[88:91], s22 offen offset:0
    buffer_load_dword v67, v51, s[88:91], s22 offen offset:0
    buffer_load_dword v68, v52, s[88:91], s22 offen offset:0
    buffer_load_dword v69, v53, s[88:91], s22 offen offset:0
    buffer_load_dword v70, v54, s[88:91], s22 offen offset:0
    buffer_load_dword v71, v55, s[88:91], s22 offen offset:0
    s_add_u32 s22, s22, 131072
    s_waitcnt vmcnt(48)
    v_perm_b32 v56, v73, v72, s92
    v_perm_b32 v57, v75, v74, s92
    v_perm_b32 v58, v77, v76, s92
    v_perm_b32 v59, v79, v78, s92
    v_accvgpr_write_b32 a32, v56
    v_accvgpr_write_b32 a33, v57
    v_accvgpr_write_b32 a34, v58
    v_accvgpr_write_b32 a35, v59
    v_perm_b32 v60, v73, v72, s93
    v_perm_b32 v61, v75, v74, s93
    v_perm_b32 v62, v77, v76, s93
    v_perm_b32 v63, v79, v78, s93
    v_accvgpr_write_b32 a192, v60
    v_accvgpr_write_b32 a193, v61
    v_accvgpr_write_b32 a194, v62
    v_accvgpr_write_b32 a195, v63
    buffer_load_dword v72, v48, s[88:91], s22 offen offset:0
    buffer_load_dword v73, v49, s[88:91], s22 offen offset:0
    buffer_load_dword v74, v50, s[88:91], s22 offen offset:0
    buffer_load_dword v75, v51, s[88:91], s22 offen offset:0
    buffer_load_dword v76, v52, s[88:91], s22 offen offset:0
    buffer_load_dword v77, v53, s[88:91], s22 offen offset:0
    buffer_load_dword v78, v54, s[88:91], s22 offen offset:0
    buffer_load_dword v79, v55, s[88:91], s22 offen offset:0
    s_add_u32 s22, s22, 131072
    s_waitcnt vmcnt(48)
    v_perm_b32 v56, v81, v80, s92
    v_perm_b32 v57, v83, v82, s92
    v_perm_b32 v58, v85, v84, s92
    v_perm_b32 v59, v87, v86, s92
    v_accvgpr_write_b32 a36, v56
    v_accvgpr_write_b32 a37, v57
    v_accvgpr_write_b32 a38, v58
    v_accvgpr_write_b32 a39, v59
    v_perm_b32 v60, v81, v80, s93
    v_perm_b32 v61, v83, v82, s93
    v_perm_b32 v62, v85, v84, s93
    v_perm_b32 v63, v87, v86, s93
    v_accvgpr_write_b32 a196, v60
    v_accvgpr_write_b32 a197, v61
    v_accvgpr_write_b32 a198, v62
    v_accvgpr_write_b32 a199, v63
    buffer_load_dword v80, v48, s[88:91], s22 offen offset:0
    buffer_load_dword v81, v49, s[88:91], s22 offen offset:0
    buffer_load_dword v82, v50, s[88:91], s22 offen offset:0
    buffer_load_dword v83, v51, s[88:91], s22 offen offset:0
    buffer_load_dword v84, v52, s[88:91], s22 offen offset:0
    buffer_load_dword v85, v53, s[88:91], s22 offen offset:0
    buffer_load_dword v86, v54, s[88:91], s22 offen offset:0
    buffer_load_dword v87, v55, s[88:91], s22 offen offset:0
    s_add_u32 s22, s22, 131072
    s_waitcnt vmcnt(48)
    v_perm_b32 v56, v89, v88, s92
    v_perm_b32 v57, v91, v90, s92
    v_perm_b32 v58, v93, v92, s92
    v_perm_b32 v59, v95, v94, s92
    v_accvgpr_write_b32 a40, v56
    v_accvgpr_write_b32 a41, v57
    v_accvgpr_write_b32 a42, v58
    v_accvgpr_write_b32 a43, v59
    v_perm_b32 v60, v89, v88, s93
    v_perm_b32 v61, v91, v90, s93
    v_perm_b32 v62, v93, v92, s93
    v_perm_b32 v63, v95, v94, s93
    v_accvgpr_write_b32 a200, v60
    v_accvgpr_write_b32 a201, v61
    v_accvgpr_write_b32 a202, v62
    v_accvgpr_write_b32 a203, v63
    buffer_load_dword v88, v48, s[88:91], s22 offen offset:0
    buffer_load_dword v89, v49, s[88:91], s22 offen offset:0
    buffer_load_dword v90, v50, s[88:91], s22 offen offset:0
    buffer_load_dword v91, v51, s[88:91], s22 offen offset:0
    buffer_load_dword v92, v52, s[88:91], s22 offen offset:0
    buffer_load_dword v93, v53, s[88:91], s22 offen offset:0
    buffer_load_dword v94, v54, s[88:91], s22 offen offset:0
    buffer_load_dword v95, v55, s[88:91], s22 offen offset:0
    s_add_u32 s22, s22, 131072
    s_waitcnt vmcnt(48)
    v_perm_b32 v56, v97, v96, s92
    v_perm_b32 v57, v99, v98, s92
    v_perm_b32 v58, v101, v100, s92
    v_perm_b32 v59, v103, v102, s92
    v_accvgpr_write_b32 a44, v56
    v_accvgpr_write_b32 a45, v57
    v_accvgpr_write_b32 a46, v58
    v_accvgpr_write_b32 a47, v59
    v_perm_b32 v60, v97, v96, s93
    v_perm_b32 v61, v99, v98, s93
    v_perm_b32 v62, v101, v100, s93
    v_perm_b32 v63, v103, v102, s93
    v_accvgpr_write_b32 a204, v60
    v_accvgpr_write_b32 a205, v61
    v_accvgpr_write_b32 a206, v62
    v_accvgpr_write_b32 a207, v63
    buffer_load_dword v96, v48, s[88:91], s22 offen offset:0
    buffer_load_dword v97, v49, s[88:91], s22 offen offset:0
    buffer_load_dword v98, v50, s[88:91], s22 offen offset:0
    buffer_load_dword v99, v51, s[88:91], s22 offen offset:0
    buffer_load_dword v100, v52, s[88:91], s22 offen offset:0
    buffer_load_dword v101, v53, s[88:91], s22 offen offset:0
    buffer_load_dword v102, v54, s[88:91], s22 offen offset:0
    buffer_load_dword v103, v55, s[88:91], s22 offen offset:0
    s_add_u32 s22, s22, 131072
    s_waitcnt vmcnt(48)
    v_perm_b32 v56, v105, v104, s92
    v_perm_b32 v57, v107, v106, s92
    v_perm_b32 v58, v109, v108, s92
    v_perm_b32 v59, v111, v110, s92
    v_accvgpr_write_b32 a48, v56
    v_accvgpr_write_b32 a49, v57
    v_accvgpr_write_b32 a50, v58
    v_accvgpr_write_b32 a51, v59
    v_perm_b32 v60, v105, v104, s93
    v_perm_b32 v61, v107, v106, s93
    v_perm_b32 v62, v109, v108, s93
    v_perm_b32 v63, v111, v110, s93
    v_accvgpr_write_b32 a208, v60
    v_accvgpr_write_b32 a209, v61
    v_accvgpr_write_b32 a210, v62
    v_accvgpr_write_b32 a211, v63
    buffer_load_dword v104, v48, s[88:91], s22 offen offset:0
    buffer_load_dword v105, v49, s[88:91], s22 offen offset:0
    buffer_load_dword v106, v50, s[88:91], s22 offen offset:0
    buffer_load_dword v107, v51, s[88:91], s22 offen offset:0
    buffer_load_dword v108, v52, s[88:91], s22 offen offset:0
    buffer_load_dword v109, v53, s[88:91], s22 offen offset:0
    buffer_load_dword v110, v54, s[88:91], s22 offen offset:0
    buffer_load_dword v111, v55, s[88:91], s22 offen offset:0
    s_add_u32 s22, s22, 131072
    s_waitcnt vmcnt(48)
    v_perm_b32 v56, v113, v112, s92
    v_perm_b32 v57, v115, v114, s92
    v_perm_b32 v58, v117, v116, s92
    v_perm_b32 v59, v119, v118, s92
    v_accvgpr_write_b32 a52, v56
    v_accvgpr_write_b32 a53, v57
    v_accvgpr_write_b32 a54, v58
    v_accvgpr_write_b32 a55, v59
    v_perm_b32 v60, v113, v112, s93
    v_perm_b32 v61, v115, v114, s93
    v_perm_b32 v62, v117, v116, s93
    v_perm_b32 v63, v119, v118, s93
    v_accvgpr_write_b32 a212, v60
    v_accvgpr_write_b32 a213, v61
    v_accvgpr_write_b32 a214, v62
    v_accvgpr_write_b32 a215, v63
    buffer_load_dword v112, v48, s[88:91], s22 offen offset:0
    buffer_load_dword v113, v49, s[88:91], s22 offen offset:0
    buffer_load_dword v114, v50, s[88:91], s22 offen offset:0
    buffer_load_dword v115, v51, s[88:91], s22 offen offset:0
    buffer_load_dword v116, v52, s[88:91], s22 offen offset:0
    buffer_load_dword v117, v53, s[88:91], s22 offen offset:0
    buffer_load_dword v118, v54, s[88:91], s22 offen offset:0
    buffer_load_dword v119, v55, s[88:91], s22 offen offset:0
    s_add_u32 s22, s22, 131072
    s_waitcnt vmcnt(48)
    v_perm_b32 v56, v65, v64, s92
    v_perm_b32 v57, v67, v66, s92
    v_perm_b32 v58, v69, v68, s92
    v_perm_b32 v59, v71, v70, s92
    v_accvgpr_write_b32 a56, v56
    v_accvgpr_write_b32 a57, v57
    v_accvgpr_write_b32 a58, v58
    v_accvgpr_write_b32 a59, v59
    v_perm_b32 v60, v65, v64, s93
    v_perm_b32 v61, v67, v66, s93
    v_perm_b32 v62, v69, v68, s93
    v_perm_b32 v63, v71, v70, s93
    v_accvgpr_write_b32 a216, v60
    v_accvgpr_write_b32 a217, v61
    v_accvgpr_write_b32 a218, v62
    v_accvgpr_write_b32 a219, v63
    buffer_load_dword v64, v48, s[88:91], s22 offen offset:0
    buffer_load_dword v65, v49, s[88:91], s22 offen offset:0
    buffer_load_dword v66, v50, s[88:91], s22 offen offset:0
    buffer_load_dword v67, v51, s[88:91], s22 offen offset:0
    buffer_load_dword v68, v52, s[88:91], s22 offen offset:0
    buffer_load_dword v69, v53, s[88:91], s22 offen offset:0
    buffer_load_dword v70, v54, s[88:91], s22 offen offset:0
    buffer_load_dword v71, v55, s[88:91], s22 offen offset:0
    s_add_u32 s22, s22, 131072
    s_waitcnt vmcnt(48)
    v_perm_b32 v56, v73, v72, s92
    v_perm_b32 v57, v75, v74, s92
    v_perm_b32 v58, v77, v76, s92
    v_perm_b32 v59, v79, v78, s92
    v_accvgpr_write_b32 a60, v56
    v_accvgpr_write_b32 a61, v57
    v_accvgpr_write_b32 a62, v58
    v_accvgpr_write_b32 a63, v59
    v_perm_b32 v60, v73, v72, s93
    v_perm_b32 v61, v75, v74, s93
    v_perm_b32 v62, v77, v76, s93
    v_perm_b32 v63, v79, v78, s93
    v_accvgpr_write_b32 a220, v60
    v_accvgpr_write_b32 a221, v61
    v_accvgpr_write_b32 a222, v62
    v_accvgpr_write_b32 a223, v63
    buffer_load_dword v72, v48, s[88:91], s22 offen offset:0
    buffer_load_dword v73, v49, s[88:91], s22 offen offset:0
    buffer_load_dword v74, v50, s[88:91], s22 offen offset:0
    buffer_load_dword v75, v51, s[88:91], s22 offen offset:0
    buffer_load_dword v76, v52, s[88:91], s22 offen offset:0
    buffer_load_dword v77, v53, s[88:91], s22 offen offset:0
    buffer_load_dword v78, v54, s[88:91], s22 offen offset:0
    buffer_load_dword v79, v55, s[88:91], s22 offen offset:0
    s_add_u32 s22, s22, 131072
    s_waitcnt vmcnt(48)
    v_perm_b32 v56, v81, v80, s92
    v_perm_b32 v57, v83, v82, s92
    v_perm_b32 v58, v85, v84, s92
    v_perm_b32 v59, v87, v86, s92
    v_accvgpr_write_b32 a64, v56
    v_accvgpr_write_b32 a65, v57
    v_accvgpr_write_b32 a66, v58
    v_accvgpr_write_b32 a67, v59
    v_perm_b32 v60, v81, v80, s93
    v_perm_b32 v61, v83, v82, s93
    v_perm_b32 v62, v85, v84, s93
    v_perm_b32 v63, v87, v86, s93
    v_accvgpr_write_b32 a224, v60
    v_accvgpr_write_b32 a225, v61
    v_accvgpr_write_b32 a226, v62
    v_accvgpr_write_b32 a227, v63
    buffer_load_dword v80, v48, s[88:91], s22 offen offset:0
    buffer_load_dword v81, v49, s[88:91], s22 offen offset:0
    buffer_load_dword v82, v50, s[88:91], s22 offen offset:0
    buffer_load_dword v83, v51, s[88:91], s22 offen offset:0
    buffer_load_dword v84, v52, s[88:91], s22 offen offset:0
    buffer_load_dword v85, v53, s[88:91], s22 offen offset:0
    buffer_load_dword v86, v54, s[88:91], s22 offen offset:0
    buffer_load_dword v87, v55, s[88:91], s22 offen offset:0
    s_add_u32 s22, s22, 131072
    s_waitcnt vmcnt(48)
    v_perm_b32 v56, v89, v88, s92
    v_perm_b32 v57, v91, v90, s92
    v_perm_b32 v58, v93, v92, s92
    v_perm_b32 v59, v95, v94, s92
    v_accvgpr_write_b32 a68, v56
    v_accvgpr_write_b32 a69, v57
    v_accvgpr_write_b32 a70, v58
    v_accvgpr_write_b32 a71, v59
    v_perm_b32 v60, v89, v88, s93
    v_perm_b32 v61, v91, v90, s93
    v_perm_b32 v62, v93, v92, s93
    v_perm_b32 v63, v95, v94, s93
    v_accvgpr_write_b32 a228, v60
    v_accvgpr_write_b32 a229, v61
    v_accvgpr_write_b32 a230, v62
    v_accvgpr_write_b32 a231, v63
    buffer_load_dword v88, v48, s[88:91], s22 offen offset:0
    buffer_load_dword v89, v49, s[88:91], s22 offen offset:0
    buffer_load_dword v90, v50, s[88:91], s22 offen offset:0
    buffer_load_dword v91, v51, s[88:91], s22 offen offset:0
    buffer_load_dword v92, v52, s[88:91], s22 offen offset:0
    buffer_load_dword v93, v53, s[88:91], s22 offen offset:0
    buffer_load_dword v94, v54, s[88:91], s22 offen offset:0
    buffer_load_dword v95, v55, s[88:91], s22 offen offset:0
    s_add_u32 s22, s22, 131072
    s_waitcnt vmcnt(48)
    v_perm_b32 v56, v97, v96, s92
    v_perm_b32 v57, v99, v98, s92
    v_perm_b32 v58, v101, v100, s92
    v_perm_b32 v59, v103, v102, s92
    v_accvgpr_write_b32 a72, v56
    v_accvgpr_write_b32 a73, v57
    v_accvgpr_write_b32 a74, v58
    v_accvgpr_write_b32 a75, v59
    v_perm_b32 v60, v97, v96, s93
    v_perm_b32 v61, v99, v98, s93
    v_perm_b32 v62, v101, v100, s93
    v_perm_b32 v63, v103, v102, s93
    v_accvgpr_write_b32 a232, v60
    v_accvgpr_write_b32 a233, v61
    v_accvgpr_write_b32 a234, v62
    v_accvgpr_write_b32 a235, v63
    buffer_load_dword v96, v48, s[88:91], s22 offen offset:0
    buffer_load_dword v97, v49, s[88:91], s22 offen offset:0
    buffer_load_dword v98, v50, s[88:91], s22 offen offset:0
    buffer_load_dword v99, v51, s[88:91], s22 offen offset:0
    buffer_load_dword v100, v52, s[88:91], s22 offen offset:0
    buffer_load_dword v101, v53, s[88:91], s22 offen offset:0
    buffer_load_dword v102, v54, s[88:91], s22 offen offset:0
    buffer_load_dword v103, v55, s[88:91], s22 offen offset:0
    s_add_u32 s22, s22, 131072
    s_waitcnt vmcnt(48)
    v_perm_b32 v56, v105, v104, s92
    v_perm_b32 v57, v107, v106, s92
    v_perm_b32 v58, v109, v108, s92
    v_perm_b32 v59, v111, v110, s92
    v_accvgpr_write_b32 a76, v56
    v_accvgpr_write_b32 a77, v57
    v_accvgpr_write_b32 a78, v58
    v_accvgpr_write_b32 a79, v59
    v_perm_b32 v60, v105, v104, s93
    v_perm_b32 v61, v107, v106, s93
    v_perm_b32 v62, v109, v108, s93
    v_perm_b32 v63, v111, v110, s93
    v_accvgpr_write_b32 a236, v60
    v_accvgpr_write_b32 a237, v61
    v_accvgpr_write_b32 a238, v62
    v_accvgpr_write_b32 a239, v63
    buffer_load_dword v104, v48, s[88:91], s22 offen offset:0
    buffer_load_dword v105, v49, s[88:91], s22 offen offset:0
    buffer_load_dword v106, v50, s[88:91], s22 offen offset:0
    buffer_load_dword v107, v51, s[88:91], s22 offen offset:0
    buffer_load_dword v108, v52, s[88:91], s22 offen offset:0
    buffer_load_dword v109, v53, s[88:91], s22 offen offset:0
    buffer_load_dword v110, v54, s[88:91], s22 offen offset:0
    buffer_load_dword v111, v55, s[88:91], s22 offen offset:0
    s_add_u32 s22, s22, 131072
    s_waitcnt vmcnt(48)
    v_perm_b32 v56, v113, v112, s92
    v_perm_b32 v57, v115, v114, s92
    v_perm_b32 v58, v117, v116, s92
    v_perm_b32 v59, v119, v118, s92
    v_accvgpr_write_b32 a80, v56
    v_accvgpr_write_b32 a81, v57
    v_accvgpr_write_b32 a82, v58
    v_accvgpr_write_b32 a83, v59
    v_perm_b32 v60, v113, v112, s93
    v_perm_b32 v61, v115, v114, s93
    v_perm_b32 v62, v117, v116, s93
    v_perm_b32 v63, v119, v118, s93
    v_accvgpr_write_b32 a240, v60
    v_accvgpr_write_b32 a241, v61
    v_accvgpr_write_b32 a242, v62
    v_accvgpr_write_b32 a243, v63
    buffer_load_dword v112, v48, s[88:91], s22 offen offset:0
    buffer_load_dword v113, v49, s[88:91], s22 offen offset:0
    buffer_load_dword v114, v50, s[88:91], s22 offen offset:0
    buffer_load_dword v115, v51, s[88:91], s22 offen offset:0
    buffer_load_dword v116, v52, s[88:91], s22 offen offset:0
    buffer_load_dword v117, v53, s[88:91], s22 offen offset:0
    buffer_load_dword v118, v54, s[88:91], s22 offen offset:0
    buffer_load_dword v119, v55, s[88:91], s22 offen offset:0
    s_add_u32 s22, s22, 131072
    s_waitcnt vmcnt(48)
    v_perm_b32 v56, v65, v64, s92
    v_perm_b32 v57, v67, v66, s92
    v_perm_b32 v58, v69, v68, s92
    v_perm_b32 v59, v71, v70, s92
    v_accvgpr_write_b32 a84, v56
    v_accvgpr_write_b32 a85, v57
    v_accvgpr_write_b32 a86, v58
    v_accvgpr_write_b32 a87, v59
    v_perm_b32 v60, v65, v64, s93
    v_perm_b32 v61, v67, v66, s93
    v_perm_b32 v62, v69, v68, s93
    v_perm_b32 v63, v71, v70, s93
    v_accvgpr_write_b32 a244, v60
    v_accvgpr_write_b32 a245, v61
    v_accvgpr_write_b32 a246, v62
    v_accvgpr_write_b32 a247, v63
    buffer_load_dword v64, v48, s[88:91], s22 offen offset:0
    buffer_load_dword v65, v49, s[88:91], s22 offen offset:0
    buffer_load_dword v66, v50, s[88:91], s22 offen offset:0
    buffer_load_dword v67, v51, s[88:91], s22 offen offset:0
    buffer_load_dword v68, v52, s[88:91], s22 offen offset:0
    buffer_load_dword v69, v53, s[88:91], s22 offen offset:0
    buffer_load_dword v70, v54, s[88:91], s22 offen offset:0
    buffer_load_dword v71, v55, s[88:91], s22 offen offset:0
    s_add_u32 s22, s22, 131072
    s_waitcnt vmcnt(48)
    v_perm_b32 v56, v73, v72, s92
    v_perm_b32 v57, v75, v74, s92
    v_perm_b32 v58, v77, v76, s92
    v_perm_b32 v59, v79, v78, s92
    v_accvgpr_write_b32 a88, v56
    v_accvgpr_write_b32 a89, v57
    v_accvgpr_write_b32 a90, v58
    v_accvgpr_write_b32 a91, v59
    v_perm_b32 v60, v73, v72, s93
    v_perm_b32 v61, v75, v74, s93
    v_perm_b32 v62, v77, v76, s93
    v_perm_b32 v63, v79, v78, s93
    v_accvgpr_write_b32 a248, v60
    v_accvgpr_write_b32 a249, v61
    v_accvgpr_write_b32 a250, v62
    v_accvgpr_write_b32 a251, v63
    buffer_load_dword v72, v48, s[88:91], s22 offen offset:0
    buffer_load_dword v73, v49, s[88:91], s22 offen offset:0
    buffer_load_dword v74, v50, s[88:91], s22 offen offset:0
    buffer_load_dword v75, v51, s[88:91], s22 offen offset:0
    buffer_load_dword v76, v52, s[88:91], s22 offen offset:0
    buffer_load_dword v77, v53, s[88:91], s22 offen offset:0
    buffer_load_dword v78, v54, s[88:91], s22 offen offset:0
    buffer_load_dword v79, v55, s[88:91], s22 offen offset:0
    s_add_u32 s22, s22, 131072
    s_waitcnt vmcnt(48)
    v_perm_b32 v56, v81, v80, s92
    v_perm_b32 v57, v83, v82, s92
    v_perm_b32 v58, v85, v84, s92
    v_perm_b32 v59, v87, v86, s92
    v_accvgpr_write_b32 a92, v56
    v_accvgpr_write_b32 a93, v57
    v_accvgpr_write_b32 a94, v58
    v_accvgpr_write_b32 a95, v59
    v_perm_b32 v60, v81, v80, s93
    v_perm_b32 v61, v83, v82, s93
    v_perm_b32 v62, v85, v84, s93
    v_perm_b32 v63, v87, v86, s93
    v_accvgpr_write_b32 a252, v60
    v_accvgpr_write_b32 a253, v61
    v_accvgpr_write_b32 a254, v62
    v_accvgpr_write_b32 a255, v63
    buffer_load_dword v80, v48, s[88:91], s22 offen offset:0
    buffer_load_dword v81, v49, s[88:91], s22 offen offset:0
    buffer_load_dword v82, v50, s[88:91], s22 offen offset:0
    buffer_load_dword v83, v51, s[88:91], s22 offen offset:0
    buffer_load_dword v84, v52, s[88:91], s22 offen offset:0
    buffer_load_dword v85, v53, s[88:91], s22 offen offset:0
    buffer_load_dword v86, v54, s[88:91], s22 offen offset:0
    buffer_load_dword v87, v55, s[88:91], s22 offen offset:0
    s_add_u32 s22, s22, 131072
    s_waitcnt vmcnt(48)
    v_perm_b32 v56, v89, v88, s92
    v_perm_b32 v57, v91, v90, s92
    v_perm_b32 v58, v93, v92, s92
    v_perm_b32 v59, v95, v94, s92
    v_accvgpr_write_b32 a96, v56
    v_accvgpr_write_b32 a97, v57
    v_accvgpr_write_b32 a98, v58
    v_accvgpr_write_b32 a99, v59
    v_perm_b32 v192, v89, v88, s93
    v_perm_b32 v193, v91, v90, s93
    v_perm_b32 v194, v93, v92, s93
    v_perm_b32 v195, v95, v94, s93
    buffer_load_dword v88, v48, s[88:91], s22 offen offset:0
    buffer_load_dword v89, v49, s[88:91], s22 offen offset:0
    buffer_load_dword v90, v50, s[88:91], s22 offen offset:0
    buffer_load_dword v91, v51, s[88:91], s22 offen offset:0
    buffer_load_dword v92, v52, s[88:91], s22 offen offset:0
    buffer_load_dword v93, v53, s[88:91], s22 offen offset:0
    buffer_load_dword v94, v54, s[88:91], s22 offen offset:0
    buffer_load_dword v95, v55, s[88:91], s22 offen offset:0
    s_add_u32 s22, s22, 131072
    s_waitcnt vmcnt(48)
    v_perm_b32 v60, v97, v96, s92
    v_perm_b32 v61, v99, v98, s92
    v_perm_b32 v62, v101, v100, s92
    v_perm_b32 v63, v103, v102, s92
    v_accvgpr_write_b32 a100, v60
    v_accvgpr_write_b32 a101, v61
    v_accvgpr_write_b32 a102, v62
    v_accvgpr_write_b32 a103, v63
    v_perm_b32 v196, v97, v96, s93
    v_perm_b32 v197, v99, v98, s93
    v_perm_b32 v198, v101, v100, s93
    v_perm_b32 v199, v103, v102, s93
    buffer_load_dword v96, v48, s[88:91], s22 offen offset:0
    buffer_load_dword v97, v49, s[88:91], s22 offen offset:0
    buffer_load_dword v98, v50, s[88:91], s22 offen offset:0
    buffer_load_dword v99, v51, s[88:91], s22 offen offset:0
    buffer_load_dword v100, v52, s[88:91], s22 offen offset:0
    buffer_load_dword v101, v53, s[88:91], s22 offen offset:0
    buffer_load_dword v102, v54, s[88:91], s22 offen offset:0
    buffer_load_dword v103, v55, s[88:91], s22 offen offset:0
    s_add_u32 s22, s22, 131072
    s_waitcnt vmcnt(48)
    v_perm_b32 v56, v105, v104, s92
    v_perm_b32 v57, v107, v106, s92
    v_perm_b32 v58, v109, v108, s92
    v_perm_b32 v59, v111, v110, s92
    v_accvgpr_write_b32 a104, v56
    v_accvgpr_write_b32 a105, v57
    v_accvgpr_write_b32 a106, v58
    v_accvgpr_write_b32 a107, v59
    v_perm_b32 v200, v105, v104, s93
    v_perm_b32 v201, v107, v106, s93
    v_perm_b32 v202, v109, v108, s93
    v_perm_b32 v203, v111, v110, s93
    buffer_load_dword v104, v48, s[88:91], s22 offen offset:0
    buffer_load_dword v105, v49, s[88:91], s22 offen offset:0
    buffer_load_dword v106, v50, s[88:91], s22 offen offset:0
    buffer_load_dword v107, v51, s[88:91], s22 offen offset:0
    buffer_load_dword v108, v52, s[88:91], s22 offen offset:0
    buffer_load_dword v109, v53, s[88:91], s22 offen offset:0
    buffer_load_dword v110, v54, s[88:91], s22 offen offset:0
    buffer_load_dword v111, v55, s[88:91], s22 offen offset:0
    s_add_u32 s22, s22, 131072
    s_waitcnt vmcnt(48)
    v_perm_b32 v60, v113, v112, s92
    v_perm_b32 v61, v115, v114, s92
    v_perm_b32 v62, v117, v116, s92
    v_perm_b32 v63, v119, v118, s92
    v_accvgpr_write_b32 a108, v60
    v_accvgpr_write_b32 a109, v61
    v_accvgpr_write_b32 a110, v62
    v_accvgpr_write_b32 a111, v63
    v_perm_b32 v204, v113, v112, s93
    v_perm_b32 v205, v115, v114, s93
    v_perm_b32 v206, v117, v116, s93
    v_perm_b32 v207, v119, v118, s93
    buffer_load_dword v112, v48, s[88:91], s22 offen offset:0
    buffer_load_dword v113, v49, s[88:91], s22 offen offset:0
    buffer_load_dword v114, v50, s[88:91], s22 offen offset:0
    buffer_load_dword v115, v51, s[88:91], s22 offen offset:0
    buffer_load_dword v116, v52, s[88:91], s22 offen offset:0
    buffer_load_dword v117, v53, s[88:91], s22 offen offset:0
    buffer_load_dword v118, v54, s[88:91], s22 offen offset:0
    buffer_load_dword v119, v55, s[88:91], s22 offen offset:0
    s_add_u32 s22, s22, 131072
    s_waitcnt vmcnt(48)
    v_perm_b32 v56, v65, v64, s92
    v_perm_b32 v57, v67, v66, s92
    v_perm_b32 v58, v69, v68, s92
    v_perm_b32 v59, v71, v70, s92
    v_accvgpr_write_b32 a112, v56
    v_accvgpr_write_b32 a113, v57
    v_accvgpr_write_b32 a114, v58
    v_accvgpr_write_b32 a115, v59
    v_perm_b32 v208, v65, v64, s93
    v_perm_b32 v209, v67, v66, s93
    v_perm_b32 v210, v69, v68, s93
    v_perm_b32 v211, v71, v70, s93
    buffer_load_dword v64, v48, s[88:91], s22 offen offset:0
    buffer_load_dword v65, v49, s[88:91], s22 offen offset:0
    buffer_load_dword v66, v50, s[88:91], s22 offen offset:0
    buffer_load_dword v67, v51, s[88:91], s22 offen offset:0
    buffer_load_dword v68, v52, s[88:91], s22 offen offset:0
    buffer_load_dword v69, v53, s[88:91], s22 offen offset:0
    buffer_load_dword v70, v54, s[88:91], s22 offen offset:0
    buffer_load_dword v71, v55, s[88:91], s22 offen offset:0
    s_add_u32 s22, s22, 131072
    s_waitcnt vmcnt(48)
    v_perm_b32 v60, v73, v72, s92
    v_perm_b32 v61, v75, v74, s92
    v_perm_b32 v62, v77, v76, s92
    v_perm_b32 v63, v79, v78, s92
    v_accvgpr_write_b32 a116, v60
    v_accvgpr_write_b32 a117, v61
    v_accvgpr_write_b32 a118, v62
    v_accvgpr_write_b32 a119, v63
    v_perm_b32 v212, v73, v72, s93
    v_perm_b32 v213, v75, v74, s93
    v_perm_b32 v214, v77, v76, s93
    v_perm_b32 v215, v79, v78, s93
    buffer_load_dword v72, v48, s[88:91], s22 offen offset:0
    buffer_load_dword v73, v49, s[88:91], s22 offen offset:0
    buffer_load_dword v74, v50, s[88:91], s22 offen offset:0
    buffer_load_dword v75, v51, s[88:91], s22 offen offset:0
    buffer_load_dword v76, v52, s[88:91], s22 offen offset:0
    buffer_load_dword v77, v53, s[88:91], s22 offen offset:0
    buffer_load_dword v78, v54, s[88:91], s22 offen offset:0
    buffer_load_dword v79, v55, s[88:91], s22 offen offset:0
    s_add_u32 s22, s22, 131072
    s_waitcnt vmcnt(48)
    v_perm_b32 v56, v81, v80, s92
    v_perm_b32 v57, v83, v82, s92
    v_perm_b32 v58, v85, v84, s92
    v_perm_b32 v59, v87, v86, s92
    v_accvgpr_write_b32 a120, v56
    v_accvgpr_write_b32 a121, v57
    v_accvgpr_write_b32 a122, v58
    v_accvgpr_write_b32 a123, v59
    v_perm_b32 v216, v81, v80, s93
    v_perm_b32 v217, v83, v82, s93
    v_perm_b32 v218, v85, v84, s93
    v_perm_b32 v219, v87, v86, s93
    buffer_load_dword v80, v48, s[88:91], s22 offen offset:0
    buffer_load_dword v81, v49, s[88:91], s22 offen offset:0
    buffer_load_dword v82, v50, s[88:91], s22 offen offset:0
    buffer_load_dword v83, v51, s[88:91], s22 offen offset:0
    buffer_load_dword v84, v52, s[88:91], s22 offen offset:0
    buffer_load_dword v85, v53, s[88:91], s22 offen offset:0
    buffer_load_dword v86, v54, s[88:91], s22 offen offset:0
    buffer_load_dword v87, v55, s[88:91], s22 offen offset:0
    s_add_u32 s22, s22, 131072
    s_waitcnt vmcnt(48)
    v_perm_b32 v60, v89, v88, s92
    v_perm_b32 v61, v91, v90, s92
    v_perm_b32 v62, v93, v92, s92
    v_perm_b32 v63, v95, v94, s92
    v_accvgpr_write_b32 a124, v60
    v_accvgpr_write_b32 a125, v61
    v_accvgpr_write_b32 a126, v62
    v_accvgpr_write_b32 a127, v63
    v_perm_b32 v220, v89, v88, s93
    v_perm_b32 v221, v91, v90, s93
    v_perm_b32 v222, v93, v92, s93
    v_perm_b32 v223, v95, v94, s93
    buffer_load_dword v88, v48, s[88:91], s22 offen offset:0
    buffer_load_dword v89, v49, s[88:91], s22 offen offset:0
    buffer_load_dword v90, v50, s[88:91], s22 offen offset:0
    buffer_load_dword v91, v51, s[88:91], s22 offen offset:0
    buffer_load_dword v92, v52, s[88:91], s22 offen offset:0
    buffer_load_dword v93, v53, s[88:91], s22 offen offset:0
    buffer_load_dword v94, v54, s[88:91], s22 offen offset:0
    buffer_load_dword v95, v55, s[88:91], s22 offen offset:0
    s_add_u32 s22, s22, 131072
    s_waitcnt vmcnt(48)
    v_perm_b32 v56, v97, v96, s92
    v_perm_b32 v57, v99, v98, s92
    v_perm_b32 v58, v101, v100, s92
    v_perm_b32 v59, v103, v102, s92
    v_accvgpr_write_b32 a128, v56
    v_accvgpr_write_b32 a129, v57
    v_accvgpr_write_b32 a130, v58
    v_accvgpr_write_b32 a131, v59
    v_perm_b32 v224, v97, v96, s93
    v_perm_b32 v225, v99, v98, s93
    v_perm_b32 v226, v101, v100, s93
    v_perm_b32 v227, v103, v102, s93
    buffer_load_dword v96, v48, s[88:91], s22 offen offset:0
    buffer_load_dword v97, v49, s[88:91], s22 offen offset:0
    buffer_load_dword v98, v50, s[88:91], s22 offen offset:0
    buffer_load_dword v99, v51, s[88:91], s22 offen offset:0
    buffer_load_dword v100, v52, s[88:91], s22 offen offset:0
    buffer_load_dword v101, v53, s[88:91], s22 offen offset:0
    buffer_load_dword v102, v54, s[88:91], s22 offen offset:0
    buffer_load_dword v103, v55, s[88:91], s22 offen offset:0
    s_add_u32 s22, s22, 131072
    s_waitcnt vmcnt(48)
    v_perm_b32 v60, v105, v104, s92
    v_perm_b32 v61, v107, v106, s92
    v_perm_b32 v62, v109, v108, s92
    v_perm_b32 v63, v111, v110, s92
    v_accvgpr_write_b32 a132, v60
    v_accvgpr_write_b32 a133, v61
    v_accvgpr_write_b32 a134, v62
    v_accvgpr_write_b32 a135, v63
    v_perm_b32 v228, v105, v104, s93
    v_perm_b32 v229, v107, v106, s93
    v_perm_b32 v230, v109, v108, s93
    v_perm_b32 v231, v111, v110, s93
    s_waitcnt vmcnt(40)
    v_perm_b32 v56, v113, v112, s92
    v_perm_b32 v57, v115, v114, s92
    v_perm_b32 v58, v117, v116, s92
    v_perm_b32 v59, v119, v118, s92
    v_accvgpr_write_b32 a136, v56
    v_accvgpr_write_b32 a137, v57
    v_accvgpr_write_b32 a138, v58
    v_accvgpr_write_b32 a139, v59
    v_perm_b32 v232, v113, v112, s93
    v_perm_b32 v233, v115, v114, s93
    v_perm_b32 v234, v117, v116, s93
    v_perm_b32 v235, v119, v118, s93
    s_waitcnt vmcnt(32)
    v_perm_b32 v60, v65, v64, s92
    v_perm_b32 v61, v67, v66, s92
    v_perm_b32 v62, v69, v68, s92
    v_perm_b32 v63, v71, v70, s92
    v_accvgpr_write_b32 a140, v60
    v_accvgpr_write_b32 a141, v61
    v_accvgpr_write_b32 a142, v62
    v_accvgpr_write_b32 a143, v63
    v_perm_b32 v236, v65, v64, s93
    v_perm_b32 v237, v67, v66, s93
    v_perm_b32 v238, v69, v68, s93
    v_perm_b32 v239, v71, v70, s93
    s_waitcnt vmcnt(24)
    v_perm_b32 v56, v73, v72, s92
    v_perm_b32 v57, v75, v74, s92
    v_perm_b32 v58, v77, v76, s92
    v_perm_b32 v59, v79, v78, s92
    v_accvgpr_write_b32 a144, v56
    v_accvgpr_write_b32 a145, v57
    v_accvgpr_write_b32 a146, v58
    v_accvgpr_write_b32 a147, v59
    v_perm_b32 v240, v73, v72, s93
    v_perm_b32 v241, v75, v74, s93
    v_perm_b32 v242, v77, v76, s93
    v_perm_b32 v243, v79, v78, s93
    s_waitcnt vmcnt(16)
    v_perm_b32 v60, v81, v80, s92
    v_perm_b32 v61, v83, v82, s92
    v_perm_b32 v62, v85, v84, s92
    v_perm_b32 v63, v87, v86, s92
    v_accvgpr_write_b32 a148, v60
    v_accvgpr_write_b32 a149, v61
    v_accvgpr_write_b32 a150, v62
    v_accvgpr_write_b32 a151, v63
    v_perm_b32 v244, v81, v80, s93
    v_perm_b32 v245, v83, v82, s93
    v_perm_b32 v246, v85, v84, s93
    v_perm_b32 v247, v87, v86, s93
    s_waitcnt vmcnt(8)
    v_perm_b32 v56, v89, v88, s92
    v_perm_b32 v57, v91, v90, s92
    v_perm_b32 v58, v93, v92, s92
    v_perm_b32 v59, v95, v94, s92
    v_accvgpr_write_b32 a152, v56
    v_accvgpr_write_b32 a153, v57
    v_accvgpr_write_b32 a154, v58
    v_accvgpr_write_b32 a155, v59
    v_perm_b32 v248, v89, v88, s93
    v_perm_b32 v249, v91, v90, s93
    v_perm_b32 v250, v93, v92, s93
    v_perm_b32 v251, v95, v94, s93
    s_waitcnt vmcnt(0)
    v_perm_b32 v60, v97, v96, s92
    v_perm_b32 v61, v99, v98, s92
    v_perm_b32 v62, v101, v100, s92
    v_perm_b32 v63, v103, v102, s92
    v_accvgpr_write_b32 a156, v60
    v_accvgpr_write_b32 a157, v61
    v_accvgpr_write_b32 a158, v62
    v_accvgpr_write_b32 a159, v63
    v_perm_b32 v252, v97, v96, s93
    v_perm_b32 v253, v99, v98, s93
    v_perm_b32 v254, v101, v100, s93
    v_perm_b32 v255, v103, v102, s93
    s_mov_b32 s24, 0
WI_113:
    buffer_load_dword v8, off, s[96:99], 0 offset:128 sc1
    s_waitcnt vmcnt(0)
    v_cmp_le_u32 vcc, 256, v8
    s_cbranch_vccnz WO_114
    s_sleep 4
    s_add_u32 s24, s24, 1
    s_cmp_lt_u32 s24, 200000
    s_cbranch_scc1 WI_113
    s_branch F_Q
WO_114:
    v_mov_b32 v16, 0x3f803f80
    v_mov_b32 v17, 0x3f803f80
    v_mov_b32 v18, 0x3f803f80
    v_mov_b32 v19, 0x3f803f80
    v_mov_b32 v7, 1
    s_nop 0
    v_mfma_f32_32x32x16_bf16 v[160:175], a[0:3], v[16:19], 0
    v_mfma_f32_32x32x16_bf16 v[176:191], a[160:163], v[16:19], 0
    v_mfma_f32_32x32x16_bf16 v[160:175], a[4:7], v[16:19], v[160:175]
    v_mfma_f32_32x32x16_bf16 v[176:191], a[164:167], v[16:19], v[176:191]
    v_mfma_f32_32x32x16_bf16 v[160:175], a[8:11], v[16:19], v[160:175]
    v_mfma_f32_32x32x16_bf16 v[176:191], a[168:171], v[16:19], v[176:191]
    v_mfma_f32_32x32x16_bf16 v[160:175], a[12:15], v[16:19], v[160:175]
    v_mfma_f32_32x32x16_bf16 v[176:191], a[172:175], v[16:19], v[176:191]
    v_mfma_f32_32x32x16_bf16 v[160:175], a[16:19], v[16:19], v[160:175]
    v_mfma_f32_32x32x16_bf16 v[176:191], a[176:179], v[16:19], v[176:191]
    v_mfma_f32_32x32x16_bf16 v[160:175], a[20:23], v[16:19], v[160:175]
    v_mfma_f32_32x32x16_bf16 v[176:191], a[180:183], v[16:19], v[176:191]
    v_mfma_f32_32x32x16_bf16 v[160:175], a[24:27], v[16:19], v[160:175]
    v_mfma_f32_32x32x16_bf16 v[176:191], a[184:187], v[16:19], v[176:191]
    v_mfma_f32_32x32x16_bf16 v[160:175], a[28:31], v[16:19], v[160:175]
    v_mfma_f32_32x32x16_bf16 v[176:191], a[188:191], v[16:19], v[176:191]
    v_mfma_f32_32x32x16_bf16 v[160:175], a[32:35], v[16:19], v[160:175]
    v_mfma_f32_32x32x16_bf16 v[176:191], a[192:195], v[16:19], v[176:191]
    v_mfma_f32_32x32x16_bf16 v[160:175], a[36:39], v[16:19], v[160:175]
    v_mfma_f32_32x32x16_bf16 v[176:191], a[196:199], v[16:19], v[176:191]
    v_mfma_f32_32x32x16_bf16 v[160:175], a[40:43], v[16:19], v[160:175]
    v_mfma_f32_32x32x16_bf16 v[176:191], a[200:203], v[16:19], v[176:191]
    v_mfma_f32_32x32x16_bf16 v[160:175], a[44:47], v[16:19], v[160:175]
    v_mfma_f32_32x32x16_bf16 v[176:191], a[204:207], v[16:19], v[176:191]
    v_mfma_f32_32x32x16_bf16 v[160:175], a[48:51], v[16:19], v[160:175]
    v_mfma_f32_32x32x16_bf16 v[176:191], a[208:211], v[16:19], v[176:191]
    v_mfma_f32_32x32x16_bf16 v[160:175], a[52:55], v[16:19], v[160:175]
    v_mfma_f32_32x32x16_bf16 v[176:191], a[212:215], v[16:19], v[176:191]
    v_mfma_f32_32x32x16_bf16 v[160:175], a[56:59], v[16:19], v[160:175]
    v_mfma_f32_32x32x16_bf16 v[176:191], a[216:219], v[16:19], v[176:191]
    v_mfma_f32_32x32x16_bf16 v[160:175], a[60:63], v[16:19], v[160:175]
    v_mfma_f32_32x32x16_bf16 v[176:191], a[220:223], v[16:19], v[176:191]
    v_mfma_f32_32x32x16_bf16 v[160:175], a[64:67], v[16:19], v[160:175]
    v_mfma_f32_32x32x16_bf16 v[176:191], a[224:227], v[16:19], v[176:191]
    v_mfma_f32_32x32x16_bf16 v[160:175], a[68:71], v[16:19], v[160:175]
    v_mfma_f32_32x32x16_bf16 v[176:191], a[228:231], v[16:19], v[176:191]
    v_mfma_f32_32x32x16_bf16 v[160:175], a[72:75], v[16:19], v[160:175]
    v_mfma_f32_32x32x16_bf16 v[176:191], a[232:235], v[16:19], v[176:191]
    v_mfma_f32_32x32x16_bf16 v[160:175], a[76:79], v[16:19], v[160:175]
    v_mfma_f32_32x32x16_bf16 v[176:191], a[236:239], v[16:19], v[176:191]
    v_mfma_f32_32x32x16_bf16 v[160:175], a[80:83], v[16:19], v[160:175]
    v_mfma_f32_32x32x16_bf16 v[176:191], a[240:243], v[16:19], v[176:191]
    v_mfma_f32_32x32x16_bf16 v[160:175], a[84:87], v[16:19], v[160:175]
    v_mfma_f32_32x32x16_bf16 v[176:191], a[244:247], v[16:19], v[176:191]
    v_mfma_f32_32x32x16_bf16 v[160:175], a[88:91], v[16:19], v[160:175]
    v_mfma_f32_32x32x16_bf16 v[176:191], a[248:251], v[16:19], v[176:191]
    v_mfma_f32_32x32x16_bf16 v[160:175], a[92:95], v[16:19], v[160:175]
    v_mfma_f32_32x32x16_bf16 v[176:191], a[252:255], v[16:19], v[176:191]
    v_mfma_f32_32x32x16_bf16 v[160:175], a[96:99], v[16:19], v[160:175]
    v_mfma_f32_32x32x16_bf16 v[176:191], v[192:195], v[16:19], v[176:191]
    v_mfma_f32_32x32x16_bf16 v[160:175], a[100:103], v[16:19], v[160:175]
    v_mfma_f32_32x32x16_bf16 v[176:191], v[196:199], v[16:19], v[176:191]
    v_mfma_f32_32x32x16_bf16 v[160:175], a[104:107], v[16:19], v[160:175]
    v_mfma_f32_32x32x16_bf16 v[176:191], v[200:203], v[16:19], v[176:191]
    v_mfma_f32_32x32x16_bf16 v[160:175], a[108:111], v[16:19], v[160:175]
    v_mfma_f32_32x32x16_bf16 v[176:191], v[204:207], v[16:19], v[176:191]
    v_mfma_f32_32x32x16_bf16 v[160:175], a[112:115], v[16:19], v[160:175]
    v_mfma_f32_32x32x16_bf16 v[176:191], v[208:211], v[16:19], v[176:191]
    v_mfma_f32_32x32x16_bf16 v[160:175], a[116:119], v[16:19], v[160:175]
    v_mfma_f32_32x32x16_bf16 v[176:191], v[212:215], v[16:19], v[176:191]
    v_mfma_f32_32x32x16_bf16 v[160:175], a[120:123], v[16:19], v[160:175]
    v_mfma_f32_32x32x16_bf16 v[176:191], v[216:219], v[16:19], v[176:191]
    v_mfma_f32_32x32x16_bf16 v[160:175], a[124:127], v[16:19], v[160:175]
    v_mfma_f32_32x32x16_bf16 v[176:191], v[220:223], v[16:19], v[176:191]
    v_mfma_f32_32x32x16_bf16 v[160:175], a[128:131], v[16:19], v[160:175]
    v_mfma_f32_32x32x16_bf16 v[176:191], v[224:227], v[16:19], v[176:191]
    v_mfma_f32_32x32x16_bf16 v[160:175], a[132:135], v[16:19], v[160:175]
    v_mfma_f32_32x32x16_bf16 v[176:191], v[228:231], v[16:19], v[176:191]
    v_mfma_f32_32x32x16_bf16 v[160:175], a[136:139], v[16:19], v[160:175]
    v_mfma_f32_32x32x16_bf16 v[176:191], v[232:235], v[16:19], v[176:191]
    v_mfma_f32_32x32x16_bf16 v[160:175], a[140:143], v[16:19], v[160:175]
    v_mfma_f32_32x32x16_bf16 v[176:191], v[236:239], v[16:19], v[176:191]
    v_mfma_f32_32x32x16_bf16 v[160:175], a[144:147], v[16:19], v[160:175]
    v_mfma_f32_32x32x16_bf16 v[176:191], v[240:243], v[16:19], v[176:191]
    v_mfma_f32_32x32x16_bf16 v[160:175], a[148:151], v[16:19], v[160:175]
    v_mfma_f32_32x32x16_bf16 v[176:191], v[244:247], v[16:19], v[176:191]
    v_mfma_f32_32x32x16_bf16 v[160:175], a[152:155], v[16:19], v[160:175]
    v_mfma_f32_32x32x16_bf16 v[176:191], v[248:251], v[16:19], v[176:191]
    v_mfma_f32_32x32x16_bf16 v[160:175], a[156:159], v[16:19], v[160:175]
    v_mfma_f32_32x32x16_bf16 v[176:191], v[252:255], v[16:19], v[176:191]
T1_ITEM_115:
    s_cmp_lg_u32 s18, 0
    s_cbranch_scc1 T1_HAVE_116
    s_mov_b32 s24, 0
    s_mov_b64 exec, s[14:15]
    buffer_load_dword v8, v11, s[4:7], s13 offen sc1
    s_waitcnt vmcnt(0)
    v_cmp_eq_u32 vcc, 0, v8
    s_cmp_eq_u32 s19, 0
    s_cbranch_scc1 NF_120
    s_mov_b64 exec, 1
    buffer_store_dword v7, off, s[4:7], s34 sc1
    s_mov_b64 exec, -1
    s_mov_b32 s19, 0
NF_120:
    s_cbranch_vccz PO_119
    s_mov_b64 exec, s[14:15]
PL_118:
    buffer_load_dword v8, v11, s[4:7], s13 offen sc1
    s_waitcnt vmcnt(0)
    v_cmp_eq_u32 vcc, 0, v8
    s_cbranch_vccz PO_119
    s_sleep 2
    s_add_u32 s24, s24, 1
    s_cmp_lt_u32 s24, 200000
    s_cbranch_scc1 PL_118
    s_branch F_Q
PO_119:
    s_mov_b64 exec, -1
    s_add_u32 m0, s20, 0
    s_add_u32 s22, s12, 0
    buffer_load_dwordx4 v1, s[4:7], s22 offen offset:0 sc1 lds
    buffer_load_dwordx4 v1, s[4:7], s22 offen offset:1024 sc1 lds
    buffer_load_dwordx4 v1, s[4:7], s22 offen offset:2048 sc1 lds
    buffer_load_dwordx4 v1, s[4:7], s22 offen offset:3072 sc1 lds
    s_add_u32 m0, s20, 4096
    s_add_u32 s22, s12, 4096
    buffer_load_dwordx4 v1, s[4:7], s22 offen offset:0 sc1 lds
    buffer_load_dwordx4 v1, s[4:7], s22 offen offset:1024 sc1 lds
    buffer_load_dwordx4 v1, s[4:7], s22 offen offset:2048 sc1 lds
    buffer_load_dwordx4 v1, s[4:7], s22 offen offset:3072 sc1 lds
    s_add_u32 m0, s20, 8192
    s_add_u32 s22, s12, 8192
    buffer_load_dwordx4 v1, s[4:7], s22 offen offset:0 sc1 lds
    buffer_load_dwordx4 v1, s[4:7], s22 offen offset:1024 sc1 lds
    s_mov_b32 s18, 1
    s_waitcnt vmcnt(6)
    s_branch T1_GO_117
T1_HAVE_116:
    s_cmp_eq_u32 s35, 0
    s_cbranch_scc1 T1_H2_121
    s_add_u32 m0, s20, 0
    s_add_u32 s22, s12, 0
    buffer_load_dwordx4 v1, s[4:7], s22 offen offset:0 sc1 lds
    buffer_load_dwordx4 v1, s[4:7], s22 offen offset:1024 sc1 lds
    buffer_load_dwordx4 v1, s[4:7], s22 offen offset:2048 sc1 lds
    buffer_load_dwordx4 v1, s[4:7], s22 offen offset:3072 sc1 lds
    s_add_u32 m0, s20, 4096
    s_add_u32 s22, s12, 4096
    buffer_load_dwordx4 v1, s[4:7], s22 offen offset:0 sc1 lds
    buffer_load_dwordx4 v1, s[4:7], s22 offen offset:1024 sc1 lds
    buffer_load_dwordx4 v1, s[4:7], s22 offen offset:2048 sc1 lds
    buffer_load_dwordx4 v1, s[4:7], s22 offen offset:3072 sc1 lds
    s_add_u32 m0, s20, 8192
    s_add_u32 s22, s12, 8192
    buffer_load_dwordx4 v1, s[4:7], s22 offen offset:0 sc1 lds
    buffer_load_dwordx4 v1, s[4:7], s22 offen offset:1024 sc1 lds
    s_mov_b32 s18, 1
    s_waitcnt vmcnt(10)
    s_cmp_eq_u32 s19, 0
    s_cbranch_scc1 NF_122
    s_mov_b64 exec, 1
    buffer_store_dword v7, off, s[4:7], s34 sc1
    s_mov_b64 exec, -1
    s_mov_b32 s19, 0
NF_122:
    s_waitcnt vmcnt(7)
    s_branch T1_GO_117
T1_H2_121:
    s_waitcnt vmcnt(4)
T1_GO_117:
    s_barrier
    ds_read_b128 v[16:19], v2 offset:0
    ds_read_b128 v[20:23], v2 offset:10240
    ds_read_b128 v[24:27], v2 offset:20480
    s_mov_b32 s18, 0
    s_add_u32 s12, s12, 40960
    s_add_u32 s13, s13, 512
    s_sub_u32 s21, s20, 40960
    s_add_u32 s22, s20, 40960
    s_cmp_ge_u32 s20, 40960
    s_cselect_b32 s20, s21, s22
    s_mov_b32 s35, 0
    v_add_u32 v11, v11, v12
    s_cmp_ge_u32 s10, 7
    s_cselect_b32 s14, 0x7ff, s14
    s_waitcnt lgkmcnt(2)
    v_mfma_f32_32x32x16_bf16 v[128:143], a[0:3], v[16:19], 0
    s_mov_b64 exec, s[14:15]
    buffer_load_dword v8, v11, s[4:7], s13 offen sc1
    s_mov_b64 exec, -1
    v_mfma_f32_32x32x16_bf16 v[144:159], a[160:163], v[16:19], 0
    ds_read_b128 v[28:31], v2 offset:30720
    s_waitcnt lgkmcnt(2)
    v_mfma_f32_32x32x16_bf16 v[128:143], a[40:43], v[20:23], v[128:143]
    v_mfma_f32_32x32x16_bf16 v[144:159], a[200:203], v[20:23], v[144:159]
    ds_read_b128 v[16:19], v2 offset:1024
    s_waitcnt lgkmcnt(2)
    v_mfma_f32_32x32x16_bf16 v[128:143], a[80:83], v[24:27], v[128:143]
    v_mfma_f32_32x32x16_bf16 v[144:159], a[240:243], v[24:27], v[144:159]
    ds_read_b128 v[20:23], v2 offset:11264
    s_waitcnt lgkmcnt(2)
    v_mfma_f32_32x32x16_bf16 v[128:143], a[120:123], v[28:31], v[128:143]
    v_mfma_f32_32x32x16_bf16 v[144:159], v[216:219], v[28:31], v[144:159]
    ds_read_b128 v[24:27], v2 offset:21504
    s_waitcnt lgkmcnt(2)
    v_mfma_f32_32x32x16_bf16 v[128:143], a[4:7], v[16:19], v[128:143]
    v_mfma_f32_32x32x16_bf16 v[144:159], a[164:167], v[16:19], v[144:159]
    ds_read_b128 v[28:31], v2 offset:31744
    s_waitcnt lgkmcnt(2)
    v_mfma_f32_32x32x16_bf16 v[128:143], a[44:47], v[20:23], v[128:143]
    v_mfma_f32_32x32x16_bf16 v[144:159], a[204:207], v[20:23], v[144:159]
    ds_read_b128 v[16:19], v2 offset:2048
    s_waitcnt lgkmcnt(2)
    v_mfma_f32_32x32x16_bf16 v[128:143], a[84:87], v[24:27], v[128:143]
    v_mfma_f32_32x32x16_bf16 v[144:159], a[244:247], v[24:27], v[144:159]
    ds_read_b128 v[20:23], v2 offset:12288
    s_waitcnt lgkmcnt(2)
    v_mfma_f32_32x32x16_bf16 v[128:143], a[124:127], v[28:31], v[128:143]
    v_mfma_f32_32x32x16_bf16 v[144:159], v[220:223], v[28:31], v[144:159]
    ds_read_b128 v[24:27], v2 offset:22528
    s_waitcnt lgkmcnt(2)
    v_mfma_f32_32x32x16_bf16 v[128:143], a[8:11], v[16:19], v[128:143]
    v_mfma_f32_32x32x16_bf16 v[144:159], a[168:171], v[16:19], v[144:159]
    ds_read_b128 v[28:31], v2 offset:32768
    s_waitcnt lgkmcnt(2)
    v_mfma_f32_32x32x16_bf16 v[128:143], a[48:51], v[20:23], v[128:143]
    v_mfma_f32_32x32x16_bf16 v[144:159], a[208:211], v[20:23], v[144:159]
    ds_read_b128 v[16:19], v2 offset:3072
    s_waitcnt lgkmcnt(2)
    v_mfma_f32_32x32x16_bf16 v[128:143], a[88:91], v[24:27], v[128:143]
    v_mfma_f32_32x32x16_bf16 v[144:159], a[248:251], v[24:27], v[144:159]
    ds_read_b128 v[20:23], v2 offset:13312
    s_waitcnt lgkmcnt(2)
    v_mfma_f32_32x32x16_bf16 v[128:143], a[128:131], v[28:31], v[128:143]
    s_waitcnt vmcnt(0)
    s_cmp_eq_u32 s19, 0
    s_cbranch_scc1 NF_123
    s_mov_b64 exec, 1
    buffer_store_dword v7, off, s[4:7], s34 sc1
    s_mov_b64 exec, -1
    s_mov_b32 s19, 0
NF_123:
    s_cmp_lg_u32 s18, 0
    s_cbranch_scc1 CK_124
    s_cmp_ge_u32 s10, 63
    s_cbranch_scc1 CK_124
    v_cmp_eq_u32 vcc, 0, v8
    s_and_b64 vcc, vcc, s[14:15]
    s_cbranch_scc1 CK_124
    s_mov_b32 s18, 1
CK_124:
    s_barrier
    v_mfma_f32_32x32x16_bf16 v[144:159], v[224:227], v[28:31], v[144:159]
    ds_read_b128 v[24:27], v2 offset:23552
    s_waitcnt lgkmcnt(2)
    v_mfma_f32_32x32x16_bf16 v[128:143], a[12:15], v[16:19], v[128:143]
    s_cmp_eq_u32 s18, 0
    s_cbranch_scc1 PC_125
    s_add_u32 m0, s20, 0
    s_add_u32 s22, s12, 0
    buffer_load_dwordx4 v1, s[4:7], s22 offen offset:0 sc1 lds
PC_125:
    v_mfma_f32_32x32x16_bf16 v[144:159], a[172:175], v[16:19], v[144:159]
    ds_read_b128 v[28:31], v2 offset:33792
    s_waitcnt lgkmcnt(2)
    v_mfma_f32_32x32x16_bf16 v[128:143], a[52:55], v[20:23], v[128:143]
    s_cmp_eq_u32 s18, 0
    s_cbranch_scc1 PC_126
    buffer_load_dwordx4 v1, s[4:7], s22 offen offset:1024 sc1 lds
PC_126:
    v_mfma_f32_32x32x16_bf16 v[144:159], a[212:215], v[20:23], v[144:159]
    ds_read_b128 v[16:19], v2 offset:4096
    s_waitcnt lgkmcnt(2)
    v_mfma_f32_32x32x16_bf16 v[128:143], a[92:95], v[24:27], v[128:143]
    s_cmp_eq_u32 s18, 0
    s_cbranch_scc1 PC_127
    buffer_load_dwordx4 v1, s[4:7], s22 offen offset:2048 sc1 lds
PC_127:
    v_mfma_f32_32x32x16_bf16 v[144:159], a[252:255], v[24:27], v[144:159]
    ds_read_b128 v[20:23], v2 offset:14336
    s_waitcnt lgkmcnt(2)
    v_mfma_f32_32x32x16_bf16 v[128:143], a[132:135], v[28:31], v[128:143]
    s_cmp_eq_u32 s18, 0
    s_cbranch_scc1 PC_128
    buffer_load_dwordx4 v1, s[4:7], s22 offen offset:3072 sc1 lds
PC_128:
    v_mfma_f32_32x32x16_bf16 v[144:159], v[228:231], v[28:31], v[144:159]
    ds_read_b128 v[24:27], v2 offset:24576
    s_waitcnt lgkmcnt(2)
    v_mfma_f32_32x32x16_bf16 v[128:143], a[16:19], v[16:19], v[128:143]
    s_cmp_eq_u32 s18, 0
    s_cbranch_scc1 PC_129
    s_add_u32 m0, s20, 4096
    s_add_u32 s22, s12, 4096
    buffer_load_dwordx4 v1, s[4:7], s22 offen offset:0 sc1 lds
PC_129:
    v_mfma_f32_32x32x16_bf16 v[144:159], a[176:179], v[16:19], v[144:159]
    ds_read_b128 v[28:31], v2 offset:34816
    s_waitcnt lgkmcnt(2)
    v_mfma_f32_32x32x16_bf16 v[128:143], a[56:59], v[20:23], v[128:143]
    s_cmp_eq_u32 s18, 0
    s_cbranch_scc1 PC_130
    buffer_load_dwordx4 v1, s[4:7], s22 offen offset:1024 sc1 lds
PC_130:
    v_mfma_f32_32x32x16_bf16 v[144:159], a[216:219], v[20:23], v[144:159]
    ds_read_b128 v[16:19], v2 offset:5120
    s_waitcnt lgkmcnt(2)
    v_mfma_f32_32x32x16_bf16 v[128:143], a[96:99], v[24:27], v[128:143]
    s_cmp_eq_u32 s18, 0
    s_cbranch_scc1 PC_131
    buffer_load_dwordx4 v1, s[4:7], s22 offen offset:2048 sc1 lds
PC_131:
    v_mfma_f32_32x32x16_bf16 v[144:159], v[192:195], v[24:27], v[144:159]
    ds_read_b128 v[20:23], v2 offset:15360
    s_waitcnt lgkmcnt(2)
    v_mfma_f32_32x32x16_bf16 v[128:143], a[136:139], v[28:31], v[128:143]
    s_cmp_eq_u32 s18, 0
    s_cbranch_scc1 PC_132
    buffer_load_dwordx4 v1, s[4:7], s22 offen offset:3072 sc1 lds
PC_132:
    v_mfma_f32_32x32x16_bf16 v[144:159], v[232:235], v[28:31], v[144:159]
    ds_read_b128 v[24:27], v2 offset:25600
    s_waitcnt lgkmcnt(2)
    v_mfma_f32_32x32x16_bf16 v[128:143], a[20:23], v[16:19], v[128:143]
    s_cmp_eq_u32 s18, 0
    s_cbranch_scc1 PC_133
    s_add_u32 m0, s20, 8192
    s_add_u32 s22, s12, 8192
    buffer_load_dwordx4 v1, s[4:7], s22 offen offset:0 sc1 lds
PC_133:
    v_mfma_f32_32x32x16_bf16 v[144:159], a[180:183], v[16:19], v[144:159]
    ds_read_b128 v[28:31], v2 offset:35840
    s_waitcnt lgkmcnt(2)
    v_mfma_f32_32x32x16_bf16 v[128:143], a[60:63], v[20:23], v[128:143]
    s_cmp_eq_u32 s18, 0
    s_cbranch_scc1 PC_134
    buffer_load_dwordx4 v1, s[4:7], s22 offen offset:1024 sc1 lds
PC_134:
    v_mfma_f32_32x32x16_bf16 v[144:159], a[220:223], v[20:23], v[144:159]
    ds_read_b128 v[16:19], v2 offset:6144
    s_waitcnt lgkmcnt(2)
    v_mfma_f32_32x32x16_bf16 v[128:143], a[100:103], v[24:27], v[128:143]
    v_mfma_f32_32x32x16_bf16 v[144:159], v[196:199], v[24:27], v[144:159]
    ds_read_b128 v[20:23], v2 offset:16384
    s_waitcnt lgkmcnt(2)
    v_mfma_f32_32x32x16_bf16 v[128:143], a[140:143], v[28:31], v[128:143]
    v_mfma_f32_32x32x16_bf16 v[144:159], v[236:239], v[28:31], v[144:159]
    ds_read_b128 v[24:27], v2 offset:26624
    s_waitcnt lgkmcnt(2)
    v_mfma_f32_32x32x16_bf16 v[128:143], a[24:27], v[16:19], v[128:143]
    v_mfma_f32_32x32x16_bf16 v[144:159], a[184:187], v[16:19], v[144:159]
    ds_read_b128 v[28:31], v2 offset:36864
    s_waitcnt lgkmcnt(2)
    v_mfma_f32_32x32x16_bf16 v[128:143], a[64:67], v[20:23], v[128:143]
    buffer_load_dwordx4 v[92:95], v4, s[4:7], s36 offen sc1
    buffer_load_dwordx4 v[96:99], v4, s[4:7], s36 offen offset:16 sc1
    v_mfma_f32_32x32x16_bf16 v[144:159], a[224:227], v[20:23], v[144:159]
    ds_read_b128 v[16:19], v2 offset:7168
    s_waitcnt lgkmcnt(2)
    v_mfma_f32_32x32x16_bf16 v[128:143], a[104:107], v[24:27], v[128:143]
    v_mfma_f32_32x32x16_bf16 v[144:159], v[200:203], v[24:27], v[144:159]
    ds_read_b128 v[20:23], v2 offset:17408
    s_waitcnt lgkmcnt(2)
    v_mfma_f32_32x32x16_bf16 v[128:143], a[144:147], v[28:31], v[128:143]
    v_mfma_f32_32x32x16_bf16 v[144:159], v[240:243], v[28:31], v[144:159]
    ds_read_b128 v[24:27], v2 offset:27648
    s_cmp_ge_u32 s10, 63
    s_cselect_b32 s21, 1, s18
    s_cmp_lg_u32 s21, 0
    s_cbranch_scc1 SK_135
    s_mov_b64 exec, s[14:15]
    buffer_load_dword v8, v11, s[4:7], s13 offen sc1
    s_mov_b64 exec, -1
SK_135:
    s_waitcnt lgkmcnt(2)
    v_mfma_f32_32x32x16_bf16 v[128:143], a[28:31], v[16:19], v[128:143]
    v_mfma_f32_32x32x16_bf16 v[144:159], a[188:191], v[16:19], v[144:159]
    ds_read_b128 v[28:31], v2 offset:37888
    s_waitcnt lgkmcnt(2)
    v_mfma_f32_32x32x16_bf16 v[128:143], a[68:71], v[20:23], v[128:143]
    v_mfma_f32_32x32x16_bf16 v[144:159], a[228:231], v[20:23], v[144:159]
    ds_read_b128 v[16:19], v2 offset:8192
    s_waitcnt lgkmcnt(2)
    v_mfma_f32_32x32x16_bf16 v[128:143], a[108:111], v[24:27], v[128:143]
    v_mfma_f32_32x32x16_bf16 v[144:159], v[204:207], v[24:27], v[144:159]
    ds_read_b128 v[20:23], v2 offset:18432
    s_waitcnt lgkmcnt(2)
    v_mfma_f32_32x32x16_bf16 v[128:143], a[148:151], v[28:31], v[128:143]
    v_mfma_f32_32x32x16_bf16 v[144:159], v[244:247], v[28:31], v[144:159]
    ds_read_b128 v[24:27], v2 offset:28672
    s_waitcnt lgkmcnt(2)
    v_mfma_f32_32x32x16_bf16 v[128:143], a[32:35], v[16:19], v[128:143]
    v_mfma_f32_32x32x16_bf16 v[144:159], a[192:195], v[16:19], v[144:159]
    ds_read_b128 v[28:31], v2 offset:38912
    s_waitcnt lgkmcnt(2)
    v_mfma_f32_32x32x16_bf16 v[128:143], a[72:75], v[20:23], v[128:143]
    v_mfma_f32_32x32x16_bf16 v[144:159], a[232:235], v[20:23], v[144:159]
    ds_read_b128 v[16:19], v2 offset:9216
    s_waitcnt lgkmcnt(2)
    v_mfma_f32_32x32x16_bf16 v[128:143], a[112:115], v[24:27], v[128:143]
    v_mfma_f32_32x32x16_bf16 v[144:159], v[208:211], v[24:27], v[144:159]
    ds_read_b128 v[20:23], v2 offset:19456
    s_waitcnt lgkmcnt(2)
    v_mfma_f32_32x32x16_bf16 v[128:143], a[152:155], v[28:31], v[128:143]
    s_waitcnt vmcnt(0)
    v_min3_u32 v40, v93, v95, v97
    v_min_u32 v40, v40, v99
    v_cmp_eq_u32 vcc, 0, v40
    s_cmp_eq_u64 vcc, 0
    s_cselect_b32 s30, 1, 0
    v_mfma_f32_32x32x16_bf16 v[144:159], v[248:251], v[28:31], v[144:159]
    ds_read_b128 v[24:27], v2 offset:29696
    s_cmp_ge_u32 s10, 63
    s_cselect_b32 s21, 1, s18
    s_cmp_lg_u32 s21, 0
    s_cbranch_scc1 SK_136
    s_waitcnt vmcnt(0)
    s_cmp_eq_u32 s19, 0
    s_cbranch_scc1 NF_137
    s_mov_b64 exec, 1
    buffer_store_dword v7, off, s[4:7], s34 sc1
    s_mov_b64 exec, -1
    s_mov_b32 s19, 0
NF_137:
    s_cmp_lg_u32 s18, 0
    s_cbranch_scc1 CK_138
    s_cmp_ge_u32 s10, 63
    s_cbranch_scc1 CK_138
    v_cmp_eq_u32 vcc, 0, v8
    s_and_b64 vcc, vcc, s[14:15]
    s_cbranch_scc1 CK_138
    s_mov_b32 s18, 1
CK_138:
    s_mov_b32 s35, s18
SK_136:
    s_waitcnt lgkmcnt(2)
    v_mfma_f32_32x32x16_bf16 v[128:143], a[36:39], v[16:19], v[128:143]
    v_add_f32 v92, v92, v94
    v_add_f32 v93, v93, v95
    v_add_f32 v96, v96, v98
    v_add_f32 v97, v97, v99
    v_mfma_f32_32x32x16_bf16 v[144:159], a[196:199], v[16:19], v[144:159]
    ds_read_b128 v[28:31], v2 offset:39936
    v_add_f32 v92, v92, v96
    v_add_f32 v93, v93, v97
    v_mul_f32 v92, 0x3acccccd, v92
    v_mul_f32 v93, 0x3acccccd, v93
    s_waitcnt lgkmcnt(2)
    v_mfma_f32_32x32x16_bf16 v[128:143], a[76:79], v[20:23], v[128:143]
    v_fma_f32 v93, -v92, v92, v93
    v_max_f32 v93, 0, v93
    v_cvt_pk_bf16_f32 v92, v92, v93
    v_lshlrev_b32 v37, 16, v92
    v_mfma_f32_32x32x16_bf16 v[144:159], a[236:239], v[20:23], v[144:159]
    v_and_b32 v93, 0xffff0000, v92
    v_xor_b32 v37, 0x80000000, v37
    v_add_f32 v93, 0x3727c5ac, v93
    v_cvt_pk_bf16_f32 v93, v93, v93
    s_waitcnt lgkmcnt(1)
    v_mfma_f32_32x32x16_bf16 v[128:143], a[116:119], v[24:27], v[128:143]
    v_lshlrev_b32 v93, 16, v93
    v_sqrt_f32 v93, v93
    s_nop 0
    v_cvt_pk_bf16_f32 v93, v93, v93
    v_lshlrev_b32 v93, 16, v93
    v_mfma_f32_32x32x16_bf16 v[144:159], v[212:215], v[24:27], v[144:159]
    v_rcp_f32 v36, v93
    s_nop 0
    v_mul_f32 v36, 0x3e0293ee, v36
    s_waitcnt lgkmcnt(0)
    v_mfma_f32_32x32x16_bf16 v[128:143], a[156:159], v[28:31], v[128:143]
    v_mfma_f32_32x32x16_bf16 v[144:159], v[252:255], v[28:31], v[144:159]
    s_cmp_lg_u32 s30, 0
    s_cbranch_scc1 SO_140
    s_mov_b32 s24, 0
SP_139:
    s_add_u32 s24, s24, 1
    s_cmp_ge_u32 s24, 200000
    s_cbranch_scc1 F_Q
    buffer_load_dwordx4 v[92:95], v4, s[4:7], s36 offen sc1
    buffer_load_dwordx4 v[96:99], v4, s[4:7], s36 offen offset:16 sc1
    s_waitcnt vmcnt(0)
    v_min3_u32 v40, v93, v95, v97
    v_min_u32 v40, v40, v99
    v_cmp_eq_u32 vcc, 0, v40
    s_cbranch_vccnz SP_139
    v_add_f32 v92, v92, v94
    v_add_f32 v93, v93, v95
    v_add_f32 v96, v96, v98
    v_add_f32 v97, v97, v99
    v_add_f32 v92, v92, v96
    v_add_f32 v93, v93, v97
    v_mul_f32 v92, 0x3acccccd, v92
    v_mul_f32 v93, 0x3acccccd, v93
    v_fma_f32 v93, -v92, v92, v93
    v_max_f32 v93, 0, v93
    v_cvt_pk_bf16_f32 v92, v92, v93
    v_lshlrev_b32 v37, 16, v92
    v_and_b32 v93, 0xffff0000, v92
    v_xor_b32 v37, 0x80000000, v37
    v_add_f32 v93, 0x3727c5ac, v93
    v_cvt_pk_bf16_f32 v93, v93, v93
    v_lshlrev_b32 v93, 16, v93
    v_sqrt_f32 v93, v93
    s_nop 0
    v_cvt_pk_bf16_f32 v93, v93, v93
    v_lshlrev_b32 v93, 16, v93
    v_rcp_f32 v36, v93
    s_nop 0
    v_mul_f32 v36, 0x3e0293ee, v36
SO_140:
    s_cmp_ge_u32 s20, 40960
    s_cselect_b32 s21, 81920, 0
    s_sub_u32 s21, s21, 40960
    v_add_u32 v2, s21, v2
    s_nop 4
    v_pk_fma_f32 v[128:129], v[160:161], v[36:37], v[128:129] op_sel:[0,1,0] op_sel_hi:[1,1,1]
    v_pk_mul_f32 v[128:129], v[128:129], v[36:37] op_sel_hi:[1,0]
    v_pk_fma_f32 v[130:131], v[162:163], v[36:37], v[130:131] op_sel:[0,1,0] op_sel_hi:[1,1,1]
    v_pk_mul_f32 v[130:131], v[130:131], v[36:37] op_sel_hi:[1,0]
    v_pk_fma_f32 v[144:145], v[176:177], v[36:37], v[144:145] op_sel:[0,1,0] op_sel_hi:[1,1,1]
    v_pk_mul_f32 v[144:145], v[144:145], v[36:37] op_sel_hi:[1,0]
    v_pk_fma_f32 v[146:147], v[178:179], v[36:37], v[146:147] op_sel:[0,1,0] op_sel_hi:[1,1,1]
    v_pk_mul_f32 v[146:147], v[146:147], v[36:37] op_sel_hi:[1,0]
    v_cvt_pk_bf16_f32 v76, v128, v144
    v_cvt_pk_bf16_f32 v77, v129, v145
    v_cvt_pk_bf16_f32 v78, v130, v146
    v_cvt_pk_bf16_f32 v79, v131, v147
    buffer_store_dwordx4 v[76:79], v1, s[4:7], s16 offen offset:0 sc1
    v_pk_fma_f32 v[132:133], v[164:165], v[36:37], v[132:133] op_sel:[0,1,0] op_sel_hi:[1,1,1]
    v_pk_mul_f32 v[132:133], v[132:133], v[36:37] op_sel_hi:[1,0]
    v_pk_fma_f32 v[134:135], v[166:167], v[36:37], v[134:135] op_sel:[0,1,0] op_sel_hi:[1,1,1]
    v_pk_mul_f32 v[134:135], v[134:135], v[36:37] op_sel_hi:[1,0]
    v_pk_fma_f32 v[148:149], v[180:181], v[36:37], v[148:149] op_sel:[0,1,0] op_sel_hi:[1,1,1]
    v_pk_mul_f32 v[148:149], v[148:149], v[36:37] op_sel_hi:[1,0]
    v_pk_fma_f32 v[150:151], v[182:183], v[36:37], v[150:151] op_sel:[0,1,0] op_sel_hi:[1,1,1]
    v_pk_mul_f32 v[150:151], v[150:151], v[36:37] op_sel_hi:[1,0]
    v_cvt_pk_bf16_f32 v80, v132, v148
    v_cvt_pk_bf16_f32 v81, v133, v149
    v_cvt_pk_bf16_f32 v82, v134, v150
    v_cvt_pk_bf16_f32 v83, v135, v151
    buffer_store_dwordx4 v[80:83], v1, s[4:7], s16 offen offset:1024 sc1
    v_pk_fma_f32 v[136:137], v[168:169], v[36:37], v[136:137] op_sel:[0,1,0] op_sel_hi:[1,1,1]
    v_pk_mul_f32 v[136:137], v[136:137], v[36:37] op_sel_hi:[1,0]
    v_pk_fma_f32 v[138:139], v[170:171], v[36:37], v[138:139] op_sel:[0,1,0] op_sel_hi:[1,1,1]
    v_pk_mul_f32 v[138:139], v[138:139], v[36:37] op_sel_hi:[1,0]
    v_pk_fma_f32 v[152:153], v[184:185], v[36:37], v[152:153] op_sel:[0,1,0] op_sel_hi:[1,1,1]
    v_pk_mul_f32 v[152:153], v[152:153], v[36:37] op_sel_hi:[1,0]
    v_pk_fma_f32 v[154:155], v[186:187], v[36:37], v[154:155] op_sel:[0,1,0] op_sel_hi:[1,1,1]
    v_pk_mul_f32 v[154:155], v[154:155], v[36:37] op_sel_hi:[1,0]
    v_cvt_pk_bf16_f32 v84, v136, v152
    v_cvt_pk_bf16_f32 v85, v137, v153
    v_cvt_pk_bf16_f32 v86, v138, v154
    v_cvt_pk_bf16_f32 v87, v139, v155
    buffer_store_dwordx4 v[84:87], v1, s[4:7], s16 offen offset:2048 sc1
    v_pk_fma_f32 v[140:141], v[172:173], v[36:37], v[140:141] op_sel:[0,1,0] op_sel_hi:[1,1,1]
    v_pk_mul_f32 v[140:141], v[140:141], v[36:37] op_sel_hi:[1,0]
    v_pk_fma_f32 v[142:143], v[174:175], v[36:37], v[142:143] op_sel:[0,1,0] op_sel_hi:[1,1,1]
    v_pk_mul_f32 v[142:143], v[142:143], v[36:37] op_sel_hi:[1,0]
    v_pk_fma_f32 v[156:157], v[188:189], v[36:37], v[156:157] op_sel:[0,1,0] op_sel_hi:[1,1,1]
    v_pk_mul_f32 v[156:157], v[156:157], v[36:37] op_sel_hi:[1,0]
    v_pk_fma_f32 v[158:159], v[190:191], v[36:37], v[158:159] op_sel:[0,1,0] op_sel_hi:[1,1,1]
    v_pk_mul_f32 v[158:159], v[158:159], v[36:37] op_sel_hi:[1,0]
    v_cvt_pk_bf16_f32 v88, v140, v156
    v_cvt_pk_bf16_f32 v89, v141, v157
    v_cvt_pk_bf16_f32 v90, v142, v158
    v_cvt_pk_bf16_f32 v91, v143, v159
    buffer_store_dwordx4 v[88:91], v1, s[4:7], s16 offen offset:3072 sc1
    s_mov_b64 exec, -1
    s_mov_b32 s19, s25
    s_mov_b32 s34, s17
    s_add_u32 s17, s17, 64
    s_add_u32 s36, s36, 1024
    s_add_u32 s16, s16, 262144
    s_add_u32 s10, s10, 1
    s_cmp_lt_u32 s10, 64
    s_cbranch_scc1 T1_ITEM_115
    s_waitcnt vmcnt(0)
    s_cmp_eq_u32 s19, 0
    s_cbranch_scc1 NF_141
    s_mov_b64 exec, 1
    buffer_store_dword v7, off, s[4:7], s34 sc1
    s_mov_b64 exec, -1
    s_mov_b32 s19, 0
NF_141:
    s_endpgm
F_Q:
    s_endpgm
.p2align 6
R_AT:
    s_cmp_ge_u32 s8, 8
    s_cbranch_scc1 A_NX_142
    s_lshl_b32 s17, s8, 1
    s_add_u32 s17, s17, s11
    v_mov_b32 v250, v0
    v_lshrrev_b32 v2, 6, v0
    v_and_b32 v0, 63, v0
    v_readfirstlane_b32 s9, v2
    s_load_dwordx2 s[88:89], s[0:1], 0
    s_mov_b32 s90, 2621440
    s_mov_b32 s91, 0x00020000
    s_mov_b32 s92, 0x05040100
    s_mov_b32 s93, 0x07060302
    s_waitcnt lgkmcnt(0)
    v_and_b32 v3, 31, v0
    v_mul_u32_u24 v3, 1280, v3
    v_lshrrev_b32 v4, 5, v0
    v_lshl_add_u32 v3, v4, 4, v3
    v_lshlrev_b32 v5, 4, v0
    v_lshlrev_b32 v6, 2, v0
    v_mov_b32 v7, 1
    s_mov_b32 s12, s17
    s_add_u32 s13, s12, 0
    s_mul_i32 s13, s13, 40960
    s_mul_i32 s14, s9, 320
    s_add_u32 s13, s13, s14
    buffer_load_dwordx4 v[16:19], v3, s[88:91], s13 offen offset:0
    buffer_load_dwordx4 v[20:23], v3, s[88:91], s13 offen offset:32
    buffer_load_dwordx4 v[24:27], v3, s[88:91], s13 offen offset:64
    buffer_load_dwordx4 v[28:31], v3, s[88:91], s13 offen offset:96
    buffer_load_dwordx4 v[32:35], v3, s[88:91], s13 offen offset:128
    buffer_load_dwordx4 v[36:39], v3, s[88:91], s13 offen offset:160
    buffer_load_dwordx4 v[40:43], v3, s[88:91], s13 offen offset:192
    buffer_load_dwordx4 v[44:47], v3, s[88:91], s13 offen offset:224
    buffer_load_dwordx4 v[48:51], v3, s[88:91], s13 offen offset:256
    buffer_load_dwordx4 v[52:55], v3, s[88:91], s13 offen offset:288
    s_add_u32 s13, s12, 16
    s_mul_i32 s13, s13, 40960
    s_mul_i32 s14, s9, 320
    s_add_u32 s13, s13, s14
    buffer_load_dwordx4 v[56:59], v3, s[88:91], s13 offen offset:0
    buffer_load_dwordx4 v[60:63], v3, s[88:91], s13 offen offset:32
    buffer_load_dwordx4 v[64:67], v3, s[88:91], s13 offen offset:64
    buffer_load_dwordx4 v[68:71], v3, s[88:91], s13 offen offset:96
    buffer_load_dwordx4 v[72:75], v3, s[88:91], s13 offen offset:128
    buffer_load_dwordx4 v[76:79], v3, s[88:91], s13 offen offset:160
    buffer_load_dwordx4 v[80:83], v3, s[88:91], s13 offen offset:192
    buffer_load_dwordx4 v[84:87], v3, s[88:91], s13 offen offset:224
    buffer_load_dwordx4 v[88:91], v3, s[88:91], s13 offen offset:256
    buffer_load_dwordx4 v[92:95], v3, s[88:91], s13 offen offset:288
    s_add_u32 s13, s12, 32
    s_mul_i32 s13, s13, 40960
    s_mul_i32 s14, s9, 320
    s_add_u32 s13, s13, s14
    buffer_load_dwordx4 v[96:99], v3, s[88:91], s13 offen offset:0
    buffer_load_dwordx4 v[100:103], v3, s[88:91], s13 offen offset:32
    buffer_load_dwordx4 v[104:107], v3, s[88:91], s13 offen offset:64
    buffer_load_dwordx4 v[108:111], v3, s[88:91], s13 offen offset:96
    buffer_load_dwordx4 v[112:115], v3, s[88:91], s13 offen offset:128
    buffer_load_dwordx4 v[116:119], v3, s[88:91], s13 offen offset:160
    buffer_load_dwordx4 v[120:123], v3, s[88:91], s13 offen offset:192
    buffer_load_dwordx4 v[124:127], v3, s[88:91], s13 offen offset:224
    buffer_load_dwordx4 v[128:131], v3, s[88:91], s13 offen offset:256
    buffer_load_dwordx4 v[132:135], v3, s[88:91], s13 offen offset:288
    s_add_u32 s13, s12, 48
    s_mul_i32 s13, s13, 40960
    s_mul_i32 s14, s9, 320
    s_add_u32 s13, s13, s14
    buffer_load_dwordx4 v[136:139], v3, s[88:91], s13 offen offset:0
    buffer_load_dwordx4 v[140:143], v3, s[88:91], s13 offen offset:32
    buffer_load_dwordx4 v[144:147], v3, s[88:91], s13 offen offset:64
    buffer_load_dwordx4 v[148:151], v3, s[88:91], s13 offen offset:96
    buffer_load_dwordx4 v[152:155], v3, s[88:91], s13 offen offset:128
    buffer_load_dwordx4 v[156:159], v3, s[88:91], s13 offen offset:160
    buffer_load_dwordx4 v[160:163], v3, s[88:91], s13 offen offset:192
    buffer_load_dwordx4 v[164:167], v3, s[88:91], s13 offen offset:224
    buffer_load_dwordx4 v[168:171], v3, s[88:91], s13 offen offset:256
    buffer_load_dwordx4 v[172:175], v3, s[88:91], s13 offen offset:288
    s_mov_b32 s24, 0
WI_144:
    buffer_load_dword v8, off, s[96:99], 0 offset:128 sc1
    s_waitcnt vmcnt(0)
    v_cmp_le_u32 vcc, 256, v8
    s_cbranch_vccnz WO_145
    s_sleep 4
    s_add_u32 s24, s24, 1
    s_cmp_lt_u32 s24, 200000
    s_cbranch_scc1 WI_144
    s_branch F_AT
WO_145:
    s_add_u32 s14, s12, 0
    s_mul_i32 s13, s14, 40960
    s_mul_i32 s15, s9, 10240
    s_add_u32 s13, s13, s15
    s_add_u32 s13, s13, 116391936
    s_lshl_b32 s15, s14, 10
    s_lshl_b32 s16, s9, 3
    s_add_u32 s15, s15, s16
    s_add_u32 s15, s15, 155975680
    s_lshl_b32 s16, s14, 9
    s_lshl_b32 s14, s9, 7
    s_add_u32 s16, s16, s14
    s_add_u32 s16, s16, 155385856
    buffer_store_dwordx4 v[16:19], v5, s[4:7], s13 offen sc1
    s_add_u32 s13, s13, 1024
    buffer_store_dwordx4 v[20:23], v5, s[4:7], s13 offen sc1
    s_add_u32 s13, s13, 1024
    buffer_store_dwordx4 v[24:27], v5, s[4:7], s13 offen sc1
    s_add_u32 s13, s13, 1024
    buffer_store_dwordx4 v[28:31], v5, s[4:7], s13 offen sc1
    s_add_u32 s13, s13, 1024
    buffer_store_dwordx4 v[32:35], v5, s[4:7], s13 offen sc1
    s_add_u32 s13, s13, 1024
    buffer_store_dwordx4 v[36:39], v5, s[4:7], s13 offen sc1
    s_add_u32 s13, s13, 1024
    buffer_store_dwordx4 v[40:43], v5, s[4:7], s13 offen sc1
    s_add_u32 s13, s13, 1024
    buffer_store_dwordx4 v[44:47], v5, s[4:7], s13 offen sc1
    s_add_u32 s13, s13, 1024
    buffer_store_dwordx4 v[48:51], v5, s[4:7], s13 offen sc1
    s_add_u32 s13, s13, 1024
    buffer_store_dwordx4 v[52:55], v5, s[4:7], s13 offen sc1
    s_add_u32 s13, s13, 1024
    v_mov_b32 v204, 0x3f803f80
    v_mov_b64 v[200:201], 0
    v_mov_b64 v[202:203], 0
    v_lshlrev_b32 v205, 5, v0
    v_dot2_f32_bf16 v200, v16, v204, v200
    v_dot2_f32_bf16 v201, v16, v16, v201
    v_dot2_f32_bf16 v202, v17, v204, v202
    v_dot2_f32_bf16 v203, v17, v17, v203
    v_dot2_f32_bf16 v200, v18, v204, v200
    v_dot2_f32_bf16 v201, v18, v18, v201
    v_dot2_f32_bf16 v202, v19, v204, v202
    v_dot2_f32_bf16 v203, v19, v19, v203
    v_dot2_f32_bf16 v200, v20, v204, v200
    v_dot2_f32_bf16 v201, v20, v20, v201
    v_dot2_f32_bf16 v202, v21, v204, v202
    v_dot2_f32_bf16 v203, v21, v21, v203
    v_dot2_f32_bf16 v200, v22, v204, v200
    v_dot2_f32_bf16 v201, v22, v22, v201
    v_dot2_f32_bf16 v202, v23, v204, v202
    v_dot2_f32_bf16 v203, v23, v23, v203
    v_dot2_f32_bf16 v200, v24, v204, v200
    v_dot2_f32_bf16 v201, v24, v24, v201
    v_dot2_f32_bf16 v202, v25, v204, v202
    v_dot2_f32_bf16 v203, v25, v25, v203
    v_dot2_f32_bf16 v200, v26, v204, v200
    v_dot2_f32_bf16 v201, v26, v26, v201
    v_dot2_f32_bf16 v202, v27, v204, v202
    v_dot2_f32_bf16 v203, v27, v27, v203
    v_dot2_f32_bf16 v200, v28, v204, v200
    v_dot2_f32_bf16 v201, v28, v28, v201
    v_dot2_f32_bf16 v202, v29, v204, v202
    v_dot2_f32_bf16 v203, v29, v29, v203
    v_dot2_f32_bf16 v200, v30, v204, v200
    v_dot2_f32_bf16 v201, v30, v30, v201
    v_dot2_f32_bf16 v202, v31, v204, v202
    v_dot2_f32_bf16 v203, v31, v31, v203
    v_dot2_f32_bf16 v200, v32, v204, v200
    v_dot2_f32_bf16 v201, v32, v32, v201
    v_dot2_f32_bf16 v202, v33, v204, v202
    v_dot2_f32_bf16 v203, v33, v33, v203
    v_dot2_f32_bf16 v200, v34, v204, v200
    v_dot2_f32_bf16 v201, v34, v34, v201
    v_dot2_f32_bf16 v202, v35, v204, v202
    v_dot2_f32_bf16 v203, v35, v35, v203
    v_dot2_f32_bf16 v200, v36, v204, v200
    v_dot2_f32_bf16 v201, v36, v36, v201
    v_dot2_f32_bf16 v202, v37, v204, v202
    v_dot2_f32_bf16 v203, v37, v37, v203
    v_dot2_f32_bf16 v200, v38, v204, v200
    v_dot2_f32_bf16 v201, v38, v38, v201
    v_dot2_f32_bf16 v202, v39, v204, v202
    v_dot2_f32_bf16 v203, v39, v39, v203
    v_dot2_f32_bf16 v200, v40, v204, v200
    v_dot2_f32_bf16 v201, v40, v40, v201
    v_dot2_f32_bf16 v202, v41, v204, v202
    v_dot2_f32_bf16 v203, v41, v41, v203
    v_dot2_f32_bf16 v200, v42, v204, v200
    v_dot2_f32_bf16 v201, v42, v42, v201
    v_dot2_f32_bf16 v202, v43, v204, v202
    v_dot2_f32_bf16 v203, v43, v43, v203
    v_dot2_f32_bf16 v200, v44, v204, v200
    v_dot2_f32_bf16 v201, v44, v44, v201
    v_dot2_f32_bf16 v202, v45, v204, v202
    v_dot2_f32_bf16 v203, v45, v45, v203
    v_dot2_f32_bf16 v200, v46, v204, v200
    v_dot2_f32_bf16 v201, v46, v46, v201
    v_dot2_f32_bf16 v202, v47, v204, v202
    v_dot2_f32_bf16 v203, v47, v47, v203
    v_dot2_f32_bf16 v200, v48, v204, v200
    v_dot2_f32_bf16 v201, v48, v48, v201
    v_dot2_f32_bf16 v202, v49, v204, v202
    v_dot2_f32_bf16 v203, v49, v49, v203
    v_dot2_f32_bf16 v200, v50, v204, v200
    v_dot2_f32_bf16 v201, v50, v50, v201
    v_dot2_f32_bf16 v202, v51, v204, v202
    v_dot2_f32_bf16 v203, v51, v51, v203
    v_dot2_f32_bf16 v200, v52, v204, v200
    v_dot2_f32_bf16 v201, v52, v52, v201
    v_dot2_f32_bf16 v202, v53, v204, v202
    v_dot2_f32_bf16 v203, v53, v53, v203
    v_dot2_f32_bf16 v200, v54, v204, v200
    v_dot2_f32_bf16 v201, v54, v54, v201
    v_dot2_f32_bf16 v202, v55, v204, v202
    v_dot2_f32_bf16 v203, v55, v55, v203
    s_nop 3
    v_pk_add_f32 v[200:201], v[200:201], v[202:203]
    v_mov_b64 v[202:203], v[200:201]
    s_nop 1
    v_permlane32_swap_b32 v200, v202
    v_permlane32_swap_b32 v201, v203
    v_pk_add_f32 v[200:201], v[200:201], v[202:203]
    v_or_b32 v201, 1, v201
    s_mov_b32 exec_hi, 0
    buffer_store_dwordx2 v[200:201], v205, s[4:7], s15 offen sc1
    s_mov_b32 exec_hi, -1
    s_waitcnt vmcnt(0)
    s_mov_b64 exec, 0x3ff
    buffer_store_dword v7, v6, s[4:7], s16 offen sc1
    s_mov_b64 exec, -1
    s_add_u32 s14, s12, 16
    s_mul_i32 s13, s14, 40960
    s_mul_i32 s15, s9, 10240
    s_add_u32 s13, s13, s15
    s_add_u32 s13, s13, 116391936
    s_lshl_b32 s15, s14, 10
    s_lshl_b32 s16, s9, 3
    s_add_u32 s15, s15, s16
    s_add_u32 s15, s15, 155975680
    s_lshl_b32 s16, s14, 9
    s_lshl_b32 s14, s9, 7
    s_add_u32 s16, s16, s14
    s_add_u32 s16, s16, 155385856
    buffer_store_dwordx4 v[56:59], v5, s[4:7], s13 offen sc1
    s_add_u32 s13, s13, 1024
    buffer_store_dwordx4 v[60:63], v5, s[4:7], s13 offen sc1
    s_add_u32 s13, s13, 1024
    buffer_store_dwordx4 v[64:67], v5, s[4:7], s13 offen sc1
    s_add_u32 s13, s13, 1024
    buffer_store_dwordx4 v[68:71], v5, s[4:7], s13 offen sc1
    s_add_u32 s13, s13, 1024
    buffer_store_dwordx4 v[72:75], v5, s[4:7], s13 offen sc1
    s_add_u32 s13, s13, 1024
    buffer_store_dwordx4 v[76:79], v5, s[4:7], s13 offen sc1
    s_add_u32 s13, s13, 1024
    buffer_store_dwordx4 v[80:83], v5, s[4:7], s13 offen sc1
    s_add_u32 s13, s13, 1024
    buffer_store_dwordx4 v[84:87], v5, s[4:7], s13 offen sc1
    s_add_u32 s13, s13, 1024
    buffer_store_dwordx4 v[88:91], v5, s[4:7], s13 offen sc1
    s_add_u32 s13, s13, 1024
    buffer_store_dwordx4 v[92:95], v5, s[4:7], s13 offen sc1
    s_add_u32 s13, s13, 1024
    v_mov_b32 v204, 0x3f803f80
    v_mov_b64 v[200:201], 0
    v_mov_b64 v[202:203], 0
    v_lshlrev_b32 v205, 5, v0
    v_dot2_f32_bf16 v200, v56, v204, v200
    v_dot2_f32_bf16 v201, v56, v56, v201
    v_dot2_f32_bf16 v202, v57, v204, v202
    v_dot2_f32_bf16 v203, v57, v57, v203
    v_dot2_f32_bf16 v200, v58, v204, v200
    v_dot2_f32_bf16 v201, v58, v58, v201
    v_dot2_f32_bf16 v202, v59, v204, v202
    v_dot2_f32_bf16 v203, v59, v59, v203
    v_dot2_f32_bf16 v200, v60, v204, v200
    v_dot2_f32_bf16 v201, v60, v60, v201
    v_dot2_f32_bf16 v202, v61, v204, v202
    v_dot2_f32_bf16 v203, v61, v61, v203
    v_dot2_f32_bf16 v200, v62, v204, v200
    v_dot2_f32_bf16 v201, v62, v62, v201
    v_dot2_f32_bf16 v202, v63, v204, v202
    v_dot2_f32_bf16 v203, v63, v63, v203
    v_dot2_f32_bf16 v200, v64, v204, v200
    v_dot2_f32_bf16 v201, v64, v64, v201
    v_dot2_f32_bf16 v202, v65, v204, v202
    v_dot2_f32_bf16 v203, v65, v65, v203
    v_dot2_f32_bf16 v200, v66, v204, v200
    v_dot2_f32_bf16 v201, v66, v66, v201
    v_dot2_f32_bf16 v202, v67, v204, v202
    v_dot2_f32_bf16 v203, v67, v67, v203
    v_dot2_f32_bf16 v200, v68, v204, v200
    v_dot2_f32_bf16 v201, v68, v68, v201
    v_dot2_f32_bf16 v202, v69, v204, v202
    v_dot2_f32_bf16 v203, v69, v69, v203
    v_dot2_f32_bf16 v200, v70, v204, v200
    v_dot2_f32_bf16 v201, v70, v70, v201
    v_dot2_f32_bf16 v202, v71, v204, v202
    v_dot2_f32_bf16 v203, v71, v71, v203
    v_dot2_f32_bf16 v200, v72, v204, v200
    v_dot2_f32_bf16 v201, v72, v72, v201
    v_dot2_f32_bf16 v202, v73, v204, v202
    v_dot2_f32_bf16 v203, v73, v73, v203
    v_dot2_f32_bf16 v200, v74, v204, v200
    v_dot2_f32_bf16 v201, v74, v74, v201
    v_dot2_f32_bf16 v202, v75, v204, v202
    v_dot2_f32_bf16 v203, v75, v75, v203
    v_dot2_f32_bf16 v200, v76, v204, v200
    v_dot2_f32_bf16 v201, v76, v76, v201
    v_dot2_f32_bf16 v202, v77, v204, v202
    v_dot2_f32_bf16 v203, v77, v77, v203
    v_dot2_f32_bf16 v200, v78, v204, v200
    v_dot2_f32_bf16 v201, v78, v78, v201
    v_dot2_f32_bf16 v202, v79, v204, v202
    v_dot2_f32_bf16 v203, v79, v79, v203
    v_dot2_f32_bf16 v200, v80, v204, v200
    v_dot2_f32_bf16 v201, v80, v80, v201
    v_dot2_f32_bf16 v202, v81, v204, v202
    v_dot2_f32_bf16 v203, v81, v81, v203
    v_dot2_f32_bf16 v200, v82, v204, v200
    v_dot2_f32_bf16 v201, v82, v82, v201
    v_dot2_f32_bf16 v202, v83, v204, v202
    v_dot2_f32_bf16 v203, v83, v83, v203
    v_dot2_f32_bf16 v200, v84, v204, v200
    v_dot2_f32_bf16 v201, v84, v84, v201
    v_dot2_f32_bf16 v202, v85, v204, v202
    v_dot2_f32_bf16 v203, v85, v85, v203
    v_dot2_f32_bf16 v200, v86, v204, v200
    v_dot2_f32_bf16 v201, v86, v86, v201
    v_dot2_f32_bf16 v202, v87, v204, v202
    v_dot2_f32_bf16 v203, v87, v87, v203
    v_dot2_f32_bf16 v200, v88, v204, v200
    v_dot2_f32_bf16 v201, v88, v88, v201
    v_dot2_f32_bf16 v202, v89, v204, v202
    v_dot2_f32_bf16 v203, v89, v89, v203
    v_dot2_f32_bf16 v200, v90, v204, v200
    v_dot2_f32_bf16 v201, v90, v90, v201
    v_dot2_f32_bf16 v202, v91, v204, v202
    v_dot2_f32_bf16 v203, v91, v91, v203
    v_dot2_f32_bf16 v200, v92, v204, v200
    v_dot2_f32_bf16 v201, v92, v92, v201
    v_dot2_f32_bf16 v202, v93, v204, v202
    v_dot2_f32_bf16 v203, v93, v93, v203
    v_dot2_f32_bf16 v200, v94, v204, v200
    v_dot2_f32_bf16 v201, v94, v94, v201
    v_dot2_f32_bf16 v202, v95, v204, v202
    v_dot2_f32_bf16 v203, v95, v95, v203
    s_nop 3
    v_pk_add_f32 v[200:201], v[200:201], v[202:203]
    v_mov_b64 v[202:203], v[200:201]
    s_nop 1
    v_permlane32_swap_b32 v200, v202
    v_permlane32_swap_b32 v201, v203
    v_pk_add_f32 v[200:201], v[200:201], v[202:203]
    v_or_b32 v201, 1, v201
    s_mov_b32 exec_hi, 0
    buffer_store_dwordx2 v[200:201], v205, s[4:7], s15 offen sc1
    s_mov_b32 exec_hi, -1
    s_waitcnt vmcnt(0)
    s_mov_b64 exec, 0x3ff
    buffer_store_dword v7, v6, s[4:7], s16 offen sc1
    s_mov_b64 exec, -1
    s_add_u32 s14, s12, 32
    s_mul_i32 s13, s14, 40960
    s_mul_i32 s15, s9, 10240
    s_add_u32 s13, s13, s15
    s_add_u32 s13, s13, 116391936
    s_lshl_b32 s15, s14, 10
    s_lshl_b32 s16, s9, 3
    s_add_u32 s15, s15, s16
    s_add_u32 s15, s15, 155975680
    s_lshl_b32 s16, s14, 9
    s_lshl_b32 s14, s9, 7
    s_add_u32 s16, s16, s14
    s_add_u32 s16, s16, 155385856
    buffer_store_dwordx4 v[96:99], v5, s[4:7], s13 offen sc1
    s_add_u32 s13, s13, 1024
    buffer_store_dwordx4 v[100:103], v5, s[4:7], s13 offen sc1
    s_add_u32 s13, s13, 1024
    buffer_store_dwordx4 v[104:107], v5, s[4:7], s13 offen sc1
    s_add_u32 s13, s13, 1024
    buffer_store_dwordx4 v[108:111], v5, s[4:7], s13 offen sc1
    s_add_u32 s13, s13, 1024
    buffer_store_dwordx4 v[112:115], v5, s[4:7], s13 offen sc1
    s_add_u32 s13, s13, 1024
    buffer_store_dwordx4 v[116:119], v5, s[4:7], s13 offen sc1
    s_add_u32 s13, s13, 1024
    buffer_store_dwordx4 v[120:123], v5, s[4:7], s13 offen sc1
    s_add_u32 s13, s13, 1024
    buffer_store_dwordx4 v[124:127], v5, s[4:7], s13 offen sc1
    s_add_u32 s13, s13, 1024
    buffer_store_dwordx4 v[128:131], v5, s[4:7], s13 offen sc1
    s_add_u32 s13, s13, 1024
    buffer_store_dwordx4 v[132:135], v5, s[4:7], s13 offen sc1
    s_add_u32 s13, s13, 1024
    v_mov_b32 v204, 0x3f803f80
    v_mov_b64 v[200:201], 0
    v_mov_b64 v[202:203], 0
    v_lshlrev_b32 v205, 5, v0
    v_dot2_f32_bf16 v200, v96, v204, v200
    v_dot2_f32_bf16 v201, v96, v96, v201
    v_dot2_f32_bf16 v202, v97, v204, v202
    v_dot2_f32_bf16 v203, v97, v97, v203
    v_dot2_f32_bf16 v200, v98, v204, v200
    v_dot2_f32_bf16 v201, v98, v98, v201
    v_dot2_f32_bf16 v202, v99, v204, v202
    v_dot2_f32_bf16 v203, v99, v99, v203
    v_dot2_f32_bf16 v200, v100, v204, v200
    v_dot2_f32_bf16 v201, v100, v100, v201
    v_dot2_f32_bf16 v202, v101, v204, v202
    v_dot2_f32_bf16 v203, v101, v101, v203
    v_dot2_f32_bf16 v200, v102, v204, v200
    v_dot2_f32_bf16 v201, v102, v102, v201
    v_dot2_f32_bf16 v202, v103, v204, v202
    v_dot2_f32_bf16 v203, v103, v103, v203
    v_dot2_f32_bf16 v200, v104, v204, v200
    v_dot2_f32_bf16 v201, v104, v104, v201
    v_dot2_f32_bf16 v202, v105, v204, v202
    v_dot2_f32_bf16 v203, v105, v105, v203
    v_dot2_f32_bf16 v200, v106, v204, v200
    v_dot2_f32_bf16 v201, v106, v106, v201
    v_dot2_f32_bf16 v202, v107, v204, v202
    v_dot2_f32_bf16 v203, v107, v107, v203
    v_dot2_f32_bf16 v200, v108, v204, v200
    v_dot2_f32_bf16 v201, v108, v108, v201
    v_dot2_f32_bf16 v202, v109, v204, v202
    v_dot2_f32_bf16 v203, v109, v109, v203
    v_dot2_f32_bf16 v200, v110, v204, v200
    v_dot2_f32_bf16 v201, v110, v110, v201
    v_dot2_f32_bf16 v202, v111, v204, v202
    v_dot2_f32_bf16 v203, v111, v111, v203
    v_dot2_f32_bf16 v200, v112, v204, v200
    v_dot2_f32_bf16 v201, v112, v112, v201
    v_dot2_f32_bf16 v202, v113, v204, v202
    v_dot2_f32_bf16 v203, v113, v113, v203
    v_dot2_f32_bf16 v200, v114, v204, v200
    v_dot2_f32_bf16 v201, v114, v114, v201
    v_dot2_f32_bf16 v202, v115, v204, v202
    v_dot2_f32_bf16 v203, v115, v115, v203
    v_dot2_f32_bf16 v200, v116, v204, v200
    v_dot2_f32_bf16 v201, v116, v116, v201
    v_dot2_f32_bf16 v202, v117, v204, v202
    v_dot2_f32_bf16 v203, v117, v117, v203
    v_dot2_f32_bf16 v200, v118, v204, v200
    v_dot2_f32_bf16 v201, v118, v118, v201
    v_dot2_f32_bf16 v202, v119, v204, v202
    v_dot2_f32_bf16 v203, v119, v119, v203
    v_dot2_f32_bf16 v200, v120, v204, v200
    v_dot2_f32_bf16 v201, v120, v120, v201
    v_dot2_f32_bf16 v202, v121, v204, v202
    v_dot2_f32_bf16 v203, v121, v121, v203
    v_dot2_f32_bf16 v200, v122, v204, v200
    v_dot2_f32_bf16 v201, v122, v122, v201
    v_dot2_f32_bf16 v202, v123, v204, v202
    v_dot2_f32_bf16 v203, v123, v123, v203
    v_dot2_f32_bf16 v200, v124, v204, v200
    v_dot2_f32_bf16 v201, v124, v124, v201
    v_dot2_f32_bf16 v202, v125, v204, v202
    v_dot2_f32_bf16 v203, v125, v125, v203
    v_dot2_f32_bf16 v200, v126, v204, v200
    v_dot2_f32_bf16 v201, v126, v126, v201
    v_dot2_f32_bf16 v202, v127, v204, v202
    v_dot2_f32_bf16 v203, v127, v127, v203
    v_dot2_f32_bf16 v200, v128, v204, v200
    v_dot2_f32_bf16 v201, v128, v128, v201
    v_dot2_f32_bf16 v202, v129, v204, v202
    v_dot2_f32_bf16 v203, v129, v129, v203
    v_dot2_f32_bf16 v200, v130, v204, v200
    v_dot2_f32_bf16 v201, v130, v130, v201
    v_dot2_f32_bf16 v202, v131, v204, v202
    v_dot2_f32_bf16 v203, v131, v131, v203
    v_dot2_f32_bf16 v200, v132, v204, v200
    v_dot2_f32_bf16 v201, v132, v132, v201
    v_dot2_f32_bf16 v202, v133, v204, v202
    v_dot2_f32_bf16 v203, v133, v133, v203
    v_dot2_f32_bf16 v200, v134, v204, v200
    v_dot2_f32_bf16 v201, v134, v134, v201
    v_dot2_f32_bf16 v202, v135, v204, v202
    v_dot2_f32_bf16 v203, v135, v135, v203
    s_nop 3
    v_pk_add_f32 v[200:201], v[200:201], v[202:203]
    v_mov_b64 v[202:203], v[200:201]
    s_nop 1
    v_permlane32_swap_b32 v200, v202
    v_permlane32_swap_b32 v201, v203
    v_pk_add_f32 v[200:201], v[200:201], v[202:203]
    v_or_b32 v201, 1, v201
    s_mov_b32 exec_hi, 0
    buffer_store_dwordx2 v[200:201], v205, s[4:7], s15 offen sc1
    s_mov_b32 exec_hi, -1
    s_waitcnt vmcnt(0)
    s_mov_b64 exec, 0x3ff
    buffer_store_dword v7, v6, s[4:7], s16 offen sc1
    s_mov_b64 exec, -1
    s_add_u32 s14, s12, 48
    s_mul_i32 s13, s14, 40960
    s_mul_i32 s15, s9, 10240
    s_add_u32 s13, s13, s15
    s_add_u32 s13, s13, 116391936
    s_lshl_b32 s15, s14, 10
    s_lshl_b32 s16, s9, 3
    s_add_u32 s15, s15, s16
    s_add_u32 s15, s15, 155975680
    s_lshl_b32 s16, s14, 9
    s_lshl_b32 s14, s9, 7
    s_add_u32 s16, s16, s14
    s_add_u32 s16, s16, 155385856
    buffer_store_dwordx4 v[136:139], v5, s[4:7], s13 offen sc1
    s_add_u32 s13, s13, 1024
    buffer_store_dwordx4 v[140:143], v5, s[4:7], s13 offen sc1
    s_add_u32 s13, s13, 1024
    buffer_store_dwordx4 v[144:147], v5, s[4:7], s13 offen sc1
    s_add_u32 s13, s13, 1024
    buffer_store_dwordx4 v[148:151], v5, s[4:7], s13 offen sc1
    s_add_u32 s13, s13, 1024
    buffer_store_dwordx4 v[152:155], v5, s[4:7], s13 offen sc1
    s_add_u32 s13, s13, 1024
    buffer_store_dwordx4 v[156:159], v5, s[4:7], s13 offen sc1
    s_add_u32 s13, s13, 1024
    buffer_store_dwordx4 v[160:163], v5, s[4:7], s13 offen sc1
    s_add_u32 s13, s13, 1024
    buffer_store_dwordx4 v[164:167], v5, s[4:7], s13 offen sc1
    s_add_u32 s13, s13, 1024
    buffer_store_dwordx4 v[168:171], v5, s[4:7], s13 offen sc1
    s_add_u32 s13, s13, 1024
    buffer_store_dwordx4 v[172:175], v5, s[4:7], s13 offen sc1
    s_add_u32 s13, s13, 1024
    v_mov_b32 v204, 0x3f803f80
    v_mov_b64 v[200:201], 0
    v_mov_b64 v[202:203], 0
    v_lshlrev_b32 v205, 5, v0
    v_dot2_f32_bf16 v200, v136, v204, v200
    v_dot2_f32_bf16 v201, v136, v136, v201
    v_dot2_f32_bf16 v202, v137, v204, v202
    v_dot2_f32_bf16 v203, v137, v137, v203
    v_dot2_f32_bf16 v200, v138, v204, v200
    v_dot2_f32_bf16 v201, v138, v138, v201
    v_dot2_f32_bf16 v202, v139, v204, v202
    v_dot2_f32_bf16 v203, v139, v139, v203
    v_dot2_f32_bf16 v200, v140, v204, v200
    v_dot2_f32_bf16 v201, v140, v140, v201
    v_dot2_f32_bf16 v202, v141, v204, v202
    v_dot2_f32_bf16 v203, v141, v141, v203
    v_dot2_f32_bf16 v200, v142, v204, v200
    v_dot2_f32_bf16 v201, v142, v142, v201
    v_dot2_f32_bf16 v202, v143, v204, v202
    v_dot2_f32_bf16 v203, v143, v143, v203
    v_dot2_f32_bf16 v200, v144, v204, v200
    v_dot2_f32_bf16 v201, v144, v144, v201
    v_dot2_f32_bf16 v202, v145, v204, v202
    v_dot2_f32_bf16 v203, v145, v145, v203
    v_dot2_f32_bf16 v200, v146, v204, v200
    v_dot2_f32_bf16 v201, v146, v146, v201
    v_dot2_f32_bf16 v202, v147, v204, v202
    v_dot2_f32_bf16 v203, v147, v147, v203
    v_dot2_f32_bf16 v200, v148, v204, v200
    v_dot2_f32_bf16 v201, v148, v148, v201
    v_dot2_f32_bf16 v202, v149, v204, v202
    v_dot2_f32_bf16 v203, v149, v149, v203
    v_dot2_f32_bf16 v200, v150, v204, v200
    v_dot2_f32_bf16 v201, v150, v150, v201
    v_dot2_f32_bf16 v202, v151, v204, v202
    v_dot2_f32_bf16 v203, v151, v151, v203
    v_dot2_f32_bf16 v200, v152, v204, v200
    v_dot2_f32_bf16 v201, v152, v152, v201
    v_dot2_f32_bf16 v202, v153, v204, v202
    v_dot2_f32_bf16 v203, v153, v153, v203
    v_dot2_f32_bf16 v200, v154, v204, v200
    v_dot2_f32_bf16 v201, v154, v154, v201
    v_dot2_f32_bf16 v202, v155, v204, v202
    v_dot2_f32_bf16 v203, v155, v155, v203
    v_dot2_f32_bf16 v200, v156, v204, v200
    v_dot2_f32_bf16 v201, v156, v156, v201
    v_dot2_f32_bf16 v202, v157, v204, v202
    v_dot2_f32_bf16 v203, v157, v157, v203
    v_dot2_f32_bf16 v200, v158, v204, v200
    v_dot2_f32_bf16 v201, v158, v158, v201
    v_dot2_f32_bf16 v202, v159, v204, v202
    v_dot2_f32_bf16 v203, v159, v159, v203
    v_dot2_f32_bf16 v200, v160, v204, v200
    v_dot2_f32_bf16 v201, v160, v160, v201
    v_dot2_f32_bf16 v202, v161, v204, v202
    v_dot2_f32_bf16 v203, v161, v161, v203
    v_dot2_f32_bf16 v200, v162, v204, v200
    v_dot2_f32_bf16 v201, v162, v162, v201
    v_dot2_f32_bf16 v202, v163, v204, v202
    v_dot2_f32_bf16 v203, v163, v163, v203
    v_dot2_f32_bf16 v200, v164, v204, v200
    v_dot2_f32_bf16 v201, v164, v164, v201
    v_dot2_f32_bf16 v202, v165, v204, v202
    v_dot2_f32_bf16 v203, v165, v165, v203
    v_dot2_f32_bf16 v200, v166, v204, v200
    v_dot2_f32_bf16 v201, v166, v166, v201
    v_dot2_f32_bf16 v202, v167, v204, v202
    v_dot2_f32_bf16 v203, v167, v167, v203
    v_dot2_f32_bf16 v200, v168, v204, v200
    v_dot2_f32_bf16 v201, v168, v168, v201
    v_dot2_f32_bf16 v202, v169, v204, v202
    v_dot2_f32_bf16 v203, v169, v169, v203
    v_dot2_f32_bf16 v200, v170, v204, v200
    v_dot2_f32_bf16 v201, v170, v170, v201
    v_dot2_f32_bf16 v202, v171, v204, v202
    v_dot2_f32_bf16 v203, v171, v171, v203
    v_dot2_f32_bf16 v200, v172, v204, v200
    v_dot2_f32_bf16 v201, v172, v172, v201
    v_dot2_f32_bf16 v202, v173, v204, v202
    v_dot2_f32_bf16 v203, v173, v173, v203
    v_dot2_f32_bf16 v200, v174, v204, v200
    v_dot2_f32_bf16 v201, v174, v174, v201
    v_dot2_f32_bf16 v202, v175, v204, v202
    v_dot2_f32_bf16 v203, v175, v175, v203
    s_nop 3
    v_pk_add_f32 v[200:201], v[200:201], v[202:203]
    v_mov_b64 v[202:203], v[200:201]
    s_nop 1
    v_permlane32_swap_b32 v200, v202
    v_permlane32_swap_b32 v201, v203
    v_pk_add_f32 v[200:201], v[200:201], v[202:203]
    v_or_b32 v201, 1, v201
    s_mov_b32 exec_hi, 0
    buffer_store_dwordx2 v[200:201], v205, s[4:7], s15 offen sc1
    s_mov_b32 exec_hi, -1
    s_waitcnt vmcnt(0)
    s_mov_b64 exec, 0x3ff
    buffer_store_dword v7, v6, s[4:7], s16 offen sc1
    s_mov_b64 exec, -1
    v_mov_b32 v0, v250
    s_branch A_NY_143
A_NX_142:
    s_mov_b32 s24, 0
WI_146:
    buffer_load_dword v8, off, s[96:99], 0 offset:128 sc1
    s_waitcnt vmcnt(0)
    v_cmp_le_u32 vcc, 256, v8
    s_cbranch_vccnz WO_147
    s_sleep 4
    s_add_u32 s24, s24, 1
    s_cmp_lt_u32 s24, 200000
    s_cbranch_scc1 WI_146
    s_branch F_AT
WO_147:
A_NY_143:
    v_lshrrev_b32 v2, 6, v0
    v_and_b32 v0, 63, v0
    v_readfirstlane_b32 s9, v2
    s_cmp_eq_u32 s9, 3
    s_cbranch_scc1 A_AUX
    v_lshlrev_b32 v1, 4, v0
    v_mov_b32 v7, 1
    v_lshlrev_b32 v9, 7, v0
    s_mul_i32 s23, s8, 3
    s_add_u32 s23, s23, s9
    s_cmp_ge_u32 s23, 32
    s_cbranch_scc1 F_AT
    s_mul_i32 s21, s11, 33554432
    s_lshl_b32 s22, s23, 14
    s_add_u32 s21, s21, s22
    s_add_u32 s13, s21, 0
    s_lshr_b32 s22, s21, 1
    s_add_u32 s12, s22, 164765696
    s_add_u32 s16, s22, 68157440
    s_lshr_b32 s22, s21, 2
    s_add_u32 s15, s22, 138412032
    s_mul_i32 s18, s11, 32768
    s_lshl_b32 s21, s23, 2
    s_add_u32 s18, s18, s21
    s_add_u32 s18, s18, 155189248
    s_lshr_b32 s21, s23, 3
    s_mul_i32 s21, s21, 96
    s_add_u32 s18, s18, s21
    s_mov_b32 s32, 0xceabae43
    s_mov_b32 s10, 0
    s_mov_b32 s19, 0
    s_mul_i32 s21, s11, 131072
    s_lshl_b32 s22, s23, 12
    s_add_u32 s21, s21, s22
    v_and_b32 v2, 7, v0
    v_lshlrev_b32 v2, 2, v2
    v_add_u32 v2, s21, v2
    v_mov_b32 v10, 155451456
    v_mov_b32 v11, 155713536
    v_mov_b32 v12, 155451392
    v_cmp_gt_u32 vcc, 8, v0
    s_nop 1
    v_cndmask_b32 v10, v11, v10, vcc
    v_cmp_gt_u32 vcc, 16, v0
    s_nop 1
    v_cndmask_b32 v10, v12, v10, vcc
    v_mov_b32 v12, 155713600
    v_cmp_gt_u32 vcc, 24, v0
    s_nop 1
    v_cndmask_b32 v10, v12, v10, vcc
    v_add_u32 v2, v2, v10
    v_and_b32 v14, 31, v0
    v_lshrrev_b32 v15, 5, v0
    v_lshlrev_b32 v10, 2, v15
    v_sub_u32 v10, v14, v10
    v_cmp_le_i32 vcc, 0, v10
    s_nop 1
    v_cndmask_b32 v192, 0, -1, vcc
    v_cmp_le_i32 vcc, 1, v10
    s_nop 1
    v_cndmask_b32 v193, 0, -1, vcc
    v_cmp_le_i32 vcc, 2, v10
    s_nop 1
    v_cndmask_b32 v194, 0, -1, vcc
    v_cmp_le_i32 vcc, 3, v10
    s_nop 1
    v_cndmask_b32 v195, 0, -1, vcc
    v_cmp_le_i32 vcc, 8, v10
    s_nop 1
    v_cndmask_b32 v196, 0, -1, vcc
    v_cmp_le_i32 vcc, 9, v10
    s_nop 1
    v_cndmask_b32 v197, 0, -1, vcc
    v_cmp_le_i32 vcc, 10, v10
    s_nop 1
    v_cndmask_b32 v198, 0, -1, vcc
    v_cmp_le_i32 vcc, 11, v10
    s_nop 1
    v_cndmask_b32 v199, 0, -1, vcc
    v_cmp_le_i32 vcc, 16, v10
    s_nop 1
    v_cndmask_b32 v200, 0, -1, vcc
    v_cmp_le_i32 vcc, 17, v10
    s_nop 1
    v_cndmask_b32 v201, 0, -1, vcc
    v_cmp_le_i32 vcc, 18, v10
    s_nop 1
    v_cndmask_b32 v202, 0, -1, vcc
    v_cmp_le_i32 vcc, 19, v10
    s_nop 1
    v_cndmask_b32 v203, 0, -1, vcc
    v_cmp_le_i32 vcc, 24, v10
    s_nop 1
    v_cndmask_b32 v204, 0, -1, vcc
    v_cmp_le_i32 vcc, 25, v10
    s_nop 1
    v_cndmask_b32 v205, 0, -1, vcc
    v_cmp_le_i32 vcc, 26, v10
    s_nop 1
    v_cndmask_b32 v206, 0, -1, vcc
    v_cmp_le_i32 vcc, 27, v10
    s_nop 1
    v_cndmask_b32 v207, 0, -1, vcc
    s_lshl_b32 s21, s9, 11
    v_bfe_u32 v10, v0, 2, 2
    v_lshlrev_b32 v4, 7, v10
    v_lshrrev_b32 v10, 4, v0
    v_lshl_add_u32 v4, v10, 5, v4
    v_and_b32 v10, 3, v0
    v_lshl_add_u32 v4, v10, 2, v4
    v_add_u32 v4, s21, v4
    v_add_u32 v8, 1024, v4
    v_and_b32 v10, 7, v0
    v_lshlrev_b32 v5, 4, v10
    v_lshl_add_u32 v5, v15, 7, v5
    v_add_u32 v5, s21, v5
    s_add_u32 s21, s21, 8192
    v_bfe_u32 v10, v0, 4, 1
    v_lshlrev_b32 v6, 9, v10
    v_and_b32 v10, 15, v0
    v_lshl_add_u32 v6, v10, 3, v6
    v_lshl_add_u32 v6, v15, 8, v6
    v_add_u32 v6, s21, v6
    v_lshlrev_b32 v9, 3, v0
    v_add_u32 v9, s21, v9
    s_lshr_b32 s3, s100, 5
    s_lshl_b32 s3, s3, 2
    buffer_load_dword v3, off, s[96:99], s3 sc1
    s_waitcnt vmcnt(0)
    v_cmp_le_u32 vcc, 32, v3
    s_cmp_lg_u64 vcc, 0
    s_cselect_b32 s35, 1, 0
    s_mov_b32 s35, 0
    s_mov_b32 s28, 0
    s_mov_b32 s30, 0
    s_add_u32 s25, s12, 4096
    s_add_u32 s14, s13, 8192
    s_add_u32 s26, s13, 4096
    s_add_u32 s27, s13, 12288
A_ITEM_148:
    s_cmp_lg_u32 s19, 0
    s_cbranch_scc1 A_HAVE_149
    s_mov_b32 s24, 0
AP_150:
    s_mov_b64 exec, 0x0f3f0f3f
    buffer_load_dword v3, v2, s[4:7], 0 offen sc1
    s_waitcnt vmcnt(0)
    v_cmp_eq_u32 vcc, 0, v3
    s_cmp_eq_u32 s28, 0
    s_cbranch_scc1 AF_152
    s_mov_b64 exec, 1
    s_cmp_eq_u32 s35, 0
    s_cbranch_scc1 BL_153
    buffer_store_dword v7, off, s[4:7], s29
    s_branch BL_154
BL_153:
    buffer_store_dword v7, off, s[4:7], s29 sc1
BL_154:
    s_mov_b32 s28, 0
AF_152:
    s_and_b32 s21, vcc_lo, 0x3f0000
    s_cbranch_scc0 AO_151
    s_sleep 1
    s_add_u32 s24, s24, 1
    s_cmp_lt_u32 s24, 200000
    s_cbranch_scc1 AP_150
    s_branch F_AT
AO_151:
    s_mov_b64 exec, -1
    buffer_load_dwordx4 v[48:51], v1, s[4:7], s13 offen offset:0 sc1
    buffer_load_dwordx4 v[52:55], v1, s[4:7], s13 offen offset:1024 sc1
    buffer_load_dwordx4 v[56:59], v1, s[4:7], s13 offen offset:2048 sc1
    buffer_load_dwordx4 v[60:63], v1, s[4:7], s13 offen offset:3072 sc1
    buffer_load_dwordx4 v[64:67], v1, s[4:7], s14 offen offset:0 sc1
    buffer_load_dwordx4 v[68:71], v1, s[4:7], s14 offen offset:1024 sc1
    buffer_load_dwordx4 v[72:75], v1, s[4:7], s14 offen offset:2048 sc1
    buffer_load_dwordx4 v[76:79], v1, s[4:7], s14 offen offset:3072 sc1
    buffer_load_dwordx4 v[16:19], v1, s[4:7], s12 offen offset:0 sc1
    buffer_load_dwordx4 v[20:23], v1, s[4:7], s12 offen offset:1024 sc1
    buffer_load_dwordx4 v[24:27], v1, s[4:7], s12 offen offset:2048 sc1
    buffer_load_dwordx4 v[28:31], v1, s[4:7], s12 offen offset:3072 sc1
    buffer_load_dwordx4 v[32:35], v1, s[4:7], s25 offen offset:0 sc1
    buffer_load_dwordx4 v[36:39], v1, s[4:7], s25 offen offset:1024 sc1
    buffer_load_dwordx4 v[40:43], v1, s[4:7], s25 offen offset:2048 sc1
    buffer_load_dwordx4 v[44:47], v1, s[4:7], s25 offen offset:3072 sc1
    buffer_load_dwordx4 v[80:83], v1, s[4:7], s26 offen offset:0 sc1
    buffer_load_dwordx4 v[84:87], v1, s[4:7], s26 offen offset:1024 sc1
    buffer_load_dwordx4 v[88:91], v1, s[4:7], s26 offen offset:2048 sc1
    buffer_load_dwordx4 v[92:95], v1, s[4:7], s26 offen offset:3072 sc1
    buffer_load_dwordx4 v[96:99], v1, s[4:7], s27 offen offset:0 sc1
    buffer_load_dwordx4 v[100:103], v1, s[4:7], s27 offen offset:1024 sc1
    buffer_load_dwordx4 v[104:107], v1, s[4:7], s27 offen offset:2048 sc1
    buffer_load_dwordx4 v[108:111], v1, s[4:7], s27 offen offset:3072 sc1
    s_waitcnt vmcnt(8)
A_HAVE_149:
    s_waitcnt vmcnt(16)
    s_cmp_eq_u32 s30, 0
    s_cbranch_scc1 A_K0_155
    buffer_load_dwordx4 v[224:227], v1, s[4:7], s15 offen offset:0 sc1
    buffer_load_dwordx4 v[228:231], v1, s[4:7], s15 offen offset:1024 sc1
    buffer_load_dwordx4 v[232:235], v1, s[4:7], s15 offen offset:2048 sc1
    buffer_load_dwordx4 v[236:239], v1, s[4:7], s15 offen offset:3072 sc1
A_K0_155:
    v_mfma_f32_32x32x16_bf16 v[160:175], v[48:51], v[16:19], 0
    v_mfma_f32_32x32x16_bf16 v[160:175], v[52:55], v[20:23], v[160:175]
    v_mfma_f32_32x32x16_bf16 v[160:175], v[56:59], v[24:27], v[160:175]
    v_mfma_f32_32x32x16_bf16 v[160:175], v[60:63], v[28:31], v[160:175]
    v_mfma_f32_32x32x16_bf16 v[160:175], v[64:67], v[32:35], v[160:175]
    v_mfma_f32_32x32x16_bf16 v[160:175], v[68:71], v[36:39], v[160:175]
    v_mfma_f32_32x32x16_bf16 v[160:175], v[72:75], v[40:43], v[160:175]
    v_mfma_f32_32x32x16_bf16 v[160:175], v[76:79], v[44:47], v[160:175]
    s_add_u32 s12, s12, 262144
    s_add_u32 s13, s13, 524288
    s_add_u32 s25, s12, 4096
    s_add_u32 s14, s13, 8192
    s_add_u32 s26, s13, 4096
    s_add_u32 s27, s13, 12288
    s_nop 5
    v_bfi_b32 v160, v192, v160, s32
    v_bfi_b32 v161, v193, v161, s32
    v_bfi_b32 v162, v194, v162, s32
    v_bfi_b32 v163, v195, v163, s32
    v_bfi_b32 v164, v196, v164, s32
    v_bfi_b32 v165, v197, v165, s32
    v_bfi_b32 v166, v198, v166, s32
    v_bfi_b32 v167, v199, v167, s32
    v_bfi_b32 v168, v200, v168, s32
    v_bfi_b32 v169, v201, v169, s32
    v_bfi_b32 v170, v202, v170, s32
    v_bfi_b32 v171, v203, v171, s32
    v_bfi_b32 v172, v204, v172, s32
    v_bfi_b32 v173, v205, v173, s32
    v_bfi_b32 v174, v206, v174, s32
    v_bfi_b32 v175, v207, v175, s32
    v_max3_f32 v10, v160, v161, v162
    v_max3_f32 v12, v163, v164, v165
    v_max3_f32 v10, v10, v166, v167
    v_max3_f32 v12, v12, v168, v169
    v_max3_f32 v10, v10, v170, v171
    v_max3_f32 v12, v12, v172, v173
    v_max3_f32 v10, v10, v174, v175
    s_cmp_eq_u32 s30, 0
    s_cselect_b32 s34, 0x0f00, 0
    s_mov_b32 s24, 0
AP_156:
    s_mov_b64 exec, 0x0f3f0f3f
    buffer_load_dword v3, v2, s[4:7], 0 offen sc1
    s_waitcnt vmcnt(0)
    v_cmp_eq_u32 vcc, 0, v3
    s_cmp_eq_u32 s28, 0
    s_cbranch_scc1 AF_158
    s_mov_b64 exec, 1
    s_cmp_eq_u32 s35, 0
    s_cbranch_scc1 BL_159
    buffer_store_dword v7, off, s[4:7], s29
    s_branch BL_160
BL_159:
    buffer_store_dword v7, off, s[4:7], s29 sc1
BL_160:
    s_mov_b32 s28, 0
AF_158:
    s_and_b32 s21, vcc_lo, s34
    s_cbranch_scc0 AO_157
    s_sleep 1
    s_add_u32 s24, s24, 1
    s_cmp_lt_u32 s24, 200000
    s_cbranch_scc1 AP_156
    s_branch F_AT
AO_157:
    s_mov_b64 exec, -1
    s_and_b32 s21, vcc_lo, 0x3f
    s_cselect_b32 s19, 0, 1
    s_cmp_ge_u32 s10, 63
    s_cselect_b32 s19, 0, s19
    s_and_b32 s21, vcc_lo, 0x0f000000
    s_cselect_b32 s31, 0, s19
    s_cmp_lg_u32 s30, 0
    s_cbranch_scc1 A_K_161
    buffer_load_dwordx4 v[224:227], v1, s[4:7], s15 offen offset:0 sc1
    buffer_load_dwordx4 v[228:231], v1, s[4:7], s15 offen offset:1024 sc1
    buffer_load_dwordx4 v[232:235], v1, s[4:7], s15 offen offset:2048 sc1
    buffer_load_dwordx4 v[236:239], v1, s[4:7], s15 offen offset:3072 sc1
    s_waitcnt vmcnt(0)
A_K_161:
    ds_write2_b32 v4, v224, v225 offset0:0 offset1:4
    ds_write2_b32 v4, v228, v229 offset0:128 offset1:132
    ds_write2_b32 v8, v232, v233 offset0:0 offset1:4
    ds_write2_b32 v8, v236, v237 offset0:128 offset1:132
    ds_write_b64 v9, v[226:227] offset:0
    ds_write_b64 v9, v[230:231] offset:512
    ds_write_b64 v9, v[234:235] offset:1024
    ds_write_b64 v9, v[238:239] offset:1536
    s_waitcnt lgkmcnt(4)
    ds_read_b128 v[112:115], v5 offset:0
    ds_read_b128 v[116:119], v5 offset:256
    ds_read_b128 v[120:123], v5 offset:512
    ds_read_b128 v[124:127], v5 offset:768
    ds_read_b128 v[128:131], v5 offset:1024
    ds_read_b128 v[132:135], v5 offset:1280
    ds_read_b128 v[136:139], v5 offset:1536
    ds_read_b128 v[140:143], v5 offset:1792
    ds_read2_b64 v[144:147], v6 offset0:0 offset1:16
    ds_read2_b64 v[148:151], v6 offset0:128 offset1:144
    s_waitcnt lgkmcnt(9)
    v_mfma_f32_32x32x16_bf16 v[176:191], v[112:115], v[16:19], 0
    s_waitcnt lgkmcnt(8)
    v_mfma_f32_32x32x16_bf16 v[176:191], v[116:119], v[20:23], v[176:191]
    s_cmp_eq_u32 s19, 0
    s_cbranch_scc1 APC_163
    buffer_load_dwordx4 v[48:51], v1, s[4:7], s13 offen offset:0 sc1
APC_163:
    s_waitcnt lgkmcnt(7)
    v_mfma_f32_32x32x16_bf16 v[176:191], v[120:123], v[24:27], v[176:191]
    s_waitcnt lgkmcnt(6)
    v_mfma_f32_32x32x16_bf16 v[176:191], v[124:127], v[28:31], v[176:191]
    s_cmp_eq_u32 s19, 0
    s_cbranch_scc1 APC_164
    buffer_load_dwordx4 v[52:55], v1, s[4:7], s13 offen offset:1024 sc1
APC_164:
    s_waitcnt lgkmcnt(5)
    v_mfma_f32_32x32x16_bf16 v[176:191], v[128:131], v[32:35], v[176:191]
    s_waitcnt lgkmcnt(4)
    v_mfma_f32_32x32x16_bf16 v[176:191], v[132:135], v[36:39], v[176:191]
    s_cmp_eq_u32 s19, 0
    s_cbranch_scc1 APC_165
    buffer_load_dwordx4 v[56:59], v1, s[4:7], s13 offen offset:2048 sc1
APC_165:
    s_waitcnt lgkmcnt(3)
    v_mfma_f32_32x32x16_bf16 v[176:191], v[136:139], v[40:43], v[176:191]
    s_waitcnt lgkmcnt(2)
    v_mfma_f32_32x32x16_bf16 v[176:191], v[140:143], v[44:47], v[176:191]
    s_cmp_eq_u32 s19, 0
    s_cbranch_scc1 APC_166
    buffer_load_dwordx4 v[60:63], v1, s[4:7], s13 offen offset:3072 sc1
APC_166:
    s_cmp_eq_u32 s19, 0
    s_cbranch_scc1 APC_167
    buffer_load_dwordx4 v[64:67], v1, s[4:7], s14 offen offset:0 sc1
APC_167:
    s_cmp_eq_u32 s19, 0
    s_cbranch_scc1 APC_168
    buffer_load_dwordx4 v[68:71], v1, s[4:7], s14 offen offset:1024 sc1
APC_168:
    s_waitcnt lgkmcnt(0)
    v_swap_b32 v145, v146
    v_swap_b32 v149, v150
    s_nop 2
    v_max3_f32 v12, v12, v176, v177
    v_max3_f32 v10, v10, v178, v179
    v_max_f32 v10, v10, v12
    v_max_f32 v12, v10, v12
    s_nop 1
    v_permlane32_swap_b32 v10, v12
    v_max_f32 v10, v10, v12
    v_pk_add_f32 v[160:161], v[160:161], v[10:11] op_sel_hi:[1,0] neg_lo:[0,1] neg_hi:[0,1]
    v_pk_add_f32 v[162:163], v[162:163], v[10:11] op_sel_hi:[1,0] neg_lo:[0,1] neg_hi:[0,1]
    v_pk_add_f32 v[164:165], v[164:165], v[10:11] op_sel_hi:[1,0] neg_lo:[0,1] neg_hi:[0,1]
    v_pk_add_f32 v[166:167], v[166:167], v[10:11] op_sel_hi:[1,0] neg_lo:[0,1] neg_hi:[0,1]
    v_pk_add_f32 v[168:169], v[168:169], v[10:11] op_sel_hi:[1,0] neg_lo:[0,1] neg_hi:[0,1]
    v_pk_add_f32 v[170:171], v[170:171], v[10:11] op_sel_hi:[1,0] neg_lo:[0,1] neg_hi:[0,1]
    v_pk_add_f32 v[172:173], v[172:173], v[10:11] op_sel_hi:[1,0] neg_lo:[0,1] neg_hi:[0,1]
    v_pk_add_f32 v[174:175], v[174:175], v[10:11] op_sel_hi:[1,0] neg_lo:[0,1] neg_hi:[0,1]
    v_pk_add_f32 v[176:177], v[176:177], v[10:11] op_sel_hi:[1,0] neg_lo:[0,1] neg_hi:[0,1]
    v_pk_add_f32 v[178:179], v[178:179], v[10:11] op_sel_hi:[1,0] neg_lo:[0,1] neg_hi:[0,1]
    s_cmp_eq_u32 s19, 0
    s_cbranch_scc1 APC_169
    buffer_load_dwordx4 v[72:75], v1, s[4:7], s14 offen offset:2048 sc1
APC_169:
    v_exp_f32 v160, v160
    v_exp_f32 v161, v161
    v_exp_f32 v162, v162
    v_exp_f32 v163, v163
    v_exp_f32 v164, v164
    v_exp_f32 v165, v165
    v_exp_f32 v166, v166
    v_exp_f32 v167, v167
    v_cvt_pk_bf16_f32 v208, v160, v161
    v_cvt_pk_bf16_f32 v209, v162, v163
    v_cvt_pk_bf16_f32 v210, v164, v165
    v_cvt_pk_bf16_f32 v211, v166, v167
    s_cmp_eq_u32 s19, 0
    s_cbranch_scc1 APC_170
    buffer_load_dwordx4 v[76:79], v1, s[4:7], s14 offen offset:3072 sc1
APC_170:
    v_mfma_f32_32x32x16_bf16 v[112:127], v[80:83], v[208:211], 0
    v_exp_f32 v168, v168
    v_exp_f32 v169, v169
    v_exp_f32 v170, v170
    v_mfma_f32_32x32x16_bf16 v[128:143], v[88:91], v[208:211], 0
    v_exp_f32 v171, v171
    v_exp_f32 v172, v172
    v_exp_f32 v173, v173
    s_cmp_eq_u32 s19, 0
    s_cbranch_scc1 APC_171
    buffer_load_dwordx4 v[16:19], v1, s[4:7], s12 offen offset:0 sc1
APC_171:
    v_mfma_f32_32x32x16_bf16 v[224:239], v[96:99], v[208:211], 0
    v_exp_f32 v174, v174
    v_exp_f32 v175, v175
    v_cvt_pk_bf16_f32 v212, v168, v169
    v_mfma_f32_32x32x16_bf16 v[240:255], v[104:107], v[208:211], 0
    v_cvt_pk_bf16_f32 v213, v170, v171
    v_cvt_pk_bf16_f32 v214, v172, v173
    v_cvt_pk_bf16_f32 v215, v174, v175
    s_cmp_eq_u32 s19, 0
    s_cbranch_scc1 APC_172
    buffer_load_dwordx4 v[20:23], v1, s[4:7], s12 offen offset:1024 sc1
APC_172:
    v_mfma_f32_32x32x16_bf16 v[112:127], v[84:87], v[212:215], v[112:127]
    v_exp_f32 v176, v176
    v_exp_f32 v177, v177
    v_exp_f32 v178, v178
    v_mfma_f32_32x32x16_bf16 v[128:143], v[92:95], v[212:215], v[128:143]
    v_exp_f32 v179, v179
    v_cvt_pk_bf16_f32 v216, v176, v177
    v_cvt_pk_bf16_f32 v217, v178, v179
    s_cmp_eq_u32 s19, 0
    s_cbranch_scc1 APC_173
    buffer_load_dwordx4 v[24:27], v1, s[4:7], s12 offen offset:2048 sc1
APC_173:
    v_mfma_f32_32x32x16_bf16 v[224:239], v[100:103], v[212:215], v[224:239]
    v_add_f32 v12, v160, v161
    v_add_f32 v13, v162, v163
    v_add_f32 v12, v12, v164
    v_add_f32 v13, v13, v165
    v_mfma_f32_32x32x16_bf16 v[240:255], v[108:111], v[212:215], v[240:255]
    v_add_f32 v12, v12, v166
    v_add_f32 v13, v13, v167
    v_add_f32 v12, v12, v168
    v_add_f32 v13, v13, v169
    s_cmp_eq_u32 s19, 0
    s_cbranch_scc1 APC_174
    buffer_load_dwordx4 v[28:31], v1, s[4:7], s12 offen offset:3072 sc1
APC_174:
    v_mfma_f32_32x32x8_bf16 v[112:127], v[144:145], v[216:217], v[112:127]
    v_add_f32 v12, v12, v170
    v_add_f32 v13, v13, v171
    v_add_f32 v12, v12, v172
    v_add_f32 v13, v13, v173
    v_mfma_f32_32x32x8_bf16 v[128:143], v[146:147], v[216:217], v[128:143]
    v_add_f32 v12, v12, v174
    v_add_f32 v13, v13, v175
    v_add_f32 v12, v12, v176
    v_add_f32 v13, v13, v177
    s_cmp_eq_u32 s19, 0
    s_cbranch_scc1 APC_175
    buffer_load_dwordx4 v[32:35], v1, s[4:7], s25 offen offset:0 sc1
APC_175:
    v_mfma_f32_32x32x8_bf16 v[224:239], v[148:149], v[216:217], v[224:239]
    v_add_f32 v12, v12, v178
    v_add_f32 v13, v13, v179
    v_add_f32 v10, v12, v13
    v_add_f32 v12, v12, v13
    v_mfma_f32_32x32x8_bf16 v[240:255], v[150:151], v[216:217], v[240:255]
    s_cmp_eq_u32 s19, 0
    s_cbranch_scc1 APC_176
    buffer_load_dwordx4 v[36:39], v1, s[4:7], s25 offen offset:1024 sc1
APC_176:
    v_permlane32_swap_b32 v10, v12
    v_add_f32 v10, v10, v12
    v_rcp_f32 v10, v10
    s_add_u32 s17, s16, 4096
    s_cmp_eq_u32 s19, 0
    s_cbranch_scc1 APC_177
    buffer_load_dwordx4 v[40:43], v1, s[4:7], s25 offen offset:2048 sc1
APC_177:
    s_cmp_eq_u32 s19, 0
    s_cbranch_scc1 APC_178
    buffer_load_dwordx4 v[44:47], v1, s[4:7], s25 offen offset:3072 sc1
APC_178:
    s_cmp_eq_u32 s35, 0
    s_cbranch_scc1 BL_179
    v_pk_mul_f32 v[112:113], v[112:113], v[10:11] op_sel_hi:[1,0]
    v_pk_mul_f32 v[114:115], v[114:115], v[10:11] op_sel_hi:[1,0]
    v_pk_mul_f32 v[128:129], v[128:129], v[10:11] op_sel_hi:[1,0]
    v_pk_mul_f32 v[130:131], v[130:131], v[10:11] op_sel_hi:[1,0]
    v_cvt_pk_bf16_f32 v160, v112, v128
    v_cvt_pk_bf16_f32 v161, v113, v129
    v_cvt_pk_bf16_f32 v162, v114, v130
    v_cvt_pk_bf16_f32 v163, v115, v131
    buffer_store_dwordx4 v[160:163], v1, s[4:7], s16 offen offset:0
    v_pk_mul_f32 v[116:117], v[116:117], v[10:11] op_sel_hi:[1,0]
    v_pk_mul_f32 v[118:119], v[118:119], v[10:11] op_sel_hi:[1,0]
    v_pk_mul_f32 v[132:133], v[132:133], v[10:11] op_sel_hi:[1,0]
    v_pk_mul_f32 v[134:135], v[134:135], v[10:11] op_sel_hi:[1,0]
    v_cvt_pk_bf16_f32 v164, v116, v132
    v_cvt_pk_bf16_f32 v165, v117, v133
    v_cvt_pk_bf16_f32 v166, v118, v134
    v_cvt_pk_bf16_f32 v167, v119, v135
    buffer_store_dwordx4 v[164:167], v1, s[4:7], s16 offen offset:1024
    v_pk_mul_f32 v[120:121], v[120:121], v[10:11] op_sel_hi:[1,0]
    v_pk_mul_f32 v[122:123], v[122:123], v[10:11] op_sel_hi:[1,0]
    v_pk_mul_f32 v[136:137], v[136:137], v[10:11] op_sel_hi:[1,0]
    v_pk_mul_f32 v[138:139], v[138:139], v[10:11] op_sel_hi:[1,0]
    v_cvt_pk_bf16_f32 v168, v120, v136
    v_cvt_pk_bf16_f32 v169, v121, v137
    v_cvt_pk_bf16_f32 v170, v122, v138
    v_cvt_pk_bf16_f32 v171, v123, v139
    buffer_store_dwordx4 v[168:171], v1, s[4:7], s16 offen offset:2048
    v_pk_mul_f32 v[124:125], v[124:125], v[10:11] op_sel_hi:[1,0]
    v_pk_mul_f32 v[126:127], v[126:127], v[10:11] op_sel_hi:[1,0]
    v_pk_mul_f32 v[140:141], v[140:141], v[10:11] op_sel_hi:[1,0]
    v_pk_mul_f32 v[142:143], v[142:143], v[10:11] op_sel_hi:[1,0]
    v_cvt_pk_bf16_f32 v172, v124, v140
    v_cvt_pk_bf16_f32 v173, v125, v141
    v_cvt_pk_bf16_f32 v174, v126, v142
    v_cvt_pk_bf16_f32 v175, v127, v143
    buffer_store_dwordx4 v[172:175], v1, s[4:7], s16 offen offset:3072
    v_pk_mul_f32 v[224:225], v[224:225], v[10:11] op_sel_hi:[1,0]
    v_pk_mul_f32 v[226:227], v[226:227], v[10:11] op_sel_hi:[1,0]
    v_pk_mul_f32 v[240:241], v[240:241], v[10:11] op_sel_hi:[1,0]
    v_pk_mul_f32 v[242:243], v[242:243], v[10:11] op_sel_hi:[1,0]
    v_cvt_pk_bf16_f32 v176, v224, v240
    v_cvt_pk_bf16_f32 v177, v225, v241
    v_cvt_pk_bf16_f32 v178, v226, v242
    v_cvt_pk_bf16_f32 v179, v227, v243
    buffer_store_dwordx4 v[176:179], v1, s[4:7], s17 offen offset:0
    v_pk_mul_f32 v[228:229], v[228:229], v[10:11] op_sel_hi:[1,0]
    v_pk_mul_f32 v[230:231], v[230:231], v[10:11] op_sel_hi:[1,0]
    v_pk_mul_f32 v[244:245], v[244:245], v[10:11] op_sel_hi:[1,0]
    v_pk_mul_f32 v[246:247], v[246:247], v[10:11] op_sel_hi:[1,0]
    v_cvt_pk_bf16_f32 v180, v228, v244
    v_cvt_pk_bf16_f32 v181, v229, v245
    v_cvt_pk_bf16_f32 v182, v230, v246
    v_cvt_pk_bf16_f32 v183, v231, v247
    buffer_store_dwordx4 v[180:183], v1, s[4:7], s17 offen offset:1024
    v_pk_mul_f32 v[232:233], v[232:233], v[10:11] op_sel_hi:[1,0]
    v_pk_mul_f32 v[234:235], v[234:235], v[10:11] op_sel_hi:[1,0]
    v_pk_mul_f32 v[248:249], v[248:249], v[10:11] op_sel_hi:[1,0]
    v_pk_mul_f32 v[250:251], v[250:251], v[10:11] op_sel_hi:[1,0]
    v_cvt_pk_bf16_f32 v184, v232, v248
    v_cvt_pk_bf16_f32 v185, v233, v249
    v_cvt_pk_bf16_f32 v186, v234, v250
    v_cvt_pk_bf16_f32 v187, v235, v251
    buffer_store_dwordx4 v[184:187], v1, s[4:7], s17 offen offset:2048
    v_pk_mul_f32 v[236:237], v[236:237], v[10:11] op_sel_hi:[1,0]
    v_pk_mul_f32 v[238:239], v[238:239], v[10:11] op_sel_hi:[1,0]
    v_pk_mul_f32 v[252:253], v[252:253], v[10:11] op_sel_hi:[1,0]
    v_pk_mul_f32 v[254:255], v[254:255], v[10:11] op_sel_hi:[1,0]
    v_cvt_pk_bf16_f32 v188, v236, v252
    v_cvt_pk_bf16_f32 v189, v237, v253
    v_cvt_pk_bf16_f32 v190, v238, v254
    v_cvt_pk_bf16_f32 v191, v239, v255
    buffer_store_dwordx4 v[188:191], v1, s[4:7], s17 offen offset:3072
    s_branch BL_180
BL_179:
    v_pk_mul_f32 v[112:113], v[112:113], v[10:11] op_sel_hi:[1,0]
    v_pk_mul_f32 v[114:115], v[114:115], v[10:11] op_sel_hi:[1,0]
    v_pk_mul_f32 v[128:129], v[128:129], v[10:11] op_sel_hi:[1,0]
    v_pk_mul_f32 v[130:131], v[130:131], v[10:11] op_sel_hi:[1,0]
    v_cvt_pk_bf16_f32 v160, v112, v128
    v_cvt_pk_bf16_f32 v161, v113, v129
    v_cvt_pk_bf16_f32 v162, v114, v130
    v_cvt_pk_bf16_f32 v163, v115, v131
    buffer_store_dwordx4 v[160:163], v1, s[4:7], s16 offen offset:0 sc1
    v_pk_mul_f32 v[116:117], v[116:117], v[10:11] op_sel_hi:[1,0]
    v_pk_mul_f32 v[118:119], v[118:119], v[10:11] op_sel_hi:[1,0]
    v_pk_mul_f32 v[132:133], v[132:133], v[10:11] op_sel_hi:[1,0]
    v_pk_mul_f32 v[134:135], v[134:135], v[10:11] op_sel_hi:[1,0]
    v_cvt_pk_bf16_f32 v164, v116, v132
    v_cvt_pk_bf16_f32 v165, v117, v133
    v_cvt_pk_bf16_f32 v166, v118, v134
    v_cvt_pk_bf16_f32 v167, v119, v135
    buffer_store_dwordx4 v[164:167], v1, s[4:7], s16 offen offset:1024 sc1
    v_pk_mul_f32 v[120:121], v[120:121], v[10:11] op_sel_hi:[1,0]
    v_pk_mul_f32 v[122:123], v[122:123], v[10:11] op_sel_hi:[1,0]
    v_pk_mul_f32 v[136:137], v[136:137], v[10:11] op_sel_hi:[1,0]
    v_pk_mul_f32 v[138:139], v[138:139], v[10:11] op_sel_hi:[1,0]
    v_cvt_pk_bf16_f32 v168, v120, v136
    v_cvt_pk_bf16_f32 v169, v121, v137
    v_cvt_pk_bf16_f32 v170, v122, v138
    v_cvt_pk_bf16_f32 v171, v123, v139
    buffer_store_dwordx4 v[168:171], v1, s[4:7], s16 offen offset:2048 sc1
    v_pk_mul_f32 v[124:125], v[124:125], v[10:11] op_sel_hi:[1,0]
    v_pk_mul_f32 v[126:127], v[126:127], v[10:11] op_sel_hi:[1,0]
    v_pk_mul_f32 v[140:141], v[140:141], v[10:11] op_sel_hi:[1,0]
    v_pk_mul_f32 v[142:143], v[142:143], v[10:11] op_sel_hi:[1,0]
    v_cvt_pk_bf16_f32 v172, v124, v140
    v_cvt_pk_bf16_f32 v173, v125, v141
    v_cvt_pk_bf16_f32 v174, v126, v142
    v_cvt_pk_bf16_f32 v175, v127, v143
    buffer_store_dwordx4 v[172:175], v1, s[4:7], s16 offen offset:3072 sc1
    v_pk_mul_f32 v[224:225], v[224:225], v[10:11] op_sel_hi:[1,0]
    v_pk_mul_f32 v[226:227], v[226:227], v[10:11] op_sel_hi:[1,0]
    v_pk_mul_f32 v[240:241], v[240:241], v[10:11] op_sel_hi:[1,0]
    v_pk_mul_f32 v[242:243], v[242:243], v[10:11] op_sel_hi:[1,0]
    v_cvt_pk_bf16_f32 v176, v224, v240
    v_cvt_pk_bf16_f32 v177, v225, v241
    v_cvt_pk_bf16_f32 v178, v226, v242
    v_cvt_pk_bf16_f32 v179, v227, v243
    buffer_store_dwordx4 v[176:179], v1, s[4:7], s17 offen offset:0 sc1
    v_pk_mul_f32 v[228:229], v[228:229], v[10:11] op_sel_hi:[1,0]
    v_pk_mul_f32 v[230:231], v[230:231], v[10:11] op_sel_hi:[1,0]
    v_pk_mul_f32 v[244:245], v[244:245], v[10:11] op_sel_hi:[1,0]
    v_pk_mul_f32 v[246:247], v[246:247], v[10:11] op_sel_hi:[1,0]
    v_cvt_pk_bf16_f32 v180, v228, v244
    v_cvt_pk_bf16_f32 v181, v229, v245
    v_cvt_pk_bf16_f32 v182, v230, v246
    v_cvt_pk_bf16_f32 v183, v231, v247
    buffer_store_dwordx4 v[180:183], v1, s[4:7], s17 offen offset:1024 sc1
    v_pk_mul_f32 v[232:233], v[232:233], v[10:11] op_sel_hi:[1,0]
    v_pk_mul_f32 v[234:235], v[234:235], v[10:11] op_sel_hi:[1,0]
    v_pk_mul_f32 v[248:249], v[248:249], v[10:11] op_sel_hi:[1,0]
    v_pk_mul_f32 v[250:251], v[250:251], v[10:11] op_sel_hi:[1,0]
    v_cvt_pk_bf16_f32 v184, v232, v248
    v_cvt_pk_bf16_f32 v185, v233, v249
    v_cvt_pk_bf16_f32 v186, v234, v250
    v_cvt_pk_bf16_f32 v187, v235, v251
    buffer_store_dwordx4 v[184:187], v1, s[4:7], s17 offen offset:2048 sc1
    v_pk_mul_f32 v[236:237], v[236:237], v[10:11] op_sel_hi:[1,0]
    v_pk_mul_f32 v[238:239], v[238:239], v[10:11] op_sel_hi:[1,0]
    v_pk_mul_f32 v[252:253], v[252:253], v[10:11] op_sel_hi:[1,0]
    v_pk_mul_f32 v[254:255], v[254:255], v[10:11] op_sel_hi:[1,0]
    v_cvt_pk_bf16_f32 v188, v236, v252
    v_cvt_pk_bf16_f32 v189, v237, v253
    v_cvt_pk_bf16_f32 v190, v238, v254
    v_cvt_pk_bf16_f32 v191, v239, v255
    buffer_store_dwordx4 v[188:191], v1, s[4:7], s17 offen offset:3072 sc1
BL_180:
    s_cmp_eq_u32 s19, 0
    s_cbranch_scc1 A_NP_181
    buffer_load_dwordx4 v[80:83], v1, s[4:7], s26 offen offset:0 sc1
    buffer_load_dwordx4 v[84:87], v1, s[4:7], s26 offen offset:1024 sc1
    buffer_load_dwordx4 v[88:91], v1, s[4:7], s26 offen offset:2048 sc1
    buffer_load_dwordx4 v[92:95], v1, s[4:7], s26 offen offset:3072 sc1
    buffer_load_dwordx4 v[96:99], v1, s[4:7], s27 offen offset:0 sc1
    buffer_load_dwordx4 v[100:103], v1, s[4:7], s27 offen offset:1024 sc1
    buffer_load_dwordx4 v[104:107], v1, s[4:7], s27 offen offset:2048 sc1
    buffer_load_dwordx4 v[108:111], v1, s[4:7], s27 offen offset:3072 sc1
A_NP_181:
    s_add_u32 s15, s15, 131072
    s_mov_b32 s30, s31
    s_mov_b32 s28, 1
    s_mov_b32 s29, s18
    v_add_u32 v2, 64, v2
    s_add_u32 s16, s16, 262144
    s_add_u32 s18, s18, 512
    s_add_u32 s10, s10, 1
    s_cmp_lt_u32 s10, 64
    s_cbranch_scc1 A_ITEM_148
    s_waitcnt vmcnt(0)
    s_cmp_eq_u32 s28, 0
    s_cbranch_scc1 AF_182
    s_mov_b64 exec, 1
    s_cmp_eq_u32 s35, 0
    s_cbranch_scc1 BL_183
    buffer_store_dword v7, off, s[4:7], s29
    s_branch BL_184
BL_183:
    buffer_store_dword v7, off, s[4:7], s29 sc1
BL_184:
    s_mov_b32 s28, 0
AF_182:
    s_endpgm
A_AUX:
    s_and_b32 s9, s8, 3
    s_lshr_b32 s8, s8, 2
    s_cmp_ge_u32 s8, 2
    s_cbranch_scc1 F_AT
    s_lshl_b32 s10, s11, 1
    s_add_u32 s8, s8, s10
    s_add_u32 s8, s8, 1
    s_cmp_ge_u32 s8, 4
    s_cbranch_scc1 F_AT
    v_lshlrev_b32 v1, 4, v0
    v_lshlrev_b32 v11, 2, v0
    s_mul_i32 s12, s8, 2621440
    s_mul_i32 s21, s9, 10240
    s_add_u32 s12, s12, s21
    s_add_u32 s12, s12, 116391936
    s_lshr_b32 s21, s8, 1
    s_mul_i32 s13, s21, 32768
    s_add_u32 s13, s13, 155254784
    s_cmp_eq_u32 s8, 2
    s_cselect_b32 s13, 155418624, s13
    s_lshl_b32 s21, s9, 7
    s_add_u32 s13, s13, s21
    s_lshl_b32 s16, s8, 16
    s_lshl_b32 s21, s9, 3
    s_add_u32 s16, s16, s21
    s_add_u32 s16, s16, 155975680
    s_mov_b32 s10, 0
ST_ITEM_185:
    s_mov_b32 s24, 0
    s_mov_b64 exec, 0x3ff
PL_186:
    buffer_load_dword v3, v11, s[4:7], s13 offen sc1
    s_waitcnt vmcnt(0)
    v_cmp_eq_u32 vcc, 0, v3
    s_cbranch_vccz PO_187
    s_sleep 2
    s_add_u32 s24, s24, 1
    s_cmp_lt_u32 s24, 200000
    s_cbranch_scc1 PL_186
    s_branch F_AT
PO_187:
    s_mov_b64 exec, -1
    s_add_u32 s21, s12, 0
    buffer_load_dwordx4 v[16:19], v1, s[4:7], s21 offen offset:0 sc1
    buffer_load_dwordx4 v[20:23], v1, s[4:7], s21 offen offset:1024 sc1
    buffer_load_dwordx4 v[24:27], v1, s[4:7], s21 offen offset:2048 sc1
    buffer_load_dwordx4 v[28:31], v1, s[4:7], s21 offen offset:3072 sc1
    s_add_u32 s21, s12, 4096
    buffer_load_dwordx4 v[32:35], v1, s[4:7], s21 offen offset:0 sc1
    buffer_load_dwordx4 v[36:39], v1, s[4:7], s21 offen offset:1024 sc1
    buffer_load_dwordx4 v[40:43], v1, s[4:7], s21 offen offset:2048 sc1
    buffer_load_dwordx4 v[44:47], v1, s[4:7], s21 offen offset:3072 sc1
    s_add_u32 s21, s12, 8192
    buffer_load_dwordx4 v[48:51], v1, s[4:7], s21 offen offset:0 sc1
    buffer_load_dwordx4 v[52:55], v1, s[4:7], s21 offen offset:1024 sc1
    v_mov_b32 v64, 0x3f803f80
    v_mov_b64 v[60:61], 0
    v_mov_b64 v[62:63], 0
    v_lshlrev_b32 v65, 5, v0
    s_waitcnt vmcnt(9)
    v_dot2_f32_bf16 v60, v16, v64, v60
    v_dot2_f32_bf16 v61, v16, v16, v61
    v_dot2_f32_bf16 v62, v17, v64, v62
    v_dot2_f32_bf16 v63, v17, v17, v63
    v_dot2_f32_bf16 v60, v18, v64, v60
    v_dot2_f32_bf16 v61, v18, v18, v61
    v_dot2_f32_bf16 v62, v19, v64, v62
    v_dot2_f32_bf16 v63, v19, v19, v63
    s_waitcnt vmcnt(8)
    v_dot2_f32_bf16 v60, v20, v64, v60
    v_dot2_f32_bf16 v61, v20, v20, v61
    v_dot2_f32_bf16 v62, v21, v64, v62
    v_dot2_f32_bf16 v63, v21, v21, v63
    v_dot2_f32_bf16 v60, v22, v64, v60
    v_dot2_f32_bf16 v61, v22, v22, v61
    v_dot2_f32_bf16 v62, v23, v64, v62
    v_dot2_f32_bf16 v63, v23, v23, v63
    s_waitcnt vmcnt(7)
    v_dot2_f32_bf16 v60, v24, v64, v60
    v_dot2_f32_bf16 v61, v24, v24, v61
    v_dot2_f32_bf16 v62, v25, v64, v62
    v_dot2_f32_bf16 v63, v25, v25, v63
    v_dot2_f32_bf16 v60, v26, v64, v60
    v_dot2_f32_bf16 v61, v26, v26, v61
    v_dot2_f32_bf16 v62, v27, v64, v62
    v_dot2_f32_bf16 v63, v27, v27, v63
    s_waitcnt vmcnt(6)
    v_dot2_f32_bf16 v60, v28, v64, v60
    v_dot2_f32_bf16 v61, v28, v28, v61
    v_dot2_f32_bf16 v62, v29, v64, v62
    v_dot2_f32_bf16 v63, v29, v29, v63
    v_dot2_f32_bf16 v60, v30, v64, v60
    v_dot2_f32_bf16 v61, v30, v30, v61
    v_dot2_f32_bf16 v62, v31, v64, v62
    v_dot2_f32_bf16 v63, v31, v31, v63
    s_waitcnt vmcnt(5)
    v_dot2_f32_bf16 v60, v32, v64, v60
    v_dot2_f32_bf16 v61, v32, v32, v61
    v_dot2_f32_bf16 v62, v33, v64, v62
    v_dot2_f32_bf16 v63, v33, v33, v63
    v_dot2_f32_bf16 v60, v34, v64, v60
    v_dot2_f32_bf16 v61, v34, v34, v61
    v_dot2_f32_bf16 v62, v35, v64, v62
    v_dot2_f32_bf16 v63, v35, v35, v63
    s_waitcnt vmcnt(4)
    v_dot2_f32_bf16 v60, v36, v64, v60
    v_dot2_f32_bf16 v61, v36, v36, v61
    v_dot2_f32_bf16 v62, v37, v64, v62
    v_dot2_f32_bf16 v63, v37, v37, v63
    v_dot2_f32_bf16 v60, v38, v64, v60
    v_dot2_f32_bf16 v61, v38, v38, v61
    v_dot2_f32_bf16 v62, v39, v64, v62
    v_dot2_f32_bf16 v63, v39, v39, v63
    s_waitcnt vmcnt(3)
    v_dot2_f32_bf16 v60, v40, v64, v60
    v_dot2_f32_bf16 v61, v40, v40, v61
    v_dot2_f32_bf16 v62, v41, v64, v62
    v_dot2_f32_bf16 v63, v41, v41, v63
    v_dot2_f32_bf16 v60, v42, v64, v60
    v_dot2_f32_bf16 v61, v42, v42, v61
    v_dot2_f32_bf16 v62, v43, v64, v62
    v_dot2_f32_bf16 v63, v43, v43, v63
    s_waitcnt vmcnt(2)
    v_dot2_f32_bf16 v60, v44, v64, v60
    v_dot2_f32_bf16 v61, v44, v44, v61
    v_dot2_f32_bf16 v62, v45, v64, v62
    v_dot2_f32_bf16 v63, v45, v45, v63
    v_dot2_f32_bf16 v60, v46, v64, v60
    v_dot2_f32_bf16 v61, v46, v46, v61
    v_dot2_f32_bf16 v62, v47, v64, v62
    v_dot2_f32_bf16 v63, v47, v47, v63
    s_waitcnt vmcnt(1)
    v_dot2_f32_bf16 v60, v48, v64, v60
    v_dot2_f32_bf16 v61, v48, v48, v61
    v_dot2_f32_bf16 v62, v49, v64, v62
    v_dot2_f32_bf16 v63, v49, v49, v63
    v_dot2_f32_bf16 v60, v50, v64, v60
    v_dot2_f32_bf16 v61, v50, v50, v61
    v_dot2_f32_bf16 v62, v51, v64, v62
    v_dot2_f32_bf16 v63, v51, v51, v63
    s_waitcnt vmcnt(0)
    v_dot2_f32_bf16 v60, v52, v64, v60
    v_dot2_f32_bf16 v61, v52, v52, v61
    v_dot2_f32_bf16 v62, v53, v64, v62
    v_dot2_f32_bf16 v63, v53, v53, v63
    v_dot2_f32_bf16 v60, v54, v64, v60
    v_dot2_f32_bf16 v61, v54, v54, v61
    v_dot2_f32_bf16 v62, v55, v64, v62
    v_dot2_f32_bf16 v63, v55, v55, v63
    s_nop 3
    v_pk_add_f32 v[60:61], v[60:61], v[62:63]
    v_mov_b64 v[62:63], v[60:61]
    s_nop 1
    v_permlane32_swap_b32 v60, v62
    v_permlane32_swap_b32 v61, v63
    v_pk_add_f32 v[60:61], v[60:61], v[62:63]
    v_or_b32 v61, 1, v61
    s_mov_b32 exec_hi, 0
    buffer_store_dwordx2 v[60:61], v65, s[4:7], s16 offen sc1
    s_mov_b32 exec_hi, -1
    s_add_u32 s12, s12, 40960
    s_add_u32 s13, s13, 512
    s_add_u32 s16, s16, 1024
    s_add_u32 s10, s10, 1
    s_cmp_lt_u32 s10, 64
    s_cbranch_scc1 ST_ITEM_185
    s_endpgm
F_AT:
    s_endpgm
.p2align 6
R_O:
    s_load_dwordx2 s[40:41], s[0:1], 80
    v_lshrrev_b32 v2, 6, v0
    v_and_b32 v0, 63, v0
    v_readfirstlane_b32 s9, v2
    v_lshlrev_b32 v1, 4, v0
    v_lshlrev_b32 v11, 2, v0
    v_mov_b32 v6, 1
    s_lshl_b32 s21, s9, 15
    s_add_u32 s21, s21, 32768
    v_add_u32 v3, s21, v1
    s_lshl_b32 s21, s9, 13
    v_add_u32 v4, s21, v1
    s_lshl_b32 s21, s9, 10
    v_add_u32 v5, s21, v1
    s_and_b32 s10, s8, 1
    s_lshr_b32 s27, s8, 1
    s_mul_i32 s12, s11, 16777216
    s_add_u32 s12, s12, 68157440
    s_mul_i32 s13, s11, 32768
    s_add_u32 s17, s13, 155254784
    s_add_u32 s13, s13, 155189248
    s_lshl_b32 s21, s9, 7
    s_add_u32 s13, s13, s21
    s_mov_b32 s14, 0xff
    s_mov_b32 s15, 0
    s_lshl_b32 s23, s11, 1
    s_mul_i32 s21, s9, 65536
    s_add_u32 s12, s12, s21
    s_mul_i32 s21, s10, 262144
    s_add_u32 s12, s12, s21
    s_lshl_b32 s21, s10, 9
    s_add_u32 s13, s13, s21
    s_add_u32 s17, s17, s21
    s_lshl_b32 s22, s27, 2
    s_add_u32 s22, s22, s9
    s_lshl_b32 s21, s22, 2
    s_add_u32 s17, s17, s21
    s_mul_i32 s21, s22, 26
    s_lshr_b32 s21, s21, 8
    s_mul_i32 s21, s21, 88
    s_add_u32 s17, s17, s21
    s_mul_i32 s18, s23, 2621440
    s_mul_i32 s21, s10, 40960
    s_add_u32 s18, s18, s21
    s_lshl_b32 s21, s22, 10
    s_add_u32 s18, s18, s21
    s_add_u32 s18, s18, 116391936
    s_add_u32 s16, s18, 2621440
    v_mov_b32 v2, v1
    s_mov_b32 s42, 2621440
    s_mov_b32 s43, 0x00020000
    s_waitcnt lgkmcnt(0)
    s_cmp_lg_u32 s23, 3
    s_cbranch_scc1 T2_WS_188
    v_and_b32 v12, 31, v0
    v_mul_u32_u24 v12, 1280, v12
    v_lshrrev_b32 v13, 5, v0
    v_lshl_add_u32 v2, v13, 4, v12
    s_lshl_b32 s16, s22, 5
    s_branch T2_G_189
T2_WS_188:
    s_mov_b32 s40, s4
    s_mov_b32 s41, s5
    s_mov_b32 s42, s6
T2_G_189:
    s_mov_b32 s32, s23
    s_load_dwordx2 s[88:89], s[0:1], 40
    s_mov_b32 s90, 5242880
    s_mov_b32 s91, 0x00020000
    s_mov_b32 s92, 0x05040100
    s_mov_b32 s93, 0x07060302
    s_waitcnt lgkmcnt(0)
    s_mul_i32 s26, s9, 1310720
    s_lshl_b32 s21, s27, 7
    s_add_u32 s26, s26, s21
    v_lshrrev_b32 v7, 5, v0
    v_mul_u32_u24 v7, 10240, v7
    v_and_b32 v10, 31, v0
    s_lshl_b32 s21, s9, 3
    v_xor_b32 v10, s21, v10
    v_lshl_add_u32 v7, v10, 2, v7
    v_add_u32 v48, 0, v7
    v_add_u32 v49, 1280, v7
    v_add_u32 v50, 2560, v7
    v_add_u32 v51, 3840, v7
    v_add_u32 v52, 5120, v7
    v_add_u32 v53, 6400, v7
    v_add_u32 v54, 7680, v7
    v_add_u32 v55, 8960, v7
    buffer_load_dword v64, v48, s[88:91], s26 offen offset:0
    buffer_load_dword v65, v49, s[88:91], s26 offen offset:0
    buffer_load_dword v66, v50, s[88:91], s26 offen offset:0
    buffer_load_dword v67, v51, s[88:91], s26 offen offset:0
    buffer_load_dword v68, v52, s[88:91], s26 offen offset:0
    buffer_load_dword v69, v53, s[88:91], s26 offen offset:0
    buffer_load_dword v70, v54, s[88:91], s26 offen offset:0
    buffer_load_dword v71, v55, s[88:91], s26 offen offset:0
    s_add_u32 s26, s26, 20480
    buffer_load_dword v72, v48, s[88:91], s26 offen offset:0
    buffer_load_dword v73, v49, s[88:91], s26 offen offset:0
    buffer_load_dword v74, v50, s[88:91], s26 offen offset:0
    buffer_load_dword v75, v51, s[88:91], s26 offen offset:0
    buffer_load_dword v76, v52, s[88:91], s26 offen offset:0
    buffer_load_dword v77, v53, s[88:91], s26 offen offset:0
    buffer_load_dword v78, v54, s[88:91], s26 offen offset:0
    buffer_load_dword v79, v55, s[88:91], s26 offen offset:0
    s_add_u32 s26, s26, 20480
    buffer_load_dword v80, v48, s[88:91], s26 offen offset:0
    buffer_load_dword v81, v49, s[88:91], s26 offen offset:0
    buffer_load_dword v82, v50, s[88:91], s26 offen offset:0
    buffer_load_dword v83, v51, s[88:91], s26 offen offset:0
    buffer_load_dword v84, v52, s[88:91], s26 offen offset:0
    buffer_load_dword v85, v53, s[88:91], s26 offen offset:0
    buffer_load_dword v86, v54, s[88:91], s26 offen offset:0
    buffer_load_dword v87, v55, s[88:91], s26 offen offset:0
    s_add_u32 s26, s26, 20480
    buffer_load_dword v88, v48, s[88:91], s26 offen offset:0
    buffer_load_dword v89, v49, s[88:91], s26 offen offset:0
    buffer_load_dword v90, v50, s[88:91], s26 offen offset:0
    buffer_load_dword v91, v51, s[88:91], s26 offen offset:0
    buffer_load_dword v92, v52, s[88:91], s26 offen offset:0
    buffer_load_dword v93, v53, s[88:91], s26 offen offset:0
    buffer_load_dword v94, v54, s[88:91], s26 offen offset:0
    buffer_load_dword v95, v55, s[88:91], s26 offen offset:0
    s_add_u32 s26, s26, 20480
    buffer_load_dword v96, v48, s[88:91], s26 offen offset:0
    buffer_load_dword v97, v49, s[88:91], s26 offen offset:0
    buffer_load_dword v98, v50, s[88:91], s26 offen offset:0
    buffer_load_dword v99, v51, s[88:91], s26 offen offset:0
    buffer_load_dword v100, v52, s[88:91], s26 offen offset:0
    buffer_load_dword v101, v53, s[88:91], s26 offen offset:0
    buffer_load_dword v102, v54, s[88:91], s26 offen offset:0
    buffer_load_dword v103, v55, s[88:91], s26 offen offset:0
    s_add_u32 s26, s26, 20480
    buffer_load_dword v104, v48, s[88:91], s26 offen offset:0
    buffer_load_dword v105, v49, s[88:91], s26 offen offset:0
    buffer_load_dword v106, v50, s[88:91], s26 offen offset:0
    buffer_load_dword v107, v51, s[88:91], s26 offen offset:0
    buffer_load_dword v108, v52, s[88:91], s26 offen offset:0
    buffer_load_dword v109, v53, s[88:91], s26 offen offset:0
    buffer_load_dword v110, v54, s[88:91], s26 offen offset:0
    buffer_load_dword v111, v55, s[88:91], s26 offen offset:0
    s_add_u32 s26, s26, 20480
    buffer_load_dword v112, v48, s[88:91], s26 offen offset:0
    buffer_load_dword v113, v49, s[88:91], s26 offen offset:0
    buffer_load_dword v114, v50, s[88:91], s26 offen offset:0
    buffer_load_dword v115, v51, s[88:91], s26 offen offset:0
    buffer_load_dword v116, v52, s[88:91], s26 offen offset:0
    buffer_load_dword v117, v53, s[88:91], s26 offen offset:0
    buffer_load_dword v118, v54, s[88:91], s26 offen offset:0
    buffer_load_dword v119, v55, s[88:91], s26 offen offset:0
    s_add_u32 s26, s26, 20480
    s_waitcnt vmcnt(48)
    v_perm_b32 v56, v65, v64, s92
    v_perm_b32 v57, v67, v66, s92
    v_perm_b32 v58, v69, v68, s92
    v_perm_b32 v59, v71, v70, s92
    v_accvgpr_write_b32 a0, v56
    v_accvgpr_write_b32 a1, v57
    v_accvgpr_write_b32 a2, v58
    v_accvgpr_write_b32 a3, v59
    v_perm_b32 v60, v65, v64, s93
    v_perm_b32 v61, v67, v66, s93
    v_perm_b32 v62, v69, v68, s93
    v_perm_b32 v63, v71, v70, s93
    v_accvgpr_write_b32 a4, v60
    v_accvgpr_write_b32 a5, v61
    v_accvgpr_write_b32 a6, v62
    v_accvgpr_write_b32 a7, v63
    buffer_load_dword v64, v48, s[88:91], s26 offen offset:0
    buffer_load_dword v65, v49, s[88:91], s26 offen offset:0
    buffer_load_dword v66, v50, s[88:91], s26 offen offset:0
    buffer_load_dword v67, v51, s[88:91], s26 offen offset:0
    buffer_load_dword v68, v52, s[88:91], s26 offen offset:0
    buffer_load_dword v69, v53, s[88:91], s26 offen offset:0
    buffer_load_dword v70, v54, s[88:91], s26 offen offset:0
    buffer_load_dword v71, v55, s[88:91], s26 offen offset:0
    s_add_u32 s26, s26, 20480
    s_waitcnt vmcnt(48)
    v_perm_b32 v56, v73, v72, s92
    v_perm_b32 v57, v75, v74, s92
    v_perm_b32 v58, v77, v76, s92
    v_perm_b32 v59, v79, v78, s92
    v_accvgpr_write_b32 a8, v56
    v_accvgpr_write_b32 a9, v57
    v_accvgpr_write_b32 a10, v58
    v_accvgpr_write_b32 a11, v59
    v_perm_b32 v60, v73, v72, s93
    v_perm_b32 v61, v75, v74, s93
    v_perm_b32 v62, v77, v76, s93
    v_perm_b32 v63, v79, v78, s93
    v_accvgpr_write_b32 a12, v60
    v_accvgpr_write_b32 a13, v61
    v_accvgpr_write_b32 a14, v62
    v_accvgpr_write_b32 a15, v63
    buffer_load_dword v72, v48, s[88:91], s26 offen offset:0
    buffer_load_dword v73, v49, s[88:91], s26 offen offset:0
    buffer_load_dword v74, v50, s[88:91], s26 offen offset:0
    buffer_load_dword v75, v51, s[88:91], s26 offen offset:0
    buffer_load_dword v76, v52, s[88:91], s26 offen offset:0
    buffer_load_dword v77, v53, s[88:91], s26 offen offset:0
    buffer_load_dword v78, v54, s[88:91], s26 offen offset:0
    buffer_load_dword v79, v55, s[88:91], s26 offen offset:0
    s_add_u32 s26, s26, 20480
    s_waitcnt vmcnt(48)
    v_perm_b32 v56, v81, v80, s92
    v_perm_b32 v57, v83, v82, s92
    v_perm_b32 v58, v85, v84, s92
    v_perm_b32 v59, v87, v86, s92
    v_accvgpr_write_b32 a16, v56
    v_accvgpr_write_b32 a17, v57
    v_accvgpr_write_b32 a18, v58
    v_accvgpr_write_b32 a19, v59
    v_perm_b32 v60, v81, v80, s93
    v_perm_b32 v61, v83, v82, s93
    v_perm_b32 v62, v85, v84, s93
    v_perm_b32 v63, v87, v86, s93
    v_accvgpr_write_b32 a20, v60
    v_accvgpr_write_b32 a21, v61
    v_accvgpr_write_b32 a22, v62
    v_accvgpr_write_b32 a23, v63
    buffer_load_dword v80, v48, s[88:91], s26 offen offset:0
    buffer_load_dword v81, v49, s[88:91], s26 offen offset:0
    buffer_load_dword v82, v50, s[88:91], s26 offen offset:0
    buffer_load_dword v83, v51, s[88:91], s26 offen offset:0
    buffer_load_dword v84, v52, s[88:91], s26 offen offset:0
    buffer_load_dword v85, v53, s[88:91], s26 offen offset:0
    buffer_load_dword v86, v54, s[88:91], s26 offen offset:0
    buffer_load_dword v87, v55, s[88:91], s26 offen offset:0
    s_add_u32 s26, s26, 20480
    s_waitcnt vmcnt(48)
    v_perm_b32 v56, v89, v88, s92
    v_perm_b32 v57, v91, v90, s92
    v_perm_b32 v58, v93, v92, s92
    v_perm_b32 v59, v95, v94, s92
    ds_write_b128 v3, v[56:59] offset:0
    v_perm_b32 v60, v89, v88, s93
    v_perm_b32 v61, v91, v90, s93
    v_perm_b32 v62, v93, v92, s93
    v_perm_b32 v63, v95, v94, s93
    ds_write_b128 v3, v[60:63] offset:1024
    buffer_load_dword v88, v48, s[88:91], s26 offen offset:0
    buffer_load_dword v89, v49, s[88:91], s26 offen offset:0
    buffer_load_dword v90, v50, s[88:91], s26 offen offset:0
    buffer_load_dword v91, v51, s[88:91], s26 offen offset:0
    buffer_load_dword v92, v52, s[88:91], s26 offen offset:0
    buffer_load_dword v93, v53, s[88:91], s26 offen offset:0
    buffer_load_dword v94, v54, s[88:91], s26 offen offset:0
    buffer_load_dword v95, v55, s[88:91], s26 offen offset:0
    s_add_u32 s26, s26, 20480
    s_waitcnt vmcnt(48)
    v_perm_b32 v56, v97, v96, s92
    v_perm_b32 v57, v99, v98, s92
    v_perm_b32 v58, v101, v100, s92
    v_perm_b32 v59, v103, v102, s92
    v_accvgpr_write_b32 a24, v56
    v_accvgpr_write_b32 a25, v57
    v_accvgpr_write_b32 a26, v58
    v_accvgpr_write_b32 a27, v59
    v_perm_b32 v60, v97, v96, s93
    v_perm_b32 v61, v99, v98, s93
    v_perm_b32 v62, v101, v100, s93
    v_perm_b32 v63, v103, v102, s93
    v_accvgpr_write_b32 a28, v60
    v_accvgpr_write_b32 a29, v61
    v_accvgpr_write_b32 a30, v62
    v_accvgpr_write_b32 a31, v63
    buffer_load_dword v96, v48, s[88:91], s26 offen offset:0
    buffer_load_dword v97, v49, s[88:91], s26 offen offset:0
    buffer_load_dword v98, v50, s[88:91], s26 offen offset:0
    buffer_load_dword v99, v51, s[88:91], s26 offen offset:0
    buffer_load_dword v100, v52, s[88:91], s26 offen offset:0
    buffer_load_dword v101, v53, s[88:91], s26 offen offset:0
    buffer_load_dword v102, v54, s[88:91], s26 offen offset:0
    buffer_load_dword v103, v55, s[88:91], s26 offen offset:0
    s_add_u32 s26, s26, 20480
    s_waitcnt vmcnt(48)
    v_perm_b32 v56, v105, v104, s92
    v_perm_b32 v57, v107, v106, s92
    v_perm_b32 v58, v109, v108, s92
    v_perm_b32 v59, v111, v110, s92
    v_accvgpr_write_b32 a32, v56
    v_accvgpr_write_b32 a33, v57
    v_accvgpr_write_b32 a34, v58
    v_accvgpr_write_b32 a35, v59
    v_perm_b32 v60, v105, v104, s93
    v_perm_b32 v61, v107, v106, s93
    v_perm_b32 v62, v109, v108, s93
    v_perm_b32 v63, v111, v110, s93
    v_accvgpr_write_b32 a36, v60
    v_accvgpr_write_b32 a37, v61
    v_accvgpr_write_b32 a38, v62
    v_accvgpr_write_b32 a39, v63
    buffer_load_dword v104, v48, s[88:91], s26 offen offset:0
    buffer_load_dword v105, v49, s[88:91], s26 offen offset:0
    buffer_load_dword v106, v50, s[88:91], s26 offen offset:0
    buffer_load_dword v107, v51, s[88:91], s26 offen offset:0
    buffer_load_dword v108, v52, s[88:91], s26 offen offset:0
    buffer_load_dword v109, v53, s[88:91], s26 offen offset:0
    buffer_load_dword v110, v54, s[88:91], s26 offen offset:0
    buffer_load_dword v111, v55, s[88:91], s26 offen offset:0
    s_add_u32 s26, s26, 20480
    s_waitcnt vmcnt(48)
    v_perm_b32 v56, v113, v112, s92
    v_perm_b32 v57, v115, v114, s92
    v_perm_b32 v58, v117, v116, s92
    v_perm_b32 v59, v119, v118, s92
    v_accvgpr_write_b32 a40, v56
    v_accvgpr_write_b32 a41, v57
    v_accvgpr_write_b32 a42, v58
    v_accvgpr_write_b32 a43, v59
    v_perm_b32 v60, v113, v112, s93
    v_perm_b32 v61, v115, v114, s93
    v_perm_b32 v62, v117, v116, s93
    v_perm_b32 v63, v119, v118, s93
    v_accvgpr_write_b32 a44, v60
    v_accvgpr_write_b32 a45, v61
    v_accvgpr_write_b32 a46, v62
    v_accvgpr_write_b32 a47, v63
    buffer_load_dword v112, v48, s[88:91], s26 offen offset:0
    buffer_load_dword v113, v49, s[88:91], s26 offen offset:0
    buffer_load_dword v114, v50, s[88:91], s26 offen offset:0
    buffer_load_dword v115, v51, s[88:91], s26 offen offset:0
    buffer_load_dword v116, v52, s[88:91], s26 offen offset:0
    buffer_load_dword v117, v53, s[88:91], s26 offen offset:0
    buffer_load_dword v118, v54, s[88:91], s26 offen offset:0
    buffer_load_dword v119, v55, s[88:91], s26 offen offset:0
    s_add_u32 s26, s26, 20480
    s_waitcnt vmcnt(48)
    v_perm_b32 v56, v65, v64, s92
    v_perm_b32 v57, v67, v66, s92
    v_perm_b32 v58, v69, v68, s92
    v_perm_b32 v59, v71, v70, s92
    ds_write_b128 v3, v[56:59] offset:2048
    v_perm_b32 v60, v65, v64, s93
    v_perm_b32 v61, v67, v66, s93
    v_perm_b32 v62, v69, v68, s93
    v_perm_b32 v63, v71, v70, s93
    ds_write_b128 v3, v[60:63] offset:3072
    buffer_load_dword v64, v48, s[88:91], s26 offen offset:0
    buffer_load_dword v65, v49, s[88:91], s26 offen offset:0
    buffer_load_dword v66, v50, s[88:91], s26 offen offset:0
    buffer_load_dword v67, v51, s[88:91], s26 offen offset:0
    buffer_load_dword v68, v52, s[88:91], s26 offen offset:0
    buffer_load_dword v69, v53, s[88:91], s26 offen offset:0
    buffer_load_dword v70, v54, s[88:91], s26 offen offset:0
    buffer_load_dword v71, v55, s[88:91], s26 offen offset:0
    s_add_u32 s26, s26, 20480
    s_waitcnt vmcnt(48)
    v_perm_b32 v56, v73, v72, s92
    v_perm_b32 v57, v75, v74, s92
    v_perm_b32 v58, v77, v76, s92
    v_perm_b32 v59, v79, v78, s92
    v_accvgpr_write_b32 a48, v56
    v_accvgpr_write_b32 a49, v57
    v_accvgpr_write_b32 a50, v58
    v_accvgpr_write_b32 a51, v59
    v_perm_b32 v60, v73, v72, s93
    v_perm_b32 v61, v75, v74, s93
    v_perm_b32 v62, v77, v76, s93
    v_perm_b32 v63, v79, v78, s93
    v_accvgpr_write_b32 a52, v60
    v_accvgpr_write_b32 a53, v61
    v_accvgpr_write_b32 a54, v62
    v_accvgpr_write_b32 a55, v63
    buffer_load_dword v72, v48, s[88:91], s26 offen offset:0
    buffer_load_dword v73, v49, s[88:91], s26 offen offset:0
    buffer_load_dword v74, v50, s[88:91], s26 offen offset:0
    buffer_load_dword v75, v51, s[88:91], s26 offen offset:0
    buffer_load_dword v76, v52, s[88:91], s26 offen offset:0
    buffer_load_dword v77, v53, s[88:91], s26 offen offset:0
    buffer_load_dword v78, v54, s[88:91], s26 offen offset:0
    buffer_load_dword v79, v55, s[88:91], s26 offen offset:0
    s_add_u32 s26, s26, 20480
    s_waitcnt vmcnt(48)
    v_perm_b32 v56, v81, v80, s92
    v_perm_b32 v57, v83, v82, s92
    v_perm_b32 v58, v85, v84, s92
    v_perm_b32 v59, v87, v86, s92
    v_accvgpr_write_b32 a56, v56
    v_accvgpr_write_b32 a57, v57
    v_accvgpr_write_b32 a58, v58
    v_accvgpr_write_b32 a59, v59
    v_perm_b32 v60, v81, v80, s93
    v_perm_b32 v61, v83, v82, s93
    v_perm_b32 v62, v85, v84, s93
    v_perm_b32 v63, v87, v86, s93
    v_accvgpr_write_b32 a60, v60
    v_accvgpr_write_b32 a61, v61
    v_accvgpr_write_b32 a62, v62
    v_accvgpr_write_b32 a63, v63
    buffer_load_dword v80, v48, s[88:91], s26 offen offset:0
    buffer_load_dword v81, v49, s[88:91], s26 offen offset:0
    buffer_load_dword v82, v50, s[88:91], s26 offen offset:0
    buffer_load_dword v83, v51, s[88:91], s26 offen offset:0
    buffer_load_dword v84, v52, s[88:91], s26 offen offset:0
    buffer_load_dword v85, v53, s[88:91], s26 offen offset:0
    buffer_load_dword v86, v54, s[88:91], s26 offen offset:0
    buffer_load_dword v87, v55, s[88:91], s26 offen offset:0
    s_add_u32 s26, s26, 20480
    s_waitcnt vmcnt(48)
    v_perm_b32 v56, v89, v88, s92
    v_perm_b32 v57, v91, v90, s92
    v_perm_b32 v58, v93, v92, s92
    v_perm_b32 v59, v95, v94, s92
    v_accvgpr_write_b32 a64, v56
    v_accvgpr_write_b32 a65, v57
    v_accvgpr_write_b32 a66, v58
    v_accvgpr_write_b32 a67, v59
    v_perm_b32 v60, v89, v88, s93
    v_perm_b32 v61, v91, v90, s93
    v_perm_b32 v62, v93, v92, s93
    v_perm_b32 v63, v95, v94, s93
    v_accvgpr_write_b32 a68, v60
    v_accvgpr_write_b32 a69, v61
    v_accvgpr_write_b32 a70, v62
    v_accvgpr_write_b32 a71, v63
    buffer_load_dword v88, v48, s[88:91], s26 offen offset:0
    buffer_load_dword v89, v49, s[88:91], s26 offen offset:0
    buffer_load_dword v90, v50, s[88:91], s26 offen offset:0
    buffer_load_dword v91, v51, s[88:91], s26 offen offset:0
    buffer_load_dword v92, v52, s[88:91], s26 offen offset:0
    buffer_load_dword v93, v53, s[88:91], s26 offen offset:0
    buffer_load_dword v94, v54, s[88:91], s26 offen offset:0
    buffer_load_dword v95, v55, s[88:91], s26 offen offset:0
    s_add_u32 s26, s26, 20480
    s_waitcnt vmcnt(48)
    v_perm_b32 v56, v97, v96, s92
    v_perm_b32 v57, v99, v98, s92
    v_perm_b32 v58, v101, v100, s92
    v_perm_b32 v59, v103, v102, s92
    ds_write_b128 v3, v[56:59] offset:4096
    v_perm_b32 v60, v97, v96, s93
    v_perm_b32 v61, v99, v98, s93
    v_perm_b32 v62, v101, v100, s93
    v_perm_b32 v63, v103, v102, s93
    ds_write_b128 v3, v[60:63] offset:5120
    buffer_load_dword v96, v48, s[88:91], s26 offen offset:0
    buffer_load_dword v97, v49, s[88:91], s26 offen offset:0
    buffer_load_dword v98, v50, s[88:91], s26 offen offset:0
    buffer_load_dword v99, v51, s[88:91], s26 offen offset:0
    buffer_load_dword v100, v52, s[88:91], s26 offen offset:0
    buffer_load_dword v101, v53, s[88:91], s26 offen offset:0
    buffer_load_dword v102, v54, s[88:91], s26 offen offset:0
    buffer_load_dword v103, v55, s[88:91], s26 offen offset:0
    s_add_u32 s26, s26, 20480
    s_waitcnt vmcnt(48)
    v_perm_b32 v56, v105, v104, s92
    v_perm_b32 v57, v107, v106, s92
    v_perm_b32 v58, v109, v108, s92
    v_perm_b32 v59, v111, v110, s92
    v_accvgpr_write_b32 a72, v56
    v_accvgpr_write_b32 a73, v57
    v_accvgpr_write_b32 a74, v58
    v_accvgpr_write_b32 a75, v59
    v_perm_b32 v60, v105, v104, s93
    v_perm_b32 v61, v107, v106, s93
    v_perm_b32 v62, v109, v108, s93
    v_perm_b32 v63, v111, v110, s93
    v_accvgpr_write_b32 a76, v60
    v_accvgpr_write_b32 a77, v61
    v_accvgpr_write_b32 a78, v62
    v_accvgpr_write_b32 a79, v63
    buffer_load_dword v104, v48, s[88:91], s26 offen offset:0
    buffer_load_dword v105, v49, s[88:91], s26 offen offset:0
    buffer_load_dword v106, v50, s[88:91], s26 offen offset:0
    buffer_load_dword v107, v51, s[88:91], s26 offen offset:0
    buffer_load_dword v108, v52, s[88:91], s26 offen offset:0
    buffer_load_dword v109, v53, s[88:91], s26 offen offset:0
    buffer_load_dword v110, v54, s[88:91], s26 offen offset:0
    buffer_load_dword v111, v55, s[88:91], s26 offen offset:0
    s_add_u32 s26, s26, 20480
    s_waitcnt vmcnt(48)
    v_perm_b32 v56, v113, v112, s92
    v_perm_b32 v57, v115, v114, s92
    v_perm_b32 v58, v117, v116, s92
    v_perm_b32 v59, v119, v118, s92
    v_accvgpr_write_b32 a80, v56
    v_accvgpr_write_b32 a81, v57
    v_accvgpr_write_b32 a82, v58
    v_accvgpr_write_b32 a83, v59
    v_perm_b32 v60, v113, v112, s93
    v_perm_b32 v61, v115, v114, s93
    v_perm_b32 v62, v117, v116, s93
    v_perm_b32 v63, v119, v118, s93
    v_accvgpr_write_b32 a84, v60
    v_accvgpr_write_b32 a85, v61
    v_accvgpr_write_b32 a86, v62
    v_accvgpr_write_b32 a87, v63
    buffer_load_dword v112, v48, s[88:91], s26 offen offset:0
    buffer_load_dword v113, v49, s[88:91], s26 offen offset:0
    buffer_load_dword v114, v50, s[88:91], s26 offen offset:0
    buffer_load_dword v115, v51, s[88:91], s26 offen offset:0
    buffer_load_dword v116, v52, s[88:91], s26 offen offset:0
    buffer_load_dword v117, v53, s[88:91], s26 offen offset:0
    buffer_load_dword v118, v54, s[88:91], s26 offen offset:0
    buffer_load_dword v119, v55, s[88:91], s26 offen offset:0
    s_add_u32 s26, s26, 20480
    s_waitcnt vmcnt(48)
    v_perm_b32 v56, v65, v64, s92
    v_perm_b32 v57, v67, v66, s92
    v_perm_b32 v58, v69, v68, s92
    v_perm_b32 v59, v71, v70, s92
    v_accvgpr_write_b32 a88, v56
    v_accvgpr_write_b32 a89, v57
    v_accvgpr_write_b32 a90, v58
    v_accvgpr_write_b32 a91, v59
    v_perm_b32 v60, v65, v64, s93
    v_perm_b32 v61, v67, v66, s93
    v_perm_b32 v62, v69, v68, s93
    v_perm_b32 v63, v71, v70, s93
    v_accvgpr_write_b32 a92, v60
    v_accvgpr_write_b32 a93, v61
    v_accvgpr_write_b32 a94, v62
    v_accvgpr_write_b32 a95, v63
    buffer_load_dword v64, v48, s[88:91], s26 offen offset:0
    buffer_load_dword v65, v49, s[88:91], s26 offen offset:0
    buffer_load_dword v66, v50, s[88:91], s26 offen offset:0
    buffer_load_dword v67, v51, s[88:91], s26 offen offset:0
    buffer_load_dword v68, v52, s[88:91], s26 offen offset:0
    buffer_load_dword v69, v53, s[88:91], s26 offen offset:0
    buffer_load_dword v70, v54, s[88:91], s26 offen offset:0
    buffer_load_dword v71, v55, s[88:91], s26 offen offset:0
    s_add_u32 s26, s26, 20480
    s_waitcnt vmcnt(48)
    v_perm_b32 v56, v73, v72, s92
    v_perm_b32 v57, v75, v74, s92
    v_perm_b32 v58, v77, v76, s92
    v_perm_b32 v59, v79, v78, s92
    ds_write_b128 v3, v[56:59] offset:6144
    v_perm_b32 v60, v73, v72, s93
    v_perm_b32 v61, v75, v74, s93
    v_perm_b32 v62, v77, v76, s93
    v_perm_b32 v63, v79, v78, s93
    ds_write_b128 v3, v[60:63] offset:7168
    buffer_load_dword v72, v48, s[88:91], s26 offen offset:0
    buffer_load_dword v73, v49, s[88:91], s26 offen offset:0
    buffer_load_dword v74, v50, s[88:91], s26 offen offset:0
    buffer_load_dword v75, v51, s[88:91], s26 offen offset:0
    buffer_load_dword v76, v52, s[88:91], s26 offen offset:0
    buffer_load_dword v77, v53, s[88:91], s26 offen offset:0
    buffer_load_dword v78, v54, s[88:91], s26 offen offset:0
    buffer_load_dword v79, v55, s[88:91], s26 offen offset:0
    s_add_u32 s26, s26, 20480
    s_waitcnt vmcnt(48)
    v_perm_b32 v56, v81, v80, s92
    v_perm_b32 v57, v83, v82, s92
    v_perm_b32 v58, v85, v84, s92
    v_perm_b32 v59, v87, v86, s92
    v_accvgpr_write_b32 a96, v56
    v_accvgpr_write_b32 a97, v57
    v_accvgpr_write_b32 a98, v58
    v_accvgpr_write_b32 a99, v59
    v_perm_b32 v60, v81, v80, s93
    v_perm_b32 v61, v83, v82, s93
    v_perm_b32 v62, v85, v84, s93
    v_perm_b32 v63, v87, v86, s93
    v_accvgpr_write_b32 a100, v60
    v_accvgpr_write_b32 a101, v61
    v_accvgpr_write_b32 a102, v62
    v_accvgpr_write_b32 a103, v63
    buffer_load_dword v80, v48, s[88:91], s26 offen offset:0
    buffer_load_dword v81, v49, s[88:91], s26 offen offset:0
    buffer_load_dword v82, v50, s[88:91], s26 offen offset:0
    buffer_load_dword v83, v51, s[88:91], s26 offen offset:0
    buffer_load_dword v84, v52, s[88:91], s26 offen offset:0
    buffer_load_dword v85, v53, s[88:91], s26 offen offset:0
    buffer_load_dword v86, v54, s[88:91], s26 offen offset:0
    buffer_load_dword v87, v55, s[88:91], s26 offen offset:0
    s_add_u32 s26, s26, 20480
    s_waitcnt vmcnt(48)
    v_perm_b32 v56, v89, v88, s92
    v_perm_b32 v57, v91, v90, s92
    v_perm_b32 v58, v93, v92, s92
    v_perm_b32 v59, v95, v94, s92
    v_accvgpr_write_b32 a104, v56
    v_accvgpr_write_b32 a105, v57
    v_accvgpr_write_b32 a106, v58
    v_accvgpr_write_b32 a107, v59
    v_perm_b32 v60, v89, v88, s93
    v_perm_b32 v61, v91, v90, s93
    v_perm_b32 v62, v93, v92, s93
    v_perm_b32 v63, v95, v94, s93
    v_accvgpr_write_b32 a108, v60
    v_accvgpr_write_b32 a109, v61
    v_accvgpr_write_b32 a110, v62
    v_accvgpr_write_b32 a111, v63
    buffer_load_dword v88, v48, s[88:91], s26 offen offset:0
    buffer_load_dword v89, v49, s[88:91], s26 offen offset:0
    buffer_load_dword v90, v50, s[88:91], s26 offen offset:0
    buffer_load_dword v91, v51, s[88:91], s26 offen offset:0
    buffer_load_dword v92, v52, s[88:91], s26 offen offset:0
    buffer_load_dword v93, v53, s[88:91], s26 offen offset:0
    buffer_load_dword v94, v54, s[88:91], s26 offen offset:0
    buffer_load_dword v95, v55, s[88:91], s26 offen offset:0
    s_add_u32 s26, s26, 20480
    s_waitcnt vmcnt(48)
    v_perm_b32 v56, v97, v96, s92
    v_perm_b32 v57, v99, v98, s92
    v_perm_b32 v58, v101, v100, s92
    v_perm_b32 v59, v103, v102, s92
    v_accvgpr_write_b32 a112, v56
    v_accvgpr_write_b32 a113, v57
    v_accvgpr_write_b32 a114, v58
    v_accvgpr_write_b32 a115, v59
    v_perm_b32 v60, v97, v96, s93
    v_perm_b32 v61, v99, v98, s93
    v_perm_b32 v62, v101, v100, s93
    v_perm_b32 v63, v103, v102, s93
    v_accvgpr_write_b32 a116, v60
    v_accvgpr_write_b32 a117, v61
    v_accvgpr_write_b32 a118, v62
    v_accvgpr_write_b32 a119, v63
    buffer_load_dword v96, v48, s[88:91], s26 offen offset:0
    buffer_load_dword v97, v49, s[88:91], s26 offen offset:0
    buffer_load_dword v98, v50, s[88:91], s26 offen offset:0
    buffer_load_dword v99, v51, s[88:91], s26 offen offset:0
    buffer_load_dword v100, v52, s[88:91], s26 offen offset:0
    buffer_load_dword v101, v53, s[88:91], s26 offen offset:0
    buffer_load_dword v102, v54, s[88:91], s26 offen offset:0
    buffer_load_dword v103, v55, s[88:91], s26 offen offset:0
    s_add_u32 s26, s26, 20480
    s_waitcnt vmcnt(48)
    v_perm_b32 v56, v105, v104, s92
    v_perm_b32 v57, v107, v106, s92
    v_perm_b32 v58, v109, v108, s92
    v_perm_b32 v59, v111, v110, s92
    ds_write_b128 v3, v[56:59] offset:8192
    v_perm_b32 v60, v105, v104, s93
    v_perm_b32 v61, v107, v106, s93
    v_perm_b32 v62, v109, v108, s93
    v_perm_b32 v63, v111, v110, s93
    ds_write_b128 v3, v[60:63] offset:9216
    buffer_load_dword v104, v48, s[88:91], s26 offen offset:0
    buffer_load_dword v105, v49, s[88:91], s26 offen offset:0
    buffer_load_dword v106, v50, s[88:91], s26 offen offset:0
    buffer_load_dword v107, v51, s[88:91], s26 offen offset:0
    buffer_load_dword v108, v52, s[88:91], s26 offen offset:0
    buffer_load_dword v109, v53, s[88:91], s26 offen offset:0
    buffer_load_dword v110, v54, s[88:91], s26 offen offset:0
    buffer_load_dword v111, v55, s[88:91], s26 offen offset:0
    s_add_u32 s26, s26, 20480
    s_waitcnt vmcnt(48)
    v_perm_b32 v56, v113, v112, s92
    v_perm_b32 v57, v115, v114, s92
    v_perm_b32 v58, v117, v116, s92
    v_perm_b32 v59, v119, v118, s92
    v_accvgpr_write_b32 a120, v56
    v_accvgpr_write_b32 a121, v57
    v_accvgpr_write_b32 a122, v58
    v_accvgpr_write_b32 a123, v59
    v_perm_b32 v60, v113, v112, s93
    v_perm_b32 v61, v115, v114, s93
    v_perm_b32 v62, v117, v116, s93
    v_perm_b32 v63, v119, v118, s93
    v_accvgpr_write_b32 a124, v60
    v_accvgpr_write_b32 a125, v61
    v_accvgpr_write_b32 a126, v62
    v_accvgpr_write_b32 a127, v63
    buffer_load_dword v112, v48, s[88:91], s26 offen offset:0
    buffer_load_dword v113, v49, s[88:91], s26 offen offset:0
    buffer_load_dword v114, v50, s[88:91], s26 offen offset:0
    buffer_load_dword v115, v51, s[88:91], s26 offen offset:0
    buffer_load_dword v116, v52, s[88:91], s26 offen offset:0
    buffer_load_dword v117, v53, s[88:91], s26 offen offset:0
    buffer_load_dword v118, v54, s[88:91], s26 offen offset:0
    buffer_load_dword v119, v55, s[88:91], s26 offen offset:0
    s_add_u32 s26, s26, 20480
    s_waitcnt vmcnt(48)
    v_perm_b32 v56, v65, v64, s92
    v_perm_b32 v57, v67, v66, s92
    v_perm_b32 v58, v69, v68, s92
    v_perm_b32 v59, v71, v70, s92
    v_accvgpr_write_b32 a128, v56
    v_accvgpr_write_b32 a129, v57
    v_accvgpr_write_b32 a130, v58
    v_accvgpr_write_b32 a131, v59
    v_perm_b32 v60, v65, v64, s93
    v_perm_b32 v61, v67, v66, s93
    v_perm_b32 v62, v69, v68, s93
    v_perm_b32 v63, v71, v70, s93
    v_accvgpr_write_b32 a132, v60
    v_accvgpr_write_b32 a133, v61
    v_accvgpr_write_b32 a134, v62
    v_accvgpr_write_b32 a135, v63
    buffer_load_dword v64, v48, s[88:91], s26 offen offset:0
    buffer_load_dword v65, v49, s[88:91], s26 offen offset:0
    buffer_load_dword v66, v50, s[88:91], s26 offen offset:0
    buffer_load_dword v67, v51, s[88:91], s26 offen offset:0
    buffer_load_dword v68, v52, s[88:91], s26 offen offset:0
    buffer_load_dword v69, v53, s[88:91], s26 offen offset:0
    buffer_load_dword v70, v54, s[88:91], s26 offen offset:0
    buffer_load_dword v71, v55, s[88:91], s26 offen offset:0
    s_add_u32 s26, s26, 20480
    s_waitcnt vmcnt(48)
    v_perm_b32 v56, v73, v72, s92
    v_perm_b32 v57, v75, v74, s92
    v_perm_b32 v58, v77, v76, s92
    v_perm_b32 v59, v79, v78, s92
    v_accvgpr_write_b32 a136, v56
    v_accvgpr_write_b32 a137, v57
    v_accvgpr_write_b32 a138, v58
    v_accvgpr_write_b32 a139, v59
    v_perm_b32 v60, v73, v72, s93
    v_perm_b32 v61, v75, v74, s93
    v_perm_b32 v62, v77, v76, s93
    v_perm_b32 v63, v79, v78, s93
    v_accvgpr_write_b32 a140, v60
    v_accvgpr_write_b32 a141, v61
    v_accvgpr_write_b32 a142, v62
    v_accvgpr_write_b32 a143, v63
    buffer_load_dword v72, v48, s[88:91], s26 offen offset:0
    buffer_load_dword v73, v49, s[88:91], s26 offen offset:0
    buffer_load_dword v74, v50, s[88:91], s26 offen offset:0
    buffer_load_dword v75, v51, s[88:91], s26 offen offset:0
    buffer_load_dword v76, v52, s[88:91], s26 offen offset:0
    buffer_load_dword v77, v53, s[88:91], s26 offen offset:0
    buffer_load_dword v78, v54, s[88:91], s26 offen offset:0
    buffer_load_dword v79, v55, s[88:91], s26 offen offset:0
    s_add_u32 s26, s26, 20480
    s_waitcnt vmcnt(48)
    v_perm_b32 v56, v81, v80, s92
    v_perm_b32 v57, v83, v82, s92
    v_perm_b32 v58, v85, v84, s92
    v_perm_b32 v59, v87, v86, s92
    ds_write_b128 v3, v[56:59] offset:10240
    v_perm_b32 v60, v81, v80, s93
    v_perm_b32 v61, v83, v82, s93
    v_perm_b32 v62, v85, v84, s93
    v_perm_b32 v63, v87, v86, s93
    ds_write_b128 v3, v[60:63] offset:11264
    buffer_load_dword v80, v48, s[88:91], s26 offen offset:0
    buffer_load_dword v81, v49, s[88:91], s26 offen offset:0
    buffer_load_dword v82, v50, s[88:91], s26 offen offset:0
    buffer_load_dword v83, v51, s[88:91], s26 offen offset:0
    buffer_load_dword v84, v52, s[88:91], s26 offen offset:0
    buffer_load_dword v85, v53, s[88:91], s26 offen offset:0
    buffer_load_dword v86, v54, s[88:91], s26 offen offset:0
    buffer_load_dword v87, v55, s[88:91], s26 offen offset:0
    s_add_u32 s26, s26, 20480
    s_waitcnt vmcnt(48)
    v_perm_b32 v56, v89, v88, s92
    v_perm_b32 v57, v91, v90, s92
    v_perm_b32 v58, v93, v92, s92
    v_perm_b32 v59, v95, v94, s92
    v_accvgpr_write_b32 a144, v56
    v_accvgpr_write_b32 a145, v57
    v_accvgpr_write_b32 a146, v58
    v_accvgpr_write_b32 a147, v59
    v_perm_b32 v60, v89, v88, s93
    v_perm_b32 v61, v91, v90, s93
    v_perm_b32 v62, v93, v92, s93
    v_perm_b32 v63, v95, v94, s93
    v_accvgpr_write_b32 a148, v60
    v_accvgpr_write_b32 a149, v61
    v_accvgpr_write_b32 a150, v62
    v_accvgpr_write_b32 a151, v63
    buffer_load_dword v88, v48, s[88:91], s26 offen offset:0
    buffer_load_dword v89, v49, s[88:91], s26 offen offset:0
    buffer_load_dword v90, v50, s[88:91], s26 offen offset:0
    buffer_load_dword v91, v51, s[88:91], s26 offen offset:0
    buffer_load_dword v92, v52, s[88:91], s26 offen offset:0
    buffer_load_dword v93, v53, s[88:91], s26 offen offset:0
    buffer_load_dword v94, v54, s[88:91], s26 offen offset:0
    buffer_load_dword v95, v55, s[88:91], s26 offen offset:0
    s_add_u32 s26, s26, 20480
    s_waitcnt vmcnt(48)
    v_perm_b32 v56, v97, v96, s92
    v_perm_b32 v57, v99, v98, s92
    v_perm_b32 v58, v101, v100, s92
    v_perm_b32 v59, v103, v102, s92
    v_accvgpr_write_b32 a152, v56
    v_accvgpr_write_b32 a153, v57
    v_accvgpr_write_b32 a154, v58
    v_accvgpr_write_b32 a155, v59
    v_perm_b32 v60, v97, v96, s93
    v_perm_b32 v61, v99, v98, s93
    v_perm_b32 v62, v101, v100, s93
    v_perm_b32 v63, v103, v102, s93
    v_accvgpr_write_b32 a156, v60
    v_accvgpr_write_b32 a157, v61
    v_accvgpr_write_b32 a158, v62
    v_accvgpr_write_b32 a159, v63
    buffer_load_dword v96, v48, s[88:91], s26 offen offset:0
    buffer_load_dword v97, v49, s[88:91], s26 offen offset:0
    buffer_load_dword v98, v50, s[88:91], s26 offen offset:0
    buffer_load_dword v99, v51, s[88:91], s26 offen offset:0
    buffer_load_dword v100, v52, s[88:91], s26 offen offset:0
    buffer_load_dword v101, v53, s[88:91], s26 offen offset:0
    buffer_load_dword v102, v54, s[88:91], s26 offen offset:0
    buffer_load_dword v103, v55, s[88:91], s26 offen offset:0
    s_add_u32 s26, s26, 20480
    s_waitcnt vmcnt(48)
    v_perm_b32 v56, v105, v104, s92
    v_perm_b32 v57, v107, v106, s92
    v_perm_b32 v58, v109, v108, s92
    v_perm_b32 v59, v111, v110, s92
    v_accvgpr_write_b32 a160, v56
    v_accvgpr_write_b32 a161, v57
    v_accvgpr_write_b32 a162, v58
    v_accvgpr_write_b32 a163, v59
    v_perm_b32 v60, v105, v104, s93
    v_perm_b32 v61, v107, v106, s93
    v_perm_b32 v62, v109, v108, s93
    v_perm_b32 v63, v111, v110, s93
    v_accvgpr_write_b32 a164, v60
    v_accvgpr_write_b32 a165, v61
    v_accvgpr_write_b32 a166, v62
    v_accvgpr_write_b32 a167, v63
    buffer_load_dword v104, v48, s[88:91], s26 offen offset:0
    buffer_load_dword v105, v49, s[88:91], s26 offen offset:0
    buffer_load_dword v106, v50, s[88:91], s26 offen offset:0
    buffer_load_dword v107, v51, s[88:91], s26 offen offset:0
    buffer_load_dword v108, v52, s[88:91], s26 offen offset:0
    buffer_load_dword v109, v53, s[88:91], s26 offen offset:0
    buffer_load_dword v110, v54, s[88:91], s26 offen offset:0
    buffer_load_dword v111, v55, s[88:91], s26 offen offset:0
    s_add_u32 s26, s26, 20480
    s_waitcnt vmcnt(48)
    v_perm_b32 v56, v113, v112, s92
    v_perm_b32 v57, v115, v114, s92
    v_perm_b32 v58, v117, v116, s92
    v_perm_b32 v59, v119, v118, s92
    ds_write_b128 v3, v[56:59] offset:12288
    v_perm_b32 v60, v113, v112, s93
    v_perm_b32 v61, v115, v114, s93
    v_perm_b32 v62, v117, v116, s93
    v_perm_b32 v63, v119, v118, s93
    ds_write_b128 v3, v[60:63] offset:13312
    buffer_load_dword v112, v48, s[88:91], s26 offen offset:0
    buffer_load_dword v113, v49, s[88:91], s26 offen offset:0
    buffer_load_dword v114, v50, s[88:91], s26 offen offset:0
    buffer_load_dword v115, v51, s[88:91], s26 offen offset:0
    buffer_load_dword v116, v52, s[88:91], s26 offen offset:0
    buffer_load_dword v117, v53, s[88:91], s26 offen offset:0
    buffer_load_dword v118, v54, s[88:91], s26 offen offset:0
    buffer_load_dword v119, v55, s[88:91], s26 offen offset:0
    s_add_u32 s26, s26, 20480
    s_waitcnt vmcnt(48)
    v_perm_b32 v56, v65, v64, s92
    v_perm_b32 v57, v67, v66, s92
    v_perm_b32 v58, v69, v68, s92
    v_perm_b32 v59, v71, v70, s92
    v_accvgpr_write_b32 a168, v56
    v_accvgpr_write_b32 a169, v57
    v_accvgpr_write_b32 a170, v58
    v_accvgpr_write_b32 a171, v59
    v_perm_b32 v60, v65, v64, s93
    v_perm_b32 v61, v67, v66, s93
    v_perm_b32 v62, v69, v68, s93
    v_perm_b32 v63, v71, v70, s93
    v_accvgpr_write_b32 a172, v60
    v_accvgpr_write_b32 a173, v61
    v_accvgpr_write_b32 a174, v62
    v_accvgpr_write_b32 a175, v63
    buffer_load_dword v64, v48, s[88:91], s26 offen offset:0
    buffer_load_dword v65, v49, s[88:91], s26 offen offset:0
    buffer_load_dword v66, v50, s[88:91], s26 offen offset:0
    buffer_load_dword v67, v51, s[88:91], s26 offen offset:0
    buffer_load_dword v68, v52, s[88:91], s26 offen offset:0
    buffer_load_dword v69, v53, s[88:91], s26 offen offset:0
    buffer_load_dword v70, v54, s[88:91], s26 offen offset:0
    buffer_load_dword v71, v55, s[88:91], s26 offen offset:0
    s_add_u32 s26, s26, 20480
    s_waitcnt vmcnt(48)
    v_perm_b32 v56, v73, v72, s92
    v_perm_b32 v57, v75, v74, s92
    v_perm_b32 v58, v77, v76, s92
    v_perm_b32 v59, v79, v78, s92
    v_accvgpr_write_b32 a176, v56
    v_accvgpr_write_b32 a177, v57
    v_accvgpr_write_b32 a178, v58
    v_accvgpr_write_b32 a179, v59
    v_perm_b32 v60, v73, v72, s93
    v_perm_b32 v61, v75, v74, s93
    v_perm_b32 v62, v77, v76, s93
    v_perm_b32 v63, v79, v78, s93
    v_accvgpr_write_b32 a180, v60
    v_accvgpr_write_b32 a181, v61
    v_accvgpr_write_b32 a182, v62
    v_accvgpr_write_b32 a183, v63
    buffer_load_dword v72, v48, s[88:91], s26 offen offset:0
    buffer_load_dword v73, v49, s[88:91], s26 offen offset:0
    buffer_load_dword v74, v50, s[88:91], s26 offen offset:0
    buffer_load_dword v75, v51, s[88:91], s26 offen offset:0
    buffer_load_dword v76, v52, s[88:91], s26 offen offset:0
    buffer_load_dword v77, v53, s[88:91], s26 offen offset:0
    buffer_load_dword v78, v54, s[88:91], s26 offen offset:0
    buffer_load_dword v79, v55, s[88:91], s26 offen offset:0
    s_add_u32 s26, s26, 20480
    s_waitcnt vmcnt(48)
    v_perm_b32 v56, v81, v80, s92
    v_perm_b32 v57, v83, v82, s92
    v_perm_b32 v58, v85, v84, s92
    v_perm_b32 v59, v87, v86, s92
    v_accvgpr_write_b32 a184, v56
    v_accvgpr_write_b32 a185, v57
    v_accvgpr_write_b32 a186, v58
    v_accvgpr_write_b32 a187, v59
    v_perm_b32 v60, v81, v80, s93
    v_perm_b32 v61, v83, v82, s93
    v_perm_b32 v62, v85, v84, s93
    v_perm_b32 v63, v87, v86, s93
    v_accvgpr_write_b32 a188, v60
    v_accvgpr_write_b32 a189, v61
    v_accvgpr_write_b32 a190, v62
    v_accvgpr_write_b32 a191, v63
    buffer_load_dword v80, v48, s[88:91], s26 offen offset:0
    buffer_load_dword v81, v49, s[88:91], s26 offen offset:0
    buffer_load_dword v82, v50, s[88:91], s26 offen offset:0
    buffer_load_dword v83, v51, s[88:91], s26 offen offset:0
    buffer_load_dword v84, v52, s[88:91], s26 offen offset:0
    buffer_load_dword v85, v53, s[88:91], s26 offen offset:0
    buffer_load_dword v86, v54, s[88:91], s26 offen offset:0
    buffer_load_dword v87, v55, s[88:91], s26 offen offset:0
    s_add_u32 s26, s26, 20480
    s_waitcnt vmcnt(48)
    v_perm_b32 v56, v89, v88, s92
    v_perm_b32 v57, v91, v90, s92
    v_perm_b32 v58, v93, v92, s92
    v_perm_b32 v59, v95, v94, s92
    ds_write_b128 v3, v[56:59] offset:14336
    v_perm_b32 v60, v89, v88, s93
    v_perm_b32 v61, v91, v90, s93
    v_perm_b32 v62, v93, v92, s93
    v_perm_b32 v63, v95, v94, s93
    ds_write_b128 v3, v[60:63] offset:15360
    buffer_load_dword v88, v48, s[88:91], s26 offen offset:0
    buffer_load_dword v89, v49, s[88:91], s26 offen offset:0
    buffer_load_dword v90, v50, s[88:91], s26 offen offset:0
    buffer_load_dword v91, v51, s[88:91], s26 offen offset:0
    buffer_load_dword v92, v52, s[88:91], s26 offen offset:0
    buffer_load_dword v93, v53, s[88:91], s26 offen offset:0
    buffer_load_dword v94, v54, s[88:91], s26 offen offset:0
    buffer_load_dword v95, v55, s[88:91], s26 offen offset:0
    s_add_u32 s26, s26, 20480
    s_waitcnt vmcnt(48)
    v_perm_b32 v56, v97, v96, s92
    v_perm_b32 v57, v99, v98, s92
    v_perm_b32 v58, v101, v100, s92
    v_perm_b32 v59, v103, v102, s92
    v_accvgpr_write_b32 a192, v56
    v_accvgpr_write_b32 a193, v57
    v_accvgpr_write_b32 a194, v58
    v_accvgpr_write_b32 a195, v59
    v_perm_b32 v60, v97, v96, s93
    v_perm_b32 v61, v99, v98, s93
    v_perm_b32 v62, v101, v100, s93
    v_perm_b32 v63, v103, v102, s93
    v_accvgpr_write_b32 a196, v60
    v_accvgpr_write_b32 a197, v61
    v_accvgpr_write_b32 a198, v62
    v_accvgpr_write_b32 a199, v63
    buffer_load_dword v96, v48, s[88:91], s26 offen offset:0
    buffer_load_dword v97, v49, s[88:91], s26 offen offset:0
    buffer_load_dword v98, v50, s[88:91], s26 offen offset:0
    buffer_load_dword v99, v51, s[88:91], s26 offen offset:0
    buffer_load_dword v100, v52, s[88:91], s26 offen offset:0
    buffer_load_dword v101, v53, s[88:91], s26 offen offset:0
    buffer_load_dword v102, v54, s[88:91], s26 offen offset:0
    buffer_load_dword v103, v55, s[88:91], s26 offen offset:0
    s_add_u32 s26, s26, 20480
    s_waitcnt vmcnt(48)
    v_perm_b32 v56, v105, v104, s92
    v_perm_b32 v57, v107, v106, s92
    v_perm_b32 v58, v109, v108, s92
    v_perm_b32 v59, v111, v110, s92
    v_accvgpr_write_b32 a200, v56
    v_accvgpr_write_b32 a201, v57
    v_accvgpr_write_b32 a202, v58
    v_accvgpr_write_b32 a203, v59
    v_perm_b32 v60, v105, v104, s93
    v_perm_b32 v61, v107, v106, s93
    v_perm_b32 v62, v109, v108, s93
    v_perm_b32 v63, v111, v110, s93
    v_accvgpr_write_b32 a204, v60
    v_accvgpr_write_b32 a205, v61
    v_accvgpr_write_b32 a206, v62
    v_accvgpr_write_b32 a207, v63
    buffer_load_dword v104, v48, s[88:91], s26 offen offset:0
    buffer_load_dword v105, v49, s[88:91], s26 offen offset:0
    buffer_load_dword v106, v50, s[88:91], s26 offen offset:0
    buffer_load_dword v107, v51, s[88:91], s26 offen offset:0
    buffer_load_dword v108, v52, s[88:91], s26 offen offset:0
    buffer_load_dword v109, v53, s[88:91], s26 offen offset:0
    buffer_load_dword v110, v54, s[88:91], s26 offen offset:0
    buffer_load_dword v111, v55, s[88:91], s26 offen offset:0
    s_add_u32 s26, s26, 20480
    s_waitcnt vmcnt(48)
    v_perm_b32 v56, v113, v112, s92
    v_perm_b32 v57, v115, v114, s92
    v_perm_b32 v58, v117, v116, s92
    v_perm_b32 v59, v119, v118, s92
    v_accvgpr_write_b32 a208, v56
    v_accvgpr_write_b32 a209, v57
    v_accvgpr_write_b32 a210, v58
    v_accvgpr_write_b32 a211, v59
    v_perm_b32 v60, v113, v112, s93
    v_perm_b32 v61, v115, v114, s93
    v_perm_b32 v62, v117, v116, s93
    v_perm_b32 v63, v119, v118, s93
    v_accvgpr_write_b32 a212, v60
    v_accvgpr_write_b32 a213, v61
    v_accvgpr_write_b32 a214, v62
    v_accvgpr_write_b32 a215, v63
    buffer_load_dword v112, v48, s[88:91], s26 offen offset:0
    buffer_load_dword v113, v49, s[88:91], s26 offen offset:0
    buffer_load_dword v114, v50, s[88:91], s26 offen offset:0
    buffer_load_dword v115, v51, s[88:91], s26 offen offset:0
    buffer_load_dword v116, v52, s[88:91], s26 offen offset:0
    buffer_load_dword v117, v53, s[88:91], s26 offen offset:0
    buffer_load_dword v118, v54, s[88:91], s26 offen offset:0
    buffer_load_dword v119, v55, s[88:91], s26 offen offset:0
    s_add_u32 s26, s26, 20480
    s_waitcnt vmcnt(48)
    v_perm_b32 v56, v65, v64, s92
    v_perm_b32 v57, v67, v66, s92
    v_perm_b32 v58, v69, v68, s92
    v_perm_b32 v59, v71, v70, s92
    ds_write_b128 v3, v[56:59] offset:16384
    v_perm_b32 v60, v65, v64, s93
    v_perm_b32 v61, v67, v66, s93
    v_perm_b32 v62, v69, v68, s93
    v_perm_b32 v63, v71, v70, s93
    ds_write_b128 v3, v[60:63] offset:17408
    buffer_load_dword v64, v48, s[88:91], s26 offen offset:0
    buffer_load_dword v65, v49, s[88:91], s26 offen offset:0
    buffer_load_dword v66, v50, s[88:91], s26 offen offset:0
    buffer_load_dword v67, v51, s[88:91], s26 offen offset:0
    buffer_load_dword v68, v52, s[88:91], s26 offen offset:0
    buffer_load_dword v69, v53, s[88:91], s26 offen offset:0
    buffer_load_dword v70, v54, s[88:91], s26 offen offset:0
    buffer_load_dword v71, v55, s[88:91], s26 offen offset:0
    s_add_u32 s26, s26, 20480
    s_waitcnt vmcnt(48)
    v_perm_b32 v56, v73, v72, s92
    v_perm_b32 v57, v75, v74, s92
    v_perm_b32 v58, v77, v76, s92
    v_perm_b32 v59, v79, v78, s92
    v_accvgpr_write_b32 a216, v56
    v_accvgpr_write_b32 a217, v57
    v_accvgpr_write_b32 a218, v58
    v_accvgpr_write_b32 a219, v59
    v_perm_b32 v60, v73, v72, s93
    v_perm_b32 v61, v75, v74, s93
    v_perm_b32 v62, v77, v76, s93
    v_perm_b32 v63, v79, v78, s93
    v_accvgpr_write_b32 a220, v60
    v_accvgpr_write_b32 a221, v61
    v_accvgpr_write_b32 a222, v62
    v_accvgpr_write_b32 a223, v63
    buffer_load_dword v72, v48, s[88:91], s26 offen offset:0
    buffer_load_dword v73, v49, s[88:91], s26 offen offset:0
    buffer_load_dword v74, v50, s[88:91], s26 offen offset:0
    buffer_load_dword v75, v51, s[88:91], s26 offen offset:0
    buffer_load_dword v76, v52, s[88:91], s26 offen offset:0
    buffer_load_dword v77, v53, s[88:91], s26 offen offset:0
    buffer_load_dword v78, v54, s[88:91], s26 offen offset:0
    buffer_load_dword v79, v55, s[88:91], s26 offen offset:0
    s_add_u32 s26, s26, 20480
    s_waitcnt vmcnt(48)
    v_perm_b32 v56, v81, v80, s92
    v_perm_b32 v57, v83, v82, s92
    v_perm_b32 v58, v85, v84, s92
    v_perm_b32 v59, v87, v86, s92
    v_accvgpr_write_b32 a224, v56
    v_accvgpr_write_b32 a225, v57
    v_accvgpr_write_b32 a226, v58
    v_accvgpr_write_b32 a227, v59
    v_perm_b32 v60, v81, v80, s93
    v_perm_b32 v61, v83, v82, s93
    v_perm_b32 v62, v85, v84, s93
    v_perm_b32 v63, v87, v86, s93
    v_accvgpr_write_b32 a228, v60
    v_accvgpr_write_b32 a229, v61
    v_accvgpr_write_b32 a230, v62
    v_accvgpr_write_b32 a231, v63
    buffer_load_dword v80, v48, s[88:91], s26 offen offset:0
    buffer_load_dword v81, v49, s[88:91], s26 offen offset:0
    buffer_load_dword v82, v50, s[88:91], s26 offen offset:0
    buffer_load_dword v83, v51, s[88:91], s26 offen offset:0
    buffer_load_dword v84, v52, s[88:91], s26 offen offset:0
    buffer_load_dword v85, v53, s[88:91], s26 offen offset:0
    buffer_load_dword v86, v54, s[88:91], s26 offen offset:0
    buffer_load_dword v87, v55, s[88:91], s26 offen offset:0
    s_add_u32 s26, s26, 20480
    s_waitcnt vmcnt(48)
    v_perm_b32 v56, v89, v88, s92
    v_perm_b32 v57, v91, v90, s92
    v_perm_b32 v58, v93, v92, s92
    v_perm_b32 v59, v95, v94, s92
    v_accvgpr_write_b32 a232, v56
    v_accvgpr_write_b32 a233, v57
    v_accvgpr_write_b32 a234, v58
    v_accvgpr_write_b32 a235, v59
    v_perm_b32 v60, v89, v88, s93
    v_perm_b32 v61, v91, v90, s93
    v_perm_b32 v62, v93, v92, s93
    v_perm_b32 v63, v95, v94, s93
    v_accvgpr_write_b32 a236, v60
    v_accvgpr_write_b32 a237, v61
    v_accvgpr_write_b32 a238, v62
    v_accvgpr_write_b32 a239, v63
    buffer_load_dword v88, v48, s[88:91], s26 offen offset:0
    buffer_load_dword v89, v49, s[88:91], s26 offen offset:0
    buffer_load_dword v90, v50, s[88:91], s26 offen offset:0
    buffer_load_dword v91, v51, s[88:91], s26 offen offset:0
    buffer_load_dword v92, v52, s[88:91], s26 offen offset:0
    buffer_load_dword v93, v53, s[88:91], s26 offen offset:0
    buffer_load_dword v94, v54, s[88:91], s26 offen offset:0
    buffer_load_dword v95, v55, s[88:91], s26 offen offset:0
    s_add_u32 s26, s26, 20480
    s_waitcnt vmcnt(48)
    v_perm_b32 v56, v97, v96, s92
    v_perm_b32 v57, v99, v98, s92
    v_perm_b32 v58, v101, v100, s92
    v_perm_b32 v59, v103, v102, s92
    ds_write_b128 v3, v[56:59] offset:18432
    v_perm_b32 v60, v97, v96, s93
    v_perm_b32 v61, v99, v98, s93
    v_perm_b32 v62, v101, v100, s93
    v_perm_b32 v63, v103, v102, s93
    ds_write_b128 v3, v[60:63] offset:19456
    buffer_load_dword v96, v48, s[88:91], s26 offen offset:0
    buffer_load_dword v97, v49, s[88:91], s26 offen offset:0
    buffer_load_dword v98, v50, s[88:91], s26 offen offset:0
    buffer_load_dword v99, v51, s[88:91], s26 offen offset:0
    buffer_load_dword v100, v52, s[88:91], s26 offen offset:0
    buffer_load_dword v101, v53, s[88:91], s26 offen offset:0
    buffer_load_dword v102, v54, s[88:91], s26 offen offset:0
    buffer_load_dword v103, v55, s[88:91], s26 offen offset:0
    s_add_u32 s26, s26, 20480
    s_waitcnt vmcnt(48)
    v_perm_b32 v56, v105, v104, s92
    v_perm_b32 v57, v107, v106, s92
    v_perm_b32 v58, v109, v108, s92
    v_perm_b32 v59, v111, v110, s92
    v_accvgpr_write_b32 a240, v56
    v_accvgpr_write_b32 a241, v57
    v_accvgpr_write_b32 a242, v58
    v_accvgpr_write_b32 a243, v59
    v_perm_b32 v60, v105, v104, s93
    v_perm_b32 v61, v107, v106, s93
    v_perm_b32 v62, v109, v108, s93
    v_perm_b32 v63, v111, v110, s93
    v_accvgpr_write_b32 a244, v60
    v_accvgpr_write_b32 a245, v61
    v_accvgpr_write_b32 a246, v62
    v_accvgpr_write_b32 a247, v63
    buffer_load_dword v104, v48, s[88:91], s26 offen offset:0
    buffer_load_dword v105, v49, s[88:91], s26 offen offset:0
    buffer_load_dword v106, v50, s[88:91], s26 offen offset:0
    buffer_load_dword v107, v51, s[88:91], s26 offen offset:0
    buffer_load_dword v108, v52, s[88:91], s26 offen offset:0
    buffer_load_dword v109, v53, s[88:91], s26 offen offset:0
    buffer_load_dword v110, v54, s[88:91], s26 offen offset:0
    buffer_load_dword v111, v55, s[88:91], s26 offen offset:0
    s_add_u32 s26, s26, 20480
    s_waitcnt vmcnt(48)
    v_perm_b32 v56, v113, v112, s92
    v_perm_b32 v57, v115, v114, s92
    v_perm_b32 v58, v117, v116, s92
    v_perm_b32 v59, v119, v118, s92
    v_accvgpr_write_b32 a248, v56
    v_accvgpr_write_b32 a249, v57
    v_accvgpr_write_b32 a250, v58
    v_accvgpr_write_b32 a251, v59
    v_perm_b32 v60, v113, v112, s93
    v_perm_b32 v61, v115, v114, s93
    v_perm_b32 v62, v117, v116, s93
    v_perm_b32 v63, v119, v118, s93
    v_accvgpr_write_b32 a252, v60
    v_accvgpr_write_b32 a253, v61
    v_accvgpr_write_b32 a254, v62
    v_accvgpr_write_b32 a255, v63
    buffer_load_dword v112, v48, s[88:91], s26 offen offset:0
    buffer_load_dword v113, v49, s[88:91], s26 offen offset:0
    buffer_load_dword v114, v50, s[88:91], s26 offen offset:0
    buffer_load_dword v115, v51, s[88:91], s26 offen offset:0
    buffer_load_dword v116, v52, s[88:91], s26 offen offset:0
    buffer_load_dword v117, v53, s[88:91], s26 offen offset:0
    buffer_load_dword v118, v54, s[88:91], s26 offen offset:0
    buffer_load_dword v119, v55, s[88:91], s26 offen offset:0
    s_add_u32 s26, s26, 20480
    s_waitcnt vmcnt(48)
    v_perm_b32 v128, v65, v64, s92
    v_perm_b32 v129, v67, v66, s92
    v_perm_b32 v130, v69, v68, s92
    v_perm_b32 v131, v71, v70, s92
    v_perm_b32 v132, v65, v64, s93
    v_perm_b32 v133, v67, v66, s93
    v_perm_b32 v134, v69, v68, s93
    v_perm_b32 v135, v71, v70, s93
    buffer_load_dword v64, v48, s[88:91], s26 offen offset:0
    buffer_load_dword v65, v49, s[88:91], s26 offen offset:0
    buffer_load_dword v66, v50, s[88:91], s26 offen offset:0
    buffer_load_dword v67, v51, s[88:91], s26 offen offset:0
    buffer_load_dword v68, v52, s[88:91], s26 offen offset:0
    buffer_load_dword v69, v53, s[88:91], s26 offen offset:0
    buffer_load_dword v70, v54, s[88:91], s26 offen offset:0
    buffer_load_dword v71, v55, s[88:91], s26 offen offset:0
    s_add_u32 s26, s26, 20480
    s_waitcnt vmcnt(48)
    v_perm_b32 v56, v73, v72, s92
    v_perm_b32 v57, v75, v74, s92
    v_perm_b32 v58, v77, v76, s92
    v_perm_b32 v59, v79, v78, s92
    ds_write_b128 v3, v[56:59] offset:20480
    v_perm_b32 v60, v73, v72, s93
    v_perm_b32 v61, v75, v74, s93
    v_perm_b32 v62, v77, v76, s93
    v_perm_b32 v63, v79, v78, s93
    ds_write_b128 v3, v[60:63] offset:21504
    buffer_load_dword v72, v48, s[88:91], s26 offen offset:0
    buffer_load_dword v73, v49, s[88:91], s26 offen offset:0
    buffer_load_dword v74, v50, s[88:91], s26 offen offset:0
    buffer_load_dword v75, v51, s[88:91], s26 offen offset:0
    buffer_load_dword v76, v52, s[88:91], s26 offen offset:0
    buffer_load_dword v77, v53, s[88:91], s26 offen offset:0
    buffer_load_dword v78, v54, s[88:91], s26 offen offset:0
    buffer_load_dword v79, v55, s[88:91], s26 offen offset:0
    s_add_u32 s26, s26, 20480
    s_waitcnt vmcnt(48)
    v_perm_b32 v136, v81, v80, s92
    v_perm_b32 v137, v83, v82, s92
    v_perm_b32 v138, v85, v84, s92
    v_perm_b32 v139, v87, v86, s92
    v_perm_b32 v140, v81, v80, s93
    v_perm_b32 v141, v83, v82, s93
    v_perm_b32 v142, v85, v84, s93
    v_perm_b32 v143, v87, v86, s93
    buffer_load_dword v80, v48, s[88:91], s26 offen offset:0
    buffer_load_dword v81, v49, s[88:91], s26 offen offset:0
    buffer_load_dword v82, v50, s[88:91], s26 offen offset:0
    buffer_load_dword v83, v51, s[88:91], s26 offen offset:0
    buffer_load_dword v84, v52, s[88:91], s26 offen offset:0
    buffer_load_dword v85, v53, s[88:91], s26 offen offset:0
    buffer_load_dword v86, v54, s[88:91], s26 offen offset:0
    buffer_load_dword v87, v55, s[88:91], s26 offen offset:0
    s_add_u32 s26, s26, 20480
    s_waitcnt vmcnt(48)
    v_perm_b32 v144, v89, v88, s92
    v_perm_b32 v145, v91, v90, s92
    v_perm_b32 v146, v93, v92, s92
    v_perm_b32 v147, v95, v94, s92
    v_perm_b32 v148, v89, v88, s93
    v_perm_b32 v149, v91, v90, s93
    v_perm_b32 v150, v93, v92, s93
    v_perm_b32 v151, v95, v94, s93
    buffer_load_dword v88, v48, s[88:91], s26 offen offset:0
    buffer_load_dword v89, v49, s[88:91], s26 offen offset:0
    buffer_load_dword v90, v50, s[88:91], s26 offen offset:0
    buffer_load_dword v91, v51, s[88:91], s26 offen offset:0
    buffer_load_dword v92, v52, s[88:91], s26 offen offset:0
    buffer_load_dword v93, v53, s[88:91], s26 offen offset:0
    buffer_load_dword v94, v54, s[88:91], s26 offen offset:0
    buffer_load_dword v95, v55, s[88:91], s26 offen offset:0
    s_add_u32 s26, s26, 20480
    s_waitcnt vmcnt(48)
    v_perm_b32 v152, v97, v96, s92
    v_perm_b32 v153, v99, v98, s92
    v_perm_b32 v154, v101, v100, s92
    v_perm_b32 v155, v103, v102, s92
    v_perm_b32 v156, v97, v96, s93
    v_perm_b32 v157, v99, v98, s93
    v_perm_b32 v158, v101, v100, s93
    v_perm_b32 v159, v103, v102, s93
    buffer_load_dword v96, v48, s[88:91], s26 offen offset:0
    buffer_load_dword v97, v49, s[88:91], s26 offen offset:0
    buffer_load_dword v98, v50, s[88:91], s26 offen offset:0
    buffer_load_dword v99, v51, s[88:91], s26 offen offset:0
    buffer_load_dword v100, v52, s[88:91], s26 offen offset:0
    buffer_load_dword v101, v53, s[88:91], s26 offen offset:0
    buffer_load_dword v102, v54, s[88:91], s26 offen offset:0
    buffer_load_dword v103, v55, s[88:91], s26 offen offset:0
    s_add_u32 s26, s26, 20480
    s_waitcnt vmcnt(48)
    v_perm_b32 v56, v105, v104, s92
    v_perm_b32 v57, v107, v106, s92
    v_perm_b32 v58, v109, v108, s92
    v_perm_b32 v59, v111, v110, s92
    ds_write_b128 v3, v[56:59] offset:22528
    v_perm_b32 v60, v105, v104, s93
    v_perm_b32 v61, v107, v106, s93
    v_perm_b32 v62, v109, v108, s93
    v_perm_b32 v63, v111, v110, s93
    ds_write_b128 v3, v[60:63] offset:23552
    buffer_load_dword v104, v48, s[88:91], s26 offen offset:0
    buffer_load_dword v105, v49, s[88:91], s26 offen offset:0
    buffer_load_dword v106, v50, s[88:91], s26 offen offset:0
    buffer_load_dword v107, v51, s[88:91], s26 offen offset:0
    buffer_load_dword v108, v52, s[88:91], s26 offen offset:0
    buffer_load_dword v109, v53, s[88:91], s26 offen offset:0
    buffer_load_dword v110, v54, s[88:91], s26 offen offset:0
    buffer_load_dword v111, v55, s[88:91], s26 offen offset:0
    s_add_u32 s26, s26, 20480
    s_waitcnt vmcnt(48)
    v_perm_b32 v160, v113, v112, s92
    v_perm_b32 v161, v115, v114, s92
    v_perm_b32 v162, v117, v116, s92
    v_perm_b32 v163, v119, v118, s92
    v_perm_b32 v164, v113, v112, s93
    v_perm_b32 v165, v115, v114, s93
    v_perm_b32 v166, v117, v116, s93
    v_perm_b32 v167, v119, v118, s93
    buffer_load_dword v112, v48, s[88:91], s26 offen offset:0
    buffer_load_dword v113, v49, s[88:91], s26 offen offset:0
    buffer_load_dword v114, v50, s[88:91], s26 offen offset:0
    buffer_load_dword v115, v51, s[88:91], s26 offen offset:0
    buffer_load_dword v116, v52, s[88:91], s26 offen offset:0
    buffer_load_dword v117, v53, s[88:91], s26 offen offset:0
    buffer_load_dword v118, v54, s[88:91], s26 offen offset:0
    buffer_load_dword v119, v55, s[88:91], s26 offen offset:0
    s_add_u32 s26, s26, 20480
    s_waitcnt vmcnt(48)
    v_perm_b32 v168, v65, v64, s92
    v_perm_b32 v169, v67, v66, s92
    v_perm_b32 v170, v69, v68, s92
    v_perm_b32 v171, v71, v70, s92
    v_perm_b32 v172, v65, v64, s93
    v_perm_b32 v173, v67, v66, s93
    v_perm_b32 v174, v69, v68, s93
    v_perm_b32 v175, v71, v70, s93
    buffer_load_dword v64, v48, s[88:91], s26 offen offset:0
    buffer_load_dword v65, v49, s[88:91], s26 offen offset:0
    buffer_load_dword v66, v50, s[88:91], s26 offen offset:0
    buffer_load_dword v67, v51, s[88:91], s26 offen offset:0
    buffer_load_dword v68, v52, s[88:91], s26 offen offset:0
    buffer_load_dword v69, v53, s[88:91], s26 offen offset:0
    buffer_load_dword v70, v54, s[88:91], s26 offen offset:0
    buffer_load_dword v71, v55, s[88:91], s26 offen offset:0
    s_add_u32 s26, s26, 20480
    s_waitcnt vmcnt(48)
    v_perm_b32 v176, v73, v72, s92
    v_perm_b32 v177, v75, v74, s92
    v_perm_b32 v178, v77, v76, s92
    v_perm_b32 v179, v79, v78, s92
    v_perm_b32 v180, v73, v72, s93
    v_perm_b32 v181, v75, v74, s93
    v_perm_b32 v182, v77, v76, s93
    v_perm_b32 v183, v79, v78, s93
    buffer_load_dword v72, v48, s[88:91], s26 offen offset:0
    buffer_load_dword v73, v49, s[88:91], s26 offen offset:0
    buffer_load_dword v74, v50, s[88:91], s26 offen offset:0
    buffer_load_dword v75, v51, s[88:91], s26 offen offset:0
    buffer_load_dword v76, v52, s[88:91], s26 offen offset:0
    buffer_load_dword v77, v53, s[88:91], s26 offen offset:0
    buffer_load_dword v78, v54, s[88:91], s26 offen offset:0
    buffer_load_dword v79, v55, s[88:91], s26 offen offset:0
    s_add_u32 s26, s26, 20480
    s_waitcnt vmcnt(48)
    v_perm_b32 v56, v81, v80, s92
    v_perm_b32 v57, v83, v82, s92
    v_perm_b32 v58, v85, v84, s92
    v_perm_b32 v59, v87, v86, s92
    ds_write_b128 v3, v[56:59] offset:24576
    v_perm_b32 v60, v81, v80, s93
    v_perm_b32 v61, v83, v82, s93
    v_perm_b32 v62, v85, v84, s93
    v_perm_b32 v63, v87, v86, s93
    ds_write_b128 v3, v[60:63] offset:25600
    buffer_load_dword v80, v48, s[88:91], s26 offen offset:0
    buffer_load_dword v81, v49, s[88:91], s26 offen offset:0
    buffer_load_dword v82, v50, s[88:91], s26 offen offset:0
    buffer_load_dword v83, v51, s[88:91], s26 offen offset:0
    buffer_load_dword v84, v52, s[88:91], s26 offen offset:0
    buffer_load_dword v85, v53, s[88:91], s26 offen offset:0
    buffer_load_dword v86, v54, s[88:91], s26 offen offset:0
    buffer_load_dword v87, v55, s[88:91], s26 offen offset:0
    s_add_u32 s26, s26, 20480
    s_waitcnt vmcnt(48)
    v_perm_b32 v184, v89, v88, s92
    v_perm_b32 v185, v91, v90, s92
    v_perm_b32 v186, v93, v92, s92
    v_perm_b32 v187, v95, v94, s92
    v_perm_b32 v188, v89, v88, s93
    v_perm_b32 v189, v91, v90, s93
    v_perm_b32 v190, v93, v92, s93
    v_perm_b32 v191, v95, v94, s93
    buffer_load_dword v88, v48, s[88:91], s26 offen offset:0
    buffer_load_dword v89, v49, s[88:91], s26 offen offset:0
    buffer_load_dword v90, v50, s[88:91], s26 offen offset:0
    buffer_load_dword v91, v51, s[88:91], s26 offen offset:0
    buffer_load_dword v92, v52, s[88:91], s26 offen offset:0
    buffer_load_dword v93, v53, s[88:91], s26 offen offset:0
    buffer_load_dword v94, v54, s[88:91], s26 offen offset:0
    buffer_load_dword v95, v55, s[88:91], s26 offen offset:0
    s_add_u32 s26, s26, 20480
    s_waitcnt vmcnt(48)
    v_perm_b32 v192, v97, v96, s92
    v_perm_b32 v193, v99, v98, s92
    v_perm_b32 v194, v101, v100, s92
    v_perm_b32 v195, v103, v102, s92
    v_perm_b32 v196, v97, v96, s93
    v_perm_b32 v197, v99, v98, s93
    v_perm_b32 v198, v101, v100, s93
    v_perm_b32 v199, v103, v102, s93
    buffer_load_dword v96, v48, s[88:91], s26 offen offset:0
    buffer_load_dword v97, v49, s[88:91], s26 offen offset:0
    buffer_load_dword v98, v50, s[88:91], s26 offen offset:0
    buffer_load_dword v99, v51, s[88:91], s26 offen offset:0
    buffer_load_dword v100, v52, s[88:91], s26 offen offset:0
    buffer_load_dword v101, v53, s[88:91], s26 offen offset:0
    buffer_load_dword v102, v54, s[88:91], s26 offen offset:0
    buffer_load_dword v103, v55, s[88:91], s26 offen offset:0
    s_add_u32 s26, s26, 20480
    s_waitcnt vmcnt(48)
    v_perm_b32 v200, v105, v104, s92
    v_perm_b32 v201, v107, v106, s92
    v_perm_b32 v202, v109, v108, s92
    v_perm_b32 v203, v111, v110, s92
    v_perm_b32 v204, v105, v104, s93
    v_perm_b32 v205, v107, v106, s93
    v_perm_b32 v206, v109, v108, s93
    v_perm_b32 v207, v111, v110, s93
    buffer_load_dword v104, v48, s[88:91], s26 offen offset:0
    buffer_load_dword v105, v49, s[88:91], s26 offen offset:0
    buffer_load_dword v106, v50, s[88:91], s26 offen offset:0
    buffer_load_dword v107, v51, s[88:91], s26 offen offset:0
    buffer_load_dword v108, v52, s[88:91], s26 offen offset:0
    buffer_load_dword v109, v53, s[88:91], s26 offen offset:0
    buffer_load_dword v110, v54, s[88:91], s26 offen offset:0
    buffer_load_dword v111, v55, s[88:91], s26 offen offset:0
    s_add_u32 s26, s26, 20480
    s_waitcnt vmcnt(48)
    v_perm_b32 v56, v113, v112, s92
    v_perm_b32 v57, v115, v114, s92
    v_perm_b32 v58, v117, v116, s92
    v_perm_b32 v59, v119, v118, s92
    ds_write_b128 v3, v[56:59] offset:26624
    v_perm_b32 v60, v113, v112, s93
    v_perm_b32 v61, v115, v114, s93
    v_perm_b32 v62, v117, v116, s93
    v_perm_b32 v63, v119, v118, s93
    ds_write_b128 v3, v[60:63] offset:27648
    buffer_load_dword v112, v48, s[88:91], s26 offen offset:0
    buffer_load_dword v113, v49, s[88:91], s26 offen offset:0
    buffer_load_dword v114, v50, s[88:91], s26 offen offset:0
    buffer_load_dword v115, v51, s[88:91], s26 offen offset:0
    buffer_load_dword v116, v52, s[88:91], s26 offen offset:0
    buffer_load_dword v117, v53, s[88:91], s26 offen offset:0
    buffer_load_dword v118, v54, s[88:91], s26 offen offset:0
    buffer_load_dword v119, v55, s[88:91], s26 offen offset:0
    s_add_u32 s26, s26, 20480
    s_waitcnt vmcnt(48)
    v_perm_b32 v208, v65, v64, s92
    v_perm_b32 v209, v67, v66, s92
    v_perm_b32 v210, v69, v68, s92
    v_perm_b32 v211, v71, v70, s92
    v_perm_b32 v212, v65, v64, s93
    v_perm_b32 v213, v67, v66, s93
    v_perm_b32 v214, v69, v68, s93
    v_perm_b32 v215, v71, v70, s93
    buffer_load_dword v64, v48, s[88:91], s26 offen offset:0
    buffer_load_dword v65, v49, s[88:91], s26 offen offset:0
    buffer_load_dword v66, v50, s[88:91], s26 offen offset:0
    buffer_load_dword v67, v51, s[88:91], s26 offen offset:0
    buffer_load_dword v68, v52, s[88:91], s26 offen offset:0
    buffer_load_dword v69, v53, s[88:91], s26 offen offset:0
    buffer_load_dword v70, v54, s[88:91], s26 offen offset:0
    buffer_load_dword v71, v55, s[88:91], s26 offen offset:0
    s_add_u32 s26, s26, 20480
    s_waitcnt vmcnt(48)
    v_perm_b32 v216, v73, v72, s92
    v_perm_b32 v217, v75, v74, s92
    v_perm_b32 v218, v77, v76, s92
    v_perm_b32 v219, v79, v78, s92
    v_perm_b32 v220, v73, v72, s93
    v_perm_b32 v221, v75, v74, s93
    v_perm_b32 v222, v77, v76, s93
    v_perm_b32 v223, v79, v78, s93
    s_waitcnt vmcnt(40)
    v_perm_b32 v224, v81, v80, s92
    v_perm_b32 v225, v83, v82, s92
    v_perm_b32 v226, v85, v84, s92
    v_perm_b32 v227, v87, v86, s92
    v_perm_b32 v228, v81, v80, s93
    v_perm_b32 v229, v83, v82, s93
    v_perm_b32 v230, v85, v84, s93
    v_perm_b32 v231, v87, v86, s93
    s_waitcnt vmcnt(32)
    v_perm_b32 v56, v89, v88, s92
    v_perm_b32 v57, v91, v90, s92
    v_perm_b32 v58, v93, v92, s92
    v_perm_b32 v59, v95, v94, s92
    ds_write_b128 v3, v[56:59] offset:28672
    v_perm_b32 v60, v89, v88, s93
    v_perm_b32 v61, v91, v90, s93
    v_perm_b32 v62, v93, v92, s93
    v_perm_b32 v63, v95, v94, s93
    ds_write_b128 v3, v[60:63] offset:29696
    s_waitcnt vmcnt(24)
    v_perm_b32 v232, v97, v96, s92
    v_perm_b32 v233, v99, v98, s92
    v_perm_b32 v234, v101, v100, s92
    v_perm_b32 v235, v103, v102, s92
    v_perm_b32 v236, v97, v96, s93
    v_perm_b32 v237, v99, v98, s93
    v_perm_b32 v238, v101, v100, s93
    v_perm_b32 v239, v103, v102, s93
    s_waitcnt vmcnt(16)
    v_perm_b32 v240, v105, v104, s92
    v_perm_b32 v241, v107, v106, s92
    v_perm_b32 v242, v109, v108, s92
    v_perm_b32 v243, v111, v110, s92
    v_perm_b32 v244, v105, v104, s93
    v_perm_b32 v245, v107, v106, s93
    v_perm_b32 v246, v109, v108, s93
    v_perm_b32 v247, v111, v110, s93
    s_waitcnt vmcnt(8)
    v_perm_b32 v248, v113, v112, s92
    v_perm_b32 v249, v115, v114, s92
    v_perm_b32 v250, v117, v116, s92
    v_perm_b32 v251, v119, v118, s92
    v_perm_b32 v252, v113, v112, s93
    v_perm_b32 v253, v115, v114, s93
    v_perm_b32 v254, v117, v116, s93
    v_perm_b32 v255, v119, v118, s93
    s_waitcnt vmcnt(0)
    v_perm_b32 v56, v65, v64, s92
    v_perm_b32 v57, v67, v66, s92
    v_perm_b32 v58, v69, v68, s92
    v_perm_b32 v59, v71, v70, s92
    ds_write_b128 v3, v[56:59] offset:30720
    v_perm_b32 v60, v65, v64, s93
    v_perm_b32 v61, v67, v66, s93
    v_perm_b32 v62, v69, v68, s93
    v_perm_b32 v63, v71, v70, s93
    ds_write_b128 v3, v[60:63] offset:31744
    s_waitcnt lgkmcnt(0)
    s_mov_b32 s24, 0
WI_190:
    buffer_load_dword v7, off, s[96:99], 0 offset:128 sc1
    s_waitcnt vmcnt(0)
    v_cmp_le_u32 vcc, 256, v7
    s_cbranch_vccnz WO_191
    s_sleep 4
    s_add_u32 s24, s24, 1
    s_cmp_lt_u32 s24, 200000
    s_cbranch_scc1 WI_190
    s_branch F_O
WO_191:
    s_mov_b32 s28, 0
    s_xor_b32 s21, s9, 1
    s_lshl_b32 s21, s21, 13
    v_add_u32 v5, s21, v1
    s_xor_b32 s21, s9, 2
    s_lshl_b32 s21, s21, 13
    v_add_u32 v9, s21, v1
    s_xor_b32 s21, s9, 3
    s_lshl_b32 s21, s21, 13
    v_add_u32 v10, s21, v1
    s_lshl_b32 s31, s100, 2
    s_add_u32 s31, s31, s9
    s_lshl_b32 s31, s31, 7
    s_add_u32 s31, s31, 156246016
    s_mov_b32 s30, s31
    s_cmp_eq_u32 s32, 3
    s_cselect_b32 s17, s31, s17
    s_cselect_b32 s33, 0, 1024
T2_ITEM_192:
    ds_read_b128 v[16:19], v3 offset:0
    ds_read_b128 v[20:23], v3 offset:1024
    ds_read_b128 v[24:27], v3 offset:2048
    ds_read_b128 v[28:31], v3 offset:3072
    s_cmp_lg_u32 s28, 0
    s_cbranch_scc1 T2_HAVE_193
    s_mov_b32 s24, 0
    s_mov_b64 exec, s[14:15]
    buffer_load_dword v7, v11, s[4:7], s13 offen sc1
    s_waitcnt vmcnt(0)
    v_cmp_eq_u32 vcc, 0, v7
    s_mov_b64 exec, 1
    buffer_store_dword v6, off, s[4:7], s30 sc1
    s_mov_b64 exec, -1
    s_mov_b32 s30, s31
    s_cbranch_vccz PO_195
    s_mov_b64 exec, s[14:15]
PL_194:
    buffer_load_dword v7, v11, s[4:7], s13 offen sc1
    s_waitcnt vmcnt(0)
    v_cmp_eq_u32 vcc, 0, v7
    s_cbranch_vccz PO_195
    s_sleep 2
    s_add_u32 s24, s24, 1
    s_cmp_lt_u32 s24, 200000
    s_cbranch_scc1 PL_194
    s_branch F_O
PO_195:
    s_mov_b64 exec, -1
    s_add_u32 s26, s12, 0
    buffer_load_dwordx4 v[32:35], v1, s[4:7], s26 offen sc1
    s_add_u32 s26, s12, 1024
    buffer_load_dwordx4 v[36:39], v1, s[4:7], s26 offen sc1
    s_add_u32 s26, s12, 2048
    buffer_load_dwordx4 v[40:43], v1, s[4:7], s26 offen sc1
    s_add_u32 s26, s12, 3072
    buffer_load_dwordx4 v[44:47], v1, s[4:7], s26 offen sc1
    s_add_u32 s26, s12, 4096
    buffer_load_dwordx4 v[48:51], v1, s[4:7], s26 offen sc1
    s_add_u32 s26, s12, 5120
    buffer_load_dwordx4 v[52:55], v1, s[4:7], s26 offen sc1
    s_add_u32 s26, s12, 6144
    buffer_load_dwordx4 v[56:59], v1, s[4:7], s26 offen sc1
    s_add_u32 s26, s12, 7168
    buffer_load_dwordx4 v[60:63], v1, s[4:7], s26 offen sc1
    s_add_u32 s26, s12, 8192
    buffer_load_dwordx4 v[64:67], v1, s[4:7], s26 offen sc1
    s_add_u32 s26, s12, 9216
    buffer_load_dwordx4 v[68:71], v1, s[4:7], s26 offen sc1
    s_add_u32 s26, s12, 10240
    buffer_load_dwordx4 v[72:75], v1, s[4:7], s26 offen sc1
    s_add_u32 s26, s12, 11264
    buffer_load_dwordx4 v[76:79], v1, s[4:7], s26 offen sc1
    s_add_u32 s26, s12, 12288
    buffer_load_dwordx4 v[80:83], v1, s[4:7], s26 offen sc1
    s_add_u32 s26, s12, 13312
    buffer_load_dwordx4 v[84:87], v1, s[4:7], s26 offen sc1
    s_add_u32 s26, s12, 14336
    buffer_load_dwordx4 v[88:91], v1, s[4:7], s26 offen sc1
    s_add_u32 s26, s12, 15360
    buffer_load_dwordx4 v[92:95], v1, s[4:7], s26 offen sc1
    buffer_load_dword v7, off, s[4:7], s13 sc1
T2_HAVE_193:
    s_add_u32 s13, s13, 1024
    s_waitcnt vmcnt(16)
    v_mfma_f32_32x32x16_bf16 v[96:111], a[0:3], v[32:35], 0
    v_mfma_f32_32x32x16_bf16 v[112:127], a[4:7], v[32:35], 0
    s_add_u32 s26, s12, 16384
    buffer_load_dwordx4 v[32:35], v1, s[4:7], s26 offen offset:0 sc1
    s_waitcnt vmcnt(16)
    v_mfma_f32_32x32x16_bf16 v[96:111], a[8:11], v[36:39], v[96:111]
    v_mfma_f32_32x32x16_bf16 v[112:127], a[12:15], v[36:39], v[112:127]
    buffer_load_dwordx4 v[36:39], v1, s[4:7], s26 offen offset:1024 sc1
    s_waitcnt vmcnt(16)
    v_mfma_f32_32x32x16_bf16 v[96:111], a[16:19], v[40:43], v[96:111]
    v_mfma_f32_32x32x16_bf16 v[112:127], a[20:23], v[40:43], v[112:127]
    buffer_load_dwordx4 v[40:43], v1, s[4:7], s26 offen offset:2048 sc1
    s_waitcnt vmcnt(16)
    s_waitcnt lgkmcnt(3)
    v_mfma_f32_32x32x16_bf16 v[96:111], v[16:19], v[44:47], v[96:111]
    s_waitcnt lgkmcnt(2)
    v_mfma_f32_32x32x16_bf16 v[112:127], v[20:23], v[44:47], v[112:127]
    buffer_load_dwordx4 v[44:47], v1, s[4:7], s26 offen offset:3072 sc1
    ds_read_b128 v[16:19], v3 offset:4096
    ds_read_b128 v[20:23], v3 offset:5120
    s_waitcnt vmcnt(16)
    v_mfma_f32_32x32x16_bf16 v[96:111], a[24:27], v[48:51], v[96:111]
    v_mfma_f32_32x32x16_bf16 v[112:127], a[28:31], v[48:51], v[112:127]
    s_add_u32 s26, s12, 20480
    buffer_load_dwordx4 v[48:51], v1, s[4:7], s26 offen offset:0 sc1
    s_waitcnt vmcnt(16)
    v_mfma_f32_32x32x16_bf16 v[96:111], a[32:35], v[52:55], v[96:111]
    v_mfma_f32_32x32x16_bf16 v[112:127], a[36:39], v[52:55], v[112:127]
    buffer_load_dwordx4 v[52:55], v1, s[4:7], s26 offen offset:1024 sc1
    s_waitcnt vmcnt(16)
    v_mfma_f32_32x32x16_bf16 v[96:111], a[40:43], v[56:59], v[96:111]
    v_mfma_f32_32x32x16_bf16 v[112:127], a[44:47], v[56:59], v[112:127]
    buffer_load_dwordx4 v[56:59], v1, s[4:7], s26 offen offset:2048 sc1
    s_waitcnt vmcnt(16)
    s_waitcnt lgkmcnt(3)
    v_mfma_f32_32x32x16_bf16 v[96:111], v[24:27], v[60:63], v[96:111]
    s_waitcnt lgkmcnt(2)
    v_mfma_f32_32x32x16_bf16 v[112:127], v[28:31], v[60:63], v[112:127]
    buffer_load_dwordx4 v[60:63], v1, s[4:7], s26 offen offset:3072 sc1
    ds_read_b128 v[24:27], v3 offset:6144
    ds_read_b128 v[28:31], v3 offset:7168
    s_waitcnt vmcnt(16)
    v_mfma_f32_32x32x16_bf16 v[96:111], a[48:51], v[64:67], v[96:111]
    v_mfma_f32_32x32x16_bf16 v[112:127], a[52:55], v[64:67], v[112:127]
    s_add_u32 s26, s12, 24576
    buffer_load_dwordx4 v[64:67], v1, s[4:7], s26 offen offset:0 sc1
    s_waitcnt vmcnt(16)
    v_mfma_f32_32x32x16_bf16 v[96:111], a[56:59], v[68:71], v[96:111]
    s_waitcnt vmcnt(9)
    s_mov_b64 exec, 1
    buffer_store_dword v6, off, s[4:7], s30 sc1
    s_mov_b64 exec, -1
    s_mov_b32 s30, s31
    v_mfma_f32_32x32x16_bf16 v[112:127], a[60:63], v[68:71], v[112:127]
    buffer_load_dwordx4 v[68:71], v1, s[4:7], s26 offen offset:1024 sc1
    v_mfma_f32_32x32x16_bf16 v[96:111], a[64:67], v[72:75], v[96:111]
    v_mfma_f32_32x32x16_bf16 v[112:127], a[68:71], v[72:75], v[112:127]
    buffer_load_dwordx4 v[72:75], v1, s[4:7], s26 offen offset:2048 sc1
    s_waitcnt lgkmcnt(3)
    v_mfma_f32_32x32x16_bf16 v[96:111], v[16:19], v[76:79], v[96:111]
    s_waitcnt lgkmcnt(2)
    v_mfma_f32_32x32x16_bf16 v[112:127], v[20:23], v[76:79], v[112:127]
    buffer_load_dwordx4 v[76:79], v1, s[4:7], s26 offen offset:3072 sc1
    ds_read_b128 v[16:19], v3 offset:8192
    ds_read_b128 v[20:23], v3 offset:9216
    v_mfma_f32_32x32x16_bf16 v[96:111], a[72:75], v[80:83], v[96:111]
    v_mfma_f32_32x32x16_bf16 v[112:127], a[76:79], v[80:83], v[112:127]
    s_add_u32 s26, s12, 28672
    buffer_load_dwordx4 v[80:83], v1, s[4:7], s26 offen offset:0 sc1
    v_mfma_f32_32x32x16_bf16 v[96:111], a[80:83], v[84:87], v[96:111]
    v_mfma_f32_32x32x16_bf16 v[112:127], a[84:87], v[84:87], v[112:127]
    buffer_load_dwordx4 v[84:87], v1, s[4:7], s26 offen offset:1024 sc1
    v_mfma_f32_32x32x16_bf16 v[96:111], a[88:91], v[88:91], v[96:111]
    v_mfma_f32_32x32x16_bf16 v[112:127], a[92:95], v[88:91], v[112:127]
    buffer_load_dwordx4 v[88:91], v1, s[4:7], s26 offen offset:2048 sc1
    s_waitcnt lgkmcnt(3)
    v_mfma_f32_32x32x16_bf16 v[96:111], v[24:27], v[92:95], v[96:111]
    s_waitcnt lgkmcnt(2)
    v_mfma_f32_32x32x16_bf16 v[112:127], v[28:31], v[92:95], v[112:127]
    buffer_load_dwordx4 v[92:95], v1, s[4:7], s26 offen offset:3072 sc1
    ds_read_b128 v[24:27], v3 offset:10240
    ds_read_b128 v[28:31], v3 offset:11264
    s_waitcnt vmcnt(16)
    v_mfma_f32_32x32x16_bf16 v[96:111], a[96:99], v[32:35], v[96:111]
    v_mfma_f32_32x32x16_bf16 v[112:127], a[100:103], v[32:35], v[112:127]
    s_add_u32 s26, s12, 32768
    buffer_load_dwordx4 v[32:35], v1, s[4:7], s26 offen offset:0 sc1
    s_waitcnt vmcnt(16)
    v_mfma_f32_32x32x16_bf16 v[96:111], a[104:107], v[36:39], v[96:111]
    v_mfma_f32_32x32x16_bf16 v[112:127], a[108:111], v[36:39], v[112:127]
    buffer_load_dwordx4 v[36:39], v1, s[4:7], s26 offen offset:1024 sc1
    s_waitcnt vmcnt(16)
    v_mfma_f32_32x32x16_bf16 v[96:111], a[112:115], v[40:43], v[96:111]
    v_mfma_f32_32x32x16_bf16 v[112:127], a[116:119], v[40:43], v[112:127]
    buffer_load_dwordx4 v[40:43], v1, s[4:7], s26 offen offset:2048 sc1
    s_waitcnt vmcnt(16)
    s_waitcnt lgkmcnt(3)
    v_mfma_f32_32x32x16_bf16 v[96:111], v[16:19], v[44:47], v[96:111]
    s_waitcnt lgkmcnt(2)
    v_mfma_f32_32x32x16_bf16 v[112:127], v[20:23], v[44:47], v[112:127]
    buffer_load_dwordx4 v[44:47], v1, s[4:7], s26 offen offset:3072 sc1
    ds_read_b128 v[16:19], v3 offset:12288
    ds_read_b128 v[20:23], v3 offset:13312
    s_waitcnt vmcnt(16)
    v_mfma_f32_32x32x16_bf16 v[96:111], a[120:123], v[48:51], v[96:111]
    v_mfma_f32_32x32x16_bf16 v[112:127], a[124:127], v[48:51], v[112:127]
    s_add_u32 s26, s12, 36864
    buffer_load_dwordx4 v[48:51], v1, s[4:7], s26 offen offset:0 sc1
    s_waitcnt vmcnt(16)
    v_mfma_f32_32x32x16_bf16 v[96:111], a[128:131], v[52:55], v[96:111]
    v_mfma_f32_32x32x16_bf16 v[112:127], a[132:135], v[52:55], v[112:127]
    buffer_load_dwordx4 v[52:55], v1, s[4:7], s26 offen offset:1024 sc1
    s_waitcnt vmcnt(16)
    v_mfma_f32_32x32x16_bf16 v[96:111], a[136:139], v[56:59], v[96:111]
    v_mfma_f32_32x32x16_bf16 v[112:127], a[140:143], v[56:59], v[112:127]
    buffer_load_dwordx4 v[56:59], v1, s[4:7], s26 offen offset:2048 sc1
    s_waitcnt vmcnt(16)
    s_waitcnt lgkmcnt(3)
    v_mfma_f32_32x32x16_bf16 v[96:111], v[24:27], v[60:63], v[96:111]
    s_waitcnt lgkmcnt(2)
    v_mfma_f32_32x32x16_bf16 v[112:127], v[28:31], v[60:63], v[112:127]
    buffer_load_dwordx4 v[60:63], v1, s[4:7], s26 offen offset:3072 sc1
    ds_read_b128 v[24:27], v3 offset:14336
    ds_read_b128 v[28:31], v3 offset:15360
    s_waitcnt vmcnt(16)
    v_mfma_f32_32x32x16_bf16 v[96:111], a[144:147], v[64:67], v[96:111]
    v_mfma_f32_32x32x16_bf16 v[112:127], a[148:151], v[64:67], v[112:127]
    s_add_u32 s26, s12, 40960
    buffer_load_dwordx4 v[64:67], v1, s[4:7], s26 offen offset:0 sc1
    s_waitcnt vmcnt(15)
    v_mfma_f32_32x32x16_bf16 v[96:111], a[152:155], v[68:71], v[96:111]
    v_mfma_f32_32x32x16_bf16 v[112:127], a[156:159], v[68:71], v[112:127]
    buffer_load_dwordx4 v[68:71], v1, s[4:7], s26 offen offset:1024 sc1
    s_waitcnt vmcnt(15)
    v_mfma_f32_32x32x16_bf16 v[96:111], a[160:163], v[72:75], v[96:111]
    v_mfma_f32_32x32x16_bf16 v[112:127], a[164:167], v[72:75], v[112:127]
    buffer_load_dwordx4 v[72:75], v1, s[4:7], s26 offen offset:2048 sc1
    s_waitcnt vmcnt(15)
    s_waitcnt lgkmcnt(3)
    v_mfma_f32_32x32x16_bf16 v[96:111], v[16:19], v[76:79], v[96:111]
    s_waitcnt lgkmcnt(2)
    v_mfma_f32_32x32x16_bf16 v[112:127], v[20:23], v[76:79], v[112:127]
    buffer_load_dwordx4 v[76:79], v1, s[4:7], s26 offen offset:3072 sc1
    ds_read_b128 v[16:19], v3 offset:16384
    ds_read_b128 v[20:23], v3 offset:17408
    s_waitcnt vmcnt(15)
    v_mfma_f32_32x32x16_bf16 v[96:111], a[168:171], v[80:83], v[96:111]
    v_mfma_f32_32x32x16_bf16 v[112:127], a[172:175], v[80:83], v[112:127]
    s_add_u32 s26, s12, 45056
    buffer_load_dwordx4 v[80:83], v1, s[4:7], s26 offen offset:0 sc1
    s_waitcnt vmcnt(15)
    v_mfma_f32_32x32x16_bf16 v[96:111], a[176:179], v[84:87], v[96:111]
    v_mfma_f32_32x32x16_bf16 v[112:127], a[180:183], v[84:87], v[112:127]
    buffer_load_dwordx4 v[84:87], v1, s[4:7], s26 offen offset:1024 sc1
    s_waitcnt vmcnt(15)
    v_mfma_f32_32x32x16_bf16 v[96:111], a[184:187], v[88:91], v[96:111]
    v_mfma_f32_32x32x16_bf16 v[112:127], a[188:191], v[88:91], v[112:127]
    buffer_load_dwordx4 v[88:91], v1, s[4:7], s26 offen offset:2048 sc1
    s_waitcnt vmcnt(15)
    s_waitcnt lgkmcnt(3)
    v_mfma_f32_32x32x16_bf16 v[96:111], v[24:27], v[92:95], v[96:111]
    s_waitcnt lgkmcnt(2)
    v_mfma_f32_32x32x16_bf16 v[112:127], v[28:31], v[92:95], v[112:127]
    buffer_load_dwordx4 v[92:95], v1, s[4:7], s26 offen offset:3072 sc1
    ds_read_b128 v[24:27], v3 offset:18432
    ds_read_b128 v[28:31], v3 offset:19456
    s_waitcnt vmcnt(15)
    v_mfma_f32_32x32x16_bf16 v[96:111], a[192:195], v[32:35], v[96:111]
    v_mfma_f32_32x32x16_bf16 v[112:127], a[196:199], v[32:35], v[112:127]
    s_add_u32 s26, s12, 49152
    buffer_load_dwordx4 v[32:35], v1, s[4:7], s26 offen offset:0 sc1
    s_waitcnt vmcnt(15)
    v_mfma_f32_32x32x16_bf16 v[96:111], a[200:203], v[36:39], v[96:111]
    v_mfma_f32_32x32x16_bf16 v[112:127], a[204:207], v[36:39], v[112:127]
    buffer_load_dwordx4 v[36:39], v1, s[4:7], s26 offen offset:1024 sc1
    s_waitcnt vmcnt(15)
    v_mfma_f32_32x32x16_bf16 v[96:111], a[208:211], v[40:43], v[96:111]
    v_mfma_f32_32x32x16_bf16 v[112:127], a[212:215], v[40:43], v[112:127]
    buffer_load_dwordx4 v[40:43], v1, s[4:7], s26 offen offset:2048 sc1
    s_waitcnt vmcnt(15)
    s_waitcnt lgkmcnt(3)
    v_mfma_f32_32x32x16_bf16 v[96:111], v[16:19], v[44:47], v[96:111]
    s_waitcnt lgkmcnt(2)
    v_mfma_f32_32x32x16_bf16 v[112:127], v[20:23], v[44:47], v[112:127]
    buffer_load_dwordx4 v[44:47], v1, s[4:7], s26 offen offset:3072 sc1
    ds_read_b128 v[16:19], v3 offset:20480
    ds_read_b128 v[20:23], v3 offset:21504
    s_waitcnt vmcnt(15)
    v_mfma_f32_32x32x16_bf16 v[96:111], a[216:219], v[48:51], v[96:111]
    v_mfma_f32_32x32x16_bf16 v[112:127], a[220:223], v[48:51], v[112:127]
    s_add_u32 s26, s12, 53248
    buffer_load_dwordx4 v[48:51], v1, s[4:7], s26 offen offset:0 sc1
    s_waitcnt vmcnt(15)
    v_mfma_f32_32x32x16_bf16 v[96:111], a[224:227], v[52:55], v[96:111]
    v_mfma_f32_32x32x16_bf16 v[112:127], a[228:231], v[52:55], v[112:127]
    buffer_load_dwordx4 v[52:55], v1, s[4:7], s26 offen offset:1024 sc1
    s_waitcnt vmcnt(15)
    v_mfma_f32_32x32x16_bf16 v[96:111], a[232:235], v[56:59], v[96:111]
    s_mov_b64 exec, s[14:15]
    buffer_load_dword v7, v11, s[4:7], s13 offen sc1
    s_mov_b64 exec, -1
    buffer_load_dwordx4 v[12:15], v1, s[4:7], s18 offen sc1
    v_mfma_f32_32x32x16_bf16 v[112:127], a[236:239], v[56:59], v[112:127]
    buffer_load_dwordx4 v[56:59], v1, s[4:7], s26 offen offset:2048 sc1
    s_waitcnt vmcnt(17)
    s_waitcnt lgkmcnt(3)
    v_mfma_f32_32x32x16_bf16 v[96:111], v[24:27], v[60:63], v[96:111]
    s_waitcnt lgkmcnt(2)
    v_mfma_f32_32x32x16_bf16 v[112:127], v[28:31], v[60:63], v[112:127]
    buffer_load_dwordx4 v[60:63], v1, s[4:7], s26 offen offset:3072 sc1
    ds_read_b128 v[24:27], v3 offset:22528
    ds_read_b128 v[28:31], v3 offset:23552
    s_waitcnt vmcnt(17)
    v_mfma_f32_32x32x16_bf16 v[96:111], a[240:243], v[64:67], v[96:111]
    v_mfma_f32_32x32x16_bf16 v[112:127], a[244:247], v[64:67], v[112:127]
    s_add_u32 s26, s12, 57344
    buffer_load_dwordx4 v[64:67], v1, s[4:7], s26 offen offset:0 sc1
    s_waitcnt vmcnt(17)
    v_mfma_f32_32x32x16_bf16 v[96:111], a[248:251], v[68:71], v[96:111]
    v_mfma_f32_32x32x16_bf16 v[112:127], a[252:255], v[68:71], v[112:127]
    buffer_load_dwordx4 v[68:71], v1, s[4:7], s26 offen offset:1024 sc1
    s_waitcnt vmcnt(17)
    v_mfma_f32_32x32x16_bf16 v[96:111], v[128:131], v[72:75], v[96:111]
    v_mfma_f32_32x32x16_bf16 v[112:127], v[132:135], v[72:75], v[112:127]
    buffer_load_dwordx4 v[72:75], v1, s[4:7], s26 offen offset:2048 sc1
    s_waitcnt vmcnt(17)
    s_waitcnt lgkmcnt(3)
    v_mfma_f32_32x32x16_bf16 v[96:111], v[16:19], v[76:79], v[96:111]
    s_waitcnt lgkmcnt(2)
    v_mfma_f32_32x32x16_bf16 v[112:127], v[20:23], v[76:79], v[112:127]
    buffer_load_dwordx4 v[76:79], v1, s[4:7], s26 offen offset:3072 sc1
    ds_read_b128 v[16:19], v3 offset:24576
    ds_read_b128 v[20:23], v3 offset:25600
    s_waitcnt vmcnt(17)
    v_mfma_f32_32x32x16_bf16 v[96:111], v[136:139], v[80:83], v[96:111]
    v_mfma_f32_32x32x16_bf16 v[112:127], v[140:143], v[80:83], v[112:127]
    s_add_u32 s26, s12, 61440
    buffer_load_dwordx4 v[80:83], v1, s[4:7], s26 offen offset:0 sc1
    s_waitcnt vmcnt(17)
    v_mfma_f32_32x32x16_bf16 v[96:111], v[144:147], v[84:87], v[96:111]
    v_mfma_f32_32x32x16_bf16 v[112:127], v[148:151], v[84:87], v[112:127]
    buffer_load_dwordx4 v[84:87], v1, s[4:7], s26 offen offset:1024 sc1
    s_waitcnt vmcnt(17)
    v_mfma_f32_32x32x16_bf16 v[96:111], v[152:155], v[88:91], v[96:111]
    v_mfma_f32_32x32x16_bf16 v[112:127], v[156:159], v[88:91], v[112:127]
    buffer_load_dwordx4 v[88:91], v1, s[4:7], s26 offen offset:2048 sc1
    s_waitcnt vmcnt(17)
    s_waitcnt lgkmcnt(3)
    v_mfma_f32_32x32x16_bf16 v[96:111], v[24:27], v[92:95], v[96:111]
    s_waitcnt lgkmcnt(2)
    v_mfma_f32_32x32x16_bf16 v[112:127], v[28:31], v[92:95], v[112:127]
    buffer_load_dwordx4 v[92:95], v1, s[4:7], s26 offen offset:3072 sc1
    ds_read_b128 v[24:27], v3 offset:26624
    ds_read_b128 v[28:31], v3 offset:27648
    s_waitcnt vmcnt(17)
    v_mfma_f32_32x32x16_bf16 v[96:111], v[160:163], v[32:35], v[96:111]
    s_waitcnt vmcnt(11)
    v_cmp_eq_u32 vcc, 0, v7
    s_and_b64 vcc, vcc, s[14:15]
    s_cselect_b32 s28, 0, 1
    s_cmp_ge_u32 s10, 62
    s_cselect_b32 s28, 0, s28
    s_mul_i32 s29, s28, 524288
    s_add_u32 s29, s29, s12
    s_cmp_lg_u32 s28, 0
    s_cselect_b64 s[36:37], -1, 1
    v_mfma_f32_32x32x16_bf16 v[112:127], v[164:167], v[32:35], v[112:127]
    s_add_u32 s26, s29, 0
    s_mov_b64 exec, s[36:37]
    buffer_load_dwordx4 v[32:35], v1, s[4:7], s26 offen sc1
    s_mov_b64 exec, -1
    v_mfma_f32_32x32x16_bf16 v[96:111], v[168:171], v[36:39], v[96:111]
    v_mfma_f32_32x32x16_bf16 v[112:127], v[172:175], v[36:39], v[112:127]
    s_add_u32 s26, s29, 1024
    s_mov_b64 exec, s[36:37]
    buffer_load_dwordx4 v[36:39], v1, s[4:7], s26 offen sc1
    s_mov_b64 exec, -1
    v_mfma_f32_32x32x16_bf16 v[96:111], v[176:179], v[40:43], v[96:111]
    v_mfma_f32_32x32x16_bf16 v[112:127], v[180:183], v[40:43], v[112:127]
    s_add_u32 s26, s29, 2048
    s_mov_b64 exec, s[36:37]
    buffer_load_dwordx4 v[40:43], v1, s[4:7], s26 offen sc1
    s_mov_b64 exec, -1
    s_waitcnt lgkmcnt(3)
    v_mfma_f32_32x32x16_bf16 v[96:111], v[16:19], v[44:47], v[96:111]
    s_waitcnt lgkmcnt(2)
    v_mfma_f32_32x32x16_bf16 v[112:127], v[20:23], v[44:47], v[112:127]
    s_add_u32 s26, s29, 3072
    s_mov_b64 exec, s[36:37]
    buffer_load_dwordx4 v[44:47], v1, s[4:7], s26 offen sc1
    s_mov_b64 exec, -1
    ds_read_b128 v[16:19], v3 offset:28672
    ds_read_b128 v[20:23], v3 offset:29696
    v_mfma_f32_32x32x16_bf16 v[96:111], v[184:187], v[48:51], v[96:111]
    v_mfma_f32_32x32x16_bf16 v[112:127], v[188:191], v[48:51], v[112:127]
    s_add_u32 s26, s29, 4096
    s_mov_b64 exec, s[36:37]
    buffer_load_dwordx4 v[48:51], v1, s[4:7], s26 offen sc1
    s_mov_b64 exec, -1
    v_mfma_f32_32x32x16_bf16 v[96:111], v[192:195], v[52:55], v[96:111]
    v_mfma_f32_32x32x16_bf16 v[112:127], v[196:199], v[52:55], v[112:127]
    s_add_u32 s26, s29, 5120
    s_mov_b64 exec, s[36:37]
    buffer_load_dwordx4 v[52:55], v1, s[4:7], s26 offen sc1
    s_mov_b64 exec, -1
    s_waitcnt vmcnt(15)
    v_mfma_f32_32x32x16_bf16 v[96:111], v[200:203], v[56:59], v[96:111]
    v_mfma_f32_32x32x16_bf16 v[112:127], v[204:207], v[56:59], v[112:127]
    s_add_u32 s26, s29, 6144
    s_mov_b64 exec, s[36:37]
    buffer_load_dwordx4 v[56:59], v1, s[4:7], s26 offen sc1
    s_mov_b64 exec, -1
    s_waitcnt vmcnt(15)
    s_waitcnt lgkmcnt(3)
    v_mfma_f32_32x32x16_bf16 v[96:111], v[24:27], v[60:63], v[96:111]
    s_waitcnt lgkmcnt(2)
    v_mfma_f32_32x32x16_bf16 v[112:127], v[28:31], v[60:63], v[112:127]
    s_add_u32 s26, s29, 7168
    s_mov_b64 exec, s[36:37]
    buffer_load_dwordx4 v[60:63], v1, s[4:7], s26 offen sc1
    s_mov_b64 exec, -1
    ds_read_b128 v[24:27], v3 offset:30720
    ds_read_b128 v[28:31], v3 offset:31744
    s_waitcnt vmcnt(15)
    v_mfma_f32_32x32x16_bf16 v[96:111], v[208:211], v[64:67], v[96:111]
    v_mfma_f32_32x32x16_bf16 v[112:127], v[212:215], v[64:67], v[112:127]
    s_add_u32 s26, s29, 8192
    s_mov_b64 exec, s[36:37]
    buffer_load_dwordx4 v[64:67], v1, s[4:7], s26 offen sc1
    s_mov_b64 exec, -1
    s_waitcnt vmcnt(15)
    v_mfma_f32_32x32x16_bf16 v[96:111], v[216:219], v[68:71], v[96:111]
    v_mfma_f32_32x32x16_bf16 v[112:127], v[220:223], v[68:71], v[112:127]
    s_add_u32 s26, s29, 9216
    s_mov_b64 exec, s[36:37]
    buffer_load_dwordx4 v[68:71], v1, s[4:7], s26 offen sc1
    s_mov_b64 exec, -1
    s_waitcnt vmcnt(15)
    v_mfma_f32_32x32x16_bf16 v[96:111], v[224:227], v[72:75], v[96:111]
    v_mfma_f32_32x32x16_bf16 v[112:127], v[228:231], v[72:75], v[112:127]
    s_add_u32 s26, s29, 10240
    s_mov_b64 exec, s[36:37]
    buffer_load_dwordx4 v[72:75], v1, s[4:7], s26 offen sc1
    s_mov_b64 exec, -1
    s_waitcnt vmcnt(15)
    s_waitcnt lgkmcnt(3)
    v_mfma_f32_32x32x16_bf16 v[96:111], v[16:19], v[76:79], v[96:111]
    s_waitcnt lgkmcnt(2)
    v_mfma_f32_32x32x16_bf16 v[112:127], v[20:23], v[76:79], v[112:127]
    s_add_u32 s26, s29, 11264
    s_mov_b64 exec, s[36:37]
    buffer_load_dwordx4 v[76:79], v1, s[4:7], s26 offen sc1
    s_mov_b64 exec, -1
    s_waitcnt vmcnt(15)
    v_mfma_f32_32x32x16_bf16 v[96:111], v[232:235], v[80:83], v[96:111]
    v_mfma_f32_32x32x16_bf16 v[112:127], v[236:239], v[80:83], v[112:127]
    s_add_u32 s26, s29, 12288
    s_mov_b64 exec, s[36:37]
    buffer_load_dwordx4 v[80:83], v1, s[4:7], s26 offen sc1
    s_mov_b64 exec, -1
    s_waitcnt vmcnt(15)
    v_mfma_f32_32x32x16_bf16 v[96:111], v[240:243], v[84:87], v[96:111]
    s_waitcnt vmcnt(14)
    v_mfma_f32_32x32x16_bf16 v[96:111], v[248:251], v[88:91], v[96:111]
    s_waitcnt lgkmcnt(1)
    s_waitcnt vmcnt(13)
    v_mfma_f32_32x32x16_bf16 v[96:111], v[24:27], v[92:95], v[96:111]
    v_mfma_f32_32x32x16_bf16 v[112:127], v[244:247], v[84:87], v[112:127]
    s_add_u32 s26, s29, 13312
    s_mov_b64 exec, s[36:37]
    buffer_load_dwordx4 v[84:87], v1, s[4:7], s26 offen sc1
    s_mov_b64 exec, -1
    v_mfma_f32_32x32x16_bf16 v[112:127], v[252:255], v[88:91], v[112:127]
    s_add_u32 s26, s29, 14336
    s_mov_b64 exec, s[36:37]
    buffer_load_dwordx4 v[88:91], v1, s[4:7], s26 offen sc1
    s_mov_b64 exec, -1
    s_waitcnt lgkmcnt(0)
    v_mfma_f32_32x32x16_bf16 v[112:127], v[28:31], v[92:95], v[112:127]
    s_add_u32 s26, s29, 15360
    s_mov_b64 exec, s[36:37]
    buffer_load_dwordx4 v[92:95], v1, s[4:7], s26 offen sc1
    s_mov_b64 exec, -1
    ds_write_b128 v4, v[100:103] offset:2048
    ds_write_b128 v4, v[104:107] offset:4096
    ds_write_b128 v4, v[108:111] offset:6144
    v_lshlrev_b32 v16, 16, v12
    v_and_b32 v17, 0xffff0000, v12
    v_lshlrev_b32 v18, 16, v13
    v_and_b32 v19, 0xffff0000, v13
    s_nop 0
    ds_write_b128 v4, v[116:119] offset:3072
    ds_write_b128 v4, v[120:123] offset:5120
    ds_write_b128 v4, v[124:127] offset:7168
    v_lshlrev_b32 v20, 16, v14
    v_and_b32 v21, 0xffff0000, v14
    v_lshlrev_b32 v22, 16, v15
    v_and_b32 v23, 0xffff0000, v15
    s_waitcnt lgkmcnt(0)
    s_barrier
    ds_read_b128 v[100:103], v5 offset:2048
    ds_read_b128 v[116:119], v5 offset:3072
    ds_read_b128 v[104:107], v9 offset:4096
    ds_read_b128 v[120:123], v9 offset:5120
    ds_read_b128 v[108:111], v10 offset:6144
    ds_read_b128 v[124:127], v10 offset:7168
    s_waitcnt lgkmcnt(5)
    v_pk_add_f32 v[96:97], v[96:97], v[100:101]
    v_pk_add_f32 v[98:99], v[98:99], v[102:103]
    s_waitcnt lgkmcnt(4)
    v_pk_add_f32 v[112:113], v[112:113], v[116:117]
    v_pk_add_f32 v[114:115], v[114:115], v[118:119]
    s_waitcnt lgkmcnt(3)
    v_pk_add_f32 v[96:97], v[96:97], v[104:105]
    v_pk_add_f32 v[98:99], v[98:99], v[106:107]
    s_waitcnt lgkmcnt(2)
    v_pk_add_f32 v[112:113], v[112:113], v[120:121]
    v_pk_add_f32 v[114:115], v[114:115], v[122:123]
    s_waitcnt lgkmcnt(1)
    v_pk_add_f32 v[96:97], v[96:97], v[108:109]
    v_pk_add_f32 v[98:99], v[98:99], v[110:111]
    s_waitcnt lgkmcnt(0)
    v_pk_add_f32 v[112:113], v[112:113], v[124:125]
    v_pk_add_f32 v[114:115], v[114:115], v[126:127]
    v_cvt_pk_bf16_f32 v12, v96, v112
    v_cvt_pk_bf16_f32 v13, v97, v113
    v_cvt_pk_bf16_f32 v14, v98, v114
    v_cvt_pk_bf16_f32 v15, v99, v115
    v_lshlrev_b32 v24, 16, v12
    v_and_b32 v25, 0xffff0000, v12
    v_lshlrev_b32 v26, 16, v13
    v_and_b32 v27, 0xffff0000, v13
    v_lshlrev_b32 v28, 16, v14
    v_and_b32 v29, 0xffff0000, v14
    v_lshlrev_b32 v30, 16, v15
    v_and_b32 v31, 0xffff0000, v15
    v_pk_add_f32 v[24:25], v[24:25], v[16:17]
    v_pk_add_f32 v[26:27], v[26:27], v[18:19]
    v_pk_add_f32 v[28:29], v[28:29], v[20:21]
    v_pk_add_f32 v[30:31], v[30:31], v[22:23]
    v_cvt_pk_bf16_f32 v12, v24, v25
    v_cvt_pk_bf16_f32 v13, v26, v27
    v_cvt_pk_bf16_f32 v14, v28, v29
    v_cvt_pk_bf16_f32 v15, v30, v31
    buffer_store_dwordx4 v[12:15], v2, s[40:43], s16 offen sc1
    s_barrier
    s_mov_b32 s30, s17
    s_add_u32 s12, s12, 524288
    s_add_u32 s17, s17, s33
    s_add_u32 s18, s18, 81920
    s_add_u32 s16, s16, 81920
    s_add_u32 s10, s10, 2
    s_cmp_lt_u32 s10, 64
    s_cbranch_scc1 T2_ITEM_192
    s_waitcnt vmcnt(0)
    s_mov_b64 exec, 1
    buffer_store_dword v6, off, s[4:7], s30 sc1
    s_mov_b64 exec, -1
    s_mov_b32 s30, s31
    s_endpgm
F_O:
    s_endpgm
.p2align 6
R_F1:
    v_lshrrev_b32 v2, 6, v0
    v_and_b32 v0, 63, v0
    v_readfirstlane_b32 s9, v2
    v_lshlrev_b32 v1, 4, v0
    v_lshlrev_b32 v11, 2, v0
    v_mov_b32 v2, v1
    v_and_b32 v6, 31, v0
    v_lshrrev_b32 v7, 5, v0
    v_lshlrev_b32 v4, 5, v6
    s_lshl_b32 s21, s9, 8
    s_add_u32 s21, s21, 83968
    v_lshlrev_b32 v3, 2, v6
    v_add_u32 v3, s21, v3
    v_lshlrev_b32 v5, 4, v7
    v_add_u32 v5, s21, v5
    s_mov_b32 s10, 0
    s_mov_b32 s18, 0
    s_mov_b32 s19, 0
    s_mov_b32 s25, 1
    s_mul_i32 s20, s9, 10240
    s_lshl_b32 s23, s8, 2
    s_add_u32 s23, s23, s9
    s_lshl_b32 s21, s11, 1
    s_add_u32 s21, s21, 1
    s_mul_i32 s12, s21, 2621440
    s_mul_i32 s13, s11, 32768
    s_add_u32 s13, s13, 155254784
    s_mov_b32 s14, 0x3ff
    s_mov_b32 s15, 0
    s_mul_i32 s16, s11, 7340032
    s_lshl_b32 s21, s23, 12
    s_add_u32 s16, s16, s21
    s_add_u32 s16, s16, 101711872
    s_mul_i32 s17, s11, 32768
    s_add_u32 s17, s17, 155320320
    s_mul_i32 s21, s23, 37
    s_lshr_b32 s21, s21, 8
    s_mul_i32 s21, s21, 100
    s_add_u32 s17, s17, s21
    s_min_u32 s22, s23, 26
    s_lshl_b32 s22, s22, 7
    s_lshl_b32 s36, s11, 17
    s_add_u32 s36, s36, 156041216
    s_add_u32 s12, s12, 116391936
    s_lshl_b32 s21, s9, 7
    s_add_u32 s13, s13, s21
    s_add_u32 s12, s12, s20
    s_lshl_b32 s21, s23, 2
    s_add_u32 s17, s17, s21
    s_load_dwordx2 s[88:89], s[0:1], 64
    s_mov_b32 s90, 2211840
    s_mov_b32 s91, 0x00020000
    s_mov_b32 s92, 0x05040100
    s_mov_b32 s93, 0x07060302
    s_waitcnt lgkmcnt(0)
    v_mul_u32_u24 v8, 27648, v7
    v_lshl_add_u32 v8, v6, 2, v8
    v_add_u32 v48, 0, v8
    v_add_u32 v49, 3456, v8
    v_add_u32 v50, 6912, v8
    v_add_u32 v51, 10368, v8
    v_add_u32 v52, 13824, v8
    v_add_u32 v53, 17280, v8
    v_add_u32 v54, 20736, v8
    v_add_u32 v55, 24192, v8
    buffer_load_dword v64, v48, s[88:91], s22 offen offset:0
    buffer_load_dword v65, v49, s[88:91], s22 offen offset:0
    buffer_load_dword v66, v50, s[88:91], s22 offen offset:0
    buffer_load_dword v67, v51, s[88:91], s22 offen offset:0
    buffer_load_dword v68, v52, s[88:91], s22 offen offset:0
    buffer_load_dword v69, v53, s[88:91], s22 offen offset:0
    buffer_load_dword v70, v54, s[88:91], s22 offen offset:0
    buffer_load_dword v71, v55, s[88:91], s22 offen offset:0
    s_add_u32 s22, s22, 55296
    buffer_load_dword v72, v48, s[88:91], s22 offen offset:0
    buffer_load_dword v73, v49, s[88:91], s22 offen offset:0
    buffer_load_dword v74, v50, s[88:91], s22 offen offset:0
    buffer_load_dword v75, v51, s[88:91], s22 offen offset:0
    buffer_load_dword v76, v52, s[88:91], s22 offen offset:0
    buffer_load_dword v77, v53, s[88:91], s22 offen offset:0
    buffer_load_dword v78, v54, s[88:91], s22 offen offset:0
    buffer_load_dword v79, v55, s[88:91], s22 offen offset:0
    s_add_u32 s22, s22, 55296
    buffer_load_dword v80, v48, s[88:91], s22 offen offset:0
    buffer_load_dword v81, v49, s[88:91], s22 offen offset:0
    buffer_load_dword v82, v50, s[88:91], s22 offen offset:0
    buffer_load_dword v83, v51, s[88:91], s22 offen offset:0
    buffer_load_dword v84, v52, s[88:91], s22 offen offset:0
    buffer_load_dword v85, v53, s[88:91], s22 offen offset:0
    buffer_load_dword v86, v54, s[88:91], s22 offen offset:0
    buffer_load_dword v87, v55, s[88:91], s22 offen offset:0
    s_add_u32 s22, s22, 55296
    buffer_load_dword v88, v48, s[88:91], s22 offen offset:0
    buffer_load_dword v89, v49, s[88:91], s22 offen offset:0
    buffer_load_dword v90, v50, s[88:91], s22 offen offset:0
    buffer_load_dword v91, v51, s[88:91], s22 offen offset:0
    buffer_load_dword v92, v52, s[88:91], s22 offen offset:0
    buffer_load_dword v93, v53, s[88:91], s22 offen offset:0
    buffer_load_dword v94, v54, s[88:91], s22 offen offset:0
    buffer_load_dword v95, v55, s[88:91], s22 offen offset:0
    s_add_u32 s22, s22, 55296
    buffer_load_dword v96, v48, s[88:91], s22 offen offset:0
    buffer_load_dword v97, v49, s[88:91], s22 offen offset:0
    buffer_load_dword v98, v50, s[88:91], s22 offen offset:0
    buffer_load_dword v99, v51, s[88:91], s22 offen offset:0
    buffer_load_dword v100, v52, s[88:91], s22 offen offset:0
    buffer_load_dword v101, v53, s[88:91], s22 offen offset:0
    buffer_load_dword v102, v54, s[88:91], s22 offen offset:0
    buffer_load_dword v103, v55, s[88:91], s22 offen offset:0
    s_add_u32 s22, s22, 55296
    buffer_load_dword v104, v48, s[88:91], s22 offen offset:0
    buffer_load_dword v105, v49, s[88:91], s22 offen offset:0
    buffer_load_dword v106, v50, s[88:91], s22 offen offset:0
    buffer_load_dword v107, v51, s[88:91], s22 offen offset:0
    buffer_load_dword v108, v52, s[88:91], s22 offen offset:0
    buffer_load_dword v109, v53, s[88:91], s22 offen offset:0
    buffer_load_dword v110, v54, s[88:91], s22 offen offset:0
    buffer_load_dword v111, v55, s[88:91], s22 offen offset:0
    s_add_u32 s22, s22, 55296
    buffer_load_dword v112, v48, s[88:91], s22 offen offset:0
    buffer_load_dword v113, v49, s[88:91], s22 offen offset:0
    buffer_load_dword v114, v50, s[88:91], s22 offen offset:0
    buffer_load_dword v115, v51, s[88:91], s22 offen offset:0
    buffer_load_dword v116, v52, s[88:91], s22 offen offset:0
    buffer_load_dword v117, v53, s[88:91], s22 offen offset:0
    buffer_load_dword v118, v54, s[88:91], s22 offen offset:0
    buffer_load_dword v119, v55, s[88:91], s22 offen offset:0
    s_add_u32 s22, s22, 55296
    s_waitcnt vmcnt(48)
    v_perm_b32 v56, v65, v64, s92
    v_perm_b32 v57, v67, v66, s92
    v_perm_b32 v58, v69, v68, s92
    v_perm_b32 v59, v71, v70, s92
    v_accvgpr_write_b32 a0, v56
    v_accvgpr_write_b32 a1, v57
    v_accvgpr_write_b32 a2, v58
    v_accvgpr_write_b32 a3, v59
    v_perm_b32 v60, v65, v64, s93
    v_perm_b32 v61, v67, v66, s93
    v_perm_b32 v62, v69, v68, s93
    v_perm_b32 v63, v71, v70, s93
    v_accvgpr_write_b32 a160, v60
    v_accvgpr_write_b32 a161, v61
    v_accvgpr_write_b32 a162, v62
    v_accvgpr_write_b32 a163, v63
    buffer_load_dword v64, v48, s[88:91], s22 offen offset:0
    buffer_load_dword v65, v49, s[88:91], s22 offen offset:0
    buffer_load_dword v66, v50, s[88:91], s22 offen offset:0
    buffer_load_dword v67, v51, s[88:91], s22 offen offset:0
    buffer_load_dword v68, v52, s[88:91], s22 offen offset:0
    buffer_load_dword v69, v53, s[88:91], s22 offen offset:0
    buffer_load_dword v70, v54, s[88:91], s22 offen offset:0
    buffer_load_dword v71, v55, s[88:91], s22 offen offset:0
    s_add_u32 s22, s22, 55296
    s_waitcnt vmcnt(48)
    v_perm_b32 v56, v73, v72, s92
    v_perm_b32 v57, v75, v74, s92
    v_perm_b32 v58, v77, v76, s92
    v_perm_b32 v59, v79, v78, s92
    v_accvgpr_write_b32 a4, v56
    v_accvgpr_write_b32 a5, v57
    v_accvgpr_write_b32 a6, v58
    v_accvgpr_write_b32 a7, v59
    v_perm_b32 v60, v73, v72, s93
    v_perm_b32 v61, v75, v74, s93
    v_perm_b32 v62, v77, v76, s93
    v_perm_b32 v63, v79, v78, s93
    v_accvgpr_write_b32 a164, v60
    v_accvgpr_write_b32 a165, v61
    v_accvgpr_write_b32 a166, v62
    v_accvgpr_write_b32 a167, v63
    buffer_load_dword v72, v48, s[88:91], s22 offen offset:0
    buffer_load_dword v73, v49, s[88:91], s22 offen offset:0
    buffer_load_dword v74, v50, s[88:91], s22 offen offset:0
    buffer_load_dword v75, v51, s[88:91], s22 offen offset:0
    buffer_load_dword v76, v52, s[88:91], s22 offen offset:0
    buffer_load_dword v77, v53, s[88:91], s22 offen offset:0
    buffer_load_dword v78, v54, s[88:91], s22 offen offset:0
    buffer_load_dword v79, v55, s[88:91], s22 offen offset:0
    s_add_u32 s22, s22, 55296
    s_waitcnt vmcnt(48)
    v_perm_b32 v56, v81, v80, s92
    v_perm_b32 v57, v83, v82, s92
    v_perm_b32 v58, v85, v84, s92
    v_perm_b32 v59, v87, v86, s92
    v_accvgpr_write_b32 a8, v56
    v_accvgpr_write_b32 a9, v57
    v_accvgpr_write_b32 a10, v58
    v_accvgpr_write_b32 a11, v59
    v_perm_b32 v60, v81, v80, s93
    v_perm_b32 v61, v83, v82, s93
    v_perm_b32 v62, v85, v84, s93
    v_perm_b32 v63, v87, v86, s93
    v_accvgpr_write_b32 a168, v60
    v_accvgpr_write_b32 a169, v61
    v_accvgpr_write_b32 a170, v62
    v_accvgpr_write_b32 a171, v63
    buffer_load_dword v80, v48, s[88:91], s22 offen offset:0
    buffer_load_dword v81, v49, s[88:91], s22 offen offset:0
    buffer_load_dword v82, v50, s[88:91], s22 offen offset:0
    buffer_load_dword v83, v51, s[88:91], s22 offen offset:0
    buffer_load_dword v84, v52, s[88:91], s22 offen offset:0
    buffer_load_dword v85, v53, s[88:91], s22 offen offset:0
    buffer_load_dword v86, v54, s[88:91], s22 offen offset:0
    buffer_load_dword v87, v55, s[88:91], s22 offen offset:0
    s_add_u32 s22, s22, 55296
    s_waitcnt vmcnt(48)
    v_perm_b32 v56, v89, v88, s92
    v_perm_b32 v57, v91, v90, s92
    v_perm_b32 v58, v93, v92, s92
    v_perm_b32 v59, v95, v94, s92
    v_accvgpr_write_b32 a12, v56
    v_accvgpr_write_b32 a13, v57
    v_accvgpr_write_b32 a14, v58
    v_accvgpr_write_b32 a15, v59
    v_perm_b32 v60, v89, v88, s93
    v_perm_b32 v61, v91, v90, s93
    v_perm_b32 v62, v93, v92, s93
    v_perm_b32 v63, v95, v94, s93
    v_accvgpr_write_b32 a172, v60
    v_accvgpr_write_b32 a173, v61
    v_accvgpr_write_b32 a174, v62
    v_accvgpr_write_b32 a175, v63
    buffer_load_dword v88, v48, s[88:91], s22 offen offset:0
    buffer_load_dword v89, v49, s[88:91], s22 offen offset:0
    buffer_load_dword v90, v50, s[88:91], s22 offen offset:0
    buffer_load_dword v91, v51, s[88:91], s22 offen offset:0
    buffer_load_dword v92, v52, s[88:91], s22 offen offset:0
    buffer_load_dword v93, v53, s[88:91], s22 offen offset:0
    buffer_load_dword v94, v54, s[88:91], s22 offen offset:0
    buffer_load_dword v95, v55, s[88:91], s22 offen offset:0
    s_add_u32 s22, s22, 55296
    s_waitcnt vmcnt(48)
    v_perm_b32 v56, v97, v96, s92
    v_perm_b32 v57, v99, v98, s92
    v_perm_b32 v58, v101, v100, s92
    v_perm_b32 v59, v103, v102, s92
    v_accvgpr_write_b32 a16, v56
    v_accvgpr_write_b32 a17, v57
    v_accvgpr_write_b32 a18, v58
    v_accvgpr_write_b32 a19, v59
    v_perm_b32 v60, v97, v96, s93
    v_perm_b32 v61, v99, v98, s93
    v_perm_b32 v62, v101, v100, s93
    v_perm_b32 v63, v103, v102, s93
    v_accvgpr_write_b32 a176, v60
    v_accvgpr_write_b32 a177, v61
    v_accvgpr_write_b32 a178, v62
    v_accvgpr_write_b32 a179, v63
    buffer_load_dword v96, v48, s[88:91], s22 offen offset:0
    buffer_load_dword v97, v49, s[88:91], s22 offen offset:0
    buffer_load_dword v98, v50, s[88:91], s22 offen offset:0
    buffer_load_dword v99, v51, s[88:91], s22 offen offset:0
    buffer_load_dword v100, v52, s[88:91], s22 offen offset:0
    buffer_load_dword v101, v53, s[88:91], s22 offen offset:0
    buffer_load_dword v102, v54, s[88:91], s22 offen offset:0
    buffer_load_dword v103, v55, s[88:91], s22 offen offset:0
    s_add_u32 s22, s22, 55296
    s_waitcnt vmcnt(48)
    v_perm_b32 v56, v105, v104, s92
    v_perm_b32 v57, v107, v106, s92
    v_perm_b32 v58, v109, v108, s92
    v_perm_b32 v59, v111, v110, s92
    v_accvgpr_write_b32 a20, v56
    v_accvgpr_write_b32 a21, v57
    v_accvgpr_write_b32 a22, v58
    v_accvgpr_write_b32 a23, v59
    v_perm_b32 v60, v105, v104, s93
    v_perm_b32 v61, v107, v106, s93
    v_perm_b32 v62, v109, v108, s93
    v_perm_b32 v63, v111, v110, s93
    v_accvgpr_write_b32 a180, v60
    v_accvgpr_write_b32 a181, v61
    v_accvgpr_write_b32 a182, v62
    v_accvgpr_write_b32 a183, v63
    buffer_load_dword v104, v48, s[88:91], s22 offen offset:0
    buffer_load_dword v105, v49, s[88:91], s22 offen offset:0
    buffer_load_dword v106, v50, s[88:91], s22 offen offset:0
    buffer_load_dword v107, v51, s[88:91], s22 offen offset:0
    buffer_load_dword v108, v52, s[88:91], s22 offen offset:0
    buffer_load_dword v109, v53, s[88:91], s22 offen offset:0
    buffer_load_dword v110, v54, s[88:91], s22 offen offset:0
    buffer_load_dword v111, v55, s[88:91], s22 offen offset:0
    s_add_u32 s22, s22, 55296
    s_waitcnt vmcnt(48)
    v_perm_b32 v56, v113, v112, s92
    v_perm_b32 v57, v115, v114, s92
    v_perm_b32 v58, v117, v116, s92
    v_perm_b32 v59, v119, v118, s92
    v_accvgpr_write_b32 a24, v56
    v_accvgpr_write_b32 a25, v57
    v_accvgpr_write_b32 a26, v58
    v_accvgpr_write_b32 a27, v59
    v_perm_b32 v60, v113, v112, s93
    v_perm_b32 v61, v115, v114, s93
    v_perm_b32 v62, v117, v116, s93
    v_perm_b32 v63, v119, v118, s93
    v_accvgpr_write_b32 a184, v60
    v_accvgpr_write_b32 a185, v61
    v_accvgpr_write_b32 a186, v62
    v_accvgpr_write_b32 a187, v63
    buffer_load_dword v112, v48, s[88:91], s22 offen offset:0
    buffer_load_dword v113, v49, s[88:91], s22 offen offset:0
    buffer_load_dword v114, v50, s[88:91], s22 offen offset:0
    buffer_load_dword v115, v51, s[88:91], s22 offen offset:0
    buffer_load_dword v116, v52, s[88:91], s22 offen offset:0
    buffer_load_dword v117, v53, s[88:91], s22 offen offset:0
    buffer_load_dword v118, v54, s[88:91], s22 offen offset:0
    buffer_load_dword v119, v55, s[88:91], s22 offen offset:0
    s_add_u32 s22, s22, 55296
    s_waitcnt vmcnt(48)
    v_perm_b32 v56, v65, v64, s92
    v_perm_b32 v57, v67, v66, s92
    v_perm_b32 v58, v69, v68, s92
    v_perm_b32 v59, v71, v70, s92
    v_accvgpr_write_b32 a28, v56
    v_accvgpr_write_b32 a29, v57
    v_accvgpr_write_b32 a30, v58
    v_accvgpr_write_b32 a31, v59
    v_perm_b32 v60, v65, v64, s93
    v_perm_b32 v61, v67, v66, s93
    v_perm_b32 v62, v69, v68, s93
    v_perm_b32 v63, v71, v70, s93
    v_accvgpr_write_b32 a188, v60
    v_accvgpr_write_b32 a189, v61
    v_accvgpr_write_b32 a190, v62
    v_accvgpr_write_b32 a191, v63
    buffer_load_dword v64, v48, s[88:91], s22 offen offset:0
    buffer_load_dword v65, v49, s[88:91], s22 offen offset:0
    buffer_load_dword v66, v50, s[88:91], s22 offen offset:0
    buffer_load_dword v67, v51, s[88:91], s22 offen offset:0
    buffer_load_dword v68, v52, s[88:91], s22 offen offset:0
    buffer_load_dword v69, v53, s[88:91], s22 offen offset:0
    buffer_load_dword v70, v54, s[88:91], s22 offen offset:0
    buffer_load_dword v71, v55, s[88:91], s22 offen offset:0
    s_add_u32 s22, s22, 55296
    s_waitcnt vmcnt(48)
    v_perm_b32 v56, v73, v72, s92
    v_perm_b32 v57, v75, v74, s92
    v_perm_b32 v58, v77, v76, s92
    v_perm_b32 v59, v79, v78, s92
    v_accvgpr_write_b32 a32, v56
    v_accvgpr_write_b32 a33, v57
    v_accvgpr_write_b32 a34, v58
    v_accvgpr_write_b32 a35, v59
    v_perm_b32 v60, v73, v72, s93
    v_perm_b32 v61, v75, v74, s93
    v_perm_b32 v62, v77, v76, s93
    v_perm_b32 v63, v79, v78, s93
    v_accvgpr_write_b32 a192, v60
    v_accvgpr_write_b32 a193, v61
    v_accvgpr_write_b32 a194, v62
    v_accvgpr_write_b32 a195, v63
    buffer_load_dword v72, v48, s[88:91], s22 offen offset:0
    buffer_load_dword v73, v49, s[88:91], s22 offen offset:0
    buffer_load_dword v74, v50, s[88:91], s22 offen offset:0
    buffer_load_dword v75, v51, s[88:91], s22 offen offset:0
    buffer_load_dword v76, v52, s[88:91], s22 offen offset:0
    buffer_load_dword v77, v53, s[88:91], s22 offen offset:0
    buffer_load_dword v78, v54, s[88:91], s22 offen offset:0
    buffer_load_dword v79, v55, s[88:91], s22 offen offset:0
    s_add_u32 s22, s22, 55296
    s_waitcnt vmcnt(48)
    v_perm_b32 v56, v81, v80, s92
    v_perm_b32 v57, v83, v82, s92
    v_perm_b32 v58, v85, v84, s92
    v_perm_b32 v59, v87, v86, s92
    v_accvgpr_write_b32 a36, v56
    v_accvgpr_write_b32 a37, v57
    v_accvgpr_write_b32 a38, v58
    v_accvgpr_write_b32 a39, v59
    v_perm_b32 v60, v81, v80, s93
    v_perm_b32 v61, v83, v82, s93
    v_perm_b32 v62, v85, v84, s93
    v_perm_b32 v63, v87, v86, s93
    v_accvgpr_write_b32 a196, v60
    v_accvgpr_write_b32 a197, v61
    v_accvgpr_write_b32 a198, v62
    v_accvgpr_write_b32 a199, v63
    buffer_load_dword v80, v48, s[88:91], s22 offen offset:0
    buffer_load_dword v81, v49, s[88:91], s22 offen offset:0
    buffer_load_dword v82, v50, s[88:91], s22 offen offset:0
    buffer_load_dword v83, v51, s[88:91], s22 offen offset:0
    buffer_load_dword v84, v52, s[88:91], s22 offen offset:0
    buffer_load_dword v85, v53, s[88:91], s22 offen offset:0
    buffer_load_dword v86, v54, s[88:91], s22 offen offset:0
    buffer_load_dword v87, v55, s[88:91], s22 offen offset:0
    s_add_u32 s22, s22, 55296
    s_waitcnt vmcnt(48)
    v_perm_b32 v56, v89, v88, s92
    v_perm_b32 v57, v91, v90, s92
    v_perm_b32 v58, v93, v92, s92
    v_perm_b32 v59, v95, v94, s92
    v_accvgpr_write_b32 a40, v56
    v_accvgpr_write_b32 a41, v57
    v_accvgpr_write_b32 a42, v58
    v_accvgpr_write_b32 a43, v59
    v_perm_b32 v60, v89, v88, s93
    v_perm_b32 v61, v91, v90, s93
    v_perm_b32 v62, v93, v92, s93
    v_perm_b32 v63, v95, v94, s93
    v_accvgpr_write_b32 a200, v60
    v_accvgpr_write_b32 a201, v61
    v_accvgpr_write_b32 a202, v62
    v_accvgpr_write_b32 a203, v63
    buffer_load_dword v88, v48, s[88:91], s22 offen offset:0
    buffer_load_dword v89, v49, s[88:91], s22 offen offset:0
    buffer_load_dword v90, v50, s[88:91], s22 offen offset:0
    buffer_load_dword v91, v51, s[88:91], s22 offen offset:0
    buffer_load_dword v92, v52, s[88:91], s22 offen offset:0
    buffer_load_dword v93, v53, s[88:91], s22 offen offset:0
    buffer_load_dword v94, v54, s[88:91], s22 offen offset:0
    buffer_load_dword v95, v55, s[88:91], s22 offen offset:0
    s_add_u32 s22, s22, 55296
    s_waitcnt vmcnt(48)
    v_perm_b32 v56, v97, v96, s92
    v_perm_b32 v57, v99, v98, s92
    v_perm_b32 v58, v101, v100, s92
    v_perm_b32 v59, v103, v102, s92
    v_accvgpr_write_b32 a44, v56
    v_accvgpr_write_b32 a45, v57
    v_accvgpr_write_b32 a46, v58
    v_accvgpr_write_b32 a47, v59
    v_perm_b32 v60, v97, v96, s93
    v_perm_b32 v61, v99, v98, s93
    v_perm_b32 v62, v101, v100, s93
    v_perm_b32 v63, v103, v102, s93
    v_accvgpr_write_b32 a204, v60
    v_accvgpr_write_b32 a205, v61
    v_accvgpr_write_b32 a206, v62
    v_accvgpr_write_b32 a207, v63
    buffer_load_dword v96, v48, s[88:91], s22 offen offset:0
    buffer_load_dword v97, v49, s[88:91], s22 offen offset:0
    buffer_load_dword v98, v50, s[88:91], s22 offen offset:0
    buffer_load_dword v99, v51, s[88:91], s22 offen offset:0
    buffer_load_dword v100, v52, s[88:91], s22 offen offset:0
    buffer_load_dword v101, v53, s[88:91], s22 offen offset:0
    buffer_load_dword v102, v54, s[88:91], s22 offen offset:0
    buffer_load_dword v103, v55, s[88:91], s22 offen offset:0
    s_add_u32 s22, s22, 55296
    s_waitcnt vmcnt(48)
    v_perm_b32 v56, v105, v104, s92
    v_perm_b32 v57, v107, v106, s92
    v_perm_b32 v58, v109, v108, s92
    v_perm_b32 v59, v111, v110, s92
    v_accvgpr_write_b32 a48, v56
    v_accvgpr_write_b32 a49, v57
    v_accvgpr_write_b32 a50, v58
    v_accvgpr_write_b32 a51, v59
    v_perm_b32 v60, v105, v104, s93
    v_perm_b32 v61, v107, v106, s93
    v_perm_b32 v62, v109, v108, s93
    v_perm_b32 v63, v111, v110, s93
    v_accvgpr_write_b32 a208, v60
    v_accvgpr_write_b32 a209, v61
    v_accvgpr_write_b32 a210, v62
    v_accvgpr_write_b32 a211, v63
    buffer_load_dword v104, v48, s[88:91], s22 offen offset:0
    buffer_load_dword v105, v49, s[88:91], s22 offen offset:0
    buffer_load_dword v106, v50, s[88:91], s22 offen offset:0
    buffer_load_dword v107, v51, s[88:91], s22 offen offset:0
    buffer_load_dword v108, v52, s[88:91], s22 offen offset:0
    buffer_load_dword v109, v53, s[88:91], s22 offen offset:0
    buffer_load_dword v110, v54, s[88:91], s22 offen offset:0
    buffer_load_dword v111, v55, s[88:91], s22 offen offset:0
    s_add_u32 s22, s22, 55296
    s_waitcnt vmcnt(48)
    v_perm_b32 v56, v113, v112, s92
    v_perm_b32 v57, v115, v114, s92
    v_perm_b32 v58, v117, v116, s92
    v_perm_b32 v59, v119, v118, s92
    v_accvgpr_write_b32 a52, v56
    v_accvgpr_write_b32 a53, v57
    v_accvgpr_write_b32 a54, v58
    v_accvgpr_write_b32 a55, v59
    v_perm_b32 v60, v113, v112, s93
    v_perm_b32 v61, v115, v114, s93
    v_perm_b32 v62, v117, v116, s93
    v_perm_b32 v63, v119, v118, s93
    v_accvgpr_write_b32 a212, v60
    v_accvgpr_write_b32 a213, v61
    v_accvgpr_write_b32 a214, v62
    v_accvgpr_write_b32 a215, v63
    buffer_load_dword v112, v48, s[88:91], s22 offen offset:0
    buffer_load_dword v113, v49, s[88:91], s22 offen offset:0
    buffer_load_dword v114, v50, s[88:91], s22 offen offset:0
    buffer_load_dword v115, v51, s[88:91], s22 offen offset:0
    buffer_load_dword v116, v52, s[88:91], s22 offen offset:0
    buffer_load_dword v117, v53, s[88:91], s22 offen offset:0
    buffer_load_dword v118, v54, s[88:91], s22 offen offset:0
    buffer_load_dword v119, v55, s[88:91], s22 offen offset:0
    s_add_u32 s22, s22, 55296
    s_waitcnt vmcnt(48)
    v_perm_b32 v56, v65, v64, s92
    v_perm_b32 v57, v67, v66, s92
    v_perm_b32 v58, v69, v68, s92
    v_perm_b32 v59, v71, v70, s92
    v_accvgpr_write_b32 a56, v56
    v_accvgpr_write_b32 a57, v57
    v_accvgpr_write_b32 a58, v58
    v_accvgpr_write_b32 a59, v59
    v_perm_b32 v60, v65, v64, s93
    v_perm_b32 v61, v67, v66, s93
    v_perm_b32 v62, v69, v68, s93
    v_perm_b32 v63, v71, v70, s93
    v_accvgpr_write_b32 a216, v60
    v_accvgpr_write_b32 a217, v61
    v_accvgpr_write_b32 a218, v62
    v_accvgpr_write_b32 a219, v63
    buffer_load_dword v64, v48, s[88:91], s22 offen offset:0
    buffer_load_dword v65, v49, s[88:91], s22 offen offset:0
    buffer_load_dword v66, v50, s[88:91], s22 offen offset:0
    buffer_load_dword v67, v51, s[88:91], s22 offen offset:0
    buffer_load_dword v68, v52, s[88:91], s22 offen offset:0
    buffer_load_dword v69, v53, s[88:91], s22 offen offset:0
    buffer_load_dword v70, v54, s[88:91], s22 offen offset:0
    buffer_load_dword v71, v55, s[88:91], s22 offen offset:0
    s_add_u32 s22, s22, 55296
    s_waitcnt vmcnt(48)
    v_perm_b32 v56, v73, v72, s92
    v_perm_b32 v57, v75, v74, s92
    v_perm_b32 v58, v77, v76, s92
    v_perm_b32 v59, v79, v78, s92
    v_accvgpr_write_b32 a60, v56
    v_accvgpr_write_b32 a61, v57
    v_accvgpr_write_b32 a62, v58
    v_accvgpr_write_b32 a63, v59
    v_perm_b32 v60, v73, v72, s93
    v_perm_b32 v61, v75, v74, s93
    v_perm_b32 v62, v77, v76, s93
    v_perm_b32 v63, v79, v78, s93
    v_accvgpr_write_b32 a220, v60
    v_accvgpr_write_b32 a221, v61
    v_accvgpr_write_b32 a222, v62
    v_accvgpr_write_b32 a223, v63
    buffer_load_dword v72, v48, s[88:91], s22 offen offset:0
    buffer_load_dword v73, v49, s[88:91], s22 offen offset:0
    buffer_load_dword v74, v50, s[88:91], s22 offen offset:0
    buffer_load_dword v75, v51, s[88:91], s22 offen offset:0
    buffer_load_dword v76, v52, s[88:91], s22 offen offset:0
    buffer_load_dword v77, v53, s[88:91], s22 offen offset:0
    buffer_load_dword v78, v54, s[88:91], s22 offen offset:0
    buffer_load_dword v79, v55, s[88:91], s22 offen offset:0
    s_add_u32 s22, s22, 55296
    s_waitcnt vmcnt(48)
    v_perm_b32 v56, v81, v80, s92
    v_perm_b32 v57, v83, v82, s92
    v_perm_b32 v58, v85, v84, s92
    v_perm_b32 v59, v87, v86, s92
    v_accvgpr_write_b32 a64, v56
    v_accvgpr_write_b32 a65, v57
    v_accvgpr_write_b32 a66, v58
    v_accvgpr_write_b32 a67, v59
    v_perm_b32 v60, v81, v80, s93
    v_perm_b32 v61, v83, v82, s93
    v_perm_b32 v62, v85, v84, s93
    v_perm_b32 v63, v87, v86, s93
    v_accvgpr_write_b32 a224, v60
    v_accvgpr_write_b32 a225, v61
    v_accvgpr_write_b32 a226, v62
    v_accvgpr_write_b32 a227, v63
    buffer_load_dword v80, v48, s[88:91], s22 offen offset:0
    buffer_load_dword v81, v49, s[88:91], s22 offen offset:0
    buffer_load_dword v82, v50, s[88:91], s22 offen offset:0
    buffer_load_dword v83, v51, s[88:91], s22 offen offset:0
    buffer_load_dword v84, v52, s[88:91], s22 offen offset:0
    buffer_load_dword v85, v53, s[88:91], s22 offen offset:0
    buffer_load_dword v86, v54, s[88:91], s22 offen offset:0
    buffer_load_dword v87, v55, s[88:91], s22 offen offset:0
    s_add_u32 s22, s22, 55296
    s_waitcnt vmcnt(48)
    v_perm_b32 v56, v89, v88, s92
    v_perm_b32 v57, v91, v90, s92
    v_perm_b32 v58, v93, v92, s92
    v_perm_b32 v59, v95, v94, s92
    v_accvgpr_write_b32 a68, v56
    v_accvgpr_write_b32 a69, v57
    v_accvgpr_write_b32 a70, v58
    v_accvgpr_write_b32 a71, v59
    v_perm_b32 v60, v89, v88, s93
    v_perm_b32 v61, v91, v90, s93
    v_perm_b32 v62, v93, v92, s93
    v_perm_b32 v63, v95, v94, s93
    v_accvgpr_write_b32 a228, v60
    v_accvgpr_write_b32 a229, v61
    v_accvgpr_write_b32 a230, v62
    v_accvgpr_write_b32 a231, v63
    buffer_load_dword v88, v48, s[88:91], s22 offen offset:0
    buffer_load_dword v89, v49, s[88:91], s22 offen offset:0
    buffer_load_dword v90, v50, s[88:91], s22 offen offset:0
    buffer_load_dword v91, v51, s[88:91], s22 offen offset:0
    buffer_load_dword v92, v52, s[88:91], s22 offen offset:0
    buffer_load_dword v93, v53, s[88:91], s22 offen offset:0
    buffer_load_dword v94, v54, s[88:91], s22 offen offset:0
    buffer_load_dword v95, v55, s[88:91], s22 offen offset:0
    s_add_u32 s22, s22, 55296
    s_waitcnt vmcnt(48)
    v_perm_b32 v56, v97, v96, s92
    v_perm_b32 v57, v99, v98, s92
    v_perm_b32 v58, v101, v100, s92
    v_perm_b32 v59, v103, v102, s92
    v_accvgpr_write_b32 a72, v56
    v_accvgpr_write_b32 a73, v57
    v_accvgpr_write_b32 a74, v58
    v_accvgpr_write_b32 a75, v59
    v_perm_b32 v60, v97, v96, s93
    v_perm_b32 v61, v99, v98, s93
    v_perm_b32 v62, v101, v100, s93
    v_perm_b32 v63, v103, v102, s93
    v_accvgpr_write_b32 a232, v60
    v_accvgpr_write_b32 a233, v61
    v_accvgpr_write_b32 a234, v62
    v_accvgpr_write_b32 a235, v63
    buffer_load_dword v96, v48, s[88:91], s22 offen offset:0
    buffer_load_dword v97, v49, s[88:91], s22 offen offset:0
    buffer_load_dword v98, v50, s[88:91], s22 offen offset:0
    buffer_load_dword v99, v51, s[88:91], s22 offen offset:0
    buffer_load_dword v100, v52, s[88:91], s22 offen offset:0
    buffer_load_dword v101, v53, s[88:91], s22 offen offset:0
    buffer_load_dword v102, v54, s[88:91], s22 offen offset:0
    buffer_load_dword v103, v55, s[88:91], s22 offen offset:0
    s_add_u32 s22, s22, 55296
    s_waitcnt vmcnt(48)
    v_perm_b32 v56, v105, v104, s92
    v_perm_b32 v57, v107, v106, s92
    v_perm_b32 v58, v109, v108, s92
    v_perm_b32 v59, v111, v110, s92
    v_accvgpr_write_b32 a76, v56
    v_accvgpr_write_b32 a77, v57
    v_accvgpr_write_b32 a78, v58
    v_accvgpr_write_b32 a79, v59
    v_perm_b32 v60, v105, v104, s93
    v_perm_b32 v61, v107, v106, s93
    v_perm_b32 v62, v109, v108, s93
    v_perm_b32 v63, v111, v110, s93
    v_accvgpr_write_b32 a236, v60
    v_accvgpr_write_b32 a237, v61
    v_accvgpr_write_b32 a238, v62
    v_accvgpr_write_b32 a239, v63
    buffer_load_dword v104, v48, s[88:91], s22 offen offset:0
    buffer_load_dword v105, v49, s[88:91], s22 offen offset:0
    buffer_load_dword v106, v50, s[88:91], s22 offen offset:0
    buffer_load_dword v107, v51, s[88:91], s22 offen offset:0
    buffer_load_dword v108, v52, s[88:91], s22 offen offset:0
    buffer_load_dword v109, v53, s[88:91], s22 offen offset:0
    buffer_load_dword v110, v54, s[88:91], s22 offen offset:0
    buffer_load_dword v111, v55, s[88:91], s22 offen offset:0
    s_add_u32 s22, s22, 55296
    s_waitcnt vmcnt(48)
    v_perm_b32 v56, v113, v112, s92
    v_perm_b32 v57, v115, v114, s92
    v_perm_b32 v58, v117, v116, s92
    v_perm_b32 v59, v119, v118, s92
    v_accvgpr_write_b32 a80, v56
    v_accvgpr_write_b32 a81, v57
    v_accvgpr_write_b32 a82, v58
    v_accvgpr_write_b32 a83, v59
    v_perm_b32 v60, v113, v112, s93
    v_perm_b32 v61, v115, v114, s93
    v_perm_b32 v62, v117, v116, s93
    v_perm_b32 v63, v119, v118, s93
    v_accvgpr_write_b32 a240, v60
    v_accvgpr_write_b32 a241, v61
    v_accvgpr_write_b32 a242, v62
    v_accvgpr_write_b32 a243, v63
    buffer_load_dword v112, v48, s[88:91], s22 offen offset:0
    buffer_load_dword v113, v49, s[88:91], s22 offen offset:0
    buffer_load_dword v114, v50, s[88:91], s22 offen offset:0
    buffer_load_dword v115, v51, s[88:91], s22 offen offset:0
    buffer_load_dword v116, v52, s[88:91], s22 offen offset:0
    buffer_load_dword v117, v53, s[88:91], s22 offen offset:0
    buffer_load_dword v118, v54, s[88:91], s22 offen offset:0
    buffer_load_dword v119, v55, s[88:91], s22 offen offset:0
    s_add_u32 s22, s22, 55296
    s_waitcnt vmcnt(48)
    v_perm_b32 v56, v65, v64, s92
    v_perm_b32 v57, v67, v66, s92
    v_perm_b32 v58, v69, v68, s92
    v_perm_b32 v59, v71, v70, s92
    v_accvgpr_write_b32 a84, v56
    v_accvgpr_write_b32 a85, v57
    v_accvgpr_write_b32 a86, v58
    v_accvgpr_write_b32 a87, v59
    v_perm_b32 v60, v65, v64, s93
    v_perm_b32 v61, v67, v66, s93
    v_perm_b32 v62, v69, v68, s93
    v_perm_b32 v63, v71, v70, s93
    v_accvgpr_write_b32 a244, v60
    v_accvgpr_write_b32 a245, v61
    v_accvgpr_write_b32 a246, v62
    v_accvgpr_write_b32 a247, v63
    buffer_load_dword v64, v48, s[88:91], s22 offen offset:0
    buffer_load_dword v65, v49, s[88:91], s22 offen offset:0
    buffer_load_dword v66, v50, s[88:91], s22 offen offset:0
    buffer_load_dword v67, v51, s[88:91], s22 offen offset:0
    buffer_load_dword v68, v52, s[88:91], s22 offen offset:0
    buffer_load_dword v69, v53, s[88:91], s22 offen offset:0
    buffer_load_dword v70, v54, s[88:91], s22 offen offset:0
    buffer_load_dword v71, v55, s[88:91], s22 offen offset:0
    s_add_u32 s22, s22, 55296
    s_waitcnt vmcnt(48)
    v_perm_b32 v56, v73, v72, s92
    v_perm_b32 v57, v75, v74, s92
    v_perm_b32 v58, v77, v76, s92
    v_perm_b32 v59, v79, v78, s92
    v_accvgpr_write_b32 a88, v56
    v_accvgpr_write_b32 a89, v57
    v_accvgpr_write_b32 a90, v58
    v_accvgpr_write_b32 a91, v59
    v_perm_b32 v60, v73, v72, s93
    v_perm_b32 v61, v75, v74, s93
    v_perm_b32 v62, v77, v76, s93
    v_perm_b32 v63, v79, v78, s93
    v_accvgpr_write_b32 a248, v60
    v_accvgpr_write_b32 a249, v61
    v_accvgpr_write_b32 a250, v62
    v_accvgpr_write_b32 a251, v63
    buffer_load_dword v72, v48, s[88:91], s22 offen offset:0
    buffer_load_dword v73, v49, s[88:91], s22 offen offset:0
    buffer_load_dword v74, v50, s[88:91], s22 offen offset:0
    buffer_load_dword v75, v51, s[88:91], s22 offen offset:0
    buffer_load_dword v76, v52, s[88:91], s22 offen offset:0
    buffer_load_dword v77, v53, s[88:91], s22 offen offset:0
    buffer_load_dword v78, v54, s[88:91], s22 offen offset:0
    buffer_load_dword v79, v55, s[88:91], s22 offen offset:0
    s_add_u32 s22, s22, 55296
    s_waitcnt vmcnt(48)
    v_perm_b32 v56, v81, v80, s92
    v_perm_b32 v57, v83, v82, s92
    v_perm_b32 v58, v85, v84, s92
    v_perm_b32 v59, v87, v86, s92
    v_accvgpr_write_b32 a92, v56
    v_accvgpr_write_b32 a93, v57
    v_accvgpr_write_b32 a94, v58
    v_accvgpr_write_b32 a95, v59
    v_perm_b32 v60, v81, v80, s93
    v_perm_b32 v61, v83, v82, s93
    v_perm_b32 v62, v85, v84, s93
    v_perm_b32 v63, v87, v86, s93
    v_accvgpr_write_b32 a252, v60
    v_accvgpr_write_b32 a253, v61
    v_accvgpr_write_b32 a254, v62
    v_accvgpr_write_b32 a255, v63
    buffer_load_dword v80, v48, s[88:91], s22 offen offset:0
    buffer_load_dword v81, v49, s[88:91], s22 offen offset:0
    buffer_load_dword v82, v50, s[88:91], s22 offen offset:0
    buffer_load_dword v83, v51, s[88:91], s22 offen offset:0
    buffer_load_dword v84, v52, s[88:91], s22 offen offset:0
    buffer_load_dword v85, v53, s[88:91], s22 offen offset:0
    buffer_load_dword v86, v54, s[88:91], s22 offen offset:0
    buffer_load_dword v87, v55, s[88:91], s22 offen offset:0
    s_add_u32 s22, s22, 55296
    s_waitcnt vmcnt(48)
    v_perm_b32 v56, v89, v88, s92
    v_perm_b32 v57, v91, v90, s92
    v_perm_b32 v58, v93, v92, s92
    v_perm_b32 v59, v95, v94, s92
    v_accvgpr_write_b32 a96, v56
    v_accvgpr_write_b32 a97, v57
    v_accvgpr_write_b32 a98, v58
    v_accvgpr_write_b32 a99, v59
    v_perm_b32 v192, v89, v88, s93
    v_perm_b32 v193, v91, v90, s93
    v_perm_b32 v194, v93, v92, s93
    v_perm_b32 v195, v95, v94, s93
    buffer_load_dword v88, v48, s[88:91], s22 offen offset:0
    buffer_load_dword v89, v49, s[88:91], s22 offen offset:0
    buffer_load_dword v90, v50, s[88:91], s22 offen offset:0
    buffer_load_dword v91, v51, s[88:91], s22 offen offset:0
    buffer_load_dword v92, v52, s[88:91], s22 offen offset:0
    buffer_load_dword v93, v53, s[88:91], s22 offen offset:0
    buffer_load_dword v94, v54, s[88:91], s22 offen offset:0
    buffer_load_dword v95, v55, s[88:91], s22 offen offset:0
    s_add_u32 s22, s22, 55296
    s_waitcnt vmcnt(48)
    v_perm_b32 v60, v97, v96, s92
    v_perm_b32 v61, v99, v98, s92
    v_perm_b32 v62, v101, v100, s92
    v_perm_b32 v63, v103, v102, s92
    v_accvgpr_write_b32 a100, v60
    v_accvgpr_write_b32 a101, v61
    v_accvgpr_write_b32 a102, v62
    v_accvgpr_write_b32 a103, v63
    v_perm_b32 v196, v97, v96, s93
    v_perm_b32 v197, v99, v98, s93
    v_perm_b32 v198, v101, v100, s93
    v_perm_b32 v199, v103, v102, s93
    buffer_load_dword v96, v48, s[88:91], s22 offen offset:0
    buffer_load_dword v97, v49, s[88:91], s22 offen offset:0
    buffer_load_dword v98, v50, s[88:91], s22 offen offset:0
    buffer_load_dword v99, v51, s[88:91], s22 offen offset:0
    buffer_load_dword v100, v52, s[88:91], s22 offen offset:0
    buffer_load_dword v101, v53, s[88:91], s22 offen offset:0
    buffer_load_dword v102, v54, s[88:91], s22 offen offset:0
    buffer_load_dword v103, v55, s[88:91], s22 offen offset:0
    s_add_u32 s22, s22, 55296
    s_waitcnt vmcnt(48)
    v_perm_b32 v56, v105, v104, s92
    v_perm_b32 v57, v107, v106, s92
    v_perm_b32 v58, v109, v108, s92
    v_perm_b32 v59, v111, v110, s92
    v_accvgpr_write_b32 a104, v56
    v_accvgpr_write_b32 a105, v57
    v_accvgpr_write_b32 a106, v58
    v_accvgpr_write_b32 a107, v59
    v_perm_b32 v200, v105, v104, s93
    v_perm_b32 v201, v107, v106, s93
    v_perm_b32 v202, v109, v108, s93
    v_perm_b32 v203, v111, v110, s93
    buffer_load_dword v104, v48, s[88:91], s22 offen offset:0
    buffer_load_dword v105, v49, s[88:91], s22 offen offset:0
    buffer_load_dword v106, v50, s[88:91], s22 offen offset:0
    buffer_load_dword v107, v51, s[88:91], s22 offen offset:0
    buffer_load_dword v108, v52, s[88:91], s22 offen offset:0
    buffer_load_dword v109, v53, s[88:91], s22 offen offset:0
    buffer_load_dword v110, v54, s[88:91], s22 offen offset:0
    buffer_load_dword v111, v55, s[88:91], s22 offen offset:0
    s_add_u32 s22, s22, 55296
    s_waitcnt vmcnt(48)
    v_perm_b32 v60, v113, v112, s92
    v_perm_b32 v61, v115, v114, s92
    v_perm_b32 v62, v117, v116, s92
    v_perm_b32 v63, v119, v118, s92
    v_accvgpr_write_b32 a108, v60
    v_accvgpr_write_b32 a109, v61
    v_accvgpr_write_b32 a110, v62
    v_accvgpr_write_b32 a111, v63
    v_perm_b32 v204, v113, v112, s93
    v_perm_b32 v205, v115, v114, s93
    v_perm_b32 v206, v117, v116, s93
    v_perm_b32 v207, v119, v118, s93
    buffer_load_dword v112, v48, s[88:91], s22 offen offset:0
    buffer_load_dword v113, v49, s[88:91], s22 offen offset:0
    buffer_load_dword v114, v50, s[88:91], s22 offen offset:0
    buffer_load_dword v115, v51, s[88:91], s22 offen offset:0
    buffer_load_dword v116, v52, s[88:91], s22 offen offset:0
    buffer_load_dword v117, v53, s[88:91], s22 offen offset:0
    buffer_load_dword v118, v54, s[88:91], s22 offen offset:0
    buffer_load_dword v119, v55, s[88:91], s22 offen offset:0
    s_add_u32 s22, s22, 55296
    s_waitcnt vmcnt(48)
    v_perm_b32 v56, v65, v64, s92
    v_perm_b32 v57, v67, v66, s92
    v_perm_b32 v58, v69, v68, s92
    v_perm_b32 v59, v71, v70, s92
    v_accvgpr_write_b32 a112, v56
    v_accvgpr_write_b32 a113, v57
    v_accvgpr_write_b32 a114, v58
    v_accvgpr_write_b32 a115, v59
    v_perm_b32 v208, v65, v64, s93
    v_perm_b32 v209, v67, v66, s93
    v_perm_b32 v210, v69, v68, s93
    v_perm_b32 v211, v71, v70, s93
    buffer_load_dword v64, v48, s[88:91], s22 offen offset:0
    buffer_load_dword v65, v49, s[88:91], s22 offen offset:0
    buffer_load_dword v66, v50, s[88:91], s22 offen offset:0
    buffer_load_dword v67, v51, s[88:91], s22 offen offset:0
    buffer_load_dword v68, v52, s[88:91], s22 offen offset:0
    buffer_load_dword v69, v53, s[88:91], s22 offen offset:0
    buffer_load_dword v70, v54, s[88:91], s22 offen offset:0
    buffer_load_dword v71, v55, s[88:91], s22 offen offset:0
    s_add_u32 s22, s22, 55296
    s_waitcnt vmcnt(48)
    v_perm_b32 v60, v73, v72, s92
    v_perm_b32 v61, v75, v74, s92
    v_perm_b32 v62, v77, v76, s92
    v_perm_b32 v63, v79, v78, s92
    v_accvgpr_write_b32 a116, v60
    v_accvgpr_write_b32 a117, v61
    v_accvgpr_write_b32 a118, v62
    v_accvgpr_write_b32 a119, v63
    v_perm_b32 v212, v73, v72, s93
    v_perm_b32 v213, v75, v74, s93
    v_perm_b32 v214, v77, v76, s93
    v_perm_b32 v215, v79, v78, s93
    buffer_load_dword v72, v48, s[88:91], s22 offen offset:0
    buffer_load_dword v73, v49, s[88:91], s22 offen offset:0
    buffer_load_dword v74, v50, s[88:91], s22 offen offset:0
    buffer_load_dword v75, v51, s[88:91], s22 offen offset:0
    buffer_load_dword v76, v52, s[88:91], s22 offen offset:0
    buffer_load_dword v77, v53, s[88:91], s22 offen offset:0
    buffer_load_dword v78, v54, s[88:91], s22 offen offset:0
    buffer_load_dword v79, v55, s[88:91], s22 offen offset:0
    s_add_u32 s22, s22, 55296
    s_waitcnt vmcnt(48)
    v_perm_b32 v56, v81, v80, s92
    v_perm_b32 v57, v83, v82, s92
    v_perm_b32 v58, v85, v84, s92
    v_perm_b32 v59, v87, v86, s92
    v_accvgpr_write_b32 a120, v56
    v_accvgpr_write_b32 a121, v57
    v_accvgpr_write_b32 a122, v58
    v_accvgpr_write_b32 a123, v59
    v_perm_b32 v216, v81, v80, s93
    v_perm_b32 v217, v83, v82, s93
    v_perm_b32 v218, v85, v84, s93
    v_perm_b32 v219, v87, v86, s93
    buffer_load_dword v80, v48, s[88:91], s22 offen offset:0
    buffer_load_dword v81, v49, s[88:91], s22 offen offset:0
    buffer_load_dword v82, v50, s[88:91], s22 offen offset:0
    buffer_load_dword v83, v51, s[88:91], s22 offen offset:0
    buffer_load_dword v84, v52, s[88:91], s22 offen offset:0
    buffer_load_dword v85, v53, s[88:91], s22 offen offset:0
    buffer_load_dword v86, v54, s[88:91], s22 offen offset:0
    buffer_load_dword v87, v55, s[88:91], s22 offen offset:0
    s_add_u32 s22, s22, 55296
    s_waitcnt vmcnt(48)
    v_perm_b32 v60, v89, v88, s92
    v_perm_b32 v61, v91, v90, s92
    v_perm_b32 v62, v93, v92, s92
    v_perm_b32 v63, v95, v94, s92
    v_accvgpr_write_b32 a124, v60
    v_accvgpr_write_b32 a125, v61
    v_accvgpr_write_b32 a126, v62
    v_accvgpr_write_b32 a127, v63
    v_perm_b32 v220, v89, v88, s93
    v_perm_b32 v221, v91, v90, s93
    v_perm_b32 v222, v93, v92, s93
    v_perm_b32 v223, v95, v94, s93
    buffer_load_dword v88, v48, s[88:91], s22 offen offset:0
    buffer_load_dword v89, v49, s[88:91], s22 offen offset:0
    buffer_load_dword v90, v50, s[88:91], s22 offen offset:0
    buffer_load_dword v91, v51, s[88:91], s22 offen offset:0
    buffer_load_dword v92, v52, s[88:91], s22 offen offset:0
    buffer_load_dword v93, v53, s[88:91], s22 offen offset:0
    buffer_load_dword v94, v54, s[88:91], s22 offen offset:0
    buffer_load_dword v95, v55, s[88:91], s22 offen offset:0
    s_add_u32 s22, s22, 55296
    s_waitcnt vmcnt(48)
    v_perm_b32 v56, v97, v96, s92
    v_perm_b32 v57, v99, v98, s92
    v_perm_b32 v58, v101, v100, s92
    v_perm_b32 v59, v103, v102, s92
    v_accvgpr_write_b32 a128, v56
    v_accvgpr_write_b32 a129, v57
    v_accvgpr_write_b32 a130, v58
    v_accvgpr_write_b32 a131, v59
    v_perm_b32 v224, v97, v96, s93
    v_perm_b32 v225, v99, v98, s93
    v_perm_b32 v226, v101, v100, s93
    v_perm_b32 v227, v103, v102, s93
    buffer_load_dword v96, v48, s[88:91], s22 offen offset:0
    buffer_load_dword v97, v49, s[88:91], s22 offen offset:0
    buffer_load_dword v98, v50, s[88:91], s22 offen offset:0
    buffer_load_dword v99, v51, s[88:91], s22 offen offset:0
    buffer_load_dword v100, v52, s[88:91], s22 offen offset:0
    buffer_load_dword v101, v53, s[88:91], s22 offen offset:0
    buffer_load_dword v102, v54, s[88:91], s22 offen offset:0
    buffer_load_dword v103, v55, s[88:91], s22 offen offset:0
    s_add_u32 s22, s22, 55296
    s_waitcnt vmcnt(48)
    v_perm_b32 v60, v105, v104, s92
    v_perm_b32 v61, v107, v106, s92
    v_perm_b32 v62, v109, v108, s92
    v_perm_b32 v63, v111, v110, s92
    v_accvgpr_write_b32 a132, v60
    v_accvgpr_write_b32 a133, v61
    v_accvgpr_write_b32 a134, v62
    v_accvgpr_write_b32 a135, v63
    v_perm_b32 v228, v105, v104, s93
    v_perm_b32 v229, v107, v106, s93
    v_perm_b32 v230, v109, v108, s93
    v_perm_b32 v231, v111, v110, s93
    s_waitcnt vmcnt(40)
    v_perm_b32 v56, v113, v112, s92
    v_perm_b32 v57, v115, v114, s92
    v_perm_b32 v58, v117, v116, s92
    v_perm_b32 v59, v119, v118, s92
    v_accvgpr_write_b32 a136, v56
    v_accvgpr_write_b32 a137, v57
    v_accvgpr_write_b32 a138, v58
    v_accvgpr_write_b32 a139, v59
    v_perm_b32 v232, v113, v112, s93
    v_perm_b32 v233, v115, v114, s93
    v_perm_b32 v234, v117, v116, s93
    v_perm_b32 v235, v119, v118, s93
    s_waitcnt vmcnt(32)
    v_perm_b32 v60, v65, v64, s92
    v_perm_b32 v61, v67, v66, s92
    v_perm_b32 v62, v69, v68, s92
    v_perm_b32 v63, v71, v70, s92
    v_accvgpr_write_b32 a140, v60
    v_accvgpr_write_b32 a141, v61
    v_accvgpr_write_b32 a142, v62
    v_accvgpr_write_b32 a143, v63
    v_perm_b32 v236, v65, v64, s93
    v_perm_b32 v237, v67, v66, s93
    v_perm_b32 v238, v69, v68, s93
    v_perm_b32 v239, v71, v70, s93
    s_waitcnt vmcnt(24)
    v_perm_b32 v56, v73, v72, s92
    v_perm_b32 v57, v75, v74, s92
    v_perm_b32 v58, v77, v76, s92
    v_perm_b32 v59, v79, v78, s92
    v_accvgpr_write_b32 a144, v56
    v_accvgpr_write_b32 a145, v57
    v_accvgpr_write_b32 a146, v58
    v_accvgpr_write_b32 a147, v59
    v_perm_b32 v240, v73, v72, s93
    v_perm_b32 v241, v75, v74, s93
    v_perm_b32 v242, v77, v76, s93
    v_perm_b32 v243, v79, v78, s93
    s_waitcnt vmcnt(16)
    v_perm_b32 v60, v81, v80, s92
    v_perm_b32 v61, v83, v82, s92
    v_perm_b32 v62, v85, v84, s92
    v_perm_b32 v63, v87, v86, s92
    v_accvgpr_write_b32 a148, v60
    v_accvgpr_write_b32 a149, v61
    v_accvgpr_write_b32 a150, v62
    v_accvgpr_write_b32 a151, v63
    v_perm_b32 v244, v81, v80, s93
    v_perm_b32 v245, v83, v82, s93
    v_perm_b32 v246, v85, v84, s93
    v_perm_b32 v247, v87, v86, s93
    s_waitcnt vmcnt(8)
    v_perm_b32 v56, v89, v88, s92
    v_perm_b32 v57, v91, v90, s92
    v_perm_b32 v58, v93, v92, s92
    v_perm_b32 v59, v95, v94, s92
    v_accvgpr_write_b32 a152, v56
    v_accvgpr_write_b32 a153, v57
    v_accvgpr_write_b32 a154, v58
    v_accvgpr_write_b32 a155, v59
    v_perm_b32 v248, v89, v88, s93
    v_perm_b32 v249, v91, v90, s93
    v_perm_b32 v250, v93, v92, s93
    v_perm_b32 v251, v95, v94, s93
    s_waitcnt vmcnt(0)
    v_perm_b32 v60, v97, v96, s92
    v_perm_b32 v61, v99, v98, s92
    v_perm_b32 v62, v101, v100, s92
    v_perm_b32 v63, v103, v102, s92
    v_accvgpr_write_b32 a156, v60
    v_accvgpr_write_b32 a157, v61
    v_accvgpr_write_b32 a158, v62
    v_accvgpr_write_b32 a159, v63
    v_perm_b32 v252, v97, v96, s93
    v_perm_b32 v253, v99, v98, s93
    v_perm_b32 v254, v101, v100, s93
    v_perm_b32 v255, v103, v102, s93
    s_mov_b32 s24, 0
WI_196:
    buffer_load_dword v8, off, s[96:99], 0 offset:128 sc1
    s_waitcnt vmcnt(0)
    v_cmp_le_u32 vcc, 256, v8
    s_cbranch_vccnz WO_197
    s_sleep 4
    s_add_u32 s24, s24, 1
    s_cmp_lt_u32 s24, 200000
    s_cbranch_scc1 WI_196
    s_branch F_F1
WO_197:
    v_mov_b32 v16, 0x3f803f80
    v_mov_b32 v17, 0x3f803f80
    v_mov_b32 v18, 0x3f803f80
    v_mov_b32 v19, 0x3f803f80
    v_mov_b32 v7, 1
    s_nop 0
    v_mfma_f32_32x32x16_bf16 v[160:175], a[0:3], v[16:19], 0
    v_mfma_f32_32x32x16_bf16 v[176:191], a[160:163], v[16:19], 0
    v_mfma_f32_32x32x16_bf16 v[160:175], a[4:7], v[16:19], v[160:175]
    v_mfma_f32_32x32x16_bf16 v[176:191], a[164:167], v[16:19], v[176:191]
    v_mfma_f32_32x32x16_bf16 v[160:175], a[8:11], v[16:19], v[160:175]
    v_mfma_f32_32x32x16_bf16 v[176:191], a[168:171], v[16:19], v[176:191]
    v_mfma_f32_32x32x16_bf16 v[160:175], a[12:15], v[16:19], v[160:175]
    v_mfma_f32_32x32x16_bf16 v[176:191], a[172:175], v[16:19], v[176:191]
    v_mfma_f32_32x32x16_bf16 v[160:175], a[16:19], v[16:19], v[160:175]
    v_mfma_f32_32x32x16_bf16 v[176:191], a[176:179], v[16:19], v[176:191]
    v_mfma_f32_32x32x16_bf16 v[160:175], a[20:23], v[16:19], v[160:175]
    v_mfma_f32_32x32x16_bf16 v[176:191], a[180:183], v[16:19], v[176:191]
    v_mfma_f32_32x32x16_bf16 v[160:175], a[24:27], v[16:19], v[160:175]
    v_mfma_f32_32x32x16_bf16 v[176:191], a[184:187], v[16:19], v[176:191]
    v_mfma_f32_32x32x16_bf16 v[160:175], a[28:31], v[16:19], v[160:175]
    v_mfma_f32_32x32x16_bf16 v[176:191], a[188:191], v[16:19], v[176:191]
    v_mfma_f32_32x32x16_bf16 v[160:175], a[32:35], v[16:19], v[160:175]
    v_mfma_f32_32x32x16_bf16 v[176:191], a[192:195], v[16:19], v[176:191]
    v_mfma_f32_32x32x16_bf16 v[160:175], a[36:39], v[16:19], v[160:175]
    v_mfma_f32_32x32x16_bf16 v[176:191], a[196:199], v[16:19], v[176:191]
    v_mfma_f32_32x32x16_bf16 v[160:175], a[40:43], v[16:19], v[160:175]
    v_mfma_f32_32x32x16_bf16 v[176:191], a[200:203], v[16:19], v[176:191]
    v_mfma_f32_32x32x16_bf16 v[160:175], a[44:47], v[16:19], v[160:175]
    v_mfma_f32_32x32x16_bf16 v[176:191], a[204:207], v[16:19], v[176:191]
    v_mfma_f32_32x32x16_bf16 v[160:175], a[48:51], v[16:19], v[160:175]
    v_mfma_f32_32x32x16_bf16 v[176:191], a[208:211], v[16:19], v[176:191]
    v_mfma_f32_32x32x16_bf16 v[160:175], a[52:55], v[16:19], v[160:175]
    v_mfma_f32_32x32x16_bf16 v[176:191], a[212:215], v[16:19], v[176:191]
    v_mfma_f32_32x32x16_bf16 v[160:175], a[56:59], v[16:19], v[160:175]
    v_mfma_f32_32x32x16_bf16 v[176:191], a[216:219], v[16:19], v[176:191]
    v_mfma_f32_32x32x16_bf16 v[160:175], a[60:63], v[16:19], v[160:175]
    v_mfma_f32_32x32x16_bf16 v[176:191], a[220:223], v[16:19], v[176:191]
    v_mfma_f32_32x32x16_bf16 v[160:175], a[64:67], v[16:19], v[160:175]
    v_mfma_f32_32x32x16_bf16 v[176:191], a[224:227], v[16:19], v[176:191]
    v_mfma_f32_32x32x16_bf16 v[160:175], a[68:71], v[16:19], v[160:175]
    v_mfma_f32_32x32x16_bf16 v[176:191], a[228:231], v[16:19], v[176:191]
    v_mfma_f32_32x32x16_bf16 v[160:175], a[72:75], v[16:19], v[160:175]
    v_mfma_f32_32x32x16_bf16 v[176:191], a[232:235], v[16:19], v[176:191]
    v_mfma_f32_32x32x16_bf16 v[160:175], a[76:79], v[16:19], v[160:175]
    v_mfma_f32_32x32x16_bf16 v[176:191], a[236:239], v[16:19], v[176:191]
    v_mfma_f32_32x32x16_bf16 v[160:175], a[80:83], v[16:19], v[160:175]
    v_mfma_f32_32x32x16_bf16 v[176:191], a[240:243], v[16:19], v[176:191]
    v_mfma_f32_32x32x16_bf16 v[160:175], a[84:87], v[16:19], v[160:175]
    v_mfma_f32_32x32x16_bf16 v[176:191], a[244:247], v[16:19], v[176:191]
    v_mfma_f32_32x32x16_bf16 v[160:175], a[88:91], v[16:19], v[160:175]
    v_mfma_f32_32x32x16_bf16 v[176:191], a[248:251], v[16:19], v[176:191]
    v_mfma_f32_32x32x16_bf16 v[160:175], a[92:95], v[16:19], v[160:175]
    v_mfma_f32_32x32x16_bf16 v[176:191], a[252:255], v[16:19], v[176:191]
    v_mfma_f32_32x32x16_bf16 v[160:175], a[96:99], v[16:19], v[160:175]
    v_mfma_f32_32x32x16_bf16 v[176:191], v[192:195], v[16:19], v[176:191]
    v_mfma_f32_32x32x16_bf16 v[160:175], a[100:103], v[16:19], v[160:175]
    v_mfma_f32_32x32x16_bf16 v[176:191], v[196:199], v[16:19], v[176:191]
    v_mfma_f32_32x32x16_bf16 v[160:175], a[104:107], v[16:19], v[160:175]
    v_mfma_f32_32x32x16_bf16 v[176:191], v[200:203], v[16:19], v[176:191]
    v_mfma_f32_32x32x16_bf16 v[160:175], a[108:111], v[16:19], v[160:175]
    v_mfma_f32_32x32x16_bf16 v[176:191], v[204:207], v[16:19], v[176:191]
    v_mfma_f32_32x32x16_bf16 v[160:175], a[112:115], v[16:19], v[160:175]
    v_mfma_f32_32x32x16_bf16 v[176:191], v[208:211], v[16:19], v[176:191]
    v_mfma_f32_32x32x16_bf16 v[160:175], a[116:119], v[16:19], v[160:175]
    v_mfma_f32_32x32x16_bf16 v[176:191], v[212:215], v[16:19], v[176:191]
    v_mfma_f32_32x32x16_bf16 v[160:175], a[120:123], v[16:19], v[160:175]
    v_mfma_f32_32x32x16_bf16 v[176:191], v[216:219], v[16:19], v[176:191]
    v_mfma_f32_32x32x16_bf16 v[160:175], a[124:127], v[16:19], v[160:175]
    v_mfma_f32_32x32x16_bf16 v[176:191], v[220:223], v[16:19], v[176:191]
    v_mfma_f32_32x32x16_bf16 v[160:175], a[128:131], v[16:19], v[160:175]
    v_mfma_f32_32x32x16_bf16 v[176:191], v[224:227], v[16:19], v[176:191]
    v_mfma_f32_32x32x16_bf16 v[160:175], a[132:135], v[16:19], v[160:175]
    v_mfma_f32_32x32x16_bf16 v[176:191], v[228:231], v[16:19], v[176:191]
    v_mfma_f32_32x32x16_bf16 v[160:175], a[136:139], v[16:19], v[160:175]
    v_mfma_f32_32x32x16_bf16 v[176:191], v[232:235], v[16:19], v[176:191]
    v_mfma_f32_32x32x16_bf16 v[160:175], a[140:143], v[16:19], v[160:175]
    v_mfma_f32_32x32x16_bf16 v[176:191], v[236:239], v[16:19], v[176:191]
    v_mfma_f32_32x32x16_bf16 v[160:175], a[144:147], v[16:19], v[160:175]
    v_mfma_f32_32x32x16_bf16 v[176:191], v[240:243], v[16:19], v[176:191]
    v_mfma_f32_32x32x16_bf16 v[160:175], a[148:151], v[16:19], v[160:175]
    v_mfma_f32_32x32x16_bf16 v[176:191], v[244:247], v[16:19], v[176:191]
    v_mfma_f32_32x32x16_bf16 v[160:175], a[152:155], v[16:19], v[160:175]
    v_mfma_f32_32x32x16_bf16 v[176:191], v[248:251], v[16:19], v[176:191]
    v_mfma_f32_32x32x16_bf16 v[160:175], a[156:159], v[16:19], v[160:175]
    v_mfma_f32_32x32x16_bf16 v[176:191], v[252:255], v[16:19], v[176:191]
T1_ITEM_198:
    s_cmp_lg_u32 s18, 0
    s_cbranch_scc1 T1_HAVE_199
    s_mov_b32 s24, 0
    s_mov_b64 exec, s[14:15]
    buffer_load_dword v8, v11, s[4:7], s13 offen sc1
    s_waitcnt vmcnt(0)
    v_cmp_eq_u32 vcc, 0, v8
    s_cmp_eq_u32 s19, 0
    s_cbranch_scc1 NF_203
    s_mov_b64 exec, 1
    buffer_store_dword v7, off, s[4:7], s34 sc1
    s_mov_b64 exec, -1
    s_mov_b32 s19, 0
NF_203:
    s_cbranch_vccz PO_202
    s_mov_b64 exec, s[14:15]
PL_201:
    buffer_load_dword v8, v11, s[4:7], s13 offen sc1
    s_waitcnt vmcnt(0)
    v_cmp_eq_u32 vcc, 0, v8
    s_cbranch_vccz PO_202
    s_sleep 2
    s_add_u32 s24, s24, 1
    s_cmp_lt_u32 s24, 200000
    s_cbranch_scc1 PL_201
    s_branch F_F1
PO_202:
    s_mov_b64 exec, -1
    s_add_u32 m0, s20, 0
    s_add_u32 s22, s12, 0
    buffer_load_dwordx4 v1, s[4:7], s22 offen offset:0 sc1 lds
    buffer_load_dwordx4 v1, s[4:7], s22 offen offset:1024 sc1 lds
    buffer_load_dwordx4 v1, s[4:7], s22 offen offset:2048 sc1 lds
    buffer_load_dwordx4 v1, s[4:7], s22 offen offset:3072 sc1 lds
    s_add_u32 m0, s20, 4096
    s_add_u32 s22, s12, 4096
    buffer_load_dwordx4 v1, s[4:7], s22 offen offset:0 sc1 lds
    buffer_load_dwordx4 v1, s[4:7], s22 offen offset:1024 sc1 lds
    buffer_load_dwordx4 v1, s[4:7], s22 offen offset:2048 sc1 lds
    buffer_load_dwordx4 v1, s[4:7], s22 offen offset:3072 sc1 lds
    s_add_u32 m0, s20, 8192
    s_add_u32 s22, s12, 8192
    buffer_load_dwordx4 v1, s[4:7], s22 offen offset:0 sc1 lds
    buffer_load_dwordx4 v1, s[4:7], s22 offen offset:1024 sc1 lds
    s_mov_b32 s18, 1
    s_waitcnt vmcnt(6)
    s_branch T1_GO_200
T1_HAVE_199:
    s_cmp_eq_u32 s35, 0
    s_cbranch_scc1 T1_H2_204
    s_add_u32 m0, s20, 0
    s_add_u32 s22, s12, 0
    buffer_load_dwordx4 v1, s[4:7], s22 offen offset:0 sc1 lds
    buffer_load_dwordx4 v1, s[4:7], s22 offen offset:1024 sc1 lds
    buffer_load_dwordx4 v1, s[4:7], s22 offen offset:2048 sc1 lds
    buffer_load_dwordx4 v1, s[4:7], s22 offen offset:3072 sc1 lds
    s_add_u32 m0, s20, 4096
    s_add_u32 s22, s12, 4096
    buffer_load_dwordx4 v1, s[4:7], s22 offen offset:0 sc1 lds
    buffer_load_dwordx4 v1, s[4:7], s22 offen offset:1024 sc1 lds
    buffer_load_dwordx4 v1, s[4:7], s22 offen offset:2048 sc1 lds
    buffer_load_dwordx4 v1, s[4:7], s22 offen offset:3072 sc1 lds
    s_add_u32 m0, s20, 8192
    s_add_u32 s22, s12, 8192
    buffer_load_dwordx4 v1, s[4:7], s22 offen offset:0 sc1 lds
    buffer_load_dwordx4 v1, s[4:7], s22 offen offset:1024 sc1 lds
    s_mov_b32 s18, 1
    s_waitcnt vmcnt(10)
    s_cmp_eq_u32 s19, 0
    s_cbranch_scc1 NF_205
    s_mov_b64 exec, 1
    buffer_store_dword v7, off, s[4:7], s34 sc1
    s_mov_b64 exec, -1
    s_mov_b32 s19, 0
NF_205:
    s_waitcnt vmcnt(7)
    s_branch T1_GO_200
T1_H2_204:
    s_waitcnt vmcnt(4)
T1_GO_200:
    s_barrier
    ds_read_b128 v[16:19], v2 offset:0
    ds_read_b128 v[20:23], v2 offset:10240
    ds_read_b128 v[24:27], v2 offset:20480
    s_mov_b32 s18, 0
    s_add_u32 s12, s12, 40960
    s_add_u32 s13, s13, 512
    s_sub_u32 s21, s20, 40960
    s_add_u32 s22, s20, 40960
    s_cmp_ge_u32 s20, 40960
    s_cselect_b32 s20, s21, s22
    s_mov_b32 s35, 0
    s_waitcnt lgkmcnt(2)
    v_mfma_f32_32x32x16_bf16 v[128:143], a[0:3], v[16:19], 0
    s_mov_b64 exec, s[14:15]
    buffer_load_dword v8, v11, s[4:7], s13 offen sc1
    s_mov_b64 exec, -1
    v_mfma_f32_32x32x16_bf16 v[144:159], a[160:163], v[16:19], 0
    ds_read_b128 v[28:31], v2 offset:30720
    s_waitcnt lgkmcnt(2)
    v_mfma_f32_32x32x16_bf16 v[128:143], a[40:43], v[20:23], v[128:143]
    v_mfma_f32_32x32x16_bf16 v[144:159], a[200:203], v[20:23], v[144:159]
    ds_read_b128 v[16:19], v2 offset:1024
    s_waitcnt lgkmcnt(2)
    v_mfma_f32_32x32x16_bf16 v[128:143], a[80:83], v[24:27], v[128:143]
    v_mfma_f32_32x32x16_bf16 v[144:159], a[240:243], v[24:27], v[144:159]
    ds_read_b128 v[20:23], v2 offset:11264
    s_waitcnt lgkmcnt(2)
    v_mfma_f32_32x32x16_bf16 v[128:143], a[120:123], v[28:31], v[128:143]
    v_mfma_f32_32x32x16_bf16 v[144:159], v[216:219], v[28:31], v[144:159]
    ds_read_b128 v[24:27], v2 offset:21504
    s_waitcnt lgkmcnt(2)
    v_mfma_f32_32x32x16_bf16 v[128:143], a[4:7], v[16:19], v[128:143]
    v_mfma_f32_32x32x16_bf16 v[144:159], a[164:167], v[16:19], v[144:159]
    ds_read_b128 v[28:31], v2 offset:31744
    s_waitcnt lgkmcnt(2)
    v_mfma_f32_32x32x16_bf16 v[128:143], a[44:47], v[20:23], v[128:143]
    v_mfma_f32_32x32x16_bf16 v[144:159], a[204:207], v[20:23], v[144:159]
    ds_read_b128 v[16:19], v2 offset:2048
    s_waitcnt lgkmcnt(2)
    v_mfma_f32_32x32x16_bf16 v[128:143], a[84:87], v[24:27], v[128:143]
    v_mfma_f32_32x32x16_bf16 v[144:159], a[244:247], v[24:27], v[144:159]
    ds_read_b128 v[20:23], v2 offset:12288
    s_waitcnt lgkmcnt(2)
    v_mfma_f32_32x32x16_bf16 v[128:143], a[124:127], v[28:31], v[128:143]
    v_mfma_f32_32x32x16_bf16 v[144:159], v[220:223], v[28:31], v[144:159]
    ds_read_b128 v[24:27], v2 offset:22528
    s_waitcnt lgkmcnt(2)
    v_mfma_f32_32x32x16_bf16 v[128:143], a[8:11], v[16:19], v[128:143]
    v_mfma_f32_32x32x16_bf16 v[144:159], a[168:171], v[16:19], v[144:159]
    ds_read_b128 v[28:31], v2 offset:32768
    s_waitcnt lgkmcnt(2)
    v_mfma_f32_32x32x16_bf16 v[128:143], a[48:51], v[20:23], v[128:143]
    v_mfma_f32_32x32x16_bf16 v[144:159], a[208:211], v[20:23], v[144:159]
    ds_read_b128 v[16:19], v2 offset:3072
    s_waitcnt lgkmcnt(2)
    v_mfma_f32_32x32x16_bf16 v[128:143], a[88:91], v[24:27], v[128:143]
    v_mfma_f32_32x32x16_bf16 v[144:159], a[248:251], v[24:27], v[144:159]
    ds_read_b128 v[20:23], v2 offset:13312
    s_waitcnt lgkmcnt(2)
    v_mfma_f32_32x32x16_bf16 v[128:143], a[128:131], v[28:31], v[128:143]
    s_waitcnt vmcnt(0)
    s_cmp_eq_u32 s19, 0
    s_cbranch_scc1 NF_206
    s_mov_b64 exec, 1
    buffer_store_dword v7, off, s[4:7], s34 sc1
    s_mov_b64 exec, -1
    s_mov_b32 s19, 0
NF_206:
    s_cmp_lg_u32 s18, 0
    s_cbranch_scc1 CK_207
    s_cmp_ge_u32 s10, 63
    s_cbranch_scc1 CK_207
    v_cmp_eq_u32 vcc, 0, v8
    s_and_b64 vcc, vcc, s[14:15]
    s_cbranch_scc1 CK_207
    s_mov_b32 s18, 1
CK_207:
    s_barrier
    v_mfma_f32_32x32x16_bf16 v[144:159], v[224:227], v[28:31], v[144:159]
    ds_read_b128 v[24:27], v2 offset:23552
    s_waitcnt lgkmcnt(2)
    v_mfma_f32_32x32x16_bf16 v[128:143], a[12:15], v[16:19], v[128:143]
    s_cmp_eq_u32 s18, 0
    s_cbranch_scc1 PC_208
    s_add_u32 m0, s20, 0
    s_add_u32 s22, s12, 0
    buffer_load_dwordx4 v1, s[4:7], s22 offen offset:0 sc1 lds
PC_208:
    v_mfma_f32_32x32x16_bf16 v[144:159], a[172:175], v[16:19], v[144:159]
    ds_read_b128 v[28:31], v2 offset:33792
    s_waitcnt lgkmcnt(2)
    v_mfma_f32_32x32x16_bf16 v[128:143], a[52:55], v[20:23], v[128:143]
    s_cmp_eq_u32 s18, 0
    s_cbranch_scc1 PC_209
    buffer_load_dwordx4 v1, s[4:7], s22 offen offset:1024 sc1 lds
PC_209:
    v_mfma_f32_32x32x16_bf16 v[144:159], a[212:215], v[20:23], v[144:159]
    ds_read_b128 v[16:19], v2 offset:4096
    s_waitcnt lgkmcnt(2)
    v_mfma_f32_32x32x16_bf16 v[128:143], a[92:95], v[24:27], v[128:143]
    s_cmp_eq_u32 s18, 0
    s_cbranch_scc1 PC_210
    buffer_load_dwordx4 v1, s[4:7], s22 offen offset:2048 sc1 lds
PC_210:
    v_mfma_f32_32x32x16_bf16 v[144:159], a[252:255], v[24:27], v[144:159]
    ds_read_b128 v[20:23], v2 offset:14336
    s_waitcnt lgkmcnt(2)
    v_mfma_f32_32x32x16_bf16 v[128:143], a[132:135], v[28:31], v[128:143]
    s_cmp_eq_u32 s18, 0
    s_cbranch_scc1 PC_211
    buffer_load_dwordx4 v1, s[4:7], s22 offen offset:3072 sc1 lds
PC_211:
    v_mfma_f32_32x32x16_bf16 v[144:159], v[228:231], v[28:31], v[144:159]
    ds_read_b128 v[24:27], v2 offset:24576
    s_waitcnt lgkmcnt(2)
    v_mfma_f32_32x32x16_bf16 v[128:143], a[16:19], v[16:19], v[128:143]
    s_cmp_eq_u32 s18, 0
    s_cbranch_scc1 PC_212
    s_add_u32 m0, s20, 4096
    s_add_u32 s22, s12, 4096
    buffer_load_dwordx4 v1, s[4:7], s22 offen offset:0 sc1 lds
PC_212:
    v_mfma_f32_32x32x16_bf16 v[144:159], a[176:179], v[16:19], v[144:159]
    ds_read_b128 v[28:31], v2 offset:34816
    s_waitcnt lgkmcnt(2)
    v_mfma_f32_32x32x16_bf16 v[128:143], a[56:59], v[20:23], v[128:143]
    s_cmp_eq_u32 s18, 0
    s_cbranch_scc1 PC_213
    buffer_load_dwordx4 v1, s[4:7], s22 offen offset:1024 sc1 lds
PC_213:
    v_mfma_f32_32x32x16_bf16 v[144:159], a[216:219], v[20:23], v[144:159]
    ds_read_b128 v[16:19], v2 offset:5120
    s_waitcnt lgkmcnt(2)
    v_mfma_f32_32x32x16_bf16 v[128:143], a[96:99], v[24:27], v[128:143]
    s_cmp_eq_u32 s18, 0
    s_cbranch_scc1 PC_214
    buffer_load_dwordx4 v1, s[4:7], s22 offen offset:2048 sc1 lds
PC_214:
    v_mfma_f32_32x32x16_bf16 v[144:159], v[192:195], v[24:27], v[144:159]
    ds_read_b128 v[20:23], v2 offset:15360
    s_waitcnt lgkmcnt(2)
    v_mfma_f32_32x32x16_bf16 v[128:143], a[136:139], v[28:31], v[128:143]
    s_cmp_eq_u32 s18, 0
    s_cbranch_scc1 PC_215
    buffer_load_dwordx4 v1, s[4:7], s22 offen offset:3072 sc1 lds
PC_215:
    v_mfma_f32_32x32x16_bf16 v[144:159], v[232:235], v[28:31], v[144:159]
    ds_read_b128 v[24:27], v2 offset:25600
    s_waitcnt lgkmcnt(2)
    v_mfma_f32_32x32x16_bf16 v[128:143], a[20:23], v[16:19], v[128:143]
    s_cmp_eq_u32 s18, 0
    s_cbranch_scc1 PC_216
    s_add_u32 m0, s20, 8192
    s_add_u32 s22, s12, 8192
    buffer_load_dwordx4 v1, s[4:7], s22 offen offset:0 sc1 lds
PC_216:
    v_mfma_f32_32x32x16_bf16 v[144:159], a[180:183], v[16:19], v[144:159]
    ds_read_b128 v[28:31], v2 offset:35840
    s_waitcnt lgkmcnt(2)
    v_mfma_f32_32x32x16_bf16 v[128:143], a[60:63], v[20:23], v[128:143]
    s_cmp_eq_u32 s18, 0
    s_cbranch_scc1 PC_217
    buffer_load_dwordx4 v1, s[4:7], s22 offen offset:1024 sc1 lds
PC_217:
    v_mfma_f32_32x32x16_bf16 v[144:159], a[220:223], v[20:23], v[144:159]
    ds_read_b128 v[16:19], v2 offset:6144
    s_waitcnt lgkmcnt(2)
    v_mfma_f32_32x32x16_bf16 v[128:143], a[100:103], v[24:27], v[128:143]
    v_mfma_f32_32x32x16_bf16 v[144:159], v[196:199], v[24:27], v[144:159]
    ds_read_b128 v[20:23], v2 offset:16384
    s_waitcnt lgkmcnt(2)
    v_mfma_f32_32x32x16_bf16 v[128:143], a[140:143], v[28:31], v[128:143]
    v_mfma_f32_32x32x16_bf16 v[144:159], v[236:239], v[28:31], v[144:159]
    ds_read_b128 v[24:27], v2 offset:26624
    s_waitcnt lgkmcnt(2)
    v_mfma_f32_32x32x16_bf16 v[128:143], a[24:27], v[16:19], v[128:143]
    v_mfma_f32_32x32x16_bf16 v[144:159], a[184:187], v[16:19], v[144:159]
    ds_read_b128 v[28:31], v2 offset:36864
    s_waitcnt lgkmcnt(2)
    v_mfma_f32_32x32x16_bf16 v[128:143], a[64:67], v[20:23], v[128:143]
    buffer_load_dwordx4 v[92:95], v4, s[4:7], s36 offen sc1
    buffer_load_dwordx4 v[96:99], v4, s[4:7], s36 offen offset:16 sc1
    v_mfma_f32_32x32x16_bf16 v[144:159], a[224:227], v[20:23], v[144:159]
    ds_read_b128 v[16:19], v2 offset:7168
    s_waitcnt lgkmcnt(2)
    v_mfma_f32_32x32x16_bf16 v[128:143], a[104:107], v[24:27], v[128:143]
    v_mfma_f32_32x32x16_bf16 v[144:159], v[200:203], v[24:27], v[144:159]
    ds_read_b128 v[20:23], v2 offset:17408
    s_waitcnt lgkmcnt(2)
    v_mfma_f32_32x32x16_bf16 v[128:143], a[144:147], v[28:31], v[128:143]
    v_mfma_f32_32x32x16_bf16 v[144:159], v[240:243], v[28:31], v[144:159]
    ds_read_b128 v[24:27], v2 offset:27648
    s_cmp_ge_u32 s10, 63
    s_cselect_b32 s21, 1, s18
    s_cmp_lg_u32 s21, 0
    s_cbranch_scc1 SK_218
    s_mov_b64 exec, s[14:15]
    buffer_load_dword v8, v11, s[4:7], s13 offen sc1
    s_mov_b64 exec, -1
SK_218:
    s_waitcnt lgkmcnt(2)
    v_mfma_f32_32x32x16_bf16 v[128:143], a[28:31], v[16:19], v[128:143]
    v_mfma_f32_32x32x16_bf16 v[144:159], a[188:191], v[16:19], v[144:159]
    ds_read_b128 v[28:31], v2 offset:37888
    s_waitcnt lgkmcnt(2)
    v_mfma_f32_32x32x16_bf16 v[128:143], a[68:71], v[20:23], v[128:143]
    v_mfma_f32_32x32x16_bf16 v[144:159], a[228:231], v[20:23], v[144:159]
    ds_read_b128 v[16:19], v2 offset:8192
    s_waitcnt lgkmcnt(2)
    v_mfma_f32_32x32x16_bf16 v[128:143], a[108:111], v[24:27], v[128:143]
    v_mfma_f32_32x32x16_bf16 v[144:159], v[204:207], v[24:27], v[144:159]
    ds_read_b128 v[20:23], v2 offset:18432
    s_waitcnt lgkmcnt(2)
    v_mfma_f32_32x32x16_bf16 v[128:143], a[148:151], v[28:31], v[128:143]
    v_mfma_f32_32x32x16_bf16 v[144:159], v[244:247], v[28:31], v[144:159]
    ds_read_b128 v[24:27], v2 offset:28672
    s_waitcnt lgkmcnt(2)
    v_mfma_f32_32x32x16_bf16 v[128:143], a[32:35], v[16:19], v[128:143]
    v_mfma_f32_32x32x16_bf16 v[144:159], a[192:195], v[16:19], v[144:159]
    ds_read_b128 v[28:31], v2 offset:38912
    s_waitcnt lgkmcnt(2)
    v_mfma_f32_32x32x16_bf16 v[128:143], a[72:75], v[20:23], v[128:143]
    v_mfma_f32_32x32x16_bf16 v[144:159], a[232:235], v[20:23], v[144:159]
    ds_read_b128 v[16:19], v2 offset:9216
    s_waitcnt lgkmcnt(2)
    v_mfma_f32_32x32x16_bf16 v[128:143], a[112:115], v[24:27], v[128:143]
    v_mfma_f32_32x32x16_bf16 v[144:159], v[208:211], v[24:27], v[144:159]
    ds_read_b128 v[20:23], v2 offset:19456
    s_waitcnt lgkmcnt(2)
    v_mfma_f32_32x32x16_bf16 v[128:143], a[152:155], v[28:31], v[128:143]
    s_waitcnt vmcnt(0)
    v_min3_u32 v40, v93, v95, v97
    v_min_u32 v40, v40, v99
    v_cmp_eq_u32 vcc, 0, v40
    s_cmp_eq_u64 vcc, 0
    s_cselect_b32 s30, 1, 0
    v_mfma_f32_32x32x16_bf16 v[144:159], v[248:251], v[28:31], v[144:159]
    ds_read_b128 v[24:27], v2 offset:29696
    s_cmp_ge_u32 s10, 63
    s_cselect_b32 s21, 1, s18
    s_cmp_lg_u32 s21, 0
    s_cbranch_scc1 SK_219
    s_waitcnt vmcnt(0)
    s_cmp_eq_u32 s19, 0
    s_cbranch_scc1 NF_220
    s_mov_b64 exec, 1
    buffer_store_dword v7, off, s[4:7], s34 sc1
    s_mov_b64 exec, -1
    s_mov_b32 s19, 0
NF_220:
    s_cmp_lg_u32 s18, 0
    s_cbranch_scc1 CK_221
    s_cmp_ge_u32 s10, 63
    s_cbranch_scc1 CK_221
    v_cmp_eq_u32 vcc, 0, v8
    s_and_b64 vcc, vcc, s[14:15]
    s_cbranch_scc1 CK_221
    s_mov_b32 s18, 1
CK_221:
    s_mov_b32 s35, s18
SK_219:
    s_waitcnt lgkmcnt(2)
    v_mfma_f32_32x32x16_bf16 v[128:143], a[36:39], v[16:19], v[128:143]
    v_add_f32 v92, v92, v94
    v_add_f32 v93, v93, v95
    v_add_f32 v96, v96, v98
    v_add_f32 v97, v97, v99
    v_mfma_f32_32x32x16_bf16 v[144:159], a[196:199], v[16:19], v[144:159]
    ds_read_b128 v[28:31], v2 offset:39936
    v_add_f32 v92, v92, v96
    v_add_f32 v93, v93, v97
    v_mul_f32 v92, 0x3acccccd, v92
    v_mul_f32 v93, 0x3acccccd, v93
    s_waitcnt lgkmcnt(2)
    v_mfma_f32_32x32x16_bf16 v[128:143], a[76:79], v[20:23], v[128:143]
    v_fma_f32 v93, -v92, v92, v93
    v_max_f32 v93, 0, v93
    v_cvt_pk_bf16_f32 v92, v92, v93
    v_lshlrev_b32 v37, 16, v92
    v_mfma_f32_32x32x16_bf16 v[144:159], a[236:239], v[20:23], v[144:159]
    v_and_b32 v93, 0xffff0000, v92
    v_xor_b32 v37, 0x80000000, v37
    v_add_f32 v93, 0x3727c5ac, v93
    v_cvt_pk_bf16_f32 v93, v93, v93
    s_waitcnt lgkmcnt(1)
    v_mfma_f32_32x32x16_bf16 v[128:143], a[116:119], v[24:27], v[128:143]
    v_lshlrev_b32 v93, 16, v93
    v_sqrt_f32 v93, v93
    s_nop 0
    v_cvt_pk_bf16_f32 v93, v93, v93
    v_lshlrev_b32 v93, 16, v93
    v_mfma_f32_32x32x16_bf16 v[144:159], v[212:215], v[24:27], v[144:159]
    v_rcp_f32 v36, v93
    s_waitcnt lgkmcnt(0)
    v_mfma_f32_32x32x16_bf16 v[128:143], a[156:159], v[28:31], v[128:143]
    v_mfma_f32_32x32x16_bf16 v[144:159], v[252:255], v[28:31], v[144:159]
    s_cmp_lg_u32 s30, 0
    s_cbranch_scc1 SO_223
    s_mov_b32 s24, 0
SP_222:
    s_add_u32 s24, s24, 1
    s_cmp_ge_u32 s24, 200000
    s_cbranch_scc1 F_F1
    buffer_load_dwordx4 v[92:95], v4, s[4:7], s36 offen sc1
    buffer_load_dwordx4 v[96:99], v4, s[4:7], s36 offen offset:16 sc1
    s_waitcnt vmcnt(0)
    v_min3_u32 v40, v93, v95, v97
    v_min_u32 v40, v40, v99
    v_cmp_eq_u32 vcc, 0, v40
    s_cbranch_vccnz SP_222
    v_add_f32 v92, v92, v94
    v_add_f32 v93, v93, v95
    v_add_f32 v96, v96, v98
    v_add_f32 v97, v97, v99
    v_add_f32 v92, v92, v96
    v_add_f32 v93, v93, v97
    v_mul_f32 v92, 0x3acccccd, v92
    v_mul_f32 v93, 0x3acccccd, v93
    v_fma_f32 v93, -v92, v92, v93
    v_max_f32 v93, 0, v93
    v_cvt_pk_bf16_f32 v92, v92, v93
    v_lshlrev_b32 v37, 16, v92
    v_and_b32 v93, 0xffff0000, v92
    v_xor_b32 v37, 0x80000000, v37
    v_add_f32 v93, 0x3727c5ac, v93
    v_cvt_pk_bf16_f32 v93, v93, v93
    v_lshlrev_b32 v93, 16, v93
    v_sqrt_f32 v93, v93
    s_nop 0
    v_cvt_pk_bf16_f32 v93, v93, v93
    v_lshlrev_b32 v93, 16, v93
    v_rcp_f32 v36, v93
SO_223:
    s_cmp_ge_u32 s20, 40960
    s_cselect_b32 s21, 81920, 0
    s_sub_u32 s21, s21, 40960
    v_add_u32 v2, s21, v2
    s_nop 4
    v_pk_fma_f32 v[128:129], v[160:161], v[36:37], v[128:129] op_sel:[0,1,0] op_sel_hi:[1,1,1]
    v_pk_mul_f32 v[128:129], v[128:129], v[36:37] op_sel_hi:[1,0]
    v_pk_fma_f32 v[130:131], v[162:163], v[36:37], v[130:131] op_sel:[0,1,0] op_sel_hi:[1,1,1]
    v_pk_mul_f32 v[130:131], v[130:131], v[36:37] op_sel_hi:[1,0]
    v_pk_fma_f32 v[144:145], v[176:177], v[36:37], v[144:145] op_sel:[0,1,0] op_sel_hi:[1,1,1]
    v_pk_mul_f32 v[144:145], v[144:145], v[36:37] op_sel_hi:[1,0]
    v_pk_fma_f32 v[146:147], v[178:179], v[36:37], v[146:147] op_sel:[0,1,0] op_sel_hi:[1,1,1]
    v_pk_mul_f32 v[146:147], v[146:147], v[36:37] op_sel_hi:[1,0]
    v_cvt_pk_bf16_f32 v76, v128, v144
    v_pk_max_i16 v76, v76, 0
    v_cvt_pk_bf16_f32 v77, v129, v145
    v_pk_max_i16 v77, v77, 0
    v_cvt_pk_bf16_f32 v78, v130, v146
    v_pk_max_i16 v78, v78, 0
    v_cvt_pk_bf16_f32 v79, v131, v147
    v_pk_max_i16 v79, v79, 0
    buffer_store_dwordx4 v[76:79], v1, s[4:7], s16 offen offset:0 sc1
    v_pk_fma_f32 v[132:133], v[164:165], v[36:37], v[132:133] op_sel:[0,1,0] op_sel_hi:[1,1,1]
    v_pk_mul_f32 v[132:133], v[132:133], v[36:37] op_sel_hi:[1,0]
    v_pk_fma_f32 v[134:135], v[166:167], v[36:37], v[134:135] op_sel:[0,1,0] op_sel_hi:[1,1,1]
    v_pk_mul_f32 v[134:135], v[134:135], v[36:37] op_sel_hi:[1,0]
    v_pk_fma_f32 v[148:149], v[180:181], v[36:37], v[148:149] op_sel:[0,1,0] op_sel_hi:[1,1,1]
    v_pk_mul_f32 v[148:149], v[148:149], v[36:37] op_sel_hi:[1,0]
    v_pk_fma_f32 v[150:151], v[182:183], v[36:37], v[150:151] op_sel:[0,1,0] op_sel_hi:[1,1,1]
    v_pk_mul_f32 v[150:151], v[150:151], v[36:37] op_sel_hi:[1,0]
    v_cvt_pk_bf16_f32 v80, v132, v148
    v_pk_max_i16 v80, v80, 0
    v_cvt_pk_bf16_f32 v81, v133, v149
    v_pk_max_i16 v81, v81, 0
    v_cvt_pk_bf16_f32 v82, v134, v150
    v_pk_max_i16 v82, v82, 0
    v_cvt_pk_bf16_f32 v83, v135, v151
    v_pk_max_i16 v83, v83, 0
    buffer_store_dwordx4 v[80:83], v1, s[4:7], s16 offen offset:1024 sc1
    v_pk_fma_f32 v[136:137], v[168:169], v[36:37], v[136:137] op_sel:[0,1,0] op_sel_hi:[1,1,1]
    v_pk_mul_f32 v[136:137], v[136:137], v[36:37] op_sel_hi:[1,0]
    v_pk_fma_f32 v[138:139], v[170:171], v[36:37], v[138:139] op_sel:[0,1,0] op_sel_hi:[1,1,1]
    v_pk_mul_f32 v[138:139], v[138:139], v[36:37] op_sel_hi:[1,0]
    v_pk_fma_f32 v[152:153], v[184:185], v[36:37], v[152:153] op_sel:[0,1,0] op_sel_hi:[1,1,1]
    v_pk_mul_f32 v[152:153], v[152:153], v[36:37] op_sel_hi:[1,0]
    v_pk_fma_f32 v[154:155], v[186:187], v[36:37], v[154:155] op_sel:[0,1,0] op_sel_hi:[1,1,1]
    v_pk_mul_f32 v[154:155], v[154:155], v[36:37] op_sel_hi:[1,0]
    v_cvt_pk_bf16_f32 v84, v136, v152
    v_pk_max_i16 v84, v84, 0
    v_cvt_pk_bf16_f32 v85, v137, v153
    v_pk_max_i16 v85, v85, 0
    v_cvt_pk_bf16_f32 v86, v138, v154
    v_pk_max_i16 v86, v86, 0
    v_cvt_pk_bf16_f32 v87, v139, v155
    v_pk_max_i16 v87, v87, 0
    buffer_store_dwordx4 v[84:87], v1, s[4:7], s16 offen offset:2048 sc1
    v_pk_fma_f32 v[140:141], v[172:173], v[36:37], v[140:141] op_sel:[0,1,0] op_sel_hi:[1,1,1]
    v_pk_mul_f32 v[140:141], v[140:141], v[36:37] op_sel_hi:[1,0]
    v_pk_fma_f32 v[142:143], v[174:175], v[36:37], v[142:143] op_sel:[0,1,0] op_sel_hi:[1,1,1]
    v_pk_mul_f32 v[142:143], v[142:143], v[36:37] op_sel_hi:[1,0]
    v_pk_fma_f32 v[156:157], v[188:189], v[36:37], v[156:157] op_sel:[0,1,0] op_sel_hi:[1,1,1]
    v_pk_mul_f32 v[156:157], v[156:157], v[36:37] op_sel_hi:[1,0]
    v_pk_fma_f32 v[158:159], v[190:191], v[36:37], v[158:159] op_sel:[0,1,0] op_sel_hi:[1,1,1]
    v_pk_mul_f32 v[158:159], v[158:159], v[36:37] op_sel_hi:[1,0]
    v_cvt_pk_bf16_f32 v88, v140, v156
    v_pk_max_i16 v88, v88, 0
    v_cvt_pk_bf16_f32 v89, v141, v157
    v_pk_max_i16 v89, v89, 0
    v_cvt_pk_bf16_f32 v90, v142, v158
    v_pk_max_i16 v90, v90, 0
    v_cvt_pk_bf16_f32 v91, v143, v159
    v_pk_max_i16 v91, v91, 0
    buffer_store_dwordx4 v[88:91], v1, s[4:7], s16 offen offset:3072 sc1
    s_mov_b64 exec, -1
    s_mov_b32 s19, s25
    s_mov_b32 s34, s17
    s_add_u32 s17, s17, 512
    s_add_u32 s36, s36, 1024
    s_add_u32 s16, s16, 114688
    s_add_u32 s10, s10, 1
    s_cmp_lt_u32 s10, 64
    s_cbranch_scc1 T1_ITEM_198
    s_waitcnt vmcnt(0)
    s_cmp_eq_u32 s19, 0
    s_cbranch_scc1 NF_224
    s_mov_b64 exec, 1
    buffer_store_dword v7, off, s[4:7], s34 sc1
    s_mov_b64 exec, -1
    s_mov_b32 s19, 0
NF_224:
    s_endpgm
F_F1:
    s_endpgm
.p2align 6
R_F2:
    s_load_dwordx2 s[40:41], s[0:1], 80
    v_lshrrev_b32 v2, 6, v0
    v_and_b32 v0, 63, v0
    v_readfirstlane_b32 s9, v2
    v_lshlrev_b32 v1, 4, v0
    v_lshlrev_b32 v11, 2, v0
    v_mov_b32 v6, 1
    s_lshl_b32 s21, s9, 15
    s_add_u32 s21, s21, 32768
    v_add_u32 v3, s21, v1
    s_lshl_b32 s21, s9, 13
    v_add_u32 v4, s21, v1
    s_lshl_b32 s21, s9, 10
    v_add_u32 v5, s21, v1
    s_mov_b32 s10, 0
    s_mov_b32 s27, s8
    s_mul_i32 s12, s11, 7340032
    s_add_u32 s12, s12, 101711872
    s_mul_i32 s13, s11, 32768
    s_add_u32 s17, s13, 155418624
    s_add_u32 s13, s13, 155320320
    s_lshl_b32 s21, s9, 7
    s_add_u32 s13, s13, s21
    s_sub_u32 s13, s13, 128
    v_add_u32 v11, 128, v11
    v_cmp_eq_u32 vcc, 7, v0
    s_nop 1
    v_cndmask_b32 v11, v11, 24, vcc
    s_cmp_eq_u32 s9, 0
    s_cselect_b32 s14, 0x7f, -1
    s_and_b32 s14, s14, 0xff
    s_mov_b32 s15, 0
    s_lshl_b32 s23, s11, 1
    s_add_u32 s23, s23, 1
    s_mul_i32 s21, s9, 27648
    s_add_u32 s12, s12, s21
    s_mul_i32 s21, s10, 114688
    s_add_u32 s12, s12, s21
    s_lshl_b32 s21, s10, 9
    s_add_u32 s13, s13, s21
    s_add_u32 s17, s17, s21
    s_lshl_b32 s22, s27, 2
    s_add_u32 s22, s22, s9
    s_lshl_b32 s21, s22, 2
    s_add_u32 s17, s17, s21
    s_mul_i32 s21, s22, 26
    s_lshr_b32 s21, s21, 8
    s_mul_i32 s21, s21, 88
    s_add_u32 s17, s17, s21
    s_mul_i32 s18, s23, 2621440
    s_mul_i32 s21, s10, 40960
    s_add_u32 s18, s18, s21
    s_lshl_b32 s21, s22, 10
    s_add_u32 s18, s18, s21
    s_add_u32 s18, s18, 116391936
    s_add_u32 s16, s18, 2621440
    v_mov_b32 v2, v1
    s_mov_b32 s42, 2621440
    s_mov_b32 s43, 0x00020000
    s_waitcnt lgkmcnt(0)
    s_cmp_lg_u32 s23, 3
    s_cbranch_scc1 T2_WS_225
    v_and_b32 v12, 31, v0
    v_mul_u32_u24 v12, 1280, v12
    v_lshrrev_b32 v13, 5, v0
    v_lshl_add_u32 v2, v13, 4, v12
    s_lshl_b32 s16, s22, 5
    s_branch T2_G_226
T2_WS_225:
    s_mov_b32 s40, s4
    s_mov_b32 s41, s5
    s_mov_b32 s42, s6
T2_G_226:
    s_mov_b32 s32, s23
    s_load_dwordx2 s[88:89], s[0:1], 72
    s_mov_b32 s90, 2211840
    s_mov_b32 s91, 0x00020000
    s_mov_b32 s92, 0x05040100
    s_mov_b32 s93, 0x07060302
    s_waitcnt lgkmcnt(0)
    s_mul_i32 s26, s9, 552960
    s_lshl_b32 s21, s27, 7
    s_add_u32 s26, s26, s21
    v_lshrrev_b32 v7, 5, v0
    v_mul_u32_u24 v7, 10240, v7
    v_and_b32 v10, 31, v0
    s_lshl_b32 s21, s9, 3
    v_xor_b32 v10, s21, v10
    v_lshl_add_u32 v7, v10, 2, v7
    v_add_u32 v48, 0, v7
    v_add_u32 v49, 1280, v7
    v_add_u32 v50, 2560, v7
    v_add_u32 v51, 3840, v7
    v_add_u32 v52, 5120, v7
    v_add_u32 v53, 6400, v7
    v_add_u32 v54, 7680, v7
    v_add_u32 v55, 8960, v7
    buffer_load_dword v64, v48, s[88:91], s26 offen offset:0
    buffer_load_dword v65, v49, s[88:91], s26 offen offset:0
    buffer_load_dword v66, v50, s[88:91], s26 offen offset:0
    buffer_load_dword v67, v51, s[88:91], s26 offen offset:0
    buffer_load_dword v68, v52, s[88:91], s26 offen offset:0
    buffer_load_dword v69, v53, s[88:91], s26 offen offset:0
    buffer_load_dword v70, v54, s[88:91], s26 offen offset:0
    buffer_load_dword v71, v55, s[88:91], s26 offen offset:0
    s_add_u32 s26, s26, 20480
    buffer_load_dword v72, v48, s[88:91], s26 offen offset:0
    buffer_load_dword v73, v49, s[88:91], s26 offen offset:0
    buffer_load_dword v74, v50, s[88:91], s26 offen offset:0
    buffer_load_dword v75, v51, s[88:91], s26 offen offset:0
    buffer_load_dword v76, v52, s[88:91], s26 offen offset:0
    buffer_load_dword v77, v53, s[88:91], s26 offen offset:0
    buffer_load_dword v78, v54, s[88:91], s26 offen offset:0
    buffer_load_dword v79, v55, s[88:91], s26 offen offset:0
    s_add_u32 s26, s26, 20480
    buffer_load_dword v80, v48, s[88:91], s26 offen offset:0
    buffer_load_dword v81, v49, s[88:91], s26 offen offset:0
    buffer_load_dword v82, v50, s[88:91], s26 offen offset:0
    buffer_load_dword v83, v51, s[88:91], s26 offen offset:0
    buffer_load_dword v84, v52, s[88:91], s26 offen offset:0
    buffer_load_dword v85, v53, s[88:91], s26 offen offset:0
    buffer_load_dword v86, v54, s[88:91], s26 offen offset:0
    buffer_load_dword v87, v55, s[88:91], s26 offen offset:0
    s_add_u32 s26, s26, 20480
    buffer_load_dword v88, v48, s[88:91], s26 offen offset:0
    buffer_load_dword v89, v49, s[88:91], s26 offen offset:0
    buffer_load_dword v90, v50, s[88:91], s26 offen offset:0
    buffer_load_dword v91, v51, s[88:91], s26 offen offset:0
    buffer_load_dword v92, v52, s[88:91], s26 offen offset:0
    buffer_load_dword v93, v53, s[88:91], s26 offen offset:0
    buffer_load_dword v94, v54, s[88:91], s26 offen offset:0
    buffer_load_dword v95, v55, s[88:91], s26 offen offset:0
    s_add_u32 s26, s26, 20480
    buffer_load_dword v96, v48, s[88:91], s26 offen offset:0
    buffer_load_dword v97, v49, s[88:91], s26 offen offset:0
    buffer_load_dword v98, v50, s[88:91], s26 offen offset:0
    buffer_load_dword v99, v51, s[88:91], s26 offen offset:0
    buffer_load_dword v100, v52, s[88:91], s26 offen offset:0
    buffer_load_dword v101, v53, s[88:91], s26 offen offset:0
    buffer_load_dword v102, v54, s[88:91], s26 offen offset:0
    buffer_load_dword v103, v55, s[88:91], s26 offen offset:0
    s_add_u32 s26, s26, 20480
    buffer_load_dword v104, v48, s[88:91], s26 offen offset:0
    buffer_load_dword v105, v49, s[88:91], s26 offen offset:0
    buffer_load_dword v106, v50, s[88:91], s26 offen offset:0
    buffer_load_dword v107, v51, s[88:91], s26 offen offset:0
    buffer_load_dword v108, v52, s[88:91], s26 offen offset:0
    buffer_load_dword v109, v53, s[88:91], s26 offen offset:0
    buffer_load_dword v110, v54, s[88:91], s26 offen offset:0
    buffer_load_dword v111, v55, s[88:91], s26 offen offset:0
    s_add_u32 s26, s26, 20480
    buffer_load_dword v112, v48, s[88:91], s26 offen offset:0
    buffer_load_dword v113, v49, s[88:91], s26 offen offset:0
    buffer_load_dword v114, v50, s[88:91], s26 offen offset:0
    buffer_load_dword v115, v51, s[88:91], s26 offen offset:0
    buffer_load_dword v116, v52, s[88:91], s26 offen offset:0
    buffer_load_dword v117, v53, s[88:91], s26 offen offset:0
    buffer_load_dword v118, v54, s[88:91], s26 offen offset:0
    buffer_load_dword v119, v55, s[88:91], s26 offen offset:0
    s_add_u32 s26, s26, 20480
    s_waitcnt vmcnt(48)
    v_perm_b32 v56, v65, v64, s92
    v_perm_b32 v57, v67, v66, s92
    v_perm_b32 v58, v69, v68, s92
    v_perm_b32 v59, v71, v70, s92
    v_accvgpr_write_b32 a0, v56
    v_accvgpr_write_b32 a1, v57
    v_accvgpr_write_b32 a2, v58
    v_accvgpr_write_b32 a3, v59
    v_perm_b32 v60, v65, v64, s93
    v_perm_b32 v61, v67, v66, s93
    v_perm_b32 v62, v69, v68, s93
    v_perm_b32 v63, v71, v70, s93
    v_accvgpr_write_b32 a4, v60
    v_accvgpr_write_b32 a5, v61
    v_accvgpr_write_b32 a6, v62
    v_accvgpr_write_b32 a7, v63
    buffer_load_dword v64, v48, s[88:91], s26 offen offset:0
    buffer_load_dword v65, v49, s[88:91], s26 offen offset:0
    buffer_load_dword v66, v50, s[88:91], s26 offen offset:0
    buffer_load_dword v67, v51, s[88:91], s26 offen offset:0
    buffer_load_dword v68, v52, s[88:91], s26 offen offset:0
    buffer_load_dword v69, v53, s[88:91], s26 offen offset:0
    buffer_load_dword v70, v54, s[88:91], s26 offen offset:0
    buffer_load_dword v71, v55, s[88:91], s26 offen offset:0
    s_add_u32 s26, s26, 20480
    s_waitcnt vmcnt(48)
    v_perm_b32 v56, v73, v72, s92
    v_perm_b32 v57, v75, v74, s92
    v_perm_b32 v58, v77, v76, s92
    v_perm_b32 v59, v79, v78, s92
    v_accvgpr_write_b32 a8, v56
    v_accvgpr_write_b32 a9, v57
    v_accvgpr_write_b32 a10, v58
    v_accvgpr_write_b32 a11, v59
    v_perm_b32 v60, v73, v72, s93
    v_perm_b32 v61, v75, v74, s93
    v_perm_b32 v62, v77, v76, s93
    v_perm_b32 v63, v79, v78, s93
    v_accvgpr_write_b32 a12, v60
    v_accvgpr_write_b32 a13, v61
    v_accvgpr_write_b32 a14, v62
    v_accvgpr_write_b32 a15, v63
    buffer_load_dword v72, v48, s[88:91], s26 offen offset:0
    buffer_load_dword v73, v49, s[88:91], s26 offen offset:0
    buffer_load_dword v74, v50, s[88:91], s26 offen offset:0
    buffer_load_dword v75, v51, s[88:91], s26 offen offset:0
    buffer_load_dword v76, v52, s[88:91], s26 offen offset:0
    buffer_load_dword v77, v53, s[88:91], s26 offen offset:0
    buffer_load_dword v78, v54, s[88:91], s26 offen offset:0
    buffer_load_dword v79, v55, s[88:91], s26 offen offset:0
    s_add_u32 s26, s26, 20480
    s_waitcnt vmcnt(48)
    v_perm_b32 v56, v81, v80, s92
    v_perm_b32 v57, v83, v82, s92
    v_perm_b32 v58, v85, v84, s92
    v_perm_b32 v59, v87, v86, s92
    v_accvgpr_write_b32 a16, v56
    v_accvgpr_write_b32 a17, v57
    v_accvgpr_write_b32 a18, v58
    v_accvgpr_write_b32 a19, v59
    v_perm_b32 v60, v81, v80, s93
    v_perm_b32 v61, v83, v82, s93
    v_perm_b32 v62, v85, v84, s93
    v_perm_b32 v63, v87, v86, s93
    v_accvgpr_write_b32 a20, v60
    v_accvgpr_write_b32 a21, v61
    v_accvgpr_write_b32 a22, v62
    v_accvgpr_write_b32 a23, v63
    buffer_load_dword v80, v48, s[88:91], s26 offen offset:0
    buffer_load_dword v81, v49, s[88:91], s26 offen offset:0
    buffer_load_dword v82, v50, s[88:91], s26 offen offset:0
    buffer_load_dword v83, v51, s[88:91], s26 offen offset:0
    buffer_load_dword v84, v52, s[88:91], s26 offen offset:0
    buffer_load_dword v85, v53, s[88:91], s26 offen offset:0
    buffer_load_dword v86, v54, s[88:91], s26 offen offset:0
    buffer_load_dword v87, v55, s[88:91], s26 offen offset:0
    s_add_u32 s26, s26, 20480
    s_waitcnt vmcnt(48)
    v_perm_b32 v56, v89, v88, s92
    v_perm_b32 v57, v91, v90, s92
    v_perm_b32 v58, v93, v92, s92
    v_perm_b32 v59, v95, v94, s92
    v_accvgpr_write_b32 a24, v56
    v_accvgpr_write_b32 a25, v57
    v_accvgpr_write_b32 a26, v58
    v_accvgpr_write_b32 a27, v59
    v_perm_b32 v60, v89, v88, s93
    v_perm_b32 v61, v91, v90, s93
    v_perm_b32 v62, v93, v92, s93
    v_perm_b32 v63, v95, v94, s93
    v_accvgpr_write_b32 a28, v60
    v_accvgpr_write_b32 a29, v61
    v_accvgpr_write_b32 a30, v62
    v_accvgpr_write_b32 a31, v63
    buffer_load_dword v88, v48, s[88:91], s26 offen offset:0
    buffer_load_dword v89, v49, s[88:91], s26 offen offset:0
    buffer_load_dword v90, v50, s[88:91], s26 offen offset:0
    buffer_load_dword v91, v51, s[88:91], s26 offen offset:0
    buffer_load_dword v92, v52, s[88:91], s26 offen offset:0
    buffer_load_dword v93, v53, s[88:91], s26 offen offset:0
    buffer_load_dword v94, v54, s[88:91], s26 offen offset:0
    buffer_load_dword v95, v55, s[88:91], s26 offen offset:0
    s_add_u32 s26, s26, 20480
    s_waitcnt vmcnt(48)
    v_perm_b32 v56, v97, v96, s92
    v_perm_b32 v57, v99, v98, s92
    v_perm_b32 v58, v101, v100, s92
    v_perm_b32 v59, v103, v102, s92
    v_accvgpr_write_b32 a32, v56
    v_accvgpr_write_b32 a33, v57
    v_accvgpr_write_b32 a34, v58
    v_accvgpr_write_b32 a35, v59
    v_perm_b32 v60, v97, v96, s93
    v_perm_b32 v61, v99, v98, s93
    v_perm_b32 v62, v101, v100, s93
    v_perm_b32 v63, v103, v102, s93
    v_accvgpr_write_b32 a36, v60
    v_accvgpr_write_b32 a37, v61
    v_accvgpr_write_b32 a38, v62
    v_accvgpr_write_b32 a39, v63
    buffer_load_dword v96, v48, s[88:91], s26 offen offset:0
    buffer_load_dword v97, v49, s[88:91], s26 offen offset:0
    buffer_load_dword v98, v50, s[88:91], s26 offen offset:0
    buffer_load_dword v99, v51, s[88:91], s26 offen offset:0
    buffer_load_dword v100, v52, s[88:91], s26 offen offset:0
    buffer_load_dword v101, v53, s[88:91], s26 offen offset:0
    buffer_load_dword v102, v54, s[88:91], s26 offen offset:0
    buffer_load_dword v103, v55, s[88:91], s26 offen offset:0
    s_add_u32 s26, s26, 20480
    s_waitcnt vmcnt(48)
    v_perm_b32 v56, v105, v104, s92
    v_perm_b32 v57, v107, v106, s92
    v_perm_b32 v58, v109, v108, s92
    v_perm_b32 v59, v111, v110, s92
    v_accvgpr_write_b32 a40, v56
    v_accvgpr_write_b32 a41, v57
    v_accvgpr_write_b32 a42, v58
    v_accvgpr_write_b32 a43, v59
    v_perm_b32 v60, v105, v104, s93
    v_perm_b32 v61, v107, v106, s93
    v_perm_b32 v62, v109, v108, s93
    v_perm_b32 v63, v111, v110, s93
    v_accvgpr_write_b32 a44, v60
    v_accvgpr_write_b32 a45, v61
    v_accvgpr_write_b32 a46, v62
    v_accvgpr_write_b32 a47, v63
    buffer_load_dword v104, v48, s[88:91], s26 offen offset:0
    buffer_load_dword v105, v49, s[88:91], s26 offen offset:0
    buffer_load_dword v106, v50, s[88:91], s26 offen offset:0
    buffer_load_dword v107, v51, s[88:91], s26 offen offset:0
    buffer_load_dword v108, v52, s[88:91], s26 offen offset:0
    buffer_load_dword v109, v53, s[88:91], s26 offen offset:0
    buffer_load_dword v110, v54, s[88:91], s26 offen offset:0
    buffer_load_dword v111, v55, s[88:91], s26 offen offset:0
    s_add_u32 s26, s26, 20480
    s_waitcnt vmcnt(48)
    v_perm_b32 v56, v113, v112, s92
    v_perm_b32 v57, v115, v114, s92
    v_perm_b32 v58, v117, v116, s92
    v_perm_b32 v59, v119, v118, s92
    v_accvgpr_write_b32 a48, v56
    v_accvgpr_write_b32 a49, v57
    v_accvgpr_write_b32 a50, v58
    v_accvgpr_write_b32 a51, v59
    v_perm_b32 v60, v113, v112, s93
    v_perm_b32 v61, v115, v114, s93
    v_perm_b32 v62, v117, v116, s93
    v_perm_b32 v63, v119, v118, s93
    v_accvgpr_write_b32 a52, v60
    v_accvgpr_write_b32 a53, v61
    v_accvgpr_write_b32 a54, v62
    v_accvgpr_write_b32 a55, v63
    buffer_load_dword v112, v48, s[88:91], s26 offen offset:0
    buffer_load_dword v113, v49, s[88:91], s26 offen offset:0
    buffer_load_dword v114, v50, s[88:91], s26 offen offset:0
    buffer_load_dword v115, v51, s[88:91], s26 offen offset:0
    buffer_load_dword v116, v52, s[88:91], s26 offen offset:0
    buffer_load_dword v117, v53, s[88:91], s26 offen offset:0
    buffer_load_dword v118, v54, s[88:91], s26 offen offset:0
    buffer_load_dword v119, v55, s[88:91], s26 offen offset:0
    s_add_u32 s26, s26, 20480
    s_waitcnt vmcnt(48)
    v_perm_b32 v56, v65, v64, s92
    v_perm_b32 v57, v67, v66, s92
    v_perm_b32 v58, v69, v68, s92
    v_perm_b32 v59, v71, v70, s92
    v_accvgpr_write_b32 a56, v56
    v_accvgpr_write_b32 a57, v57
    v_accvgpr_write_b32 a58, v58
    v_accvgpr_write_b32 a59, v59
    v_perm_b32 v60, v65, v64, s93
    v_perm_b32 v61, v67, v66, s93
    v_perm_b32 v62, v69, v68, s93
    v_perm_b32 v63, v71, v70, s93
    v_accvgpr_write_b32 a60, v60
    v_accvgpr_write_b32 a61, v61
    v_accvgpr_write_b32 a62, v62
    v_accvgpr_write_b32 a63, v63
    buffer_load_dword v64, v48, s[88:91], s26 offen offset:0
    buffer_load_dword v65, v49, s[88:91], s26 offen offset:0
    buffer_load_dword v66, v50, s[88:91], s26 offen offset:0
    buffer_load_dword v67, v51, s[88:91], s26 offen offset:0
    buffer_load_dword v68, v52, s[88:91], s26 offen offset:0
    buffer_load_dword v69, v53, s[88:91], s26 offen offset:0
    buffer_load_dword v70, v54, s[88:91], s26 offen offset:0
    buffer_load_dword v71, v55, s[88:91], s26 offen offset:0
    s_add_u32 s26, s26, 20480
    s_waitcnt vmcnt(48)
    v_perm_b32 v56, v73, v72, s92
    v_perm_b32 v57, v75, v74, s92
    v_perm_b32 v58, v77, v76, s92
    v_perm_b32 v59, v79, v78, s92
    v_accvgpr_write_b32 a64, v56
    v_accvgpr_write_b32 a65, v57
    v_accvgpr_write_b32 a66, v58
    v_accvgpr_write_b32 a67, v59
    v_perm_b32 v60, v73, v72, s93
    v_perm_b32 v61, v75, v74, s93
    v_perm_b32 v62, v77, v76, s93
    v_perm_b32 v63, v79, v78, s93
    v_accvgpr_write_b32 a68, v60
    v_accvgpr_write_b32 a69, v61
    v_accvgpr_write_b32 a70, v62
    v_accvgpr_write_b32 a71, v63
    buffer_load_dword v72, v48, s[88:91], s26 offen offset:0
    buffer_load_dword v73, v49, s[88:91], s26 offen offset:0
    buffer_load_dword v74, v50, s[88:91], s26 offen offset:0
    buffer_load_dword v75, v51, s[88:91], s26 offen offset:0
    buffer_load_dword v76, v52, s[88:91], s26 offen offset:0
    buffer_load_dword v77, v53, s[88:91], s26 offen offset:0
    buffer_load_dword v78, v54, s[88:91], s26 offen offset:0
    buffer_load_dword v79, v55, s[88:91], s26 offen offset:0
    s_add_u32 s26, s26, 20480
    s_waitcnt vmcnt(48)
    v_perm_b32 v56, v81, v80, s92
    v_perm_b32 v57, v83, v82, s92
    v_perm_b32 v58, v85, v84, s92
    v_perm_b32 v59, v87, v86, s92
    v_accvgpr_write_b32 a72, v56
    v_accvgpr_write_b32 a73, v57
    v_accvgpr_write_b32 a74, v58
    v_accvgpr_write_b32 a75, v59
    v_perm_b32 v60, v81, v80, s93
    v_perm_b32 v61, v83, v82, s93
    v_perm_b32 v62, v85, v84, s93
    v_perm_b32 v63, v87, v86, s93
    v_accvgpr_write_b32 a76, v60
    v_accvgpr_write_b32 a77, v61
    v_accvgpr_write_b32 a78, v62
    v_accvgpr_write_b32 a79, v63
    buffer_load_dword v80, v48, s[88:91], s26 offen offset:0
    buffer_load_dword v81, v49, s[88:91], s26 offen offset:0
    buffer_load_dword v82, v50, s[88:91], s26 offen offset:0
    buffer_load_dword v83, v51, s[88:91], s26 offen offset:0
    buffer_load_dword v84, v52, s[88:91], s26 offen offset:0
    buffer_load_dword v85, v53, s[88:91], s26 offen offset:0
    buffer_load_dword v86, v54, s[88:91], s26 offen offset:0
    buffer_load_dword v87, v55, s[88:91], s26 offen offset:0
    s_add_u32 s26, s26, 20480
    s_waitcnt vmcnt(48)
    v_perm_b32 v56, v89, v88, s92
    v_perm_b32 v57, v91, v90, s92
    v_perm_b32 v58, v93, v92, s92
    v_perm_b32 v59, v95, v94, s92
    v_accvgpr_write_b32 a80, v56
    v_accvgpr_write_b32 a81, v57
    v_accvgpr_write_b32 a82, v58
    v_accvgpr_write_b32 a83, v59
    v_perm_b32 v60, v89, v88, s93
    v_perm_b32 v61, v91, v90, s93
    v_perm_b32 v62, v93, v92, s93
    v_perm_b32 v63, v95, v94, s93
    v_accvgpr_write_b32 a84, v60
    v_accvgpr_write_b32 a85, v61
    v_accvgpr_write_b32 a86, v62
    v_accvgpr_write_b32 a87, v63
    buffer_load_dword v88, v48, s[88:91], s26 offen offset:0
    buffer_load_dword v89, v49, s[88:91], s26 offen offset:0
    buffer_load_dword v90, v50, s[88:91], s26 offen offset:0
    buffer_load_dword v91, v51, s[88:91], s26 offen offset:0
    buffer_load_dword v92, v52, s[88:91], s26 offen offset:0
    buffer_load_dword v93, v53, s[88:91], s26 offen offset:0
    buffer_load_dword v94, v54, s[88:91], s26 offen offset:0
    buffer_load_dword v95, v55, s[88:91], s26 offen offset:0
    s_add_u32 s26, s26, 20480
    s_waitcnt vmcnt(48)
    v_perm_b32 v56, v97, v96, s92
    v_perm_b32 v57, v99, v98, s92
    v_perm_b32 v58, v101, v100, s92
    v_perm_b32 v59, v103, v102, s92
    v_accvgpr_write_b32 a88, v56
    v_accvgpr_write_b32 a89, v57
    v_accvgpr_write_b32 a90, v58
    v_accvgpr_write_b32 a91, v59
    v_perm_b32 v60, v97, v96, s93
    v_perm_b32 v61, v99, v98, s93
    v_perm_b32 v62, v101, v100, s93
    v_perm_b32 v63, v103, v102, s93
    v_accvgpr_write_b32 a92, v60
    v_accvgpr_write_b32 a93, v61
    v_accvgpr_write_b32 a94, v62
    v_accvgpr_write_b32 a95, v63
    buffer_load_dword v96, v48, s[88:91], s26 offen offset:0
    buffer_load_dword v97, v49, s[88:91], s26 offen offset:0
    buffer_load_dword v98, v50, s[88:91], s26 offen offset:0
    buffer_load_dword v99, v51, s[88:91], s26 offen offset:0
    buffer_load_dword v100, v52, s[88:91], s26 offen offset:0
    buffer_load_dword v101, v53, s[88:91], s26 offen offset:0
    buffer_load_dword v102, v54, s[88:91], s26 offen offset:0
    buffer_load_dword v103, v55, s[88:91], s26 offen offset:0
    s_add_u32 s26, s26, 20480
    s_waitcnt vmcnt(48)
    v_perm_b32 v56, v105, v104, s92
    v_perm_b32 v57, v107, v106, s92
    v_perm_b32 v58, v109, v108, s92
    v_perm_b32 v59, v111, v110, s92
    v_accvgpr_write_b32 a96, v56
    v_accvgpr_write_b32 a97, v57
    v_accvgpr_write_b32 a98, v58
    v_accvgpr_write_b32 a99, v59
    v_perm_b32 v60, v105, v104, s93
    v_perm_b32 v61, v107, v106, s93
    v_perm_b32 v62, v109, v108, s93
    v_perm_b32 v63, v111, v110, s93
    v_accvgpr_write_b32 a100, v60
    v_accvgpr_write_b32 a101, v61
    v_accvgpr_write_b32 a102, v62
    v_accvgpr_write_b32 a103, v63
    buffer_load_dword v104, v48, s[88:91], s26 offen offset:0
    buffer_load_dword v105, v49, s[88:91], s26 offen offset:0
    buffer_load_dword v106, v50, s[88:91], s26 offen offset:0
    buffer_load_dword v107, v51, s[88:91], s26 offen offset:0
    buffer_load_dword v108, v52, s[88:91], s26 offen offset:0
    buffer_load_dword v109, v53, s[88:91], s26 offen offset:0
    buffer_load_dword v110, v54, s[88:91], s26 offen offset:0
    buffer_load_dword v111, v55, s[88:91], s26 offen offset:0
    s_add_u32 s26, s26, 20480
    s_waitcnt vmcnt(48)
    v_perm_b32 v56, v113, v112, s92
    v_perm_b32 v57, v115, v114, s92
    v_perm_b32 v58, v117, v116, s92
    v_perm_b32 v59, v119, v118, s92
    v_accvgpr_write_b32 a104, v56
    v_accvgpr_write_b32 a105, v57
    v_accvgpr_write_b32 a106, v58
    v_accvgpr_write_b32 a107, v59
    v_perm_b32 v60, v113, v112, s93
    v_perm_b32 v61, v115, v114, s93
    v_perm_b32 v62, v117, v116, s93
    v_perm_b32 v63, v119, v118, s93
    v_accvgpr_write_b32 a108, v60
    v_accvgpr_write_b32 a109, v61
    v_accvgpr_write_b32 a110, v62
    v_accvgpr_write_b32 a111, v63
    buffer_load_dword v112, v48, s[88:91], s26 offen offset:0
    buffer_load_dword v113, v49, s[88:91], s26 offen offset:0
    buffer_load_dword v114, v50, s[88:91], s26 offen offset:0
    buffer_load_dword v115, v51, s[88:91], s26 offen offset:0
    buffer_load_dword v116, v52, s[88:91], s26 offen offset:0
    buffer_load_dword v117, v53, s[88:91], s26 offen offset:0
    buffer_load_dword v118, v54, s[88:91], s26 offen offset:0
    buffer_load_dword v119, v55, s[88:91], s26 offen offset:0
    s_add_u32 s26, s26, 20480
    s_waitcnt vmcnt(48)
    v_perm_b32 v56, v65, v64, s92
    v_perm_b32 v57, v67, v66, s92
    v_perm_b32 v58, v69, v68, s92
    v_perm_b32 v59, v71, v70, s92
    v_accvgpr_write_b32 a112, v56
    v_accvgpr_write_b32 a113, v57
    v_accvgpr_write_b32 a114, v58
    v_accvgpr_write_b32 a115, v59
    v_perm_b32 v60, v65, v64, s93
    v_perm_b32 v61, v67, v66, s93
    v_perm_b32 v62, v69, v68, s93
    v_perm_b32 v63, v71, v70, s93
    v_accvgpr_write_b32 a116, v60
    v_accvgpr_write_b32 a117, v61
    v_accvgpr_write_b32 a118, v62
    v_accvgpr_write_b32 a119, v63
    buffer_load_dword v64, v48, s[88:91], s26 offen offset:0
    buffer_load_dword v65, v49, s[88:91], s26 offen offset:0
    buffer_load_dword v66, v50, s[88:91], s26 offen offset:0
    buffer_load_dword v67, v51, s[88:91], s26 offen offset:0
    buffer_load_dword v68, v52, s[88:91], s26 offen offset:0
    buffer_load_dword v69, v53, s[88:91], s26 offen offset:0
    buffer_load_dword v70, v54, s[88:91], s26 offen offset:0
    buffer_load_dword v71, v55, s[88:91], s26 offen offset:0
    s_add_u32 s26, s26, 20480
    s_waitcnt vmcnt(48)
    v_perm_b32 v56, v73, v72, s92
    v_perm_b32 v57, v75, v74, s92
    v_perm_b32 v58, v77, v76, s92
    v_perm_b32 v59, v79, v78, s92
    v_accvgpr_write_b32 a120, v56
    v_accvgpr_write_b32 a121, v57
    v_accvgpr_write_b32 a122, v58
    v_accvgpr_write_b32 a123, v59
    v_perm_b32 v60, v73, v72, s93
    v_perm_b32 v61, v75, v74, s93
    v_perm_b32 v62, v77, v76, s93
    v_perm_b32 v63, v79, v78, s93
    v_accvgpr_write_b32 a124, v60
    v_accvgpr_write_b32 a125, v61
    v_accvgpr_write_b32 a126, v62
    v_accvgpr_write_b32 a127, v63
    buffer_load_dword v72, v48, s[88:91], s26 offen offset:0
    buffer_load_dword v73, v49, s[88:91], s26 offen offset:0
    buffer_load_dword v74, v50, s[88:91], s26 offen offset:0
    buffer_load_dword v75, v51, s[88:91], s26 offen offset:0
    buffer_load_dword v76, v52, s[88:91], s26 offen offset:0
    buffer_load_dword v77, v53, s[88:91], s26 offen offset:0
    buffer_load_dword v78, v54, s[88:91], s26 offen offset:0
    buffer_load_dword v79, v55, s[88:91], s26 offen offset:0
    s_add_u32 s26, s26, 20480
    s_waitcnt vmcnt(48)
    v_perm_b32 v56, v81, v80, s92
    v_perm_b32 v57, v83, v82, s92
    v_perm_b32 v58, v85, v84, s92
    v_perm_b32 v59, v87, v86, s92
    v_accvgpr_write_b32 a128, v56
    v_accvgpr_write_b32 a129, v57
    v_accvgpr_write_b32 a130, v58
    v_accvgpr_write_b32 a131, v59
    v_perm_b32 v60, v81, v80, s93
    v_perm_b32 v61, v83, v82, s93
    v_perm_b32 v62, v85, v84, s93
    v_perm_b32 v63, v87, v86, s93
    v_accvgpr_write_b32 a132, v60
    v_accvgpr_write_b32 a133, v61
    v_accvgpr_write_b32 a134, v62
    v_accvgpr_write_b32 a135, v63
    buffer_load_dword v80, v48, s[88:91], s26 offen offset:0
    buffer_load_dword v81, v49, s[88:91], s26 offen offset:0
    buffer_load_dword v82, v50, s[88:91], s26 offen offset:0
    buffer_load_dword v83, v51, s[88:91], s26 offen offset:0
    buffer_load_dword v84, v52, s[88:91], s26 offen offset:0
    buffer_load_dword v85, v53, s[88:91], s26 offen offset:0
    buffer_load_dword v86, v54, s[88:91], s26 offen offset:0
    buffer_load_dword v87, v55, s[88:91], s26 offen offset:0
    s_add_u32 s26, s26, 20480
    s_waitcnt vmcnt(48)
    v_perm_b32 v56, v89, v88, s92
    v_perm_b32 v57, v91, v90, s92
    v_perm_b32 v58, v93, v92, s92
    v_perm_b32 v59, v95, v94, s92
    v_accvgpr_write_b32 a136, v56
    v_accvgpr_write_b32 a137, v57
    v_accvgpr_write_b32 a138, v58
    v_accvgpr_write_b32 a139, v59
    v_perm_b32 v60, v89, v88, s93
    v_perm_b32 v61, v91, v90, s93
    v_perm_b32 v62, v93, v92, s93
    v_perm_b32 v63, v95, v94, s93
    v_accvgpr_write_b32 a140, v60
    v_accvgpr_write_b32 a141, v61
    v_accvgpr_write_b32 a142, v62
    v_accvgpr_write_b32 a143, v63
    buffer_load_dword v88, v48, s[88:91], s26 offen offset:0
    buffer_load_dword v89, v49, s[88:91], s26 offen offset:0
    buffer_load_dword v90, v50, s[88:91], s26 offen offset:0
    buffer_load_dword v91, v51, s[88:91], s26 offen offset:0
    buffer_load_dword v92, v52, s[88:91], s26 offen offset:0
    buffer_load_dword v93, v53, s[88:91], s26 offen offset:0
    buffer_load_dword v94, v54, s[88:91], s26 offen offset:0
    buffer_load_dword v95, v55, s[88:91], s26 offen offset:0
    s_add_u32 s26, s26, 20480
    s_waitcnt vmcnt(48)
    v_perm_b32 v56, v97, v96, s92
    v_perm_b32 v57, v99, v98, s92
    v_perm_b32 v58, v101, v100, s92
    v_perm_b32 v59, v103, v102, s92
    v_accvgpr_write_b32 a144, v56
    v_accvgpr_write_b32 a145, v57
    v_accvgpr_write_b32 a146, v58
    v_accvgpr_write_b32 a147, v59
    v_perm_b32 v60, v97, v96, s93
    v_perm_b32 v61, v99, v98, s93
    v_perm_b32 v62, v101, v100, s93
    v_perm_b32 v63, v103, v102, s93
    v_accvgpr_write_b32 a148, v60
    v_accvgpr_write_b32 a149, v61
    v_accvgpr_write_b32 a150, v62
    v_accvgpr_write_b32 a151, v63
    buffer_load_dword v96, v48, s[88:91], s26 offen offset:0
    buffer_load_dword v97, v49, s[88:91], s26 offen offset:0
    buffer_load_dword v98, v50, s[88:91], s26 offen offset:0
    buffer_load_dword v99, v51, s[88:91], s26 offen offset:0
    buffer_load_dword v100, v52, s[88:91], s26 offen offset:0
    buffer_load_dword v101, v53, s[88:91], s26 offen offset:0
    buffer_load_dword v102, v54, s[88:91], s26 offen offset:0
    buffer_load_dword v103, v55, s[88:91], s26 offen offset:0
    s_add_u32 s26, s26, 20480
    s_waitcnt vmcnt(48)
    v_perm_b32 v56, v105, v104, s92
    v_perm_b32 v57, v107, v106, s92
    v_perm_b32 v58, v109, v108, s92
    v_perm_b32 v59, v111, v110, s92
    v_accvgpr_write_b32 a152, v56
    v_accvgpr_write_b32 a153, v57
    v_accvgpr_write_b32 a154, v58
    v_accvgpr_write_b32 a155, v59
    v_perm_b32 v60, v105, v104, s93
    v_perm_b32 v61, v107, v106, s93
    v_perm_b32 v62, v109, v108, s93
    v_perm_b32 v63, v111, v110, s93
    v_accvgpr_write_b32 a156, v60
    v_accvgpr_write_b32 a157, v61
    v_accvgpr_write_b32 a158, v62
    v_accvgpr_write_b32 a159, v63
    buffer_load_dword v104, v48, s[88:91], s26 offen offset:0
    buffer_load_dword v105, v49, s[88:91], s26 offen offset:0
    buffer_load_dword v106, v50, s[88:91], s26 offen offset:0
    buffer_load_dword v107, v51, s[88:91], s26 offen offset:0
    buffer_load_dword v108, v52, s[88:91], s26 offen offset:0
    buffer_load_dword v109, v53, s[88:91], s26 offen offset:0
    buffer_load_dword v110, v54, s[88:91], s26 offen offset:0
    buffer_load_dword v111, v55, s[88:91], s26 offen offset:0
    s_add_u32 s26, s26, 20480
    s_waitcnt vmcnt(48)
    v_perm_b32 v56, v113, v112, s92
    v_perm_b32 v57, v115, v114, s92
    v_perm_b32 v58, v117, v116, s92
    v_perm_b32 v59, v119, v118, s92
    v_accvgpr_write_b32 a160, v56
    v_accvgpr_write_b32 a161, v57
    v_accvgpr_write_b32 a162, v58
    v_accvgpr_write_b32 a163, v59
    v_perm_b32 v60, v113, v112, s93
    v_perm_b32 v61, v115, v114, s93
    v_perm_b32 v62, v117, v116, s93
    v_perm_b32 v63, v119, v118, s93
    v_accvgpr_write_b32 a164, v60
    v_accvgpr_write_b32 a165, v61
    v_accvgpr_write_b32 a166, v62
    v_accvgpr_write_b32 a167, v63
    s_waitcnt vmcnt(40)
    v_perm_b32 v56, v65, v64, s92
    v_perm_b32 v57, v67, v66, s92
    v_perm_b32 v58, v69, v68, s92
    v_perm_b32 v59, v71, v70, s92
    v_accvgpr_write_b32 a168, v56
    v_accvgpr_write_b32 a169, v57
    v_accvgpr_write_b32 a170, v58
    v_accvgpr_write_b32 a171, v59
    v_perm_b32 v60, v65, v64, s93
    v_perm_b32 v61, v67, v66, s93
    v_perm_b32 v62, v69, v68, s93
    v_perm_b32 v63, v71, v70, s93
    v_accvgpr_write_b32 a172, v60
    v_accvgpr_write_b32 a173, v61
    v_accvgpr_write_b32 a174, v62
    v_accvgpr_write_b32 a175, v63
    s_waitcnt vmcnt(32)
    v_perm_b32 v56, v73, v72, s92
    v_perm_b32 v57, v75, v74, s92
    v_perm_b32 v58, v77, v76, s92
    v_perm_b32 v59, v79, v78, s92
    v_accvgpr_write_b32 a176, v56
    v_accvgpr_write_b32 a177, v57
    v_accvgpr_write_b32 a178, v58
    v_accvgpr_write_b32 a179, v59
    v_perm_b32 v60, v73, v72, s93
    v_perm_b32 v61, v75, v74, s93
    v_perm_b32 v62, v77, v76, s93
    v_perm_b32 v63, v79, v78, s93
    v_accvgpr_write_b32 a180, v60
    v_accvgpr_write_b32 a181, v61
    v_accvgpr_write_b32 a182, v62
    v_accvgpr_write_b32 a183, v63
    s_waitcnt vmcnt(24)
    v_perm_b32 v56, v81, v80, s92
    v_perm_b32 v57, v83, v82, s92
    v_perm_b32 v58, v85, v84, s92
    v_perm_b32 v59, v87, v86, s92
    v_accvgpr_write_b32 a184, v56
    v_accvgpr_write_b32 a185, v57
    v_accvgpr_write_b32 a186, v58
    v_accvgpr_write_b32 a187, v59
    v_perm_b32 v60, v81, v80, s93
    v_perm_b32 v61, v83, v82, s93
    v_perm_b32 v62, v85, v84, s93
    v_perm_b32 v63, v87, v86, s93
    v_accvgpr_write_b32 a188, v60
    v_accvgpr_write_b32 a189, v61
    v_accvgpr_write_b32 a190, v62
    v_accvgpr_write_b32 a191, v63
    s_waitcnt vmcnt(16)
    v_perm_b32 v56, v89, v88, s92
    v_perm_b32 v57, v91, v90, s92
    v_perm_b32 v58, v93, v92, s92
    v_perm_b32 v59, v95, v94, s92
    v_accvgpr_write_b32 a192, v56
    v_accvgpr_write_b32 a193, v57
    v_accvgpr_write_b32 a194, v58
    v_accvgpr_write_b32 a195, v59
    v_perm_b32 v60, v89, v88, s93
    v_perm_b32 v61, v91, v90, s93
    v_perm_b32 v62, v93, v92, s93
    v_perm_b32 v63, v95, v94, s93
    v_accvgpr_write_b32 a196, v60
    v_accvgpr_write_b32 a197, v61
    v_accvgpr_write_b32 a198, v62
    v_accvgpr_write_b32 a199, v63
    s_waitcnt vmcnt(8)
    v_perm_b32 v56, v97, v96, s92
    v_perm_b32 v57, v99, v98, s92
    v_perm_b32 v58, v101, v100, s92
    v_perm_b32 v59, v103, v102, s92
    v_accvgpr_write_b32 a200, v56
    v_accvgpr_write_b32 a201, v57
    v_accvgpr_write_b32 a202, v58
    v_accvgpr_write_b32 a203, v59
    v_perm_b32 v60, v97, v96, s93
    v_perm_b32 v61, v99, v98, s93
    v_perm_b32 v62, v101, v100, s93
    v_perm_b32 v63, v103, v102, s93
    v_accvgpr_write_b32 a204, v60
    v_accvgpr_write_b32 a205, v61
    v_accvgpr_write_b32 a206, v62
    v_accvgpr_write_b32 a207, v63
    s_waitcnt vmcnt(0)
    v_perm_b32 v56, v105, v104, s92
    v_perm_b32 v57, v107, v106, s92
    v_perm_b32 v58, v109, v108, s92
    v_perm_b32 v59, v111, v110, s92
    v_accvgpr_write_b32 a208, v56
    v_accvgpr_write_b32 a209, v57
    v_accvgpr_write_b32 a210, v58
    v_accvgpr_write_b32 a211, v59
    v_perm_b32 v60, v105, v104, s93
    v_perm_b32 v61, v107, v106, s93
    v_perm_b32 v62, v109, v108, s93
    v_perm_b32 v63, v111, v110, s93
    v_accvgpr_write_b32 a212, v60
    v_accvgpr_write_b32 a213, v61
    v_accvgpr_write_b32 a214, v62
    v_accvgpr_write_b32 a215, v63
    s_waitcnt lgkmcnt(0)
    s_mov_b32 s24, 0
WI_227:
    buffer_load_dword v7, off, s[96:99], 0 offset:128 sc1
    s_waitcnt vmcnt(0)
    v_cmp_le_u32 vcc, 256, v7
    s_cbranch_vccnz WO_228
    s_sleep 4
    s_add_u32 s24, s24, 1
    s_cmp_lt_u32 s24, 200000
    s_cbranch_scc1 WI_227
    s_branch F_F2
WO_228:
    s_mov_b32 s28, 0
    s_xor_b32 s21, s9, 1
    s_lshl_b32 s21, s21, 13
    v_add_u32 v5, s21, v1
    s_xor_b32 s21, s9, 2
    s_lshl_b32 s21, s21, 13
    v_add_u32 v9, s21, v1
    s_xor_b32 s21, s9, 3
    s_lshl_b32 s21, s21, 13
    v_add_u32 v10, s21, v1
    s_lshl_b32 s31, s100, 2
    s_add_u32 s31, s31, s9
    s_lshl_b32 s31, s31, 7
    s_add_u32 s31, s31, 156246016
    s_mov_b32 s30, s31
    s_cmp_eq_u32 s32, 3
    s_cselect_b32 s17, s31, s17
    s_cselect_b32 s33, 0, 512
T2_ITEM_229:
    s_cmp_lg_u32 s28, 0
    s_cbranch_scc1 T2_HAVE_230
    s_mov_b32 s24, 0
    s_mov_b64 exec, s[14:15]
    buffer_load_dword v7, v11, s[4:7], s13 offen sc1
    s_waitcnt vmcnt(0)
    v_cmp_eq_u32 vcc, 0, v7
    s_mov_b64 exec, 1
    buffer_store_dword v6, off, s[4:7], s30 sc1
    s_mov_b64 exec, -1
    s_mov_b32 s30, s31
    s_cbranch_vccz PO_232
    s_mov_b64 exec, s[14:15]
PL_231:
    buffer_load_dword v7, v11, s[4:7], s13 offen sc1
    s_waitcnt vmcnt(0)
    v_cmp_eq_u32 vcc, 0, v7
    s_cbranch_vccz PO_232
    s_sleep 2
    s_add_u32 s24, s24, 1
    s_cmp_lt_u32 s24, 200000
    s_cbranch_scc1 PL_231
    s_branch F_F2
PO_232:
    s_mov_b64 exec, -1
    s_add_u32 s26, s12, 0
    buffer_load_dwordx4 v[128:131], v1, s[4:7], s26 offen sc1
    s_add_u32 s26, s12, 1024
    buffer_load_dwordx4 v[132:135], v1, s[4:7], s26 offen sc1
    s_add_u32 s26, s12, 2048
    buffer_load_dwordx4 v[136:139], v1, s[4:7], s26 offen sc1
    s_add_u32 s26, s12, 3072
    buffer_load_dwordx4 v[140:143], v1, s[4:7], s26 offen sc1
    s_add_u32 s26, s12, 4096
    buffer_load_dwordx4 v[144:147], v1, s[4:7], s26 offen sc1
    s_add_u32 s26, s12, 5120
    buffer_load_dwordx4 v[148:151], v1, s[4:7], s26 offen sc1
    s_add_u32 s26, s12, 6144
    buffer_load_dwordx4 v[152:155], v1, s[4:7], s26 offen sc1
    s_add_u32 s26, s12, 7168
    buffer_load_dwordx4 v[156:159], v1, s[4:7], s26 offen sc1
    s_add_u32 s26, s12, 8192
    buffer_load_dwordx4 v[160:163], v1, s[4:7], s26 offen sc1
    s_add_u32 s26, s12, 9216
    buffer_load_dwordx4 v[164:167], v1, s[4:7], s26 offen sc1
    s_add_u32 s26, s12, 10240
    buffer_load_dwordx4 v[168:171], v1, s[4:7], s26 offen sc1
    s_add_u32 s26, s12, 11264
    buffer_load_dwordx4 v[172:175], v1, s[4:7], s26 offen sc1
    s_add_u32 s26, s12, 12288
    buffer_load_dwordx4 v[176:179], v1, s[4:7], s26 offen sc1
    s_add_u32 s26, s12, 13312
    buffer_load_dwordx4 v[180:183], v1, s[4:7], s26 offen sc1
    s_add_u32 s26, s12, 14336
    buffer_load_dwordx4 v[184:187], v1, s[4:7], s26 offen sc1
    s_add_u32 s26, s12, 15360
    buffer_load_dwordx4 v[188:191], v1, s[4:7], s26 offen sc1
    buffer_load_dword v7, off, s[4:7], s13 sc1
T2_HAVE_230:
    s_add_u32 s13, s13, 512
    s_waitcnt vmcnt(16)
    v_mfma_f32_32x32x16_bf16 v[96:111], a[0:3], v[128:131], 0
    v_mfma_f32_32x32x16_bf16 v[112:127], a[4:7], v[128:131], 0
    s_add_u32 s26, s12, 16384
    buffer_load_dwordx4 v[192:195], v1, s[4:7], s26 offen offset:0 sc1
    s_waitcnt vmcnt(16)
    v_mfma_f32_32x32x16_bf16 v[96:111], a[8:11], v[132:135], v[96:111]
    s_mov_b64 exec, s[14:15]
    buffer_load_dword v7, v11, s[4:7], s13 offen sc1
    s_mov_b64 exec, -1
    buffer_load_dwordx4 v[12:15], v1, s[4:7], s18 offen sc1
    v_mfma_f32_32x32x16_bf16 v[112:127], a[12:15], v[132:135], v[112:127]
    buffer_load_dwordx4 v[196:199], v1, s[4:7], s26 offen offset:1024 sc1
    s_waitcnt vmcnt(18)
    v_mfma_f32_32x32x16_bf16 v[96:111], a[16:19], v[136:139], v[96:111]
    v_mfma_f32_32x32x16_bf16 v[112:127], a[20:23], v[136:139], v[112:127]
    buffer_load_dwordx4 v[200:203], v1, s[4:7], s26 offen offset:2048 sc1
    s_waitcnt vmcnt(18)
    v_mfma_f32_32x32x16_bf16 v[96:111], a[24:27], v[140:143], v[96:111]
    v_mfma_f32_32x32x16_bf16 v[112:127], a[28:31], v[140:143], v[112:127]
    buffer_load_dwordx4 v[204:207], v1, s[4:7], s26 offen offset:3072 sc1
    s_waitcnt vmcnt(18)
    v_mfma_f32_32x32x16_bf16 v[96:111], a[32:35], v[144:147], v[96:111]
    v_mfma_f32_32x32x16_bf16 v[112:127], a[36:39], v[144:147], v[112:127]
    s_add_u32 s26, s12, 20480
    buffer_load_dwordx4 v[208:211], v1, s[4:7], s26 offen offset:0 sc1
    s_waitcnt vmcnt(18)
    v_mfma_f32_32x32x16_bf16 v[96:111], a[40:43], v[148:151], v[96:111]
    v_mfma_f32_32x32x16_bf16 v[112:127], a[44:47], v[148:151], v[112:127]
    buffer_load_dwordx4 v[212:215], v1, s[4:7], s26 offen offset:1024 sc1
    s_waitcnt vmcnt(18)
    v_mfma_f32_32x32x16_bf16 v[96:111], a[48:51], v[152:155], v[96:111]
    v_mfma_f32_32x32x16_bf16 v[112:127], a[52:55], v[152:155], v[112:127]
    buffer_load_dwordx4 v[216:219], v1, s[4:7], s26 offen offset:2048 sc1
    s_waitcnt vmcnt(18)
    v_mfma_f32_32x32x16_bf16 v[96:111], a[56:59], v[156:159], v[96:111]
    v_mfma_f32_32x32x16_bf16 v[112:127], a[60:63], v[156:159], v[112:127]
    buffer_load_dwordx4 v[220:223], v1, s[4:7], s26 offen offset:3072 sc1
    s_waitcnt vmcnt(18)
    v_mfma_f32_32x32x16_bf16 v[96:111], a[64:67], v[160:163], v[96:111]
    v_mfma_f32_32x32x16_bf16 v[112:127], a[68:71], v[160:163], v[112:127]
    s_add_u32 s26, s12, 24576
    buffer_load_dwordx4 v[224:227], v1, s[4:7], s26 offen offset:0 sc1
    s_waitcnt vmcnt(18)
    v_mfma_f32_32x32x16_bf16 v[96:111], a[72:75], v[164:167], v[96:111]
    v_mfma_f32_32x32x16_bf16 v[112:127], a[76:79], v[164:167], v[112:127]
    buffer_load_dwordx4 v[228:231], v1, s[4:7], s26 offen offset:1024 sc1
    s_waitcnt vmcnt(18)
    v_mfma_f32_32x32x16_bf16 v[96:111], a[80:83], v[168:171], v[96:111]
    s_waitcnt vmcnt(12)
    s_mov_b64 exec, 1
    buffer_store_dword v6, off, s[4:7], s30 sc1
    s_mov_b64 exec, -1
    s_mov_b32 s30, s31
    v_mfma_f32_32x32x16_bf16 v[112:127], a[84:87], v[168:171], v[112:127]
    buffer_load_dwordx4 v[232:235], v1, s[4:7], s26 offen offset:2048 sc1
    v_mfma_f32_32x32x16_bf16 v[96:111], a[88:91], v[172:175], v[96:111]
    s_waitcnt vmcnt(12)
    v_cmp_eq_u32 vcc, 0, v7
    s_and_b64 vcc, vcc, s[14:15]
    s_cselect_b32 s28, 0, 1
    s_cmp_ge_u32 s10, 63
    s_cselect_b32 s28, 0, s28
    s_mul_i32 s29, s28, 114688
    s_add_u32 s29, s29, s12
    s_cmp_lg_u32 s28, 0
    s_cselect_b64 s[36:37], -1, 1
    v_mfma_f32_32x32x16_bf16 v[112:127], a[92:95], v[172:175], v[112:127]
    s_add_u32 s26, s29, 0
    s_mov_b64 exec, s[36:37]
    buffer_load_dwordx4 v[128:131], v1, s[4:7], s26 offen sc1
    s_mov_b64 exec, -1
    v_mfma_f32_32x32x16_bf16 v[96:111], a[96:99], v[176:179], v[96:111]
    v_mfma_f32_32x32x16_bf16 v[112:127], a[100:103], v[176:179], v[112:127]
    s_add_u32 s26, s29, 1024
    s_mov_b64 exec, s[36:37]
    buffer_load_dwordx4 v[132:135], v1, s[4:7], s26 offen sc1
    s_mov_b64 exec, -1
    v_mfma_f32_32x32x16_bf16 v[96:111], a[104:107], v[180:183], v[96:111]
    v_mfma_f32_32x32x16_bf16 v[112:127], a[108:111], v[180:183], v[112:127]
    s_add_u32 s26, s29, 2048
    s_mov_b64 exec, s[36:37]
    buffer_load_dwordx4 v[136:139], v1, s[4:7], s26 offen sc1
    s_mov_b64 exec, -1
    v_mfma_f32_32x32x16_bf16 v[96:111], a[112:115], v[184:187], v[96:111]
    v_mfma_f32_32x32x16_bf16 v[112:127], a[116:119], v[184:187], v[112:127]
    s_add_u32 s26, s29, 3072
    s_mov_b64 exec, s[36:37]
    buffer_load_dwordx4 v[140:143], v1, s[4:7], s26 offen sc1
    s_mov_b64 exec, -1
    v_mfma_f32_32x32x16_bf16 v[96:111], a[120:123], v[188:191], v[96:111]
    v_mfma_f32_32x32x16_bf16 v[112:127], a[124:127], v[188:191], v[112:127]
    s_add_u32 s26, s29, 4096
    s_mov_b64 exec, s[36:37]
    buffer_load_dwordx4 v[144:147], v1, s[4:7], s26 offen sc1
    s_mov_b64 exec, -1
    v_mfma_f32_32x32x16_bf16 v[96:111], a[128:131], v[192:195], v[96:111]
    v_mfma_f32_32x32x16_bf16 v[112:127], a[132:135], v[192:195], v[112:127]
    s_add_u32 s26, s29, 5120
    s_mov_b64 exec, s[36:37]
    buffer_load_dwordx4 v[148:151], v1, s[4:7], s26 offen sc1
    s_mov_b64 exec, -1
    s_waitcnt vmcnt(16)
    v_mfma_f32_32x32x16_bf16 v[96:111], a[136:139], v[196:199], v[96:111]
    v_mfma_f32_32x32x16_bf16 v[112:127], a[140:143], v[196:199], v[112:127]
    s_add_u32 s26, s29, 6144
    s_mov_b64 exec, s[36:37]
    buffer_load_dwordx4 v[152:155], v1, s[4:7], s26 offen sc1
    s_mov_b64 exec, -1
    s_waitcnt vmcnt(16)
    v_mfma_f32_32x32x16_bf16 v[96:111], a[144:147], v[200:203], v[96:111]
    v_mfma_f32_32x32x16_bf16 v[112:127], a[148:151], v[200:203], v[112:127]
    s_add_u32 s26, s29, 7168
    s_mov_b64 exec, s[36:37]
    buffer_load_dwordx4 v[156:159], v1, s[4:7], s26 offen sc1
    s_mov_b64 exec, -1
    s_waitcnt vmcnt(16)
    v_mfma_f32_32x32x16_bf16 v[96:111], a[152:155], v[204:207], v[96:111]
    v_mfma_f32_32x32x16_bf16 v[112:127], a[156:159], v[204:207], v[112:127]
    s_add_u32 s26, s29, 8192
    s_mov_b64 exec, s[36:37]
    buffer_load_dwordx4 v[160:163], v1, s[4:7], s26 offen sc1
    s_mov_b64 exec, -1
    s_waitcnt vmcnt(16)
    v_mfma_f32_32x32x16_bf16 v[96:111], a[160:163], v[208:211], v[96:111]
    v_mfma_f32_32x32x16_bf16 v[112:127], a[164:167], v[208:211], v[112:127]
    s_add_u32 s26, s29, 9216
    s_mov_b64 exec, s[36:37]
    buffer_load_dwordx4 v[164:167], v1, s[4:7], s26 offen sc1
    s_mov_b64 exec, -1
    s_waitcnt vmcnt(16)
    v_mfma_f32_32x32x16_bf16 v[96:111], a[168:171], v[212:215], v[96:111]
    v_mfma_f32_32x32x16_bf16 v[112:127], a[172:175], v[212:215], v[112:127]
    s_add_u32 s26, s29, 10240
    s_mov_b64 exec, s[36:37]
    buffer_load_dwordx4 v[168:171], v1, s[4:7], s26 offen sc1
    s_mov_b64 exec, -1
    s_waitcnt vmcnt(16)
    v_mfma_f32_32x32x16_bf16 v[96:111], a[176:179], v[216:219], v[96:111]
    v_mfma_f32_32x32x16_bf16 v[112:127], a[180:183], v[216:219], v[112:127]
    s_add_u32 s26, s29, 11264
    s_mov_b64 exec, s[36:37]
    buffer_load_dwordx4 v[172:175], v1, s[4:7], s26 offen sc1
    s_mov_b64 exec, -1
    s_waitcnt vmcnt(16)
    v_mfma_f32_32x32x16_bf16 v[96:111], a[184:187], v[220:223], v[96:111]
    v_mfma_f32_32x32x16_bf16 v[112:127], a[188:191], v[220:223], v[112:127]
    s_add_u32 s26, s29, 12288
    s_mov_b64 exec, s[36:37]
    buffer_load_dwordx4 v[176:179], v1, s[4:7], s26 offen sc1
    s_mov_b64 exec, -1
    s_waitcnt vmcnt(16)
    v_mfma_f32_32x32x16_bf16 v[96:111], a[192:195], v[224:227], v[96:111]
    s_waitcnt vmcnt(15)
    v_mfma_f32_32x32x16_bf16 v[96:111], a[200:203], v[228:231], v[96:111]
    s_waitcnt vmcnt(13)
    v_mfma_f32_32x32x16_bf16 v[96:111], a[208:211], v[232:235], v[96:111]
    v_mfma_f32_32x32x16_bf16 v[112:127], a[196:199], v[224:227], v[112:127]
    s_add_u32 s26, s29, 13312
    s_mov_b64 exec, s[36:37]
    buffer_load_dwordx4 v[180:183], v1, s[4:7], s26 offen sc1
    s_mov_b64 exec, -1
    v_mfma_f32_32x32x16_bf16 v[112:127], a[204:207], v[228:231], v[112:127]
    s_add_u32 s26, s29, 14336
    s_mov_b64 exec, s[36:37]
    buffer_load_dwordx4 v[184:187], v1, s[4:7], s26 offen sc1
    s_mov_b64 exec, -1
    v_mfma_f32_32x32x16_bf16 v[112:127], a[212:215], v[232:235], v[112:127]
    s_add_u32 s26, s29, 15360
    s_mov_b64 exec, s[36:37]
    buffer_load_dwordx4 v[188:191], v1, s[4:7], s26 offen sc1
    s_mov_b64 exec, -1
    ds_write_b128 v4, v[100:103] offset:2048
    ds_write_b128 v4, v[104:107] offset:4096
    ds_write_b128 v4, v[108:111] offset:6144
    v_lshlrev_b32 v16, 16, v12
    v_and_b32 v17, 0xffff0000, v12
    v_lshlrev_b32 v18, 16, v13
    v_and_b32 v19, 0xffff0000, v13
    s_nop 0
    ds_write_b128 v4, v[116:119] offset:3072
    ds_write_b128 v4, v[120:123] offset:5120
    ds_write_b128 v4, v[124:127] offset:7168
    v_lshlrev_b32 v20, 16, v14
    v_and_b32 v21, 0xffff0000, v14
    v_lshlrev_b32 v22, 16, v15
    v_and_b32 v23, 0xffff0000, v15
    s_waitcnt lgkmcnt(0)
    s_barrier
    ds_read_b128 v[100:103], v5 offset:2048
    ds_read_b128 v[116:119], v5 offset:3072
    ds_read_b128 v[104:107], v9 offset:4096
    ds_read_b128 v[120:123], v9 offset:5120
    ds_read_b128 v[108:111], v10 offset:6144
    ds_read_b128 v[124:127], v10 offset:7168
    s_waitcnt lgkmcnt(5)
    v_pk_add_f32 v[96:97], v[96:97], v[100:101]
    v_pk_add_f32 v[98:99], v[98:99], v[102:103]
    s_waitcnt lgkmcnt(4)
    v_pk_add_f32 v[112:113], v[112:113], v[116:117]
    v_pk_add_f32 v[114:115], v[114:115], v[118:119]
    s_waitcnt lgkmcnt(3)
    v_pk_add_f32 v[96:97], v[96:97], v[104:105]
    v_pk_add_f32 v[98:99], v[98:99], v[106:107]
    s_waitcnt lgkmcnt(2)
    v_pk_add_f32 v[112:113], v[112:113], v[120:121]
    v_pk_add_f32 v[114:115], v[114:115], v[122:123]
    s_waitcnt lgkmcnt(1)
    v_pk_add_f32 v[96:97], v[96:97], v[108:109]
    v_pk_add_f32 v[98:99], v[98:99], v[110:111]
    s_waitcnt lgkmcnt(0)
    v_pk_add_f32 v[112:113], v[112:113], v[124:125]
    v_pk_add_f32 v[114:115], v[114:115], v[126:127]
    v_cvt_pk_bf16_f32 v12, v96, v112
    v_cvt_pk_bf16_f32 v13, v97, v113
    v_cvt_pk_bf16_f32 v14, v98, v114
    v_cvt_pk_bf16_f32 v15, v99, v115
    v_lshlrev_b32 v24, 16, v12
    v_and_b32 v25, 0xffff0000, v12
    v_lshlrev_b32 v26, 16, v13
    v_and_b32 v27, 0xffff0000, v13
    v_lshlrev_b32 v28, 16, v14
    v_and_b32 v29, 0xffff0000, v14
    v_lshlrev_b32 v30, 16, v15
    v_and_b32 v31, 0xffff0000, v15
    v_pk_add_f32 v[24:25], v[24:25], v[16:17]
    v_pk_add_f32 v[26:27], v[26:27], v[18:19]
    v_pk_add_f32 v[28:29], v[28:29], v[20:21]
    v_pk_add_f32 v[30:31], v[30:31], v[22:23]
    v_cvt_pk_bf16_f32 v12, v24, v25
    v_cvt_pk_bf16_f32 v13, v26, v27
    v_cvt_pk_bf16_f32 v14, v28, v29
    v_cvt_pk_bf16_f32 v15, v30, v31
    buffer_store_dwordx4 v[12:15], v2, s[40:43], s16 offen sc1
    s_barrier
    s_mov_b32 s30, s17
    s_add_u32 s12, s12, 114688
    s_add_u32 s17, s17, s33
    s_add_u32 s18, s18, 40960
    s_add_u32 s16, s16, 40960
    s_add_u32 s10, s10, 1
    s_cmp_lt_u32 s10, 64
    s_cbranch_scc1 T2_ITEM_229
    s_waitcnt vmcnt(0)
    s_mov_b64 exec, 1
    buffer_store_dword v6, off, s[4:7], s30 sc1
    s_mov_b64 exec, -1
    s_mov_b32 s30, s31
    s_endpgm
F_F2:
    s_endpgm
.section .rodata,"a"
.p2align 6
.amdhsa_kernel interleave_layers__memory_aug_recurrent_mem_tr__dense_activation_relu__prompt_kernel
  .amdhsa_next_free_vgpr 512
  .amdhsa_next_free_sgpr 102
  .amdhsa_accum_offset 256
  .amdhsa_group_segment_fixed_size 0
  .amdhsa_kernarg_size 104
  .amdhsa_user_sgpr_count 2
  .amdhsa_user_sgpr_kernarg_segment_ptr 1
  .amdhsa_system_sgpr_workgroup_id_x 1
.end_amdhsa_kernel
.text
```
